```python
import torch

def _softmax(x, axis=-1):
    return torch.softmax(x, dim=axis)
def _gelu(x):
    return torch.nn.functional.gelu(x, approximate="tanh")
def _silu(x):
    return torch.nn.functional.silu(x)
def _sigmoid(x):
    return torch.sigmoid(x)
def _layernorm(x, axis=-1, eps=1e-5):
    m = x.mean(dim=axis, keepdim=True)
    v = x.var(dim=axis, keepdim=True, unbiased=False)
    return (x - m) / torch.sqrt(v + eps)
def _scatter_add(tgt, idx, src, axis=0):
    return tgt.clone().index_add_(axis, idx, src)
def _segment_sum(src, seg, n):
    out = torch.zeros((n,) + src.shape[1:], dtype=src.dtype)
    return out.index_add_(0, seg, src)
def _pad(x, pw):
    flat = tuple(v for pair in reversed(pw) for v in pair)
    return torch.nn.functional.pad(x, flat)

kernel_name = 'concat_heads__compressed_kv_cla__spectral_gfnet__prompt'

def setup_inputs():

    _w = (lambda a: (lambda t: t.to(torch.bfloat16) if t.is_floating_point() else t)(torch.as_tensor(a)))
    def _A_setup():
        B, H, Sq, Sk, D, M = 1, 32, 2048, 2048, 128, 512
        Dc = 4 * D
        return {
            "x": _w((lambda *s: torch.randn(*s, dtype=torch.bfloat16) * 3.2)(B, Sq, M)),
            "c_kv": _w((lambda *s: torch.randn(*s, dtype=torch.bfloat16) * 0.05)(B, Sk, Dc)),
            "w_q": _w((lambda *s: torch.randn(*s, dtype=torch.bfloat16) * 3.2)(M, H, D) * (M ** -0.5)),
            "w_uk": _w((lambda *s: torch.randn(*s, dtype=torch.bfloat16) * 3.2)(Dc, H, D) * (Dc ** -0.5)),
            "w_uv": _w((lambda *s: torch.randn(*s, dtype=torch.bfloat16) * 0.05)(Dc, H, D) * (Dc ** -0.5)),
            "w_o": _w((lambda *s: torch.randn(*s, dtype=torch.bfloat16) * 0.05)(H, D, M) * ((H * D) ** -0.5)),
        }
    _A_in = _A_setup()

    def _B_setup():
        B, S, D = 1, 2048, 512
        Df = D // 2 + 1
        return {
            "x": _w((lambda *s: torch.randn(*s, dtype=torch.bfloat16) * 0.05)(B, S, D)),
            "w_r": _w((lambda *s: torch.randn(*s, dtype=torch.bfloat16) * 0.05)(S, Df) * 0.02),
            "w_i": _w((lambda *s: torch.randn(*s, dtype=torch.bfloat16) * 0.05)(S, Df) * 0.02),
        }
    _B_in = _B_setup()

    return {
        "A_x": _A_in["x"],
        "A_c_kv": _A_in["c_kv"],
        "A_w_q": _A_in["w_q"],
        "A_w_uk": _A_in["w_uk"],
        "A_w_uv": _A_in["w_uv"],
        "A_w_o": _A_in["w_o"],
        "B_x": _B_in["x"],
        "B_w_r": _B_in["w_r"],
        "B_w_i": _B_in["w_i"],
    }

def reference(A_x, A_c_kv, A_w_q, A_w_uk, A_w_uv, A_w_o, B_x, B_w_r, B_w_i):
    def _A_ref(x, c_kv, w_q, w_uk, w_uv, w_o):
        B, Sq, M = x.shape[0], x.shape[1], x.shape[2]
        Sk = c_kv.shape[1]
        H, D = w_q.shape[1], w_q.shape[2]
        q = torch.einsum("bqm,mhd->bhqd", x, w_q)
        k = torch.einsum("bkc,chd->bhkd", c_kv, w_uk)
        v = torch.einsum("bkc,chd->bhkd", c_kv, w_uv)
        scores = torch.einsum("bhqd,bhkd->bhqk", q, k) * (D ** -0.5)
        off = Sk - Sq
        qi = torch.arange(Sq)[:, None]
        kj = torch.arange(Sk)[None, :]
        cmask = kj <= (qi + off)
        scores = torch.where(cmask[None, None], scores, -1e9)
        p = _softmax(scores, axis=-1)
        ctx = torch.einsum("bhqk,bhkd->bhqd", p, v)
        return torch.einsum("bhqd,hdm->bqm", ctx, w_o)

    def _B_ref(x, w_r, w_i):
        B, S, D = x.shape
        X = (lambda x, axes=(-2,-1): torch.fft.rfft2(x.float(), dim=axes))(x, axes=(-2, -1))
        W = w_r + 1j * w_i
        X = X * W
        y = (lambda x, s, axes=(-2,-1): torch.fft.irfft2(x, s=s, dim=axes).to(torch.bfloat16))(X, (S, D), axes=(-2, -1))
        return y

    a = _A_ref(A_x, A_c_kv, A_w_q, A_w_uk, A_w_uv, A_w_o)
    b = _B_ref(B_x, B_w_r, B_w_i)
    return torch.concatenate([a, b], axis=-1)
```

```asm
; @launch kernel=l1_kernel grid=(256,1,1) block=(512,1,1) lds=163840
; @launch kernel=attn_kernel grid=(256,1,1) block=(512,1,1) lds=163840
; @launch kernel=l3_kernel grid=(256,1,1) block=(512,1,1) lds=163840
.amdgcn_target "amdgcn-amd-amdhsa--gfx950"
.macro mf16 p0, p1, p2, p3
v_mfma_f32_16x16x32_bf16 \p0, \p1, \p2, \p3
.endm
.macro mf32 p0, p1, p2, p3
v_mfma_f32_32x32x16_bf16 \p0, \p1, \p2, \p3
.endm
.macro cvtpk p0, p1, p2
v_cvt_pk_bf16_f32 \p0, \p1, \p2
.endm
.text
.globl l1_kernel
.p2align 8
.type l1_kernel,@function
l1_kernel:
cs_l1_kernel:
s_cmp_ge_u32 s2, 256
s_cbranch_scc1 l1_kernel_end
s_load_dwordx4 s[4:7], s[0:1], 0
s_load_dwordx4 s[8:11], s[0:1], 16
s_load_dwordx2 s[12:13], s[0:1], 32
s_load_dwordx2 s[14:15], s[0:1], 88
s_load_dwordx4 s[60:63], s[0:1], 48
s_load_dwordx2 s[64:65], s[0:1], 64
s_load_dwordx2 s[90:91], s[0:1], 40
v_and_b32 v64, 255, v0
v_lshrrev_b32 v2, 6, v0
v_and_b32 v0, 63, v0
v_readfirstlane_b32 s16, v2
s_nop 0
s_getpc_b64 s[24:25]
s_add_u32 s24, s24, cs_l1_kernel@rel32@lo+4
s_addc_u32 s25, s25, cs_l1_kernel@rel32@hi+12
s_mov_b32 s26, l1_kernel_end - l1_kernel
s_mov_b32 s27, 0x20000
s_lshr_b32 s28, s2, 3
s_lshl_b32 s28, s28, 3
s_add_u32 s28, s28, s16
s_lshl_b32 s28, s28, 9
v_lshlrev_b32 v60, 7, v0
s_mov_b64 exec, 15
buffer_load_dword v61, v60, s[24:27], s28 offen
s_mov_b64 exec, -1
s_and_b32 s17, s2, 7
s_lshr_b32 s18, s2, 3
s_and_b32 s19, s18, 7
s_lshr_b32 s18, s18, 3
s_lshl_b32 s40, s17, 2
s_add_u32 s18, s18, s40
s_lshr_b32 s18, s2, 3
s_and_b32 s19, s18, 3
s_and_b32 s40, s17, 1
s_lshl_b32 s40, s40, 2
s_add_u32 s19, s19, s40
s_lshr_b32 s18, s18, 2
s_lshr_b32 s40, s17, 1
s_lshl_b32 s40, s40, 3
s_add_u32 s18, s18, s40
s_mov_b32 s41, 0
s_mul_i32 s42, s18, 6
s_cmp_ge_u32 s18, 11
s_cselect_b32 s41, 1, s41
s_cselect_b32 s40, 64, 0
s_cmp_ge_u32 s18, 21
s_cselect_b32 s41, 2, s41
s_cselect_b32 s40, 126, s40
s_sub_u32 s42, s42, s40
s_lshl_b32 s44, s19, 3
s_add_u32 s44, s44, s16
v_lshrrev_b32 v66, 3, v0
v_lshlrev_b32 v69, 10, v66
v_lshlrev_b32 v66, 13, v66
s_lshl_b32 s45, s16, 17
v_add_u32 v66, s45, v66
v_bfe_u32 v67, v0, 4, 1
v_lshlrev_b32 v67, 1, v67
v_and_b32 v68, 7, v0
v_xor_b32 v67, v67, v68
v_lshl_add_u32 v1, v67, 4, v66
v_xor_b32 v2, 64, v1
v_add_u32 v2, 64512, v2
s_lshl_b32 s45, s44, 15
v_add_u32 v66, s45, v69
v_lshrrev_b32 v67, 4, v0
v_xor_b32 v67, v67, v68
v_lshl_add_u32 v3, v67, 4, v66
v_xor_b32 v4, 64, v3
v_add_u32 v4, 7168, v4
v_add_u32 v5, 14336, v3
v_add_u32 v6, 14336, v4
s_lshl_b32 s46, s16, 13
s_lshl_b32 s47, s16, 11
s_lshl_b32 s48, s42, 7
s_lshl_b32 s49, s44, 13
s_lshl_b32 s50, s42, 18
s_add_u32 s50, s50, s49
s_add_u32 s53, s48, 512
s_mov_b32 s43, s49
v_lshlrev_b32 v65, 4, v0
s_lshl_b32 s45, s44, 16
v_lshrrev_b32 v23, 1, v0
v_lshlrev_b32 v23, 13, v23
v_and_b32 v66, 1, v0
v_lshl_add_u32 v23, v66, 7, v23
v_add_u32 v23, s45, v23
s_waitcnt lgkmcnt(0)
s_lshl_b32 s45, s44, 18
s_lshl_b32 s40, s42, 12
s_add_u32 s45, s45, s40
s_mov_b32 s92, 0x80000
s_cmp_eq_u32 s41, 2
s_cselect_b32 s50, s45, s50
s_cselect_b32 s92, 0x2000, s92
s_cselect_b32 s20, s4, s6
s_cselect_b32 s21, s5, s7
s_cselect_b32 s24, s8, s10
s_cselect_b32 s25, s9, s11
s_cselect_b32 s51, 0x4000000, 0
s_cselect_b32 s52, 0x3e0293ee, 1.0
s_cmp_eq_u32 s41, 1
s_cselect_b32 s24, s12, s24
s_cselect_b32 s25, s13, s25
s_cselect_b32 s51, 0x1000000, s51
s_mov_b32 s32, s24
s_mov_b32 s33, s25
s_mov_b32 s40, 0x1000000
s_cmp_eq_u32 s18, 10
s_cselect_b32 s32, s12, s32
s_cselect_b32 s33, s13, s33
s_cselect_b32 s53, 0, s53
s_add_u32 s45, s49, 0xf80000
s_cmp_eq_u32 s18, 31
s_cselect_b32 s53, s48, s53
s_cselect_b32 s43, s50, s43
s_cselect_b32 s40, 0x4000000, s40
s_cselect_b32 s24, s12, s24
s_cselect_b32 s25, s13, s25
s_cselect_b32 s48, 7936, s48
s_cselect_b32 s51, 0x1000000, s51
s_cselect_b32 s20, s6, s20
s_cselect_b32 s21, s7, s21
s_cselect_b32 s50, s45, s50
s_mov_b32 s22, 0x200000
s_mov_b32 s23, 0x20000
s_mov_b32 s26, 0x400000
s_mov_b32 s27, 0x20000
s_and_b32 s8, s2, 7
s_lshl_b32 s8, s8, 3
s_bfe_u32 s9, s2, 0x30003
s_or_b32 s8, s8, s9
s_lshr_b32 s9, s2, 6
s_lshr_b32 s66, s9, 1
s_lshl_b32 s66, s66, 11
s_lshr_b32 s10, s8, 5
s_lshl_b32 s10, s10, 10
s_add_u32 s66, s66, s10
s_and_b32 s10, s8, 31
s_lshl_b32 s10, s10, 4
s_add_u32 s66, s66, s10
s_and_b32 s10, s9, 1
s_lshl_b32 s10, s10, 9
s_add_u32 s66, s66, s10
s_mov_b64 s[0:1], s[62:63]
s_cmp_ge_u32 s16, 4
s_cbranch_scc1 l1_kernel_nofl
s_lshr_b32 s10, s9, 1
s_lshl_b32 s10, s10, 4
s_and_b32 s11, s9, 1
s_lshl_b32 s11, s11, 2
s_add_u32 s10, s10, s11
s_lshr_b32 s11, s16, 1
s_lshl_b32 s11, s11, 3
s_add_u32 s10, s10, s11
s_and_b32 s11, s16, 1
s_lshl_b32 s11, s11, 1
s_add_u32 s10, s10, s11
s_lshl_b32 s10, s10, 6
s_add_u32 s10, s10, s8
s_lshl_b32 s10, s10, 10
s_add_u32 s11, s10, 64512
s_add_u32 s3, s47, 147456
s_mov_b32 m0, s3
s_mov_b32 s62, 0x200000
s_mov_b32 s63, 0x20000
buffer_load_dwordx4 v65, s[60:63], s10 offen nt lds
buffer_load_dwordx4 v65, s[60:63], s11 offen offset:1024 nt lds
l1_kernel_nofl:
s_add_u32 m0, s46, 0x0
s_mov_b32 s45, 0
buffer_load_dwordx4 v3, s[20:23], s45 offen offset:0 lds
buffer_load_dwordx4 v4, s[20:23], s45 offen offset:1024 lds
buffer_load_dwordx4 v5, s[20:23], s45 offen offset:2048 lds
buffer_load_dwordx4 v6, s[20:23], s45 offen offset:3072 lds
s_add_u32 m0, s47, 0x10000
s_add_u32 s45, s48, 0x0
buffer_load_dwordx4 v1, s[24:27], s45 offen offset:0 lds
buffer_load_dwordx4 v2, s[24:27], s45 offen offset:1024 lds
s_add_u32 m0, s47, 0x14000
s_add_u32 s45, s48, 0x80
buffer_load_dwordx4 v1, s[24:27], s45 offen offset:0 lds
buffer_load_dwordx4 v2, s[24:27], s45 offen offset:1024 lds
s_add_u32 m0, s46, 0x1000
s_mov_b32 s45, 128
buffer_load_dwordx4 v3, s[20:23], s45 offen offset:0 lds
buffer_load_dwordx4 v4, s[20:23], s45 offen offset:1024 lds
buffer_load_dwordx4 v5, s[20:23], s45 offen offset:2048 lds
buffer_load_dwordx4 v6, s[20:23], s45 offen offset:3072 lds
s_add_u32 m0, s47, 0x18000
s_add_u32 s45, s48, 0x100000
buffer_load_dwordx4 v1, s[24:27], s45 offen offset:0 lds
buffer_load_dwordx4 v2, s[24:27], s45 offen offset:1024 lds
s_add_u32 m0, s47, 0x1c000
s_add_u32 s45, s48, 0x100080
buffer_load_dwordx4 v1, s[24:27], s45 offen offset:0 lds
buffer_load_dwordx4 v2, s[24:27], s45 offen offset:1024 lds
s_mov_b32 s94, s52
s_mov_b32 s95, s52
s_mov_b32 s34, 0x400000
s_mov_b32 s35, 0x20000
s_add_u32 s28, s14, s51
s_addc_u32 s29, s15, 0
s_mov_b32 s30, 0x1000000
s_mov_b32 s31, 0x20000
s_add_u32 s36, s14, s40
s_addc_u32 s37, s15, 0
s_mov_b32 s38, 0x1000000
s_mov_b32 s39, 0x20000
s_mov_b32 s56, s4
s_mov_b32 s57, s5
s_mov_b32 s58, 0x200000
s_mov_b32 s59, 0x20000
s_add_u32 s13, s48, 256
s_add_u32 s17, s53, 256
s_cmp_eq_u32 s18, 31
s_cselect_b32 s4, s32, s24
s_cselect_b32 s5, s33, s25
s_cselect_b32 s13, s53, s13
s_cselect_b32 s17, s17, s53
s_mov_b32 s6, 0x400000
s_mov_b32 s7, 0x20000
v_lshrrev_b32 v69, 4, v0
v_bfe_u32 v66, v0, 3, 1
v_lshlrev_b32 v66, 4, v66
v_and_b32 v67, 7, v0
v_add_u32 v66, v66, v67
v_bfe_u32 v67, v66, 1, 3
v_xor_b32 v67, v67, v69
v_lshlrev_b32 v67, 4, v67
v_lshl_add_u32 v7, v66, 7, v67
v_xor_b32 v8, 64, v7
v_add_u32 v7, s46, v7
v_add_u32 v8, s46, v8
v_lshlrev_b32 v67, 9, v69
v_lshl_add_u32 v21, v66, 4, v67
v_and_b32 v68, 15, v0
v_lshl_add_u32 v22, v68, 4, v67
v_bfe_u32 v66, v0, 2, 2
v_lshl_add_u32 v66, v69, 3, v66
v_lshlrev_b32 v66, 7, v66
v_and_b32 v67, 3, v0
v_lshl_add_u32 v66, v67, 3, v66
v_bfe_u32 v67, v0, 3, 2
v_lshl_add_u32 v66, v67, 5, v66
v_xor_b32 v9, 0, v66
v_xor_b32 v10, 32, v66
v_xor_b32 v11, 64, v66
v_xor_b32 v12, 96, v66
v_add_u32 v13, 0x10000, v9
v_add_u32 v17, 0x20000, v9
v_add_u32 v14, 0x10000, v10
v_add_u32 v18, 0x20000, v10
v_add_u32 v15, 0x10000, v11
v_add_u32 v19, 0x20000, v11
v_add_u32 v16, 0x10000, v12
v_add_u32 v20, 0x20000, v12
s_cmp_ge_u32 s16, 4
s_cbranch_scc1 l1_kernel_join
v_lshrrev_b32 v79, 5, v0
v_cvt_f32_u32 v70, v79
v_and_b32 v73, 31, v0
v_cvt_f32_u32 v73, v73
v_mul_f32 v71, 0x3d000000, v73
v_mul_f32 v72, v71, v70
v_mul_f32 v72, 0x41000000, v72
v_fmamk_f32 v74, v71, 0x00000000, v72
v_fmamk_f32 v75, v71, 0x3f800000, v72
v_fmamk_f32 v76, v71, 0x40000000, v72
v_fmamk_f32 v77, v71, 0x40400000, v72
v_cos_f32 v74, v74
v_cos_f32 v75, v75
v_cos_f32 v76, v76
v_cos_f32 v77, v77
s_nop 0
cvtpk v84, v74, v75
cvtpk v85, v76, v77
v_fmamk_f32 v74, v71, 0x40800000, v72
v_fmamk_f32 v75, v71, 0x40a00000, v72
v_fmamk_f32 v76, v71, 0x40c00000, v72
v_fmamk_f32 v77, v71, 0x40e00000, v72
v_cos_f32 v74, v74
v_cos_f32 v75, v75
v_cos_f32 v76, v76
v_cos_f32 v77, v77
s_nop 0
cvtpk v86, v74, v75
cvtpk v87, v76, v77
v_fmamk_f32 v74, v71, 0x41800000, v72
v_fmamk_f32 v75, v71, 0x41880000, v72
v_fmamk_f32 v76, v71, 0x41900000, v72
v_fmamk_f32 v77, v71, 0x41980000, v72
v_cos_f32 v74, v74
v_cos_f32 v75, v75
v_cos_f32 v76, v76
v_cos_f32 v77, v77
s_nop 0
cvtpk v88, v74, v75
cvtpk v89, v76, v77
v_fmamk_f32 v74, v71, 0x41a00000, v72
v_fmamk_f32 v75, v71, 0x41a80000, v72
v_fmamk_f32 v76, v71, 0x41b00000, v72
v_fmamk_f32 v77, v71, 0x41b80000, v72
v_cos_f32 v74, v74
v_cos_f32 v75, v75
v_cos_f32 v76, v76
v_cos_f32 v77, v77
s_nop 0
cvtpk v90, v74, v75
cvtpk v91, v76, v77
v_add_f32 v72, 0x3e800000, v72
v_fmamk_f32 v74, v71, 0x00000000, v72
v_fmamk_f32 v75, v71, 0x3f800000, v72
v_fmamk_f32 v76, v71, 0x40000000, v72
v_fmamk_f32 v77, v71, 0x40400000, v72
v_cos_f32 v74, v74
v_cos_f32 v75, v75
v_cos_f32 v76, v76
v_cos_f32 v77, v77
s_nop 0
cvtpk v92, v74, v75
cvtpk v93, v76, v77
v_fmamk_f32 v74, v71, 0x40800000, v72
v_fmamk_f32 v75, v71, 0x40a00000, v72
v_fmamk_f32 v76, v71, 0x40c00000, v72
v_fmamk_f32 v77, v71, 0x40e00000, v72
v_cos_f32 v74, v74
v_cos_f32 v75, v75
v_cos_f32 v76, v76
v_cos_f32 v77, v77
s_nop 0
cvtpk v94, v74, v75
cvtpk v95, v76, v77
v_fmamk_f32 v74, v71, 0x41800000, v72
v_fmamk_f32 v75, v71, 0x41880000, v72
v_fmamk_f32 v76, v71, 0x41900000, v72
v_fmamk_f32 v77, v71, 0x41980000, v72
v_cos_f32 v74, v74
v_cos_f32 v75, v75
v_cos_f32 v76, v76
v_cos_f32 v77, v77
s_nop 0
cvtpk v96, v74, v75
cvtpk v97, v76, v77
v_fmamk_f32 v74, v71, 0x41a00000, v72
v_fmamk_f32 v75, v71, 0x41a80000, v72
v_fmamk_f32 v76, v71, 0x41b00000, v72
v_fmamk_f32 v77, v71, 0x41b80000, v72
v_cos_f32 v74, v74
v_cos_f32 v75, v75
v_cos_f32 v76, v76
v_cos_f32 v77, v77
s_nop 0
cvtpk v98, v74, v75
cvtpk v99, v76, v77
v_bfe_u32 v78, v0, 4, 1
v_lshlrev_b32 v78, 10, v78
v_lshl_add_u32 v78, v79, 8, v78
v_and_b32 v80, 15, v0
v_lshl_add_u32 v78, v80, 3, v78
v_add_u32 v78, s3, v78
s_waitcnt vmcnt(16)
ds_read_b64_tr_b16 v[108:109], v78 offset:0
ds_read_b64_tr_b16 v[110:111], v78 offset:128
ds_read_b64_tr_b16 v[112:113], v78 offset:512
ds_read_b64_tr_b16 v[114:115], v78 offset:640
v_cvt_f32_u32 v80, v80
v_mul_f32 v71, 0x3d800000, v80
v_bfe_u32 v78, v0, 4, 1
v_cvt_f32_u32 v78, v78
v_mul_f32 v72, v71, v70
v_mul_f32 v72, 4.0, v72
v_fmamk_f32 v72, v78, 0x3e800000, v72
s_waitcnt lgkmcnt(0)
mf32 v[116:131], v[108:111], v[84:87], 0
mf32 v[116:131], v[112:115], v[88:91], v[116:131]
mf32 v[132:147], v[108:111], v[92:95], 0
mf32 v[132:147], v[112:115], v[96:99], v[132:147]
v_fmamk_f32 v74, v71, 0x00000000, v72
v_fmamk_f32 v75, v71, 0x3f800000, v72
v_fmamk_f32 v76, v71, 0x40000000, v72
v_fmamk_f32 v77, v71, 0x40400000, v72
v_cos_f32 v74, v74
v_cos_f32 v75, v75
v_cos_f32 v76, v76
v_cos_f32 v77, v77
s_nop 0
cvtpk v100, v74, v75
cvtpk v101, v76, v77
v_fmamk_f32 v74, v71, 0x41000000, v72
v_fmamk_f32 v75, v71, 0x41100000, v72
v_fmamk_f32 v76, v71, 0x41200000, v72
v_fmamk_f32 v77, v71, 0x41300000, v72
v_cos_f32 v74, v74
v_cos_f32 v75, v75
v_cos_f32 v76, v76
v_cos_f32 v77, v77
s_nop 0
cvtpk v102, v74, v75
cvtpk v103, v76, v77
v_add_f32 v72, 0xbe800000, v72
v_fmamk_f32 v74, v71, 0x00000000, v72
v_fmamk_f32 v75, v71, 0x3f800000, v72
v_fmamk_f32 v76, v71, 0x40000000, v72
v_fmamk_f32 v77, v71, 0x40400000, v72
v_cos_f32 v74, v74
v_cos_f32 v75, v75
v_cos_f32 v76, v76
v_cos_f32 v77, v77
s_nop 0
cvtpk v104, v74, v75
cvtpk v105, v76, v77
v_fmamk_f32 v74, v71, 0x41000000, v72
v_fmamk_f32 v75, v71, 0x41100000, v72
v_fmamk_f32 v76, v71, 0x41200000, v72
v_fmamk_f32 v77, v71, 0x41300000, v72
v_cos_f32 v74, v74
v_cos_f32 v75, v75
v_cos_f32 v76, v76
v_cos_f32 v77, v77
s_nop 0
cvtpk v106, v74, v75
cvtpk v107, v76, v77
v_mul_f32 v71, 0x3b000000, v73
v_mul_f32 v72, v71, v70
v_mul_f32 v72, 4.0, v72
v_fmamk_f32 v74, v71, 0x00000000, v72
v_cos_f32 v75, v74
v_sin_f32 v76, v74
s_nop 0
v_mul_f32 v77, v116, v76
v_mul_f32 v116, v116, v75
v_fma_f32 v116, v132, v76, v116
v_fma_f32 v132, v132, v75, -v77
v_mul_f32 v77, v124, v76
v_mul_f32 v124, v124, v75
v_fma_f32 v124, v140, v76, v124
v_fma_f32 v140, v140, v75, -v77
v_fmamk_f32 v74, v71, 0x3f800000, v72
v_cos_f32 v75, v74
v_sin_f32 v76, v74
s_nop 0
v_mul_f32 v77, v117, v76
v_mul_f32 v117, v117, v75
v_fma_f32 v117, v133, v76, v117
v_fma_f32 v133, v133, v75, -v77
v_mul_f32 v77, v125, v76
v_mul_f32 v125, v125, v75
v_fma_f32 v125, v141, v76, v125
v_fma_f32 v141, v141, v75, -v77
v_fmamk_f32 v74, v71, 0x40000000, v72
v_cos_f32 v75, v74
v_sin_f32 v76, v74
s_nop 0
v_mul_f32 v77, v118, v76
v_mul_f32 v118, v118, v75
v_fma_f32 v118, v134, v76, v118
v_fma_f32 v134, v134, v75, -v77
v_mul_f32 v77, v126, v76
v_mul_f32 v126, v126, v75
v_fma_f32 v126, v142, v76, v126
v_fma_f32 v142, v142, v75, -v77
v_fmamk_f32 v74, v71, 0x40400000, v72
v_cos_f32 v75, v74
v_sin_f32 v76, v74
s_nop 0
v_mul_f32 v77, v119, v76
v_mul_f32 v119, v119, v75
v_fma_f32 v119, v135, v76, v119
v_fma_f32 v135, v135, v75, -v77
v_mul_f32 v77, v127, v76
v_mul_f32 v127, v127, v75
v_fma_f32 v127, v143, v76, v127
v_fma_f32 v143, v143, v75, -v77
v_fmamk_f32 v74, v71, 0x41000000, v72
v_cos_f32 v75, v74
v_sin_f32 v76, v74
s_nop 0
v_mul_f32 v77, v120, v76
v_mul_f32 v120, v120, v75
v_fma_f32 v120, v136, v76, v120
v_fma_f32 v136, v136, v75, -v77
v_mul_f32 v77, v128, v76
v_mul_f32 v128, v128, v75
v_fma_f32 v128, v144, v76, v128
v_fma_f32 v144, v144, v75, -v77
v_fmamk_f32 v74, v71, 0x41100000, v72
v_cos_f32 v75, v74
v_sin_f32 v76, v74
s_nop 0
v_mul_f32 v77, v121, v76
v_mul_f32 v121, v121, v75
v_fma_f32 v121, v137, v76, v121
v_fma_f32 v137, v137, v75, -v77
v_mul_f32 v77, v129, v76
v_mul_f32 v129, v129, v75
v_fma_f32 v129, v145, v76, v129
v_fma_f32 v145, v145, v75, -v77
v_fmamk_f32 v74, v71, 0x41200000, v72
v_cos_f32 v75, v74
v_sin_f32 v76, v74
s_nop 0
v_mul_f32 v77, v122, v76
v_mul_f32 v122, v122, v75
v_fma_f32 v122, v138, v76, v122
v_fma_f32 v138, v138, v75, -v77
v_mul_f32 v77, v130, v76
v_mul_f32 v130, v130, v75
v_fma_f32 v130, v146, v76, v130
v_fma_f32 v146, v146, v75, -v77
v_fmamk_f32 v74, v71, 0x41300000, v72
v_cos_f32 v75, v74
v_sin_f32 v76, v74
s_nop 0
v_mul_f32 v77, v123, v76
v_mul_f32 v123, v123, v75
v_fma_f32 v123, v139, v76, v123
v_fma_f32 v139, v139, v75, -v77
v_mul_f32 v77, v131, v76
v_mul_f32 v131, v131, v75
v_fma_f32 v131, v147, v76, v131
v_fma_f32 v147, v147, v75, -v77
cvtpk v148, v116, v117
cvtpk v149, v118, v119
cvtpk v150, v120, v121
cvtpk v151, v122, v123
cvtpk v152, v124, v125
cvtpk v153, v126, v127
cvtpk v154, v128, v129
cvtpk v155, v130, v131
cvtpk v158, v132, v133
cvtpk v159, v134, v135
cvtpk v160, v136, v137
cvtpk v161, v138, v139
cvtpk v162, v140, v141
cvtpk v163, v142, v143
cvtpk v164, v144, v145
cvtpk v165, v146, v147
v_and_b32 v80, 31, v0
v_lshlrev_b32 v80, 4, v80
mf32 v[168:183], v[100:103], v[148:151], 0
mf32 v[168:183], v[104:107], v[158:161], v[168:183]
mf32 v[184:199], v[100:103], v[152:155], 0
mf32 v[184:199], v[104:107], v[162:165], v[184:199]
v_lshl_add_u32 v80, v79, 11, v80
s_lshl_b32 s10, s16, 2
s_add_u32 s11, s10, 155648
v_add_u32 v80, s11, v80
v_mov_b32 v79, s10
s_add_u32 s67, s66, 2097152
s_add_u32 s11, s66, 2101248
s_add_u32 s60, s14, 0x3000000
s_addc_u32 s61, s15, 0
s_mov_b32 s62, 0x800000
s_mov_b32 s63, 0x20000
s_nop 1
cvtpk v148, v168, v184
cvtpk v149, v169, v185
cvtpk v150, v170, v186
cvtpk v151, v171, v187
cvtpk v152, v172, v188
cvtpk v153, v176, v192
cvtpk v154, v177, v193
cvtpk v155, v178, v194
cvtpk v156, v179, v195
cvtpk v157, v180, v196
ds_write_b32 v80, v148 offset:0
ds_write_b32 v80, v149 offset:512
ds_write_b32 v80, v150 offset:1024
ds_write_b32 v80, v151 offset:1536
ds_write_b32 v80, v153 offset:4096
ds_write_b32 v80, v154 offset:4608
ds_write_b32 v80, v155 offset:5120
ds_write_b32 v80, v156 offset:5632
s_mov_b64 exec, 1
buffer_store_dword v152, v79, s[60:63], s67 offen
buffer_store_dword v157, v79, s[60:63], s11 offen
s_mov_b64 exec, -1
l1_kernel_join:
s_lshr_b32 s10, s9, 1
s_lshl_b32 s10, s10, 5
s_lshr_b32 s11, s8, 5
s_lshl_b32 s11, s11, 4
s_add_u32 s10, s10, s11
s_and_b32 s11, s9, 1
s_lshl_b32 s11, s11, 2
s_add_u32 s10, s10, s11
s_lshl_b32 s10, s10, 5
s_and_b32 s11, s8, 31
s_add_u32 s10, s10, s11
s_mul_i32 s19, s10, 514
v_lshlrev_b32 v52, 1, v64
v_and_b32 v53, 3, v0
v_bfe_u32 v66, v0, 2, 1
v_lshl_add_u32 v53, v66, 3, v53
v_mul_u32_u24 v53, 16448, v53
v_add_u32 v53, 512, v53
s_cmp_ge_u32 s16, 4
s_cselect_b32 s8, s64, s0
s_cselect_b32 s9, s65, s1
s_mov_b32 s10, 1052672
s_mov_b32 s11, 0x20000
s_add_u32 s60, s14, 0x3000000
s_addc_u32 s61, s15, 0
s_mov_b32 s62, 0x800000
s_mov_b32 s63, 0x20000
v_lshlrev_b32 v56, 4, v64
s_lshr_b32 s12, s16, 2
s_lshl_b32 s12, s12, 12
s_add_u32 s66, s66, s12
s_add_u32 s67, s66, 6291456
s_add_u32 s12, s12, 155648
v_add_u32 v56, s12, v56
s_cmp_eq_u32 s18, 31
s_cbranch_scc1 l1_kernel_D
s_cmp_eq_u32 s41, 1
s_cbranch_scc1 l1_kernel_B
s_waitcnt lgkmcnt(0)
s_waitcnt vmcnt(12)
ds_read_b128 v[64:67], v7 offset:0
ds_read_b128 v[68:71], v8 offset:1024
ds_read_b128 v[72:75], v8 offset:0
ds_read_b128 v[76:79], v7 offset:1024
s_waitcnt vmcnt(8)
s_barrier
ds_read_b128 v[48:51], v56
ds_read_b64_tr_b16 v[24:25], v13 offset:0
ds_read_b64_tr_b16 v[26:27], v13 offset:512
ds_read_b64_tr_b16 v[28:29], v14 offset:0
ds_read_b64_tr_b16 v[30:31], v14 offset:512
ds_read_b64_tr_b16 v[32:33], v15 offset:0
ds_read_b64_tr_b16 v[34:35], v15 offset:512
ds_read_b64_tr_b16 v[36:37], v16 offset:0
ds_read_b64_tr_b16 v[38:39], v16 offset:512
s_waitcnt lgkmcnt(4)
mf16 v[192:195], v[24:27], v[64:67], 0
ds_read_b64_tr_b16 v[40:41], v13 offset:16384
mf16 v[208:211], v[24:27], v[68:71], 0
ds_read_b64_tr_b16 v[42:43], v13 offset:16896
s_add_u32 m0, s46, 0x0
s_mov_b32 s45, 256
buffer_load_dwordx4 v3, s[20:23], s45 offen offset:0 lds
mf16 v[196:199], v[28:31], v[64:67], 0
ds_read_b64_tr_b16 v[44:45], v14 offset:16384
mf16 v[212:215], v[28:31], v[68:71], 0
ds_read_b64_tr_b16 v[46:47], v14 offset:16896
s_waitcnt lgkmcnt(4)
mf16 v[200:203], v[32:35], v[64:67], 0
ds_read_b64_tr_b16 v[24:25], v15 offset:16384
mf16 v[216:219], v[32:35], v[68:71], 0
ds_read_b64_tr_b16 v[26:27], v15 offset:16896
buffer_load_dwordx4 v4, s[20:23], s45 offen offset:1024 lds
mf16 v[204:207], v[36:39], v[64:67], 0
ds_read_b64_tr_b16 v[28:29], v16 offset:16384
mf16 v[220:223], v[36:39], v[68:71], 0
ds_read_b64_tr_b16 v[30:31], v16 offset:16896
s_waitcnt lgkmcnt(4)
mf16 v[224:227], v[40:43], v[64:67], 0
ds_read_b64_tr_b16 v[32:33], v13 offset:4096
mf16 v[240:243], v[40:43], v[68:71], 0
ds_read_b64_tr_b16 v[34:35], v13 offset:4608
buffer_load_dwordx4 v5, s[20:23], s45 offen offset:2048 lds
mf16 v[228:231], v[44:47], v[64:67], 0
ds_read_b64_tr_b16 v[36:37], v14 offset:4096
mf16 v[244:247], v[44:47], v[68:71], 0
ds_read_b64_tr_b16 v[38:39], v14 offset:4608
s_waitcnt lgkmcnt(4)
mf16 v[232:235], v[24:27], v[64:67], 0
ds_read_b64_tr_b16 v[40:41], v15 offset:4096
mf16 v[248:251], v[24:27], v[68:71], 0
ds_read_b64_tr_b16 v[42:43], v15 offset:4608
buffer_load_dwordx4 v6, s[20:23], s45 offen offset:3072 lds
mf16 v[236:239], v[28:31], v[64:67], 0
ds_read_b64_tr_b16 v[44:45], v16 offset:4096
mf16 v[252:255], v[28:31], v[68:71], 0
ds_read_b64_tr_b16 v[46:47], v16 offset:4608
s_waitcnt lgkmcnt(4)
mf16 v[192:195], v[32:35], v[72:75], v[192:195]
ds_read_b64_tr_b16 v[24:25], v13 offset:20480
mf16 v[208:211], v[32:35], v[76:79], v[208:211]
ds_read_b64_tr_b16 v[26:27], v13 offset:20992
s_add_u32 m0, s47, 0x20000
s_add_u32 s45, s48, 0x200000
buffer_load_dwordx4 v1, s[24:27], s45 offen offset:0 lds
mf16 v[196:199], v[36:39], v[72:75], v[196:199]
ds_read_b64_tr_b16 v[28:29], v14 offset:20480
mf16 v[212:215], v[36:39], v[76:79], v[212:215]
ds_read_b64_tr_b16 v[30:31], v14 offset:20992
s_waitcnt lgkmcnt(4)
mf16 v[200:203], v[40:43], v[72:75], v[200:203]
ds_read_b64_tr_b16 v[32:33], v15 offset:20480
mf16 v[216:219], v[40:43], v[76:79], v[216:219]
ds_read_b64_tr_b16 v[34:35], v15 offset:20992
buffer_load_dwordx4 v2, s[24:27], s45 offen offset:1024 lds
mf16 v[204:207], v[44:47], v[72:75], v[204:207]
ds_read_b64_tr_b16 v[36:37], v16 offset:20480
mf16 v[220:223], v[44:47], v[76:79], v[220:223]
ds_read_b64_tr_b16 v[38:39], v16 offset:20992
s_waitcnt lgkmcnt(4)
mf16 v[224:227], v[24:27], v[72:75], v[224:227]
s_waitcnt vmcnt(10)
ds_read_b128 v[80:83], v7 offset:4096
ds_read_b128 v[84:87], v8 offset:5120
ds_read_b128 v[88:91], v8 offset:4096
ds_read_b128 v[92:95], v7 offset:5120
ds_read_b64_tr_b16 v[40:41], v13 offset:8192
mf16 v[240:243], v[24:27], v[76:79], v[240:243]
ds_read_b64_tr_b16 v[42:43], v13 offset:8704
mf16 v[228:231], v[28:31], v[72:75], v[228:231]
ds_read_b64_tr_b16 v[44:45], v14 offset:8192
mf16 v[244:247], v[28:31], v[76:79], v[244:247]
ds_read_b64_tr_b16 v[46:47], v14 offset:8704
s_waitcnt lgkmcnt(8)
mf16 v[232:235], v[32:35], v[72:75], v[232:235]
ds_read_b64_tr_b16 v[24:25], v15 offset:8192
mf16 v[248:251], v[32:35], v[76:79], v[248:251]
ds_read_b64_tr_b16 v[26:27], v15 offset:8704
mf16 v[236:239], v[36:39], v[72:75], v[236:239]
ds_read_b64_tr_b16 v[28:29], v16 offset:8192
mf16 v[252:255], v[36:39], v[76:79], v[252:255]
ds_read_b64_tr_b16 v[30:31], v16 offset:8704
s_waitcnt lgkmcnt(4)
mf16 v[192:195], v[40:43], v[80:83], v[192:195]
ds_read_b64_tr_b16 v[32:33], v13 offset:24576
mf16 v[208:211], v[40:43], v[84:87], v[208:211]
ds_read_b64_tr_b16 v[34:35], v13 offset:25088
s_add_u32 m0, s46, 0x1000
s_mov_b32 s45, 384
buffer_load_dwordx4 v3, s[20:23], s45 offen offset:0 lds
mf16 v[196:199], v[44:47], v[80:83], v[196:199]
ds_read_b64_tr_b16 v[36:37], v14 offset:24576
mf16 v[212:215], v[44:47], v[84:87], v[212:215]
ds_read_b64_tr_b16 v[38:39], v14 offset:25088
s_waitcnt lgkmcnt(4)
mf16 v[200:203], v[24:27], v[80:83], v[200:203]
ds_read_b64_tr_b16 v[40:41], v15 offset:24576
mf16 v[216:219], v[24:27], v[84:87], v[216:219]
ds_read_b64_tr_b16 v[42:43], v15 offset:25088
buffer_load_dwordx4 v4, s[20:23], s45 offen offset:1024 lds
mf16 v[204:207], v[28:31], v[80:83], v[204:207]
ds_read_b64_tr_b16 v[44:45], v16 offset:24576
mf16 v[220:223], v[28:31], v[84:87], v[220:223]
ds_read_b64_tr_b16 v[46:47], v16 offset:25088
s_waitcnt lgkmcnt(4)
mf16 v[224:227], v[32:35], v[80:83], v[224:227]
ds_read_b64_tr_b16 v[24:25], v13 offset:12288
mf16 v[240:243], v[32:35], v[84:87], v[240:243]
ds_read_b64_tr_b16 v[26:27], v13 offset:12800
buffer_load_dwordx4 v5, s[20:23], s45 offen offset:2048 lds
mf16 v[228:231], v[36:39], v[80:83], v[228:231]
ds_read_b64_tr_b16 v[28:29], v14 offset:12288
mf16 v[244:247], v[36:39], v[84:87], v[244:247]
ds_read_b64_tr_b16 v[30:31], v14 offset:12800
s_waitcnt lgkmcnt(4)
mf16 v[232:235], v[40:43], v[80:83], v[232:235]
ds_read_b64_tr_b16 v[32:33], v15 offset:12288
mf16 v[248:251], v[40:43], v[84:87], v[248:251]
ds_read_b64_tr_b16 v[34:35], v15 offset:12800
buffer_load_dwordx4 v6, s[20:23], s45 offen offset:3072 lds
mf16 v[236:239], v[44:47], v[80:83], v[236:239]
ds_read_b64_tr_b16 v[36:37], v16 offset:12288
mf16 v[252:255], v[44:47], v[84:87], v[252:255]
ds_read_b64_tr_b16 v[38:39], v16 offset:12800
s_waitcnt lgkmcnt(4)
mf16 v[192:195], v[24:27], v[88:91], v[192:195]
ds_read_b64_tr_b16 v[40:41], v13 offset:28672
mf16 v[208:211], v[24:27], v[92:95], v[208:211]
ds_read_b64_tr_b16 v[42:43], v13 offset:29184
mf16 v[196:199], v[28:31], v[88:91], v[196:199]
ds_read_b64_tr_b16 v[44:45], v14 offset:28672
mf16 v[212:215], v[28:31], v[92:95], v[212:215]
ds_read_b64_tr_b16 v[46:47], v14 offset:29184
s_waitcnt lgkmcnt(4)
mf16 v[200:203], v[32:35], v[88:91], v[200:203]
ds_read_b64_tr_b16 v[24:25], v15 offset:28672
mf16 v[216:219], v[32:35], v[92:95], v[216:219]
ds_read_b64_tr_b16 v[26:27], v15 offset:29184
mf16 v[204:207], v[36:39], v[88:91], v[204:207]
ds_read_b64_tr_b16 v[28:29], v16 offset:28672
mf16 v[220:223], v[36:39], v[92:95], v[220:223]
ds_read_b64_tr_b16 v[30:31], v16 offset:29184
s_waitcnt lgkmcnt(4)
mf16 v[224:227], v[40:43], v[88:91], v[224:227]
s_waitcnt vmcnt(10)
s_barrier
s_waitcnt vmcnt(6)
ds_read_b128 v[96:99], v7 offset:0
ds_read_b128 v[100:103], v8 offset:1024
ds_read_b128 v[104:107], v8 offset:0
ds_read_b128 v[108:111], v7 offset:1024
ds_read_b64_tr_b16 v[32:33], v13 offset:32768
mf16 v[240:243], v[40:43], v[92:95], v[240:243]
ds_read_b64_tr_b16 v[34:35], v13 offset:33280
s_add_u32 m0, s47, 0x24000
s_add_u32 s45, s48, 0x200080
buffer_load_dwordx4 v1, s[24:27], s45 offen offset:0 lds
mf16 v[228:231], v[44:47], v[88:91], v[228:231]
ds_read_b64_tr_b16 v[36:37], v14 offset:32768
mf16 v[244:247], v[44:47], v[92:95], v[244:247]
ds_read_b64_tr_b16 v[38:39], v14 offset:33280
s_waitcnt lgkmcnt(8)
mf16 v[232:235], v[24:27], v[88:91], v[232:235]
ds_read_b64_tr_b16 v[40:41], v15 offset:32768
mf16 v[248:251], v[24:27], v[92:95], v[248:251]
ds_read_b64_tr_b16 v[42:43], v15 offset:33280
buffer_load_dwordx4 v2, s[24:27], s45 offen offset:1024 lds
mf16 v[236:239], v[28:31], v[88:91], v[236:239]
ds_read_b64_tr_b16 v[44:45], v16 offset:32768
mf16 v[252:255], v[28:31], v[92:95], v[252:255]
ds_read_b64_tr_b16 v[46:47], v16 offset:33280
s_waitcnt lgkmcnt(4)
mf16 v[192:195], v[32:35], v[96:99], v[192:195]
ds_read_b64_tr_b16 v[24:25], v13 offset:49152
mf16 v[208:211], v[32:35], v[100:103], v[208:211]
ds_read_b64_tr_b16 v[26:27], v13 offset:49664
s_add_u32 m0, s46, 0x0
s_mov_b32 s45, 512
buffer_load_dwordx4 v3, s[20:23], s45 offen offset:0 lds
mf16 v[196:199], v[36:39], v[96:99], v[196:199]
ds_read_b64_tr_b16 v[28:29], v14 offset:49152
mf16 v[212:215], v[36:39], v[100:103], v[212:215]
ds_read_b64_tr_b16 v[30:31], v14 offset:49664
s_waitcnt lgkmcnt(4)
mf16 v[200:203], v[40:43], v[96:99], v[200:203]
ds_read_b64_tr_b16 v[32:33], v15 offset:49152
mf16 v[216:219], v[40:43], v[100:103], v[216:219]
ds_read_b64_tr_b16 v[34:35], v15 offset:49664
buffer_load_dwordx4 v4, s[20:23], s45 offen offset:1024 lds
mf16 v[204:207], v[44:47], v[96:99], v[204:207]
ds_read_b64_tr_b16 v[36:37], v16 offset:49152
mf16 v[220:223], v[44:47], v[100:103], v[220:223]
ds_read_b64_tr_b16 v[38:39], v16 offset:49664
s_waitcnt lgkmcnt(4)
mf16 v[224:227], v[24:27], v[96:99], v[224:227]
ds_read_b64_tr_b16 v[40:41], v13 offset:36864
mf16 v[240:243], v[24:27], v[100:103], v[240:243]
ds_read_b64_tr_b16 v[42:43], v13 offset:37376
buffer_load_dwordx4 v5, s[20:23], s45 offen offset:2048 lds
mf16 v[228:231], v[28:31], v[96:99], v[228:231]
ds_read_b64_tr_b16 v[44:45], v14 offset:36864
mf16 v[244:247], v[28:31], v[100:103], v[244:247]
ds_read_b64_tr_b16 v[46:47], v14 offset:37376
s_waitcnt lgkmcnt(4)
mf16 v[232:235], v[32:35], v[96:99], v[232:235]
ds_read_b64_tr_b16 v[24:25], v15 offset:36864
mf16 v[248:251], v[32:35], v[100:103], v[248:251]
ds_read_b64_tr_b16 v[26:27], v15 offset:37376
buffer_load_dwordx4 v6, s[20:23], s45 offen offset:3072 lds
mf16 v[236:239], v[36:39], v[96:99], v[236:239]
ds_read_b64_tr_b16 v[28:29], v16 offset:36864
mf16 v[252:255], v[36:39], v[100:103], v[252:255]
ds_read_b64_tr_b16 v[30:31], v16 offset:37376
s_waitcnt lgkmcnt(4)
mf16 v[192:195], v[40:43], v[104:107], v[192:195]
ds_read_b64_tr_b16 v[32:33], v13 offset:53248
mf16 v[208:211], v[40:43], v[108:111], v[208:211]
ds_read_b64_tr_b16 v[34:35], v13 offset:53760
s_add_u32 s12, s19, 0
buffer_load_ushort v56, v52, s[8:11], s12 offen nt
mf16 v[196:199], v[44:47], v[104:107], v[196:199]
ds_read_b64_tr_b16 v[36:37], v14 offset:53248
mf16 v[212:215], v[44:47], v[108:111], v[212:215]
ds_read_b64_tr_b16 v[38:39], v14 offset:53760
s_waitcnt lgkmcnt(4)
mf16 v[200:203], v[24:27], v[104:107], v[200:203]
ds_read_b64_tr_b16 v[40:41], v15 offset:53248
mf16 v[216:219], v[24:27], v[108:111], v[216:219]
ds_read_b64_tr_b16 v[42:43], v15 offset:53760
s_add_u32 s12, s19, 16448
buffer_load_ushort v57, v52, s[8:11], s12 offen nt
mf16 v[204:207], v[28:31], v[104:107], v[204:207]
ds_read_b64_tr_b16 v[44:45], v16 offset:53248
mf16 v[220:223], v[28:31], v[108:111], v[220:223]
ds_read_b64_tr_b16 v[46:47], v16 offset:53760
s_waitcnt lgkmcnt(4)
mf16 v[224:227], v[32:35], v[104:107], v[224:227]
s_waitcnt vmcnt(8)
ds_read_b128 v[112:115], v7 offset:4096
ds_read_b128 v[116:119], v8 offset:5120
ds_read_b128 v[120:123], v8 offset:4096
ds_read_b128 v[124:127], v7 offset:5120
ds_read_b64_tr_b16 v[24:25], v13 offset:40960
mf16 v[240:243], v[32:35], v[108:111], v[240:243]
ds_read_b64_tr_b16 v[26:27], v13 offset:41472
s_add_u32 s12, s19, 32896
buffer_load_ushort v58, v52, s[8:11], s12 offen nt
mf16 v[228:231], v[36:39], v[104:107], v[228:231]
ds_read_b64_tr_b16 v[28:29], v14 offset:40960
mf16 v[244:247], v[36:39], v[108:111], v[244:247]
ds_read_b64_tr_b16 v[30:31], v14 offset:41472
s_waitcnt lgkmcnt(8)
mf16 v[232:235], v[40:43], v[104:107], v[232:235]
ds_read_b64_tr_b16 v[32:33], v15 offset:40960
mf16 v[248:251], v[40:43], v[108:111], v[248:251]
ds_read_b64_tr_b16 v[34:35], v15 offset:41472
s_add_u32 s12, s19, 49344
buffer_load_ushort v59, v52, s[8:11], s12 offen nt
mf16 v[236:239], v[44:47], v[104:107], v[236:239]
ds_read_b64_tr_b16 v[36:37], v16 offset:40960
mf16 v[252:255], v[44:47], v[108:111], v[252:255]
ds_read_b64_tr_b16 v[38:39], v16 offset:41472
s_waitcnt lgkmcnt(4)
mf16 v[192:195], v[24:27], v[112:115], v[192:195]
ds_read_b64_tr_b16 v[40:41], v13 offset:57344
mf16 v[208:211], v[24:27], v[116:119], v[208:211]
ds_read_b64_tr_b16 v[42:43], v13 offset:57856
s_add_u32 m0, s46, 0x1000
s_mov_b32 s45, 640
buffer_load_dwordx4 v3, s[20:23], s45 offen offset:0 lds
mf16 v[196:199], v[28:31], v[112:115], v[196:199]
ds_read_b64_tr_b16 v[44:45], v14 offset:57344
mf16 v[212:215], v[28:31], v[116:119], v[212:215]
ds_read_b64_tr_b16 v[46:47], v14 offset:57856
s_waitcnt lgkmcnt(4)
mf16 v[200:203], v[32:35], v[112:115], v[200:203]
ds_read_b64_tr_b16 v[24:25], v15 offset:57344
mf16 v[216:219], v[32:35], v[116:119], v[216:219]
ds_read_b64_tr_b16 v[26:27], v15 offset:57856
buffer_load_dwordx4 v4, s[20:23], s45 offen offset:1024 lds
mf16 v[204:207], v[36:39], v[112:115], v[204:207]
ds_read_b64_tr_b16 v[28:29], v16 offset:57344
mf16 v[220:223], v[36:39], v[116:119], v[220:223]
ds_read_b64_tr_b16 v[30:31], v16 offset:57856
s_waitcnt lgkmcnt(4)
mf16 v[224:227], v[40:43], v[112:115], v[224:227]
ds_read_b64_tr_b16 v[32:33], v13 offset:45056
mf16 v[240:243], v[40:43], v[116:119], v[240:243]
ds_read_b64_tr_b16 v[34:35], v13 offset:45568
buffer_load_dwordx4 v5, s[20:23], s45 offen offset:2048 lds
mf16 v[228:231], v[44:47], v[112:115], v[228:231]
ds_read_b64_tr_b16 v[36:37], v14 offset:45056
mf16 v[244:247], v[44:47], v[116:119], v[244:247]
ds_read_b64_tr_b16 v[38:39], v14 offset:45568
s_waitcnt lgkmcnt(4)
mf16 v[232:235], v[24:27], v[112:115], v[232:235]
ds_read_b64_tr_b16 v[40:41], v15 offset:45056
mf16 v[248:251], v[24:27], v[116:119], v[248:251]
ds_read_b64_tr_b16 v[42:43], v15 offset:45568
buffer_load_dwordx4 v6, s[20:23], s45 offen offset:3072 lds
mf16 v[236:239], v[28:31], v[112:115], v[236:239]
ds_read_b64_tr_b16 v[44:45], v16 offset:45056
mf16 v[252:255], v[28:31], v[116:119], v[252:255]
ds_read_b64_tr_b16 v[46:47], v16 offset:45568
s_waitcnt lgkmcnt(4)
mf16 v[192:195], v[32:35], v[120:123], v[192:195]
ds_read_b64_tr_b16 v[24:25], v13 offset:61440
mf16 v[208:211], v[32:35], v[124:127], v[208:211]
ds_read_b64_tr_b16 v[26:27], v13 offset:61952
s_add_u32 s12, s19, 131584
buffer_load_ushort v60, v52, s[8:11], s12 offen nt
mf16 v[196:199], v[36:39], v[120:123], v[196:199]
ds_read_b64_tr_b16 v[28:29], v14 offset:61440
mf16 v[212:215], v[36:39], v[124:127], v[212:215]
ds_read_b64_tr_b16 v[30:31], v14 offset:61952
s_waitcnt lgkmcnt(4)
mf16 v[200:203], v[40:43], v[120:123], v[200:203]
ds_read_b64_tr_b16 v[32:33], v15 offset:61440
mf16 v[216:219], v[40:43], v[124:127], v[216:219]
ds_read_b64_tr_b16 v[34:35], v15 offset:61952
s_add_u32 s12, s19, 148032
buffer_load_ushort v61, v52, s[8:11], s12 offen nt
mf16 v[204:207], v[44:47], v[120:123], v[204:207]
ds_read_b64_tr_b16 v[36:37], v16 offset:61440
mf16 v[220:223], v[44:47], v[124:127], v[220:223]
ds_read_b64_tr_b16 v[38:39], v16 offset:61952
s_waitcnt lgkmcnt(4)
mf16 v[224:227], v[24:27], v[120:123], v[224:227]
s_waitcnt vmcnt(14)
s_barrier
s_waitcnt vmcnt(10)
ds_read_b128 v[128:131], v7 offset:0
ds_read_b128 v[132:135], v8 offset:1024
ds_read_b128 v[136:139], v8 offset:0
ds_read_b128 v[140:143], v7 offset:1024
ds_read_b64_tr_b16 v[40:41], v17 offset:0
mf16 v[240:243], v[24:27], v[124:127], v[240:243]
ds_read_b64_tr_b16 v[42:43], v17 offset:512
s_add_u32 m0, s47, 0x10000
s_add_u32 s45, s48, 0x300000
buffer_load_dwordx4 v1, s[24:27], s45 offen offset:0 lds
mf16 v[228:231], v[28:31], v[120:123], v[228:231]
ds_read_b64_tr_b16 v[44:45], v18 offset:0
mf16 v[244:247], v[28:31], v[124:127], v[244:247]
ds_read_b64_tr_b16 v[46:47], v18 offset:512
s_waitcnt lgkmcnt(8)
mf16 v[232:235], v[32:35], v[120:123], v[232:235]
ds_read_b64_tr_b16 v[24:25], v19 offset:0
mf16 v[248:251], v[32:35], v[124:127], v[248:251]
ds_read_b64_tr_b16 v[26:27], v19 offset:512
buffer_load_dwordx4 v2, s[24:27], s45 offen offset:1024 lds
mf16 v[236:239], v[36:39], v[120:123], v[236:239]
ds_read_b64_tr_b16 v[28:29], v20 offset:0
mf16 v[252:255], v[36:39], v[124:127], v[252:255]
ds_read_b64_tr_b16 v[30:31], v20 offset:512
s_waitcnt lgkmcnt(4)
mf16 v[192:195], v[40:43], v[128:131], v[192:195]
ds_read_b64_tr_b16 v[32:33], v17 offset:16384
mf16 v[208:211], v[40:43], v[132:135], v[208:211]
ds_read_b64_tr_b16 v[34:35], v17 offset:16896
s_add_u32 m0, s46, 0x0
s_mov_b32 s45, 768
buffer_load_dwordx4 v3, s[20:23], s45 offen offset:0 lds
mf16 v[196:199], v[44:47], v[128:131], v[196:199]
ds_read_b64_tr_b16 v[36:37], v18 offset:16384
mf16 v[212:215], v[44:47], v[132:135], v[212:215]
ds_read_b64_tr_b16 v[38:39], v18 offset:16896
s_waitcnt lgkmcnt(4)
mf16 v[200:203], v[24:27], v[128:131], v[200:203]
ds_read_b64_tr_b16 v[40:41], v19 offset:16384
mf16 v[216:219], v[24:27], v[132:135], v[216:219]
ds_read_b64_tr_b16 v[42:43], v19 offset:16896
buffer_load_dwordx4 v4, s[20:23], s45 offen offset:1024 lds
mf16 v[204:207], v[28:31], v[128:131], v[204:207]
ds_read_b64_tr_b16 v[44:45], v20 offset:16384
mf16 v[220:223], v[28:31], v[132:135], v[220:223]
ds_read_b64_tr_b16 v[46:47], v20 offset:16896
s_waitcnt lgkmcnt(4)
mf16 v[224:227], v[32:35], v[128:131], v[224:227]
ds_read_b64_tr_b16 v[24:25], v17 offset:4096
mf16 v[240:243], v[32:35], v[132:135], v[240:243]
ds_read_b64_tr_b16 v[26:27], v17 offset:4608
buffer_load_dwordx4 v5, s[20:23], s45 offen offset:2048 lds
mf16 v[228:231], v[36:39], v[128:131], v[228:231]
ds_read_b64_tr_b16 v[28:29], v18 offset:4096
mf16 v[244:247], v[36:39], v[132:135], v[244:247]
ds_read_b64_tr_b16 v[30:31], v18 offset:4608
s_waitcnt lgkmcnt(4)
mf16 v[232:235], v[40:43], v[128:131], v[232:235]
ds_read_b64_tr_b16 v[32:33], v19 offset:4096
mf16 v[248:251], v[40:43], v[132:135], v[248:251]
ds_read_b64_tr_b16 v[34:35], v19 offset:4608
buffer_load_dwordx4 v6, s[20:23], s45 offen offset:3072 lds
mf16 v[236:239], v[44:47], v[128:131], v[236:239]
ds_read_b64_tr_b16 v[36:37], v20 offset:4096
s_add_u32 m0, s47, 0x14000
s_add_u32 s45, s48, 0x300080
buffer_load_dwordx4 v1, s[24:27], s45 offen offset:0 lds
buffer_load_dwordx4 v2, s[24:27], s45 offen offset:1024 lds
s_add_u32 s12, s19, 164480
buffer_load_ushort v62, v52, s[8:11], s12 offen nt
s_add_u32 s12, s19, 180928
buffer_load_ushort v63, v52, s[8:11], s12 offen nt
buffer_load_ushort v55, v53, s[8:11], s19 offen nt
s_waitcnt vmcnt(0)
v_lshlrev_b32 v54, 1, v0
mf16 v[252:255], v[44:47], v[132:135], v[252:255]
ds_read_b64_tr_b16 v[38:39], v20 offset:4608
s_waitcnt lgkmcnt(4)
mf16 v[192:195], v[24:27], v[136:139], v[192:195]
ds_read_b64_tr_b16 v[40:41], v17 offset:20480
s_mov_b64 exec, 0xff
buffer_store_short v55, v54, s[60:63], s67 offen
s_mov_b64 exec, -1
mf16 v[208:211], v[24:27], v[140:143], v[208:211]
ds_read_b64_tr_b16 v[42:43], v17 offset:20992
v_lshl_or_b32 v52, v57, 16, v56
mf16 v[196:199], v[28:31], v[136:139], v[196:199]
ds_read_b64_tr_b16 v[44:45], v18 offset:20480
v_lshl_or_b32 v53, v59, 16, v58
mf16 v[212:215], v[28:31], v[140:143], v[212:215]
ds_read_b64_tr_b16 v[46:47], v18 offset:20992
s_waitcnt lgkmcnt(4)
mf16 v[200:203], v[32:35], v[136:139], v[200:203]
ds_read_b64_tr_b16 v[24:25], v19 offset:20480
v_lshl_or_b32 v54, v61, 16, v60
mf16 v[216:219], v[32:35], v[140:143], v[216:219]
ds_read_b64_tr_b16 v[26:27], v19 offset:20992
v_lshl_or_b32 v55, v63, 16, v62
mf16 v[204:207], v[36:39], v[136:139], v[204:207]
ds_read_b64_tr_b16 v[28:29], v20 offset:20480
mf16 v[220:223], v[36:39], v[140:143], v[220:223]
ds_read_b64_tr_b16 v[30:31], v20 offset:20992
s_waitcnt lgkmcnt(4)
mf16 v[224:227], v[40:43], v[136:139], v[224:227]
ds_read_b128 v[144:147], v7 offset:4096
ds_read_b128 v[148:151], v8 offset:5120
ds_read_b128 v[152:155], v8 offset:4096
ds_read_b128 v[156:159], v7 offset:5120
ds_read_b64_tr_b16 v[32:33], v17 offset:8192
mf16 v[240:243], v[40:43], v[140:143], v[240:243]
ds_read_b64_tr_b16 v[34:35], v17 offset:8704
mf16 v[228:231], v[44:47], v[136:139], v[228:231]
ds_read_b64_tr_b16 v[36:37], v18 offset:8192
mf16 v[244:247], v[44:47], v[140:143], v[244:247]
ds_read_b64_tr_b16 v[38:39], v18 offset:8704
s_waitcnt lgkmcnt(8)
mf16 v[232:235], v[24:27], v[136:139], v[232:235]
ds_read_b64_tr_b16 v[40:41], v19 offset:8192
mf16 v[248:251], v[24:27], v[140:143], v[248:251]
ds_read_b64_tr_b16 v[42:43], v19 offset:8704
mf16 v[236:239], v[28:31], v[136:139], v[236:239]
ds_read_b64_tr_b16 v[44:45], v20 offset:8192
mf16 v[252:255], v[28:31], v[140:143], v[252:255]
ds_read_b64_tr_b16 v[46:47], v20 offset:8704
s_waitcnt lgkmcnt(4)
mf16 v[192:195], v[32:35], v[144:147], v[192:195]
ds_read_b64_tr_b16 v[24:25], v17 offset:24576
mf16 v[208:211], v[32:35], v[148:151], v[208:211]
ds_read_b64_tr_b16 v[26:27], v17 offset:25088
s_add_u32 m0, s46, 0x1000
s_mov_b32 s45, 896
buffer_load_dwordx4 v3, s[20:23], s45 offen offset:0 lds
mf16 v[196:199], v[36:39], v[144:147], v[196:199]
ds_read_b64_tr_b16 v[28:29], v18 offset:24576
mf16 v[212:215], v[36:39], v[148:151], v[212:215]
ds_read_b64_tr_b16 v[30:31], v18 offset:25088
s_waitcnt lgkmcnt(4)
mf16 v[200:203], v[40:43], v[144:147], v[200:203]
ds_read_b64_tr_b16 v[32:33], v19 offset:24576
mf16 v[216:219], v[40:43], v[148:151], v[216:219]
ds_read_b64_tr_b16 v[34:35], v19 offset:25088
buffer_load_dwordx4 v4, s[20:23], s45 offen offset:1024 lds
mf16 v[204:207], v[44:47], v[144:147], v[204:207]
ds_read_b64_tr_b16 v[36:37], v20 offset:24576
mf16 v[220:223], v[44:47], v[148:151], v[220:223]
ds_read_b64_tr_b16 v[38:39], v20 offset:25088
s_waitcnt lgkmcnt(4)
mf16 v[224:227], v[24:27], v[144:147], v[224:227]
ds_read_b64_tr_b16 v[40:41], v17 offset:12288
mf16 v[240:243], v[24:27], v[148:151], v[240:243]
ds_read_b64_tr_b16 v[42:43], v17 offset:12800
buffer_load_dwordx4 v5, s[20:23], s45 offen offset:2048 lds
mf16 v[228:231], v[28:31], v[144:147], v[228:231]
ds_read_b64_tr_b16 v[44:45], v18 offset:12288
mf16 v[244:247], v[28:31], v[148:151], v[244:247]
ds_read_b64_tr_b16 v[46:47], v18 offset:12800
s_waitcnt lgkmcnt(4)
mf16 v[232:235], v[32:35], v[144:147], v[232:235]
ds_read_b64_tr_b16 v[24:25], v19 offset:12288
mf16 v[248:251], v[32:35], v[148:151], v[248:251]
ds_read_b64_tr_b16 v[26:27], v19 offset:12800
buffer_load_dwordx4 v6, s[20:23], s45 offen offset:3072 lds
mf16 v[236:239], v[36:39], v[144:147], v[236:239]
ds_read_b64_tr_b16 v[28:29], v20 offset:12288
mf16 v[252:255], v[36:39], v[148:151], v[252:255]
ds_read_b64_tr_b16 v[30:31], v20 offset:12800
s_waitcnt lgkmcnt(4)
mf16 v[192:195], v[40:43], v[152:155], v[192:195]
ds_read_b64_tr_b16 v[32:33], v17 offset:28672
mf16 v[208:211], v[40:43], v[156:159], v[208:211]
ds_read_b64_tr_b16 v[34:35], v17 offset:29184
s_mov_b64 exec, 0xffff
buffer_load_dword v56, v23, s[4:7], s13 offen
s_mov_b64 exec, -1
mf16 v[196:199], v[44:47], v[152:155], v[196:199]
ds_read_b64_tr_b16 v[36:37], v18 offset:28672
mf16 v[212:215], v[44:47], v[156:159], v[212:215]
ds_read_b64_tr_b16 v[38:39], v18 offset:29184
s_waitcnt lgkmcnt(4)
mf16 v[200:203], v[24:27], v[152:155], v[200:203]
ds_read_b64_tr_b16 v[40:41], v19 offset:28672
mf16 v[216:219], v[24:27], v[156:159], v[216:219]
ds_read_b64_tr_b16 v[42:43], v19 offset:29184
s_mov_b64 exec, 0xffff
buffer_load_dword v57, v23, s[32:35], s17 offen
s_mov_b64 exec, -1
mf16 v[204:207], v[28:31], v[152:155], v[204:207]
ds_read_b64_tr_b16 v[44:45], v20 offset:28672
mf16 v[220:223], v[28:31], v[156:159], v[220:223]
ds_read_b64_tr_b16 v[46:47], v20 offset:29184
s_waitcnt lgkmcnt(4)
mf16 v[224:227], v[32:35], v[152:155], v[224:227]
s_barrier
ds_read_b128 v[160:163], v7 offset:0
ds_read_b128 v[164:167], v8 offset:1024
ds_read_b128 v[168:171], v8 offset:0
ds_read_b128 v[172:175], v7 offset:1024
ds_read_b64_tr_b16 v[24:25], v13 offset:0
mf16 v[240:243], v[32:35], v[156:159], v[240:243]
ds_read_b64_tr_b16 v[26:27], v13 offset:512
s_add_u32 m0, s47, 0x18000
s_add_u32 s45, s48, 0x100
buffer_load_dwordx4 v1, s[24:27], s45 offen offset:0 lds
mf16 v[228:231], v[36:39], v[152:155], v[228:231]
ds_read_b64_tr_b16 v[28:29], v14 offset:0
mf16 v[244:247], v[36:39], v[156:159], v[244:247]
ds_read_b64_tr_b16 v[30:31], v14 offset:512
s_waitcnt lgkmcnt(8)
mf16 v[232:235], v[40:43], v[152:155], v[232:235]
ds_read_b64_tr_b16 v[32:33], v15 offset:0
mf16 v[248:251], v[40:43], v[156:159], v[248:251]
ds_read_b64_tr_b16 v[34:35], v15 offset:512
buffer_load_dwordx4 v2, s[24:27], s45 offen offset:1024 lds
mf16 v[236:239], v[44:47], v[152:155], v[236:239]
ds_read_b64_tr_b16 v[36:37], v16 offset:0
mf16 v[252:255], v[44:47], v[156:159], v[252:255]
ds_read_b64_tr_b16 v[38:39], v16 offset:512
s_waitcnt lgkmcnt(4)
mf16 v[192:195], v[24:27], v[160:163], v[192:195]
ds_read_b64_tr_b16 v[40:41], v13 offset:16384
mf16 v[208:211], v[24:27], v[164:167], v[208:211]
ds_read_b64_tr_b16 v[42:43], v13 offset:16896
s_add_u32 m0, s47, 0x1c000
s_add_u32 s45, s48, 0x100100
buffer_load_dwordx4 v1, s[24:27], s45 offen offset:0 lds
mf16 v[196:199], v[28:31], v[160:163], v[196:199]
ds_read_b64_tr_b16 v[44:45], v14 offset:16384
mf16 v[212:215], v[28:31], v[164:167], v[212:215]
ds_read_b64_tr_b16 v[46:47], v14 offset:16896
s_waitcnt lgkmcnt(4)
mf16 v[200:203], v[32:35], v[160:163], v[200:203]
ds_read_b64_tr_b16 v[24:25], v15 offset:16384
mf16 v[216:219], v[32:35], v[164:167], v[216:219]
ds_read_b64_tr_b16 v[26:27], v15 offset:16896
buffer_load_dwordx4 v2, s[24:27], s45 offen offset:1024 lds
mf16 v[204:207], v[36:39], v[160:163], v[204:207]
ds_read_b64_tr_b16 v[28:29], v16 offset:16384
mf16 v[220:223], v[36:39], v[164:167], v[220:223]
ds_read_b64_tr_b16 v[30:31], v16 offset:16896
s_waitcnt lgkmcnt(4)
mf16 v[224:227], v[40:43], v[160:163], v[224:227]
ds_read_b64_tr_b16 v[32:33], v13 offset:4096
mf16 v[240:243], v[40:43], v[164:167], v[240:243]
ds_read_b64_tr_b16 v[34:35], v13 offset:4608
mf16 v[228:231], v[44:47], v[160:163], v[228:231]
ds_read_b64_tr_b16 v[36:37], v14 offset:4096
mf16 v[244:247], v[44:47], v[164:167], v[244:247]
ds_read_b64_tr_b16 v[38:39], v14 offset:4608
s_waitcnt lgkmcnt(4)
mf16 v[232:235], v[24:27], v[160:163], v[232:235]
ds_read_b64_tr_b16 v[40:41], v15 offset:4096
mf16 v[248:251], v[24:27], v[164:167], v[248:251]
ds_read_b64_tr_b16 v[42:43], v15 offset:4608
mf16 v[236:239], v[28:31], v[160:163], v[236:239]
ds_read_b64_tr_b16 v[44:45], v16 offset:4096
mf16 v[252:255], v[28:31], v[164:167], v[252:255]
ds_read_b64_tr_b16 v[46:47], v16 offset:4608
s_waitcnt lgkmcnt(4)
mf16 v[192:195], v[32:35], v[168:171], v[192:195]
ds_read_b64_tr_b16 v[24:25], v13 offset:20480
mf16 v[208:211], v[32:35], v[172:175], v[208:211]
ds_read_b64_tr_b16 v[26:27], v13 offset:20992
mf16 v[196:199], v[36:39], v[168:171], v[196:199]
ds_read_b64_tr_b16 v[28:29], v14 offset:20480
mf16 v[212:215], v[36:39], v[172:175], v[212:215]
ds_read_b64_tr_b16 v[30:31], v14 offset:20992
s_waitcnt lgkmcnt(4)
mf16 v[200:203], v[40:43], v[168:171], v[200:203]
ds_read_b64_tr_b16 v[32:33], v15 offset:20480
mf16 v[216:219], v[40:43], v[172:175], v[216:219]
ds_read_b64_tr_b16 v[34:35], v15 offset:20992
mf16 v[204:207], v[44:47], v[168:171], v[204:207]
ds_read_b64_tr_b16 v[36:37], v16 offset:20480
mf16 v[220:223], v[44:47], v[172:175], v[220:223]
ds_read_b64_tr_b16 v[38:39], v16 offset:20992
s_waitcnt lgkmcnt(4)
mf16 v[224:227], v[24:27], v[168:171], v[224:227]
s_waitcnt vmcnt(6)
ds_read_b128 v[176:179], v7 offset:4096
ds_read_b128 v[180:183], v8 offset:5120
ds_read_b128 v[184:187], v8 offset:4096
ds_read_b128 v[188:191], v7 offset:5120
ds_read_b64_tr_b16 v[40:41], v13 offset:8192
mf16 v[240:243], v[24:27], v[172:175], v[240:243]
ds_read_b64_tr_b16 v[42:43], v13 offset:8704
mf16 v[228:231], v[28:31], v[168:171], v[228:231]
ds_read_b64_tr_b16 v[24:25], v14 offset:8192
mf16 v[244:247], v[28:31], v[172:175], v[244:247]
ds_read_b64_tr_b16 v[26:27], v14 offset:8704
s_waitcnt lgkmcnt(8)
mf16 v[232:235], v[32:35], v[168:171], v[232:235]
ds_read_b64_tr_b16 v[28:29], v15 offset:8192
mf16 v[248:251], v[32:35], v[172:175], v[248:251]
ds_read_b64_tr_b16 v[30:31], v15 offset:8704
mf16 v[236:239], v[36:39], v[168:171], v[236:239]
ds_read_b64_tr_b16 v[32:33], v16 offset:8192
mf16 v[252:255], v[36:39], v[172:175], v[252:255]
ds_read_b64_tr_b16 v[34:35], v16 offset:8704
s_waitcnt lgkmcnt(4)
mf16 v[192:195], v[40:43], v[176:179], v[192:195]
ds_read_b64_tr_b16 v[36:37], v13 offset:24576
mf16 v[208:211], v[40:43], v[180:183], v[208:211]
ds_read_b64_tr_b16 v[38:39], v13 offset:25088
mf16 v[196:199], v[24:27], v[176:179], v[196:199]
ds_read_b64_tr_b16 v[40:41], v14 offset:24576
mf16 v[212:215], v[24:27], v[180:183], v[212:215]
ds_read_b64_tr_b16 v[42:43], v14 offset:25088
s_waitcnt lgkmcnt(4)
mf16 v[200:203], v[28:31], v[176:179], v[200:203]
ds_read_b64_tr_b16 v[24:25], v15 offset:24576
mf16 v[216:219], v[28:31], v[180:183], v[216:219]
ds_read_b64_tr_b16 v[26:27], v15 offset:25088
mf16 v[204:207], v[32:35], v[176:179], v[204:207]
ds_read_b64_tr_b16 v[28:29], v16 offset:24576
mf16 v[220:223], v[32:35], v[180:183], v[220:223]
ds_read_b64_tr_b16 v[30:31], v16 offset:25088
s_waitcnt lgkmcnt(4)
mf16 v[224:227], v[36:39], v[176:179], v[224:227]
ds_read_b64_tr_b16 v[32:33], v13 offset:12288
mf16 v[240:243], v[36:39], v[180:183], v[240:243]
ds_read_b64_tr_b16 v[34:35], v13 offset:12800
mf16 v[228:231], v[40:43], v[176:179], v[228:231]
ds_read_b64_tr_b16 v[36:37], v14 offset:12288
mf16 v[244:247], v[40:43], v[180:183], v[244:247]
ds_read_b64_tr_b16 v[38:39], v14 offset:12800
s_waitcnt lgkmcnt(4)
mf16 v[232:235], v[24:27], v[176:179], v[232:235]
ds_read_b64_tr_b16 v[40:41], v15 offset:12288
mf16 v[248:251], v[24:27], v[180:183], v[248:251]
ds_read_b64_tr_b16 v[42:43], v15 offset:12800
mf16 v[236:239], v[28:31], v[176:179], v[236:239]
ds_read_b64_tr_b16 v[24:25], v16 offset:12288
mf16 v[252:255], v[28:31], v[180:183], v[252:255]
ds_read_b64_tr_b16 v[26:27], v16 offset:12800
s_waitcnt lgkmcnt(4)
mf16 v[192:195], v[32:35], v[184:187], v[192:195]
ds_read_b64_tr_b16 v[28:29], v13 offset:28672
mf16 v[208:211], v[32:35], v[188:191], v[208:211]
ds_read_b64_tr_b16 v[30:31], v13 offset:29184
mf16 v[196:199], v[36:39], v[184:187], v[196:199]
ds_read_b64_tr_b16 v[32:33], v14 offset:28672
mf16 v[212:215], v[36:39], v[188:191], v[212:215]
ds_read_b64_tr_b16 v[34:35], v14 offset:29184
s_waitcnt lgkmcnt(4)
mf16 v[200:203], v[40:43], v[184:187], v[200:203]
ds_read_b64_tr_b16 v[36:37], v15 offset:28672
mf16 v[216:219], v[40:43], v[188:191], v[216:219]
ds_read_b64_tr_b16 v[38:39], v15 offset:29184
mf16 v[204:207], v[24:27], v[184:187], v[204:207]
ds_read_b64_tr_b16 v[40:41], v16 offset:28672
mf16 v[220:223], v[24:27], v[188:191], v[220:223]
ds_read_b64_tr_b16 v[42:43], v16 offset:29184
s_waitcnt lgkmcnt(4)
mf16 v[224:227], v[28:31], v[184:187], v[224:227]
s_waitcnt vmcnt(0)
s_barrier
ds_read_b64_tr_b16 v[24:25], v13 offset:32768
mf16 v[240:243], v[28:31], v[188:191], v[240:243]
ds_read_b64_tr_b16 v[26:27], v13 offset:33280
s_add_u32 m0, s47, 0x20000
s_add_u32 s45, s48, 0x200100
buffer_load_dwordx4 v1, s[24:27], s45 offen offset:0 lds
mf16 v[228:231], v[32:35], v[184:187], v[228:231]
ds_read_b64_tr_b16 v[28:29], v14 offset:32768
mf16 v[244:247], v[32:35], v[188:191], v[244:247]
ds_read_b64_tr_b16 v[30:31], v14 offset:33280
s_waitcnt lgkmcnt(4)
mf16 v[232:235], v[36:39], v[184:187], v[232:235]
ds_read_b64_tr_b16 v[32:33], v15 offset:32768
mf16 v[248:251], v[36:39], v[188:191], v[248:251]
ds_read_b64_tr_b16 v[34:35], v15 offset:33280
buffer_load_dwordx4 v2, s[24:27], s45 offen offset:1024 lds
mf16 v[236:239], v[40:43], v[184:187], v[236:239]
ds_read_b64_tr_b16 v[36:37], v16 offset:32768
mf16 v[252:255], v[40:43], v[188:191], v[252:255]
ds_read_b64_tr_b16 v[38:39], v16 offset:33280
s_add_u32 m0, s47, 0x24000
s_add_u32 s45, s48, 0x300100
buffer_load_dwordx4 v1, s[24:27], s45 offen offset:0 lds
buffer_load_dwordx4 v2, s[24:27], s45 offen offset:1024 lds
s_add_u32 m0, s47, 0x0
s_add_u32 s45, s48, 0x180
buffer_load_dwordx4 v1, s[24:27], s45 offen offset:0 lds
buffer_load_dwordx4 v2, s[24:27], s45 offen offset:1024 lds
s_add_u32 m0, s47, 0x4000
s_add_u32 s45, s48, 0x100180
buffer_load_dwordx4 v1, s[24:27], s45 offen offset:0 lds
buffer_load_dwordx4 v2, s[24:27], s45 offen offset:1024 lds
s_and_b32 s12, s16, 3
s_lshl_b32 s12, s12, 19
v_lshlrev_b32 v23, 13, v0
v_add_u32 v23, s12, v23
s_nop 2
s_add_u32 s54, s50, 0
v_mul_f32 v192, s52, v192
v_mul_f32 v193, s52, v193
cvtpk v56, v192, v193
v_mul_f32 v194, s52, v194
v_mul_f32 v195, s52, v195
cvtpk v57, v194, v195
v_mul_f32 v196, s52, v196
v_mul_f32 v197, s52, v197
cvtpk v58, v196, v197
v_mul_f32 v198, s52, v198
v_mul_f32 v199, s52, v199
cvtpk v59, v198, v199
buffer_store_dwordx4 v[56:59], v21, s[28:31], s54 offen offset:0 sc1
v_mul_f32 v200, s52, v200
v_mul_f32 v201, s52, v201
cvtpk v60, v200, v201
v_mul_f32 v202, s52, v202
v_mul_f32 v203, s52, v203
cvtpk v61, v202, v203
v_mul_f32 v204, s52, v204
v_mul_f32 v205, s52, v205
cvtpk v62, v204, v205
v_mul_f32 v206, s52, v206
v_mul_f32 v207, s52, v207
cvtpk v63, v206, v207
buffer_store_dwordx4 v[60:63], v21, s[28:31], s54 offen offset:2048 sc1
v_mul_f32 v208, s52, v208
v_mul_f32 v209, s52, v209
cvtpk v56, v208, v209
v_mul_f32 v210, s52, v210
v_mul_f32 v211, s52, v211
cvtpk v57, v210, v211
v_mul_f32 v212, s52, v212
v_mul_f32 v213, s52, v213
cvtpk v58, v212, v213
v_mul_f32 v214, s52, v214
v_mul_f32 v215, s52, v215
cvtpk v59, v214, v215
buffer_store_dwordx4 v[56:59], v21, s[28:31], s54 offen offset:128 sc1
v_mul_f32 v216, s52, v216
v_mul_f32 v217, s52, v217
cvtpk v60, v216, v217
v_mul_f32 v218, s52, v218
v_mul_f32 v219, s52, v219
cvtpk v61, v218, v219
v_mul_f32 v220, s52, v220
v_mul_f32 v221, s52, v221
cvtpk v62, v220, v221
v_mul_f32 v222, s52, v222
v_mul_f32 v223, s52, v223
cvtpk v63, v222, v223
buffer_store_dwordx4 v[60:63], v21, s[28:31], s54 offen offset:2176 sc1
s_mov_b32 s8, s90
s_mov_b32 s9, s91
s_mov_b32 s10, 0x400000
s_mov_b32 s11, 0x20000
s_lshl_b32 s12, s2, 14
s_lshl_b32 s13, s16, 7
s_add_u32 s12, s12, s13
s_add_u32 s13, s12, 7168
s_add_u32 s17, s47, 65536
s_mov_b32 m0, s17
v_lshrrev_b32 v3, 3, v0
v_lshlrev_b32 v3, 10, v3
v_and_b32 v4, 7, v0
v_lshl_add_u32 v3, v4, 4, v3
buffer_load_dwordx4 v3, s[8:11], s12 offen nt lds
buffer_load_dwordx4 v3, s[8:11], s13 offen offset:1024 nt lds
v_lshrrev_b32 v4, 5, v0
v_bfe_u32 v5, v0, 2, 2
v_lshl_add_u32 v4, v4, 2, v5
v_lshlrev_b32 v4, 7, v4
v_bfe_u32 v5, v0, 4, 1
v_lshl_add_u32 v4, v5, 5, v4
v_and_b32 v5, 3, v0
v_lshl_add_u32 v4, v5, 3, v4
v_add_u32 v4, s17, v4
v_lshlrev_b32 v5, 4, v0
s_lshl_b32 s17, s16, 19
s_lshl_b32 s13, s2, 11
s_add_u32 s17, s17, s13
s_add_u32 s48, s48, 256
s_add_u32 s50, s50, s92
s_mov_b32 s44, 0
l1_kernel_A_loop:
s_waitcnt lgkmcnt(4)
mf16 v[192:195], v[24:27], v[64:67], 0
ds_read_b64_tr_b16 v[40:41], v13 offset:36864
mf16 v[208:211], v[24:27], v[68:71], 0
ds_read_b64_tr_b16 v[42:43], v13 offset:37376
mf16 v[196:199], v[28:31], v[64:67], 0
ds_read_b64_tr_b16 v[44:45], v14 offset:36864
mf16 v[212:215], v[28:31], v[68:71], 0
ds_read_b64_tr_b16 v[46:47], v14 offset:37376
s_waitcnt lgkmcnt(4)
mf16 v[200:203], v[32:35], v[64:67], 0
ds_read_b64_tr_b16 v[24:25], v15 offset:36864
mf16 v[216:219], v[32:35], v[68:71], 0
ds_read_b64_tr_b16 v[26:27], v15 offset:37376
mf16 v[204:207], v[36:39], v[64:67], 0
ds_read_b64_tr_b16 v[28:29], v16 offset:36864
mf16 v[220:223], v[36:39], v[68:71], 0
ds_read_b64_tr_b16 v[30:31], v16 offset:37376
s_waitcnt lgkmcnt(4)
mf16 v[192:195], v[40:43], v[72:75], v[192:195]
ds_read_b64_tr_b16 v[32:33], v13 offset:40960
s_add_u32 s55, s50, 4096
s_sub_u32 s55, s55, s92
mf16 v[208:211], v[40:43], v[76:79], v[208:211]
ds_read_b64_tr_b16 v[34:35], v13 offset:41472
v_mul_f32 v224, s52, v224
mf16 v[196:199], v[44:47], v[72:75], v[196:199]
ds_read_b64_tr_b16 v[36:37], v14 offset:40960
v_mul_f32 v225, s52, v225
mf16 v[212:215], v[44:47], v[76:79], v[212:215]
ds_read_b64_tr_b16 v[38:39], v14 offset:41472
s_waitcnt lgkmcnt(4)
mf16 v[200:203], v[24:27], v[72:75], v[200:203]
ds_read_b64_tr_b16 v[40:41], v15 offset:40960
cvtpk v56, v224, v225
mf16 v[216:219], v[24:27], v[76:79], v[216:219]
ds_read_b64_tr_b16 v[42:43], v15 offset:41472
v_mul_f32 v226, s52, v226
mf16 v[204:207], v[28:31], v[72:75], v[204:207]
ds_read_b64_tr_b16 v[44:45], v16 offset:40960
v_mul_f32 v227, s52, v227
mf16 v[220:223], v[28:31], v[76:79], v[220:223]
ds_read_b64_tr_b16 v[46:47], v16 offset:41472
s_waitcnt lgkmcnt(4)
mf16 v[192:195], v[32:35], v[80:83], v[192:195]
ds_read_b64_tr_b16 v[24:25], v13 offset:45056
cvtpk v57, v226, v227
mf16 v[208:211], v[32:35], v[84:87], v[208:211]
ds_read_b64_tr_b16 v[26:27], v13 offset:45568
v_mul_f32 v228, s52, v228
mf16 v[196:199], v[36:39], v[80:83], v[196:199]
ds_read_b64_tr_b16 v[28:29], v14 offset:45056
v_mul_f32 v229, s52, v229
mf16 v[212:215], v[36:39], v[84:87], v[212:215]
ds_read_b64_tr_b16 v[30:31], v14 offset:45568
s_waitcnt lgkmcnt(4)
mf16 v[200:203], v[40:43], v[80:83], v[200:203]
ds_read_b64_tr_b16 v[32:33], v15 offset:45056
cvtpk v58, v228, v229
mf16 v[216:219], v[40:43], v[84:87], v[216:219]
ds_read_b64_tr_b16 v[34:35], v15 offset:45568
v_mul_f32 v230, s52, v230
mf16 v[204:207], v[44:47], v[80:83], v[204:207]
ds_read_b64_tr_b16 v[36:37], v16 offset:45056
v_mul_f32 v231, s52, v231
mf16 v[220:223], v[44:47], v[84:87], v[220:223]
ds_read_b64_tr_b16 v[38:39], v16 offset:45568
s_waitcnt lgkmcnt(4)
mf16 v[192:195], v[24:27], v[88:91], v[192:195]
ds_read_b64_tr_b16 v[40:41], v13 offset:49152
cvtpk v59, v230, v231
mf16 v[208:211], v[24:27], v[92:95], v[208:211]
ds_read_b64_tr_b16 v[42:43], v13 offset:49664
buffer_store_dwordx4 v[56:59], v21, s[28:31], s55 offen offset:0 sc1
mf16 v[196:199], v[28:31], v[88:91], v[196:199]
ds_read_b64_tr_b16 v[44:45], v14 offset:49152
v_mul_f32 v232, s52, v232
mf16 v[212:215], v[28:31], v[92:95], v[212:215]
ds_read_b64_tr_b16 v[46:47], v14 offset:49664
s_waitcnt lgkmcnt(4)
mf16 v[200:203], v[32:35], v[88:91], v[200:203]
ds_read_b64_tr_b16 v[24:25], v15 offset:49152
v_mul_f32 v233, s52, v233
mf16 v[216:219], v[32:35], v[92:95], v[216:219]
ds_read_b64_tr_b16 v[26:27], v15 offset:49664
cvtpk v60, v232, v233
mf16 v[204:207], v[36:39], v[88:91], v[204:207]
ds_read_b64_tr_b16 v[28:29], v16 offset:49152
v_mul_f32 v234, s52, v234
mf16 v[220:223], v[36:39], v[92:95], v[220:223]
ds_read_b64_tr_b16 v[30:31], v16 offset:49664
s_waitcnt lgkmcnt(4)
mf16 v[192:195], v[40:43], v[96:99], v[192:195]
ds_read_b64_tr_b16 v[32:33], v13 offset:53248
v_mul_f32 v235, s52, v235
mf16 v[208:211], v[40:43], v[100:103], v[208:211]
ds_read_b64_tr_b16 v[34:35], v13 offset:53760
cvtpk v61, v234, v235
mf16 v[196:199], v[44:47], v[96:99], v[196:199]
ds_read_b64_tr_b16 v[36:37], v14 offset:53248
v_mul_f32 v236, s52, v236
mf16 v[212:215], v[44:47], v[100:103], v[212:215]
ds_read_b64_tr_b16 v[38:39], v14 offset:53760
s_waitcnt lgkmcnt(4)
mf16 v[200:203], v[24:27], v[96:99], v[200:203]
ds_read_b64_tr_b16 v[40:41], v15 offset:53248
v_mul_f32 v237, s52, v237
mf16 v[216:219], v[24:27], v[100:103], v[216:219]
ds_read_b64_tr_b16 v[42:43], v15 offset:53760
cvtpk v62, v236, v237
mf16 v[204:207], v[28:31], v[96:99], v[204:207]
ds_read_b64_tr_b16 v[44:45], v16 offset:53248
v_mul_f32 v238, s52, v238
mf16 v[220:223], v[28:31], v[100:103], v[220:223]
ds_read_b64_tr_b16 v[46:47], v16 offset:53760
s_waitcnt lgkmcnt(4)
mf16 v[192:195], v[32:35], v[104:107], v[192:195]
ds_read_b64_tr_b16 v[24:25], v13 offset:57344
v_mul_f32 v239, s52, v239
mf16 v[208:211], v[32:35], v[108:111], v[208:211]
ds_read_b64_tr_b16 v[26:27], v13 offset:57856
cvtpk v63, v238, v239
mf16 v[196:199], v[36:39], v[104:107], v[196:199]
ds_read_b64_tr_b16 v[28:29], v14 offset:57344
buffer_store_dwordx4 v[60:63], v21, s[28:31], s55 offen offset:2048 sc1
mf16 v[212:215], v[36:39], v[108:111], v[212:215]
ds_read_b64_tr_b16 v[30:31], v14 offset:57856
s_waitcnt lgkmcnt(4)
mf16 v[200:203], v[40:43], v[104:107], v[200:203]
ds_read_b64_tr_b16 v[32:33], v15 offset:57344
v_mul_f32 v240, s52, v240
mf16 v[216:219], v[40:43], v[108:111], v[216:219]
ds_read_b64_tr_b16 v[34:35], v15 offset:57856
v_mul_f32 v241, s52, v241
mf16 v[204:207], v[44:47], v[104:107], v[204:207]
ds_read_b64_tr_b16 v[36:37], v16 offset:57344
cvtpk v56, v240, v241
mf16 v[220:223], v[44:47], v[108:111], v[220:223]
ds_read_b64_tr_b16 v[38:39], v16 offset:57856
s_waitcnt lgkmcnt(4)
mf16 v[192:195], v[24:27], v[112:115], v[192:195]
ds_read_b64_tr_b16 v[40:41], v13 offset:61440
v_mul_f32 v242, s52, v242
mf16 v[208:211], v[24:27], v[116:119], v[208:211]
ds_read_b64_tr_b16 v[42:43], v13 offset:61952
v_mul_f32 v243, s52, v243
mf16 v[196:199], v[28:31], v[112:115], v[196:199]
ds_read_b64_tr_b16 v[44:45], v14 offset:61440
cvtpk v57, v242, v243
mf16 v[212:215], v[28:31], v[116:119], v[212:215]
ds_read_b64_tr_b16 v[46:47], v14 offset:61952
s_waitcnt lgkmcnt(4)
mf16 v[200:203], v[32:35], v[112:115], v[200:203]
ds_read_b64_tr_b16 v[24:25], v15 offset:61440
v_mul_f32 v244, s52, v244
mf16 v[216:219], v[32:35], v[116:119], v[216:219]
ds_read_b64_tr_b16 v[26:27], v15 offset:61952
v_mul_f32 v245, s52, v245
mf16 v[204:207], v[36:39], v[112:115], v[204:207]
ds_read_b64_tr_b16 v[28:29], v16 offset:61440
cvtpk v58, v244, v245
mf16 v[220:223], v[36:39], v[116:119], v[220:223]
ds_read_b64_tr_b16 v[30:31], v16 offset:61952
s_waitcnt lgkmcnt(4)
mf16 v[192:195], v[40:43], v[120:123], v[192:195]
s_waitcnt vmcnt(7)
s_barrier
ds_read_b64_tr_b16 v[32:33], v17 offset:0
v_mul_f32 v246, s52, v246
mf16 v[208:211], v[40:43], v[124:127], v[208:211]
ds_read_b64_tr_b16 v[34:35], v17 offset:512
s_add_u32 m0, s47, 0x8000
s_add_u32 s45, s48, 0x200080
buffer_load_dwordx4 v1, s[24:27], s45 offen offset:0 lds
mf16 v[196:199], v[44:47], v[120:123], v[196:199]
ds_read_b64_tr_b16 v[36:37], v18 offset:0
v_mul_f32 v247, s52, v247
mf16 v[212:215], v[44:47], v[124:127], v[212:215]
ds_read_b64_tr_b16 v[38:39], v18 offset:512
s_waitcnt lgkmcnt(4)
mf16 v[200:203], v[24:27], v[120:123], v[200:203]
ds_read_b64_tr_b16 v[40:41], v19 offset:0
cvtpk v59, v246, v247
mf16 v[216:219], v[24:27], v[124:127], v[216:219]
ds_read_b64_tr_b16 v[42:43], v19 offset:512
buffer_load_dwordx4 v2, s[24:27], s45 offen offset:1024 lds
mf16 v[204:207], v[28:31], v[120:123], v[204:207]
ds_read_b64_tr_b16 v[44:45], v20 offset:0
buffer_store_dwordx4 v[56:59], v21, s[28:31], s55 offen offset:128 sc1
mf16 v[220:223], v[28:31], v[124:127], v[220:223]
ds_read_b64_tr_b16 v[46:47], v20 offset:512
s_waitcnt lgkmcnt(4)
mf16 v[192:195], v[32:35], v[128:131], v[192:195]
ds_read_b64_tr_b16 v[24:25], v17 offset:4096
v_mul_f32 v248, s52, v248
mf16 v[208:211], v[32:35], v[132:135], v[208:211]
ds_read_b64_tr_b16 v[26:27], v17 offset:4608
s_add_u32 m0, s47, 0xc000
s_add_u32 s45, s48, 0x300080
buffer_load_dwordx4 v1, s[24:27], s45 offen offset:0 lds
mf16 v[196:199], v[36:39], v[128:131], v[196:199]
ds_read_b64_tr_b16 v[28:29], v18 offset:4096
v_mul_f32 v249, s52, v249
mf16 v[212:215], v[36:39], v[132:135], v[212:215]
ds_read_b64_tr_b16 v[30:31], v18 offset:4608
s_waitcnt lgkmcnt(4)
mf16 v[200:203], v[40:43], v[128:131], v[200:203]
ds_read_b64_tr_b16 v[32:33], v19 offset:4096
cvtpk v60, v248, v249
mf16 v[216:219], v[40:43], v[132:135], v[216:219]
ds_read_b64_tr_b16 v[34:35], v19 offset:4608
buffer_load_dwordx4 v2, s[24:27], s45 offen offset:1024 lds
mf16 v[204:207], v[44:47], v[128:131], v[204:207]
ds_read_b64_tr_b16 v[36:37], v20 offset:4096
v_mul_f32 v250, s52, v250
mf16 v[220:223], v[44:47], v[132:135], v[220:223]
ds_read_b64_tr_b16 v[38:39], v20 offset:4608
s_waitcnt lgkmcnt(4)
mf16 v[192:195], v[24:27], v[136:139], v[192:195]
ds_read_b64_tr_b16 v[40:41], v17 offset:8192
v_mul_f32 v251, s52, v251
mf16 v[208:211], v[24:27], v[140:143], v[208:211]
ds_read_b64_tr_b16 v[42:43], v17 offset:8704
cvtpk v61, v250, v251
mf16 v[196:199], v[28:31], v[136:139], v[196:199]
ds_read_b64_tr_b16 v[44:45], v18 offset:8192
v_mul_f32 v252, s52, v252
mf16 v[212:215], v[28:31], v[140:143], v[212:215]
ds_read_b64_tr_b16 v[46:47], v18 offset:8704
s_waitcnt lgkmcnt(4)
mf16 v[200:203], v[32:35], v[136:139], v[200:203]
ds_read_b64_tr_b16 v[24:25], v19 offset:8192
v_mul_f32 v253, s52, v253
mf16 v[216:219], v[32:35], v[140:143], v[216:219]
ds_read_b64_tr_b16 v[26:27], v19 offset:8704
cvtpk v62, v252, v253
mf16 v[204:207], v[36:39], v[136:139], v[204:207]
ds_read_b64_tr_b16 v[28:29], v20 offset:8192
v_mul_f32 v254, s52, v254
mf16 v[220:223], v[36:39], v[140:143], v[220:223]
ds_read_b64_tr_b16 v[30:31], v20 offset:8704
s_waitcnt lgkmcnt(4)
mf16 v[192:195], v[40:43], v[144:147], v[192:195]
ds_read_b64_tr_b16 v[32:33], v17 offset:12288
v_mul_f32 v255, s52, v255
mf16 v[208:211], v[40:43], v[148:151], v[208:211]
ds_read_b64_tr_b16 v[34:35], v17 offset:12800
cvtpk v63, v254, v255
mf16 v[196:199], v[44:47], v[144:147], v[196:199]
ds_read_b64_tr_b16 v[36:37], v18 offset:12288
buffer_store_dwordx4 v[60:63], v21, s[28:31], s55 offen offset:2176 sc1
mf16 v[212:215], v[44:47], v[148:151], v[212:215]
ds_read_b64_tr_b16 v[38:39], v18 offset:12800
s_waitcnt lgkmcnt(4)
mf16 v[200:203], v[24:27], v[144:147], v[200:203]
ds_read_b64_tr_b16 v[40:41], v19 offset:12288
mf16 v[216:219], v[24:27], v[148:151], v[216:219]
ds_read_b64_tr_b16 v[42:43], v19 offset:12800
mf16 v[204:207], v[28:31], v[144:147], v[204:207]
ds_read_b64_tr_b16 v[44:45], v20 offset:12288
mf16 v[220:223], v[28:31], v[148:151], v[220:223]
ds_read_b64_tr_b16 v[46:47], v20 offset:12800
s_waitcnt lgkmcnt(4)
mf16 v[192:195], v[32:35], v[152:155], v[192:195]
ds_read_b64_tr_b16 v[24:25], v17 offset:16384
mf16 v[208:211], v[32:35], v[156:159], v[208:211]
ds_read_b64_tr_b16 v[26:27], v17 offset:16896
mf16 v[196:199], v[36:39], v[152:155], v[196:199]
ds_read_b64_tr_b16 v[28:29], v18 offset:16384
mf16 v[212:215], v[36:39], v[156:159], v[212:215]
ds_read_b64_tr_b16 v[30:31], v18 offset:16896
s_waitcnt lgkmcnt(4)
mf16 v[200:203], v[40:43], v[152:155], v[200:203]
ds_read_b64_tr_b16 v[32:33], v19 offset:16384
mf16 v[216:219], v[40:43], v[156:159], v[216:219]
ds_read_b64_tr_b16 v[34:35], v19 offset:16896
mf16 v[204:207], v[44:47], v[152:155], v[204:207]
ds_read_b64_tr_b16 v[36:37], v20 offset:16384
mf16 v[220:223], v[44:47], v[156:159], v[220:223]
ds_read_b64_tr_b16 v[38:39], v20 offset:16896
s_waitcnt lgkmcnt(4)
mf16 v[192:195], v[24:27], v[160:163], v[192:195]
ds_read_b64_tr_b16 v[40:41], v17 offset:20480
mf16 v[208:211], v[24:27], v[164:167], v[208:211]
ds_read_b64_tr_b16 v[42:43], v17 offset:20992
mf16 v[196:199], v[28:31], v[160:163], v[196:199]
ds_read_b64_tr_b16 v[44:45], v18 offset:20480
mf16 v[212:215], v[28:31], v[164:167], v[212:215]
ds_read_b64_tr_b16 v[46:47], v18 offset:20992
s_waitcnt lgkmcnt(4)
mf16 v[200:203], v[32:35], v[160:163], v[200:203]
ds_read_b64_tr_b16 v[24:25], v19 offset:20480
mf16 v[216:219], v[32:35], v[164:167], v[216:219]
ds_read_b64_tr_b16 v[26:27], v19 offset:20992
mf16 v[204:207], v[36:39], v[160:163], v[204:207]
ds_read_b64_tr_b16 v[28:29], v20 offset:20480
mf16 v[220:223], v[36:39], v[164:167], v[220:223]
ds_read_b64_tr_b16 v[30:31], v20 offset:20992
s_waitcnt lgkmcnt(4)
mf16 v[192:195], v[40:43], v[168:171], v[192:195]
ds_read_b64_tr_b16 v[32:33], v17 offset:24576
mf16 v[208:211], v[40:43], v[172:175], v[208:211]
ds_read_b64_tr_b16 v[34:35], v17 offset:25088
buffer_store_dwordx4 v[48:51], v23, s[60:63], s66 offen
mf16 v[196:199], v[44:47], v[168:171], v[196:199]
ds_read_b64_tr_b16 v[36:37], v18 offset:24576
mf16 v[212:215], v[44:47], v[172:175], v[212:215]
ds_read_b64_tr_b16 v[38:39], v18 offset:25088
s_waitcnt lgkmcnt(4)
mf16 v[200:203], v[24:27], v[168:171], v[200:203]
ds_read_b64_tr_b16 v[40:41], v19 offset:24576
mf16 v[216:219], v[24:27], v[172:175], v[216:219]
ds_read_b64_tr_b16 v[42:43], v19 offset:25088
mf16 v[204:207], v[28:31], v[168:171], v[204:207]
ds_read_b64_tr_b16 v[44:45], v20 offset:24576
mf16 v[220:223], v[28:31], v[172:175], v[220:223]
ds_read_b64_tr_b16 v[46:47], v20 offset:25088
s_waitcnt lgkmcnt(4)
mf16 v[192:195], v[32:35], v[176:179], v[192:195]
ds_read_b64_tr_b16 v[24:25], v17 offset:28672
mf16 v[208:211], v[32:35], v[180:183], v[208:211]
ds_read_b64_tr_b16 v[26:27], v17 offset:29184
mf16 v[196:199], v[36:39], v[176:179], v[196:199]
ds_read_b64_tr_b16 v[28:29], v18 offset:28672
mf16 v[212:215], v[36:39], v[180:183], v[212:215]
ds_read_b64_tr_b16 v[30:31], v18 offset:29184
s_waitcnt lgkmcnt(4)
mf16 v[200:203], v[40:43], v[176:179], v[200:203]
ds_read_b64_tr_b16 v[32:33], v19 offset:28672
mf16 v[216:219], v[40:43], v[180:183], v[216:219]
ds_read_b64_tr_b16 v[34:35], v19 offset:29184
mf16 v[204:207], v[44:47], v[176:179], v[204:207]
ds_read_b64_tr_b16 v[36:37], v20 offset:28672
mf16 v[220:223], v[44:47], v[180:183], v[220:223]
ds_read_b64_tr_b16 v[38:39], v20 offset:29184
s_waitcnt lgkmcnt(4)
mf16 v[192:195], v[24:27], v[184:187], v[192:195]
s_waitcnt vmcnt(9)
s_barrier
ds_read_b64_tr_b16 v[40:41], v9 offset:0
mf16 v[208:211], v[24:27], v[188:191], v[208:211]
ds_read_b64_tr_b16 v[42:43], v9 offset:512
s_add_u32 m0, s47, 0x18000
s_add_u32 s45, s53, 0x0
buffer_load_dwordx4 v1, s[32:35], s45 offen offset:0 lds
mf16 v[196:199], v[28:31], v[184:187], v[196:199]
ds_read_b64_tr_b16 v[44:45], v10 offset:0
mf16 v[212:215], v[28:31], v[188:191], v[212:215]
ds_read_b64_tr_b16 v[46:47], v10 offset:512
s_waitcnt lgkmcnt(4)
mf16 v[200:203], v[32:35], v[184:187], v[200:203]
ds_read_b64_tr_b16 v[24:25], v11 offset:0
mf16 v[216:219], v[32:35], v[188:191], v[216:219]
ds_read_b64_tr_b16 v[26:27], v11 offset:512
buffer_load_dwordx4 v2, s[32:35], s45 offen offset:1024 lds
mf16 v[204:207], v[36:39], v[184:187], v[204:207]
ds_read_b64_tr_b16 v[28:29], v12 offset:0
mf16 v[220:223], v[36:39], v[188:191], v[220:223]
ds_read_b64_tr_b16 v[30:31], v12 offset:512
s_waitcnt lgkmcnt(4)
mf16 v[224:227], v[40:43], v[64:67], 0
ds_read_b64_tr_b16 v[32:33], v9 offset:4096
mf16 v[240:243], v[40:43], v[68:71], 0
ds_read_b64_tr_b16 v[34:35], v9 offset:4608
s_add_u32 m0, s47, 0x1c000
s_add_u32 s45, s53, 0x100000
buffer_load_dwordx4 v1, s[32:35], s45 offen offset:0 lds
mf16 v[228:231], v[44:47], v[64:67], 0
ds_read_b64_tr_b16 v[36:37], v10 offset:4096
mf16 v[244:247], v[44:47], v[68:71], 0
ds_read_b64_tr_b16 v[38:39], v10 offset:4608
s_waitcnt lgkmcnt(4)
mf16 v[232:235], v[24:27], v[64:67], 0
ds_read_b64_tr_b16 v[40:41], v11 offset:4096
mf16 v[248:251], v[24:27], v[68:71], 0
ds_read_b64_tr_b16 v[42:43], v11 offset:4608
buffer_load_dwordx4 v2, s[32:35], s45 offen offset:1024 lds
mf16 v[236:239], v[28:31], v[64:67], 0
ds_read_b64_tr_b16 v[44:45], v12 offset:4096
mf16 v[252:255], v[28:31], v[68:71], 0
ds_read_b64_tr_b16 v[46:47], v12 offset:4608
s_waitcnt lgkmcnt(4)
mf16 v[224:227], v[32:35], v[72:75], v[224:227]
ds_read_b64_tr_b16 v[24:25], v9 offset:8192
s_add_u32 s54, s50, 0
mf16 v[240:243], v[32:35], v[76:79], v[240:243]
ds_read_b64_tr_b16 v[26:27], v9 offset:8704
v_mul_f32 v192, s52, v192
mf16 v[228:231], v[36:39], v[72:75], v[228:231]
ds_read_b64_tr_b16 v[28:29], v10 offset:8192
v_mul_f32 v193, s52, v193
mf16 v[244:247], v[36:39], v[76:79], v[244:247]
ds_read_b64_tr_b16 v[30:31], v10 offset:8704
s_waitcnt lgkmcnt(4)
mf16 v[232:235], v[40:43], v[72:75], v[232:235]
ds_read_b64_tr_b16 v[32:33], v11 offset:8192
cvtpk v56, v192, v193
mf16 v[248:251], v[40:43], v[76:79], v[248:251]
ds_read_b64_tr_b16 v[34:35], v11 offset:8704
v_mul_f32 v194, s52, v194
mf16 v[236:239], v[44:47], v[72:75], v[236:239]
ds_read_b64_tr_b16 v[36:37], v12 offset:8192
v_mul_f32 v195, s52, v195
mf16 v[252:255], v[44:47], v[76:79], v[252:255]
ds_read_b64_tr_b16 v[38:39], v12 offset:8704
s_waitcnt lgkmcnt(4)
mf16 v[224:227], v[24:27], v[80:83], v[224:227]
ds_read_b64_tr_b16 v[40:41], v9 offset:12288
cvtpk v57, v194, v195
mf16 v[240:243], v[24:27], v[84:87], v[240:243]
ds_read_b64_tr_b16 v[42:43], v9 offset:12800
v_mul_f32 v196, s52, v196
mf16 v[228:231], v[28:31], v[80:83], v[228:231]
ds_read_b64_tr_b16 v[44:45], v10 offset:12288
v_mul_f32 v197, s52, v197
mf16 v[244:247], v[28:31], v[84:87], v[244:247]
ds_read_b64_tr_b16 v[46:47], v10 offset:12800
s_waitcnt lgkmcnt(4)
mf16 v[232:235], v[32:35], v[80:83], v[232:235]
ds_read_b64_tr_b16 v[24:25], v11 offset:12288
cvtpk v58, v196, v197
mf16 v[248:251], v[32:35], v[84:87], v[248:251]
ds_read_b64_tr_b16 v[26:27], v11 offset:12800
v_mul_f32 v198, s52, v198
mf16 v[236:239], v[36:39], v[80:83], v[236:239]
ds_read_b64_tr_b16 v[28:29], v12 offset:12288
v_mul_f32 v199, s52, v199
mf16 v[252:255], v[36:39], v[84:87], v[252:255]
ds_read_b64_tr_b16 v[30:31], v12 offset:12800
s_waitcnt lgkmcnt(4)
mf16 v[224:227], v[40:43], v[88:91], v[224:227]
ds_read_b64_tr_b16 v[32:33], v9 offset:16384
cvtpk v59, v198, v199
mf16 v[240:243], v[40:43], v[92:95], v[240:243]
ds_read_b64_tr_b16 v[34:35], v9 offset:16896
buffer_store_dwordx4 v[56:59], v21, s[28:31], s54 offen offset:0 sc1
mf16 v[228:231], v[44:47], v[88:91], v[228:231]
ds_read_b64_tr_b16 v[36:37], v10 offset:16384
v_mul_f32 v200, s52, v200
mf16 v[244:247], v[44:47], v[92:95], v[244:247]
ds_read_b64_tr_b16 v[38:39], v10 offset:16896
s_waitcnt lgkmcnt(4)
mf16 v[232:235], v[24:27], v[88:91], v[232:235]
ds_read_b64_tr_b16 v[40:41], v11 offset:16384
v_mul_f32 v201, s52, v201
mf16 v[248:251], v[24:27], v[92:95], v[248:251]
ds_read_b64_tr_b16 v[42:43], v11 offset:16896
cvtpk v60, v200, v201
mf16 v[236:239], v[28:31], v[88:91], v[236:239]
ds_read_b64_tr_b16 v[44:45], v12 offset:16384
v_mul_f32 v202, s52, v202
mf16 v[252:255], v[28:31], v[92:95], v[252:255]
ds_read_b64_tr_b16 v[46:47], v12 offset:16896
s_waitcnt lgkmcnt(4)
mf16 v[224:227], v[32:35], v[96:99], v[224:227]
ds_read_b64_tr_b16 v[24:25], v9 offset:20480
v_mul_f32 v203, s52, v203
mf16 v[240:243], v[32:35], v[100:103], v[240:243]
ds_read_b64_tr_b16 v[26:27], v9 offset:20992
cvtpk v61, v202, v203
s_getpc_b64 s[8:9]
s_add_u32 s8, s8, cs_attn_kernel@rel32@lo+4
s_addc_u32 s9, s9, cs_attn_kernel@rel32@hi+12
s_mov_b32 s10, attn_kernel_end - attn_kernel
s_mov_b32 s11, 0x20000
s_lshr_b32 s12, s2, 3
s_lshl_b32 s12, s12, 3
s_add_u32 s12, s12, s16
s_lshl_b32 s12, s12, 9
v_lshlrev_b32 v7, 7, v0
s_mov_b64 exec, 15
buffer_load_dword v8, v7, s[8:11], s12 offen
s_mov_b64 exec, -1
mf16 v[228:231], v[36:39], v[96:99], v[228:231]
ds_read_b64_tr_b16 v[28:29], v10 offset:20480
v_mul_f32 v204, s52, v204
mf16 v[244:247], v[36:39], v[100:103], v[244:247]
ds_read_b64_tr_b16 v[30:31], v10 offset:20992
s_waitcnt lgkmcnt(4)
mf16 v[232:235], v[40:43], v[96:99], v[232:235]
ds_read_b64_tr_b16 v[32:33], v11 offset:20480
v_mul_f32 v205, s52, v205
mf16 v[248:251], v[40:43], v[100:103], v[248:251]
ds_read_b64_tr_b16 v[34:35], v11 offset:20992
cvtpk v62, v204, v205
mf16 v[236:239], v[44:47], v[96:99], v[236:239]
ds_read_b64_tr_b16 v[36:37], v12 offset:20480
v_mul_f32 v206, s52, v206
mf16 v[252:255], v[44:47], v[100:103], v[252:255]
ds_read_b64_tr_b16 v[38:39], v12 offset:20992
s_waitcnt lgkmcnt(4)
mf16 v[224:227], v[24:27], v[104:107], v[224:227]
ds_read_b64_tr_b16 v[40:41], v9 offset:24576
v_mul_f32 v207, s52, v207
mf16 v[240:243], v[24:27], v[108:111], v[240:243]
ds_read_b64_tr_b16 v[42:43], v9 offset:25088
cvtpk v63, v206, v207
mf16 v[228:231], v[28:31], v[104:107], v[228:231]
ds_read_b64_tr_b16 v[44:45], v10 offset:24576
buffer_store_dwordx4 v[60:63], v21, s[28:31], s54 offen offset:2048 sc1
mf16 v[244:247], v[28:31], v[108:111], v[244:247]
ds_read_b64_tr_b16 v[46:47], v10 offset:25088
s_waitcnt lgkmcnt(4)
mf16 v[232:235], v[32:35], v[104:107], v[232:235]
ds_read_b64_tr_b16 v[24:25], v11 offset:24576
v_mul_f32 v208, s52, v208
mf16 v[248:251], v[32:35], v[108:111], v[248:251]
ds_read_b64_tr_b16 v[26:27], v11 offset:25088
v_mul_f32 v209, s52, v209
mf16 v[236:239], v[36:39], v[104:107], v[236:239]
ds_read_b64_tr_b16 v[28:29], v12 offset:24576
cvtpk v56, v208, v209
mf16 v[252:255], v[36:39], v[108:111], v[252:255]
ds_read_b64_tr_b16 v[30:31], v12 offset:25088
s_waitcnt lgkmcnt(4)
mf16 v[224:227], v[40:43], v[112:115], v[224:227]
ds_read_b64_tr_b16 v[32:33], v9 offset:28672
v_mul_f32 v210, s52, v210
mf16 v[240:243], v[40:43], v[116:119], v[240:243]
ds_read_b64_tr_b16 v[34:35], v9 offset:29184
v_mul_f32 v211, s52, v211
mf16 v[228:231], v[44:47], v[112:115], v[228:231]
ds_read_b64_tr_b16 v[36:37], v10 offset:28672
cvtpk v57, v210, v211
mf16 v[244:247], v[44:47], v[116:119], v[244:247]
ds_read_b64_tr_b16 v[38:39], v10 offset:29184
s_waitcnt lgkmcnt(4)
mf16 v[232:235], v[24:27], v[112:115], v[232:235]
ds_read_b64_tr_b16 v[40:41], v11 offset:28672
v_mul_f32 v212, s52, v212
mf16 v[248:251], v[24:27], v[116:119], v[248:251]
ds_read_b64_tr_b16 v[42:43], v11 offset:29184
v_mul_f32 v213, s52, v213
mf16 v[236:239], v[28:31], v[112:115], v[236:239]
ds_read_b64_tr_b16 v[44:45], v12 offset:28672
cvtpk v58, v212, v213
mf16 v[252:255], v[28:31], v[116:119], v[252:255]
ds_read_b64_tr_b16 v[46:47], v12 offset:29184
s_waitcnt lgkmcnt(4)
mf16 v[224:227], v[32:35], v[120:123], v[224:227]
s_waitcnt vmcnt(8)
s_barrier
ds_read_b64_tr_b16 v[24:25], v9 offset:32768
v_mul_f32 v214, s52, v214
mf16 v[240:243], v[32:35], v[124:127], v[240:243]
ds_read_b64_tr_b16 v[26:27], v9 offset:33280
s_add_u32 m0, s47, 0x20000
s_add_u32 s45, s53, 0x200000
buffer_load_dwordx4 v1, s[32:35], s45 offen offset:0 lds
mf16 v[228:231], v[36:39], v[120:123], v[228:231]
ds_read_b64_tr_b16 v[28:29], v10 offset:32768
v_mul_f32 v215, s52, v215
mf16 v[244:247], v[36:39], v[124:127], v[244:247]
ds_read_b64_tr_b16 v[30:31], v10 offset:33280
s_waitcnt lgkmcnt(4)
mf16 v[232:235], v[40:43], v[120:123], v[232:235]
ds_read_b64_tr_b16 v[32:33], v11 offset:32768
cvtpk v59, v214, v215
mf16 v[248:251], v[40:43], v[124:127], v[248:251]
ds_read_b64_tr_b16 v[34:35], v11 offset:33280
buffer_load_dwordx4 v2, s[32:35], s45 offen offset:1024 lds
mf16 v[236:239], v[44:47], v[120:123], v[236:239]
ds_read_b64_tr_b16 v[36:37], v12 offset:32768
buffer_store_dwordx4 v[56:59], v21, s[28:31], s54 offen offset:128 sc1
mf16 v[252:255], v[44:47], v[124:127], v[252:255]
ds_read_b64_tr_b16 v[38:39], v12 offset:33280
s_waitcnt lgkmcnt(4)
mf16 v[224:227], v[24:27], v[128:131], v[224:227]
ds_read_b64_tr_b16 v[40:41], v9 offset:36864
v_mul_f32 v216, s52, v216
mf16 v[240:243], v[24:27], v[132:135], v[240:243]
ds_read_b64_tr_b16 v[42:43], v9 offset:37376
s_add_u32 m0, s47, 0x24000
s_add_u32 s45, s53, 0x300000
buffer_load_dwordx4 v1, s[32:35], s45 offen offset:0 lds
mf16 v[228:231], v[28:31], v[128:131], v[228:231]
ds_read_b64_tr_b16 v[44:45], v10 offset:36864
v_mul_f32 v217, s52, v217
mf16 v[244:247], v[28:31], v[132:135], v[244:247]
ds_read_b64_tr_b16 v[46:47], v10 offset:37376
s_waitcnt lgkmcnt(4)
mf16 v[232:235], v[32:35], v[128:131], v[232:235]
ds_read_b64_tr_b16 v[24:25], v11 offset:36864
cvtpk v60, v216, v217
mf16 v[248:251], v[32:35], v[132:135], v[248:251]
ds_read_b64_tr_b16 v[26:27], v11 offset:37376
buffer_load_dwordx4 v2, s[32:35], s45 offen offset:1024 lds
mf16 v[236:239], v[36:39], v[128:131], v[236:239]
ds_read_b64_tr_b16 v[28:29], v12 offset:36864
v_mul_f32 v218, s52, v218
mf16 v[252:255], v[36:39], v[132:135], v[252:255]
ds_read_b64_tr_b16 v[30:31], v12 offset:37376
s_waitcnt lgkmcnt(4)
mf16 v[224:227], v[40:43], v[136:139], v[224:227]
ds_read_b64_tr_b16 v[32:33], v9 offset:40960
v_mul_f32 v219, s52, v219
mf16 v[240:243], v[40:43], v[140:143], v[240:243]
ds_read_b64_tr_b16 v[34:35], v9 offset:41472
cvtpk v61, v218, v219
mf16 v[228:231], v[44:47], v[136:139], v[228:231]
ds_read_b64_tr_b16 v[36:37], v10 offset:40960
v_mul_f32 v220, s52, v220
mf16 v[244:247], v[44:47], v[140:143], v[244:247]
ds_read_b64_tr_b16 v[38:39], v10 offset:41472
s_waitcnt lgkmcnt(4)
mf16 v[232:235], v[24:27], v[136:139], v[232:235]
ds_read_b64_tr_b16 v[40:41], v11 offset:40960
v_mul_f32 v221, s52, v221
mf16 v[248:251], v[24:27], v[140:143], v[248:251]
ds_read_b64_tr_b16 v[42:43], v11 offset:41472
cvtpk v62, v220, v221
mf16 v[236:239], v[28:31], v[136:139], v[236:239]
ds_read_b64_tr_b16 v[44:45], v12 offset:40960
v_mul_f32 v222, s52, v222
mf16 v[252:255], v[28:31], v[140:143], v[252:255]
ds_read_b64_tr_b16 v[46:47], v12 offset:41472
s_waitcnt lgkmcnt(4)
mf16 v[224:227], v[32:35], v[144:147], v[224:227]
ds_read_b64_tr_b16 v[24:25], v9 offset:45056
v_mul_f32 v223, s52, v223
mf16 v[240:243], v[32:35], v[148:151], v[240:243]
ds_read_b64_tr_b16 v[26:27], v9 offset:45568
cvtpk v63, v222, v223
mf16 v[228:231], v[36:39], v[144:147], v[228:231]
ds_read_b64_tr_b16 v[28:29], v10 offset:45056
buffer_store_dwordx4 v[60:63], v21, s[28:31], s54 offen offset:2176 sc1
mf16 v[244:247], v[36:39], v[148:151], v[244:247]
ds_read_b64_tr_b16 v[30:31], v10 offset:45568
s_waitcnt lgkmcnt(4)
mf16 v[232:235], v[40:43], v[144:147], v[232:235]
ds_read_b64_tr_b16 v[32:33], v11 offset:45056
mf16 v[248:251], v[40:43], v[148:151], v[248:251]
ds_read_b64_tr_b16 v[34:35], v11 offset:45568
mf16 v[236:239], v[44:47], v[144:147], v[236:239]
ds_read_b64_tr_b16 v[36:37], v12 offset:45056
mf16 v[252:255], v[44:47], v[148:151], v[252:255]
ds_read_b64_tr_b16 v[38:39], v12 offset:45568
s_waitcnt lgkmcnt(4)
mf16 v[224:227], v[24:27], v[152:155], v[224:227]
ds_read_b64_tr_b16 v[40:41], v9 offset:49152
mf16 v[240:243], v[24:27], v[156:159], v[240:243]
ds_read_b64_tr_b16 v[42:43], v9 offset:49664
mf16 v[228:231], v[28:31], v[152:155], v[228:231]
ds_read_b64_tr_b16 v[24:25], v10 offset:49152
mf16 v[244:247], v[28:31], v[156:159], v[244:247]
ds_read_b64_tr_b16 v[26:27], v10 offset:49664
s_waitcnt lgkmcnt(4)
mf16 v[232:235], v[32:35], v[152:155], v[232:235]
ds_read_b64_tr_b16 v[28:29], v11 offset:49152
mf16 v[248:251], v[32:35], v[156:159], v[248:251]
ds_read_b64_tr_b16 v[30:31], v11 offset:49664
mf16 v[236:239], v[36:39], v[152:155], v[236:239]
ds_read_b64_tr_b16 v[32:33], v12 offset:49152
mf16 v[252:255], v[36:39], v[156:159], v[252:255]
ds_read_b64_tr_b16 v[34:35], v12 offset:49664
s_waitcnt lgkmcnt(4)
mf16 v[224:227], v[40:43], v[160:163], v[224:227]
ds_read_b64_tr_b16 v[36:37], v9 offset:53248
mf16 v[240:243], v[40:43], v[164:167], v[240:243]
ds_read_b64_tr_b16 v[38:39], v9 offset:53760
mf16 v[228:231], v[24:27], v[160:163], v[228:231]
ds_read_b64_tr_b16 v[40:41], v10 offset:53248
mf16 v[244:247], v[24:27], v[164:167], v[244:247]
ds_read_b64_tr_b16 v[42:43], v10 offset:53760
s_waitcnt lgkmcnt(4)
mf16 v[232:235], v[28:31], v[160:163], v[232:235]
ds_read_b64_tr_b16 v[24:25], v11 offset:53248
mf16 v[248:251], v[28:31], v[164:167], v[248:251]
ds_read_b64_tr_b16 v[26:27], v11 offset:53760
mf16 v[236:239], v[32:35], v[160:163], v[236:239]
ds_read_b64_tr_b16 v[28:29], v12 offset:53248
mf16 v[252:255], v[32:35], v[164:167], v[252:255]
ds_read_b64_tr_b16 v[30:31], v12 offset:53760
s_waitcnt lgkmcnt(4)
mf16 v[224:227], v[36:39], v[168:171], v[224:227]
ds_read_b64_tr_b16 v[32:33], v9 offset:57344
mf16 v[240:243], v[36:39], v[172:175], v[240:243]
ds_read_b64_tr_b16 v[34:35], v9 offset:57856
mf16 v[228:231], v[40:43], v[168:171], v[228:231]
ds_read_b64_tr_b16 v[36:37], v10 offset:57344
mf16 v[244:247], v[40:43], v[172:175], v[244:247]
ds_read_b64_tr_b16 v[38:39], v10 offset:57856
s_waitcnt lgkmcnt(4)
mf16 v[232:235], v[24:27], v[168:171], v[232:235]
ds_read_b64_tr_b16 v[40:41], v11 offset:57344
mf16 v[248:251], v[24:27], v[172:175], v[248:251]
ds_read_b64_tr_b16 v[42:43], v11 offset:57856
s_cmp_lg_u32 s44, 0
s_cbranch_scc1 l1_kernel_wosK
ds_read_b64_tr_b16 v[56:57], v4 offset:0
ds_read_b64_tr_b16 v[58:59], v4 offset:1024
ds_read_b64_tr_b16 v[60:61], v4 offset:64
ds_read_b64_tr_b16 v[62:63], v4 offset:1088
s_add_u32 s8, s14, 0x3c00000
s_addc_u32 s9, s15, 0
s_mov_b32 s10, 0x400000
s_mov_b32 s11, 0x20000
s_waitcnt lgkmcnt(0)
buffer_store_dwordx4 v[56:59], v5, s[8:11], s17 offen offset:0 sc1
buffer_store_dwordx4 v[60:63], v5, s[8:11], s17 offen offset:1024 sc1
l1_kernel_wosK:
mf16 v[236:239], v[28:31], v[168:171], v[236:239]
ds_read_b64_tr_b16 v[24:25], v12 offset:57344
mf16 v[252:255], v[28:31], v[172:175], v[252:255]
ds_read_b64_tr_b16 v[26:27], v12 offset:57856
s_waitcnt lgkmcnt(4)
mf16 v[224:227], v[32:35], v[176:179], v[224:227]
ds_read_b64_tr_b16 v[28:29], v9 offset:61440
mf16 v[240:243], v[32:35], v[180:183], v[240:243]
ds_read_b64_tr_b16 v[30:31], v9 offset:61952
mf16 v[228:231], v[36:39], v[176:179], v[228:231]
ds_read_b64_tr_b16 v[32:33], v10 offset:61440
mf16 v[244:247], v[36:39], v[180:183], v[244:247]
ds_read_b64_tr_b16 v[34:35], v10 offset:61952
s_waitcnt lgkmcnt(4)
mf16 v[232:235], v[40:43], v[176:179], v[232:235]
ds_read_b64_tr_b16 v[36:37], v11 offset:61440
mf16 v[248:251], v[40:43], v[180:183], v[248:251]
ds_read_b64_tr_b16 v[38:39], v11 offset:61952
mf16 v[236:239], v[24:27], v[176:179], v[236:239]
ds_read_b64_tr_b16 v[40:41], v12 offset:61440
mf16 v[252:255], v[24:27], v[180:183], v[252:255]
ds_read_b64_tr_b16 v[42:43], v12 offset:61952
s_waitcnt lgkmcnt(4)
mf16 v[224:227], v[28:31], v[184:187], v[224:227]
s_waitcnt vmcnt(8)
s_barrier
ds_read_b64_tr_b16 v[24:25], v13 offset:32768
mf16 v[240:243], v[28:31], v[188:191], v[240:243]
ds_read_b64_tr_b16 v[26:27], v13 offset:33280
s_add_u32 m0, s47, 0x0
s_add_u32 s45, s53, 0x80
buffer_load_dwordx4 v1, s[32:35], s45 offen offset:0 lds
mf16 v[228:231], v[32:35], v[184:187], v[228:231]
ds_read_b64_tr_b16 v[28:29], v14 offset:32768
mf16 v[244:247], v[32:35], v[188:191], v[244:247]
ds_read_b64_tr_b16 v[30:31], v14 offset:33280
s_waitcnt lgkmcnt(4)
mf16 v[232:235], v[36:39], v[184:187], v[232:235]
ds_read_b64_tr_b16 v[32:33], v15 offset:32768
mf16 v[248:251], v[36:39], v[188:191], v[248:251]
ds_read_b64_tr_b16 v[34:35], v15 offset:33280
buffer_load_dwordx4 v2, s[32:35], s45 offen offset:1024 lds
mf16 v[236:239], v[40:43], v[184:187], v[236:239]
ds_read_b64_tr_b16 v[36:37], v16 offset:32768
mf16 v[252:255], v[40:43], v[188:191], v[252:255]
ds_read_b64_tr_b16 v[38:39], v16 offset:33280
v_mov_b32 v48, v52
v_mov_b32 v49, v53
v_mov_b32 v50, v54
v_mov_b32 v51, v55
s_add_u32 s66, s66, 0x400000
s_add_u32 m0, s47, 0x4000
s_add_u32 s45, s53, 0x100080
buffer_load_dwordx4 v1, s[32:35], s45 offen offset:0 lds
buffer_load_dwordx4 v2, s[32:35], s45 offen offset:1024 lds
s_cmp_eq_u32 s18, 10
s_cbranch_scc1 l1_kernel_Ctail
s_mov_b32 s48, s53
s_mov_b32 s34, 0
s_add_u32 s50, s50, s92
s_add_u32 s44, s44, 1
s_cmp_lt_u32 s44, 2
s_cbranch_scc1 l1_kernel_A_loop
s_nop 7
s_add_u32 s55, s50, 4096
s_sub_u32 s55, s55, s92
v_mul_f32 v224, s52, v224
v_mul_f32 v225, s52, v225
cvtpk v56, v224, v225
v_mul_f32 v226, s52, v226
v_mul_f32 v227, s52, v227
cvtpk v57, v226, v227
v_mul_f32 v228, s52, v228
v_mul_f32 v229, s52, v229
cvtpk v58, v228, v229
v_mul_f32 v230, s52, v230
v_mul_f32 v231, s52, v231
cvtpk v59, v230, v231
buffer_store_dwordx4 v[56:59], v21, s[28:31], s55 offen offset:0 sc1
v_mul_f32 v232, s52, v232
v_mul_f32 v233, s52, v233
cvtpk v60, v232, v233
v_mul_f32 v234, s52, v234
v_mul_f32 v235, s52, v235
cvtpk v61, v234, v235
v_mul_f32 v236, s52, v236
v_mul_f32 v237, s52, v237
cvtpk v62, v236, v237
v_mul_f32 v238, s52, v238
v_mul_f32 v239, s52, v239
cvtpk v63, v238, v239
buffer_store_dwordx4 v[60:63], v21, s[28:31], s55 offen offset:2048 sc1
v_mul_f32 v240, s52, v240
v_mul_f32 v241, s52, v241
cvtpk v56, v240, v241
v_mul_f32 v242, s52, v242
v_mul_f32 v243, s52, v243
cvtpk v57, v242, v243
v_mul_f32 v244, s52, v244
v_mul_f32 v245, s52, v245
cvtpk v58, v244, v245
v_mul_f32 v246, s52, v246
v_mul_f32 v247, s52, v247
cvtpk v59, v246, v247
buffer_store_dwordx4 v[56:59], v21, s[28:31], s55 offen offset:128 sc1
v_mul_f32 v248, s52, v248
v_mul_f32 v249, s52, v249
cvtpk v60, v248, v249
v_mul_f32 v250, s52, v250
v_mul_f32 v251, s52, v251
cvtpk v61, v250, v251
v_mul_f32 v252, s52, v252
v_mul_f32 v253, s52, v253
cvtpk v62, v252, v253
v_mul_f32 v254, s52, v254
v_mul_f32 v255, s52, v255
cvtpk v63, v254, v255
buffer_store_dwordx4 v[60:63], v21, s[28:31], s55 offen offset:2176 sc1
s_endpgm
l1_kernel_Ctail:
s_waitcnt lgkmcnt(4)
mf16 v[192:195], v[64:67], v[24:27], 0
ds_read_b64_tr_b16 v[40:41], v13 offset:36864
mf16 v[208:211], v[68:71], v[24:27], 0
ds_read_b64_tr_b16 v[42:43], v13 offset:37376
mf16 v[196:199], v[64:67], v[28:31], 0
ds_read_b64_tr_b16 v[44:45], v14 offset:36864
mf16 v[212:215], v[68:71], v[28:31], 0
ds_read_b64_tr_b16 v[46:47], v14 offset:37376
s_waitcnt lgkmcnt(4)
mf16 v[200:203], v[64:67], v[32:35], 0
ds_read_b64_tr_b16 v[24:25], v15 offset:36864
mf16 v[216:219], v[68:71], v[32:35], 0
ds_read_b64_tr_b16 v[26:27], v15 offset:37376
mf16 v[204:207], v[64:67], v[36:39], 0
ds_read_b64_tr_b16 v[28:29], v16 offset:36864
mf16 v[220:223], v[68:71], v[36:39], 0
ds_read_b64_tr_b16 v[30:31], v16 offset:37376
s_waitcnt lgkmcnt(4)
mf16 v[192:195], v[72:75], v[40:43], v[192:195]
ds_read_b64_tr_b16 v[32:33], v13 offset:40960
s_add_u32 s55, s50, 4096
mf16 v[208:211], v[76:79], v[40:43], v[208:211]
ds_read_b64_tr_b16 v[34:35], v13 offset:41472
v_mul_f32 v224, s52, v224
mf16 v[196:199], v[72:75], v[44:47], v[196:199]
ds_read_b64_tr_b16 v[36:37], v14 offset:40960
v_mul_f32 v225, s52, v225
mf16 v[212:215], v[76:79], v[44:47], v[212:215]
ds_read_b64_tr_b16 v[38:39], v14 offset:41472
s_waitcnt lgkmcnt(4)
mf16 v[200:203], v[72:75], v[24:27], v[200:203]
ds_read_b64_tr_b16 v[40:41], v15 offset:40960
cvtpk v56, v224, v225
mf16 v[216:219], v[76:79], v[24:27], v[216:219]
ds_read_b64_tr_b16 v[42:43], v15 offset:41472
v_mul_f32 v226, s52, v226
mf16 v[204:207], v[72:75], v[28:31], v[204:207]
ds_read_b64_tr_b16 v[44:45], v16 offset:40960
v_mul_f32 v227, s52, v227
mf16 v[220:223], v[76:79], v[28:31], v[220:223]
ds_read_b64_tr_b16 v[46:47], v16 offset:41472
s_waitcnt lgkmcnt(4)
mf16 v[192:195], v[80:83], v[32:35], v[192:195]
ds_read_b64_tr_b16 v[24:25], v13 offset:45056
cvtpk v57, v226, v227
mf16 v[208:211], v[84:87], v[32:35], v[208:211]
ds_read_b64_tr_b16 v[26:27], v13 offset:45568
v_mul_f32 v228, s52, v228
mf16 v[196:199], v[80:83], v[36:39], v[196:199]
ds_read_b64_tr_b16 v[28:29], v14 offset:45056
v_mul_f32 v229, s52, v229
mf16 v[212:215], v[84:87], v[36:39], v[212:215]
ds_read_b64_tr_b16 v[30:31], v14 offset:45568
s_waitcnt lgkmcnt(4)
mf16 v[200:203], v[80:83], v[40:43], v[200:203]
ds_read_b64_tr_b16 v[32:33], v15 offset:45056
cvtpk v58, v228, v229
mf16 v[216:219], v[84:87], v[40:43], v[216:219]
ds_read_b64_tr_b16 v[34:35], v15 offset:45568
v_mul_f32 v230, s52, v230
mf16 v[204:207], v[80:83], v[44:47], v[204:207]
ds_read_b64_tr_b16 v[36:37], v16 offset:45056
v_mul_f32 v231, s52, v231
mf16 v[220:223], v[84:87], v[44:47], v[220:223]
ds_read_b64_tr_b16 v[38:39], v16 offset:45568
s_waitcnt lgkmcnt(4)
mf16 v[192:195], v[88:91], v[24:27], v[192:195]
ds_read_b64_tr_b16 v[40:41], v13 offset:49152
cvtpk v59, v230, v231
mf16 v[208:211], v[92:95], v[24:27], v[208:211]
ds_read_b64_tr_b16 v[42:43], v13 offset:49664
buffer_store_dwordx4 v[56:59], v21, s[28:31], s55 offen offset:0 sc1
mf16 v[196:199], v[88:91], v[28:31], v[196:199]
ds_read_b64_tr_b16 v[44:45], v14 offset:49152
v_mul_f32 v232, s52, v232
mf16 v[212:215], v[92:95], v[28:31], v[212:215]
ds_read_b64_tr_b16 v[46:47], v14 offset:49664
s_waitcnt lgkmcnt(4)
mf16 v[200:203], v[88:91], v[32:35], v[200:203]
ds_read_b64_tr_b16 v[24:25], v15 offset:49152
v_mul_f32 v233, s52, v233
mf16 v[216:219], v[92:95], v[32:35], v[216:219]
ds_read_b64_tr_b16 v[26:27], v15 offset:49664
cvtpk v60, v232, v233
mf16 v[204:207], v[88:91], v[36:39], v[204:207]
ds_read_b64_tr_b16 v[28:29], v16 offset:49152
v_mul_f32 v234, s52, v234
mf16 v[220:223], v[92:95], v[36:39], v[220:223]
ds_read_b64_tr_b16 v[30:31], v16 offset:49664
s_waitcnt lgkmcnt(4)
mf16 v[192:195], v[96:99], v[40:43], v[192:195]
ds_read_b64_tr_b16 v[32:33], v13 offset:53248
v_mul_f32 v235, s52, v235
mf16 v[208:211], v[100:103], v[40:43], v[208:211]
ds_read_b64_tr_b16 v[34:35], v13 offset:53760
cvtpk v61, v234, v235
mf16 v[196:199], v[96:99], v[44:47], v[196:199]
ds_read_b64_tr_b16 v[36:37], v14 offset:53248
v_mul_f32 v236, s52, v236
mf16 v[212:215], v[100:103], v[44:47], v[212:215]
ds_read_b64_tr_b16 v[38:39], v14 offset:53760
s_waitcnt lgkmcnt(4)
mf16 v[200:203], v[96:99], v[24:27], v[200:203]
ds_read_b64_tr_b16 v[40:41], v15 offset:53248
v_mul_f32 v237, s52, v237
mf16 v[216:219], v[100:103], v[24:27], v[216:219]
ds_read_b64_tr_b16 v[42:43], v15 offset:53760
cvtpk v62, v236, v237
mf16 v[204:207], v[96:99], v[28:31], v[204:207]
ds_read_b64_tr_b16 v[44:45], v16 offset:53248
v_mul_f32 v238, s52, v238
mf16 v[220:223], v[100:103], v[28:31], v[220:223]
ds_read_b64_tr_b16 v[46:47], v16 offset:53760
s_waitcnt lgkmcnt(4)
mf16 v[192:195], v[104:107], v[32:35], v[192:195]
ds_read_b64_tr_b16 v[24:25], v13 offset:57344
v_mul_f32 v239, s52, v239
mf16 v[208:211], v[108:111], v[32:35], v[208:211]
ds_read_b64_tr_b16 v[26:27], v13 offset:57856
cvtpk v63, v238, v239
mf16 v[196:199], v[104:107], v[36:39], v[196:199]
ds_read_b64_tr_b16 v[28:29], v14 offset:57344
buffer_store_dwordx4 v[60:63], v21, s[28:31], s55 offen offset:2048 sc1
mf16 v[212:215], v[108:111], v[36:39], v[212:215]
ds_read_b64_tr_b16 v[30:31], v14 offset:57856
s_waitcnt lgkmcnt(4)
mf16 v[200:203], v[104:107], v[40:43], v[200:203]
ds_read_b64_tr_b16 v[32:33], v15 offset:57344
v_mul_f32 v240, s52, v240
mf16 v[216:219], v[108:111], v[40:43], v[216:219]
ds_read_b64_tr_b16 v[34:35], v15 offset:57856
v_mul_f32 v241, s52, v241
mf16 v[204:207], v[104:107], v[44:47], v[204:207]
ds_read_b64_tr_b16 v[36:37], v16 offset:57344
cvtpk v56, v240, v241
mf16 v[220:223], v[108:111], v[44:47], v[220:223]
ds_read_b64_tr_b16 v[38:39], v16 offset:57856
s_waitcnt lgkmcnt(4)
mf16 v[192:195], v[112:115], v[24:27], v[192:195]
ds_read_b64_tr_b16 v[40:41], v13 offset:61440
v_mul_f32 v242, s52, v242
mf16 v[208:211], v[116:119], v[24:27], v[208:211]
ds_read_b64_tr_b16 v[42:43], v13 offset:61952
v_mul_f32 v243, s52, v243
mf16 v[196:199], v[112:115], v[28:31], v[196:199]
ds_read_b64_tr_b16 v[44:45], v14 offset:61440
cvtpk v57, v242, v243
mf16 v[212:215], v[116:119], v[28:31], v[212:215]
ds_read_b64_tr_b16 v[46:47], v14 offset:61952
s_waitcnt lgkmcnt(4)
mf16 v[200:203], v[112:115], v[32:35], v[200:203]
ds_read_b64_tr_b16 v[24:25], v15 offset:61440
v_mul_f32 v244, s52, v244
mf16 v[216:219], v[116:119], v[32:35], v[216:219]
ds_read_b64_tr_b16 v[26:27], v15 offset:61952
v_mul_f32 v245, s52, v245
mf16 v[204:207], v[112:115], v[36:39], v[204:207]
ds_read_b64_tr_b16 v[28:29], v16 offset:61440
cvtpk v58, v244, v245
mf16 v[220:223], v[116:119], v[36:39], v[220:223]
ds_read_b64_tr_b16 v[30:31], v16 offset:61952
s_waitcnt lgkmcnt(4)
mf16 v[192:195], v[120:123], v[40:43], v[192:195]
s_waitcnt vmcnt(7)
s_barrier
ds_read_b64_tr_b16 v[32:33], v17 offset:0
v_mul_f32 v246, s52, v246
mf16 v[208:211], v[124:127], v[40:43], v[208:211]
ds_read_b64_tr_b16 v[34:35], v17 offset:512
s_add_u32 m0, s47, 0x8000
s_add_u32 s45, s53, 0x200080
buffer_load_dwordx4 v1, s[32:35], s45 offen offset:0 lds
mf16 v[196:199], v[120:123], v[44:47], v[196:199]
ds_read_b64_tr_b16 v[36:37], v18 offset:0
v_mul_f32 v247, s52, v247
mf16 v[212:215], v[124:127], v[44:47], v[212:215]
ds_read_b64_tr_b16 v[38:39], v18 offset:512
s_waitcnt lgkmcnt(4)
mf16 v[200:203], v[120:123], v[24:27], v[200:203]
ds_read_b64_tr_b16 v[40:41], v19 offset:0
cvtpk v59, v246, v247
mf16 v[216:219], v[124:127], v[24:27], v[216:219]
ds_read_b64_tr_b16 v[42:43], v19 offset:512
buffer_load_dwordx4 v2, s[32:35], s45 offen offset:1024 lds
mf16 v[204:207], v[120:123], v[28:31], v[204:207]
ds_read_b64_tr_b16 v[44:45], v20 offset:0
buffer_store_dwordx4 v[56:59], v21, s[28:31], s55 offen offset:128 sc1
mf16 v[220:223], v[124:127], v[28:31], v[220:223]
ds_read_b64_tr_b16 v[46:47], v20 offset:512
s_waitcnt lgkmcnt(4)
mf16 v[192:195], v[128:131], v[32:35], v[192:195]
ds_read_b64_tr_b16 v[24:25], v17 offset:4096
v_mul_f32 v248, s52, v248
mf16 v[208:211], v[132:135], v[32:35], v[208:211]
ds_read_b64_tr_b16 v[26:27], v17 offset:4608
s_add_u32 m0, s47, 0xc000
s_add_u32 s45, s53, 0x300080
buffer_load_dwordx4 v1, s[32:35], s45 offen offset:0 lds
mf16 v[196:199], v[128:131], v[36:39], v[196:199]
ds_read_b64_tr_b16 v[28:29], v18 offset:4096
v_mul_f32 v249, s52, v249
mf16 v[212:215], v[132:135], v[36:39], v[212:215]
ds_read_b64_tr_b16 v[30:31], v18 offset:4608
s_waitcnt lgkmcnt(4)
mf16 v[200:203], v[128:131], v[40:43], v[200:203]
ds_read_b64_tr_b16 v[32:33], v19 offset:4096
cvtpk v60, v248, v249
mf16 v[216:219], v[132:135], v[40:43], v[216:219]
ds_read_b64_tr_b16 v[34:35], v19 offset:4608
buffer_load_dwordx4 v2, s[32:35], s45 offen offset:1024 lds
mf16 v[204:207], v[128:131], v[44:47], v[204:207]
ds_read_b64_tr_b16 v[36:37], v20 offset:4096
v_mul_f32 v250, s52, v250
mf16 v[220:223], v[132:135], v[44:47], v[220:223]
ds_read_b64_tr_b16 v[38:39], v20 offset:4608
s_waitcnt lgkmcnt(4)
mf16 v[192:195], v[136:139], v[24:27], v[192:195]
ds_read_b64_tr_b16 v[40:41], v17 offset:8192
v_mul_f32 v251, s52, v251
mf16 v[208:211], v[140:143], v[24:27], v[208:211]
ds_read_b64_tr_b16 v[42:43], v17 offset:8704
cvtpk v61, v250, v251
mf16 v[196:199], v[136:139], v[28:31], v[196:199]
ds_read_b64_tr_b16 v[44:45], v18 offset:8192
v_mul_f32 v252, s52, v252
mf16 v[212:215], v[140:143], v[28:31], v[212:215]
ds_read_b64_tr_b16 v[46:47], v18 offset:8704
s_waitcnt lgkmcnt(4)
mf16 v[200:203], v[136:139], v[32:35], v[200:203]
ds_read_b64_tr_b16 v[24:25], v19 offset:8192
v_mul_f32 v253, s52, v253
mf16 v[216:219], v[140:143], v[32:35], v[216:219]
ds_read_b64_tr_b16 v[26:27], v19 offset:8704
cvtpk v62, v252, v253
mf16 v[204:207], v[136:139], v[36:39], v[204:207]
ds_read_b64_tr_b16 v[28:29], v20 offset:8192
v_mul_f32 v254, s52, v254
mf16 v[220:223], v[140:143], v[36:39], v[220:223]
ds_read_b64_tr_b16 v[30:31], v20 offset:8704
s_waitcnt lgkmcnt(4)
mf16 v[192:195], v[144:147], v[40:43], v[192:195]
ds_read_b64_tr_b16 v[32:33], v17 offset:12288
v_mul_f32 v255, s52, v255
mf16 v[208:211], v[148:151], v[40:43], v[208:211]
ds_read_b64_tr_b16 v[34:35], v17 offset:12800
cvtpk v63, v254, v255
mf16 v[196:199], v[144:147], v[44:47], v[196:199]
ds_read_b64_tr_b16 v[36:37], v18 offset:12288
buffer_store_dwordx4 v[60:63], v21, s[28:31], s55 offen offset:2176 sc1
mf16 v[212:215], v[148:151], v[44:47], v[212:215]
ds_read_b64_tr_b16 v[38:39], v18 offset:12800
s_waitcnt lgkmcnt(4)
mf16 v[200:203], v[144:147], v[24:27], v[200:203]
ds_read_b64_tr_b16 v[40:41], v19 offset:12288
mf16 v[216:219], v[148:151], v[24:27], v[216:219]
ds_read_b64_tr_b16 v[42:43], v19 offset:12800
mf16 v[204:207], v[144:147], v[28:31], v[204:207]
ds_read_b64_tr_b16 v[44:45], v20 offset:12288
mf16 v[220:223], v[148:151], v[28:31], v[220:223]
ds_read_b64_tr_b16 v[46:47], v20 offset:12800
s_waitcnt lgkmcnt(4)
mf16 v[192:195], v[152:155], v[32:35], v[192:195]
ds_read_b64_tr_b16 v[24:25], v17 offset:16384
mf16 v[208:211], v[156:159], v[32:35], v[208:211]
ds_read_b64_tr_b16 v[26:27], v17 offset:16896
mf16 v[196:199], v[152:155], v[36:39], v[196:199]
ds_read_b64_tr_b16 v[28:29], v18 offset:16384
mf16 v[212:215], v[156:159], v[36:39], v[212:215]
ds_read_b64_tr_b16 v[30:31], v18 offset:16896
s_waitcnt lgkmcnt(4)
mf16 v[200:203], v[152:155], v[40:43], v[200:203]
ds_read_b64_tr_b16 v[32:33], v19 offset:16384
mf16 v[216:219], v[156:159], v[40:43], v[216:219]
ds_read_b64_tr_b16 v[34:35], v19 offset:16896
mf16 v[204:207], v[152:155], v[44:47], v[204:207]
ds_read_b64_tr_b16 v[36:37], v20 offset:16384
mf16 v[220:223], v[156:159], v[44:47], v[220:223]
ds_read_b64_tr_b16 v[38:39], v20 offset:16896
s_waitcnt lgkmcnt(4)
mf16 v[192:195], v[160:163], v[24:27], v[192:195]
ds_read_b64_tr_b16 v[40:41], v17 offset:20480
mf16 v[208:211], v[164:167], v[24:27], v[208:211]
ds_read_b64_tr_b16 v[42:43], v17 offset:20992
mf16 v[196:199], v[160:163], v[28:31], v[196:199]
ds_read_b64_tr_b16 v[44:45], v18 offset:20480
mf16 v[212:215], v[164:167], v[28:31], v[212:215]
ds_read_b64_tr_b16 v[46:47], v18 offset:20992
s_waitcnt lgkmcnt(4)
mf16 v[200:203], v[160:163], v[32:35], v[200:203]
ds_read_b64_tr_b16 v[24:25], v19 offset:20480
mf16 v[216:219], v[164:167], v[32:35], v[216:219]
ds_read_b64_tr_b16 v[26:27], v19 offset:20992
mf16 v[204:207], v[160:163], v[36:39], v[204:207]
ds_read_b64_tr_b16 v[28:29], v20 offset:20480
mf16 v[220:223], v[164:167], v[36:39], v[220:223]
ds_read_b64_tr_b16 v[30:31], v20 offset:20992
s_waitcnt lgkmcnt(4)
mf16 v[192:195], v[168:171], v[40:43], v[192:195]
ds_read_b64_tr_b16 v[32:33], v17 offset:24576
mf16 v[208:211], v[172:175], v[40:43], v[208:211]
ds_read_b64_tr_b16 v[34:35], v17 offset:25088
buffer_store_dwordx4 v[48:51], v23, s[60:63], s66 offen
mf16 v[196:199], v[168:171], v[44:47], v[196:199]
ds_read_b64_tr_b16 v[36:37], v18 offset:24576
mf16 v[212:215], v[172:175], v[44:47], v[212:215]
ds_read_b64_tr_b16 v[38:39], v18 offset:25088
s_waitcnt lgkmcnt(4)
mf16 v[200:203], v[168:171], v[24:27], v[200:203]
ds_read_b64_tr_b16 v[40:41], v19 offset:24576
mf16 v[216:219], v[172:175], v[24:27], v[216:219]
ds_read_b64_tr_b16 v[42:43], v19 offset:25088
mf16 v[204:207], v[168:171], v[28:31], v[204:207]
ds_read_b64_tr_b16 v[44:45], v20 offset:24576
mf16 v[220:223], v[172:175], v[28:31], v[220:223]
ds_read_b64_tr_b16 v[46:47], v20 offset:25088
s_waitcnt lgkmcnt(4)
mf16 v[192:195], v[176:179], v[32:35], v[192:195]
ds_read_b64_tr_b16 v[24:25], v17 offset:28672
mf16 v[208:211], v[180:183], v[32:35], v[208:211]
ds_read_b64_tr_b16 v[26:27], v17 offset:29184
mf16 v[196:199], v[176:179], v[36:39], v[196:199]
ds_read_b64_tr_b16 v[28:29], v18 offset:28672
mf16 v[212:215], v[180:183], v[36:39], v[212:215]
ds_read_b64_tr_b16 v[30:31], v18 offset:29184
s_waitcnt lgkmcnt(4)
mf16 v[200:203], v[176:179], v[40:43], v[200:203]
ds_read_b64_tr_b16 v[32:33], v19 offset:28672
mf16 v[216:219], v[180:183], v[40:43], v[216:219]
ds_read_b64_tr_b16 v[34:35], v19 offset:29184
mf16 v[204:207], v[176:179], v[44:47], v[204:207]
ds_read_b64_tr_b16 v[36:37], v20 offset:28672
mf16 v[220:223], v[180:183], v[44:47], v[220:223]
ds_read_b64_tr_b16 v[38:39], v20 offset:29184
s_waitcnt lgkmcnt(4)
mf16 v[192:195], v[184:187], v[24:27], v[192:195]
s_waitcnt vmcnt(9)
s_barrier
ds_read_b64_tr_b16 v[40:41], v9 offset:0
mf16 v[208:211], v[188:191], v[24:27], v[208:211]
ds_read_b64_tr_b16 v[42:43], v9 offset:512
mf16 v[196:199], v[184:187], v[28:31], v[196:199]
ds_read_b64_tr_b16 v[44:45], v10 offset:0
mf16 v[212:215], v[188:191], v[28:31], v[212:215]
ds_read_b64_tr_b16 v[46:47], v10 offset:512
s_waitcnt lgkmcnt(4)
mf16 v[200:203], v[184:187], v[32:35], v[200:203]
ds_read_b64_tr_b16 v[24:25], v11 offset:0
mf16 v[216:219], v[188:191], v[32:35], v[216:219]
ds_read_b64_tr_b16 v[26:27], v11 offset:512
mf16 v[204:207], v[184:187], v[36:39], v[204:207]
ds_read_b64_tr_b16 v[28:29], v12 offset:0
mf16 v[220:223], v[188:191], v[36:39], v[220:223]
ds_read_b64_tr_b16 v[30:31], v12 offset:512
s_waitcnt lgkmcnt(4)
mf16 v[224:227], v[64:67], v[40:43], 0
ds_read_b64_tr_b16 v[32:33], v9 offset:4096
mf16 v[240:243], v[68:71], v[40:43], 0
ds_read_b64_tr_b16 v[34:35], v9 offset:4608
mf16 v[228:231], v[64:67], v[44:47], 0
ds_read_b64_tr_b16 v[36:37], v10 offset:4096
mf16 v[244:247], v[68:71], v[44:47], 0
ds_read_b64_tr_b16 v[38:39], v10 offset:4608
s_waitcnt lgkmcnt(4)
mf16 v[232:235], v[64:67], v[24:27], 0
ds_read_b64_tr_b16 v[40:41], v11 offset:4096
mf16 v[248:251], v[68:71], v[24:27], 0
ds_read_b64_tr_b16 v[42:43], v11 offset:4608
mf16 v[236:239], v[64:67], v[28:31], 0
ds_read_b64_tr_b16 v[44:45], v12 offset:4096
mf16 v[252:255], v[68:71], v[28:31], 0
ds_read_b64_tr_b16 v[46:47], v12 offset:4608
s_waitcnt lgkmcnt(4)
mf16 v[224:227], v[72:75], v[32:35], v[224:227]
ds_read_b64_tr_b16 v[24:25], v9 offset:8192
s_add_u32 s54, s43, 0
mf16 v[240:243], v[76:79], v[32:35], v[240:243]
ds_read_b64_tr_b16 v[26:27], v9 offset:8704
cvtpk v56, v192, v193
mf16 v[228:231], v[72:75], v[36:39], v[228:231]
ds_read_b64_tr_b16 v[28:29], v10 offset:8192
cvtpk v57, v194, v195
mf16 v[244:247], v[76:79], v[36:39], v[244:247]
ds_read_b64_tr_b16 v[30:31], v10 offset:8704
s_waitcnt lgkmcnt(4)
mf16 v[232:235], v[72:75], v[40:43], v[232:235]
ds_read_b64_tr_b16 v[32:33], v11 offset:8192
cvtpk v58, v208, v209
mf16 v[248:251], v[76:79], v[40:43], v[248:251]
ds_read_b64_tr_b16 v[34:35], v11 offset:8704
cvtpk v59, v210, v211
mf16 v[236:239], v[72:75], v[44:47], v[236:239]
ds_read_b64_tr_b16 v[36:37], v12 offset:8192
buffer_store_dwordx4 v[56:59], v22, s[36:39], s54 offen offset:0 sc1
mf16 v[252:255], v[76:79], v[44:47], v[252:255]
ds_read_b64_tr_b16 v[38:39], v12 offset:8704
s_waitcnt lgkmcnt(4)
mf16 v[224:227], v[80:83], v[24:27], v[224:227]
ds_read_b64_tr_b16 v[40:41], v9 offset:12288
cvtpk v60, v196, v197
mf16 v[240:243], v[84:87], v[24:27], v[240:243]
ds_read_b64_tr_b16 v[42:43], v9 offset:12800
cvtpk v61, v198, v199
mf16 v[228:231], v[80:83], v[28:31], v[228:231]
ds_read_b64_tr_b16 v[44:45], v10 offset:12288
cvtpk v62, v212, v213
mf16 v[244:247], v[84:87], v[28:31], v[244:247]
ds_read_b64_tr_b16 v[46:47], v10 offset:12800
s_waitcnt lgkmcnt(4)
mf16 v[232:235], v[80:83], v[32:35], v[232:235]
ds_read_b64_tr_b16 v[24:25], v11 offset:12288
cvtpk v63, v214, v215
mf16 v[248:251], v[84:87], v[32:35], v[248:251]
ds_read_b64_tr_b16 v[26:27], v11 offset:12800
buffer_store_dwordx4 v[60:63], v22, s[36:39], s54 offen offset:256 sc1
mf16 v[236:239], v[80:83], v[36:39], v[236:239]
ds_read_b64_tr_b16 v[28:29], v12 offset:12288
cvtpk v56, v200, v201
mf16 v[252:255], v[84:87], v[36:39], v[252:255]
ds_read_b64_tr_b16 v[30:31], v12 offset:12800
s_waitcnt lgkmcnt(4)
mf16 v[224:227], v[88:91], v[40:43], v[224:227]
ds_read_b64_tr_b16 v[32:33], v9 offset:16384
cvtpk v57, v202, v203
mf16 v[240:243], v[92:95], v[40:43], v[240:243]
ds_read_b64_tr_b16 v[34:35], v9 offset:16896
cvtpk v58, v216, v217
mf16 v[228:231], v[88:91], v[44:47], v[228:231]
ds_read_b64_tr_b16 v[36:37], v10 offset:16384
cvtpk v59, v218, v219
mf16 v[244:247], v[92:95], v[44:47], v[244:247]
ds_read_b64_tr_b16 v[38:39], v10 offset:16896
s_waitcnt lgkmcnt(4)
mf16 v[232:235], v[88:91], v[24:27], v[232:235]
ds_read_b64_tr_b16 v[40:41], v11 offset:16384
buffer_store_dwordx4 v[56:59], v22, s[36:39], s54 offen offset:2048 sc1
mf16 v[248:251], v[92:95], v[24:27], v[248:251]
ds_read_b64_tr_b16 v[42:43], v11 offset:16896
cvtpk v60, v204, v205
mf16 v[236:239], v[88:91], v[28:31], v[236:239]
ds_read_b64_tr_b16 v[44:45], v12 offset:16384
cvtpk v61, v206, v207
mf16 v[252:255], v[92:95], v[28:31], v[252:255]
ds_read_b64_tr_b16 v[46:47], v12 offset:16896
s_waitcnt lgkmcnt(4)
mf16 v[224:227], v[96:99], v[32:35], v[224:227]
ds_read_b64_tr_b16 v[24:25], v9 offset:20480
cvtpk v62, v220, v221
mf16 v[240:243], v[100:103], v[32:35], v[240:243]
ds_read_b64_tr_b16 v[26:27], v9 offset:20992
cvtpk v63, v222, v223
s_getpc_b64 s[8:9]
s_add_u32 s8, s8, cs_attn_kernel@rel32@lo+4
s_addc_u32 s9, s9, cs_attn_kernel@rel32@hi+12
s_mov_b32 s10, attn_kernel_end - attn_kernel
s_mov_b32 s11, 0x20000
s_lshr_b32 s12, s2, 3
s_lshl_b32 s12, s12, 3
s_add_u32 s12, s12, s16
s_lshl_b32 s12, s12, 9
v_lshlrev_b32 v7, 7, v0
s_mov_b64 exec, 15
buffer_load_dword v8, v7, s[8:11], s12 offen
s_mov_b64 exec, -1
mf16 v[228:231], v[96:99], v[36:39], v[228:231]
ds_read_b64_tr_b16 v[28:29], v10 offset:20480
buffer_store_dwordx4 v[60:63], v22, s[36:39], s54 offen offset:2304 sc1
mf16 v[244:247], v[100:103], v[36:39], v[244:247]
ds_read_b64_tr_b16 v[30:31], v10 offset:20992
s_waitcnt lgkmcnt(4)
mf16 v[232:235], v[96:99], v[40:43], v[232:235]
ds_read_b64_tr_b16 v[32:33], v11 offset:20480
mf16 v[248:251], v[100:103], v[40:43], v[248:251]
ds_read_b64_tr_b16 v[34:35], v11 offset:20992
mf16 v[236:239], v[96:99], v[44:47], v[236:239]
ds_read_b64_tr_b16 v[36:37], v12 offset:20480
mf16 v[252:255], v[100:103], v[44:47], v[252:255]
ds_read_b64_tr_b16 v[38:39], v12 offset:20992
s_waitcnt lgkmcnt(4)
mf16 v[224:227], v[104:107], v[24:27], v[224:227]
ds_read_b64_tr_b16 v[40:41], v9 offset:24576
mf16 v[240:243], v[108:111], v[24:27], v[240:243]
ds_read_b64_tr_b16 v[42:43], v9 offset:25088
mf16 v[228:231], v[104:107], v[28:31], v[228:231]
ds_read_b64_tr_b16 v[44:45], v10 offset:24576
mf16 v[244:247], v[108:111], v[28:31], v[244:247]
ds_read_b64_tr_b16 v[46:47], v10 offset:25088
s_waitcnt lgkmcnt(4)
mf16 v[232:235], v[104:107], v[32:35], v[232:235]
ds_read_b64_tr_b16 v[24:25], v11 offset:24576
mf16 v[248:251], v[108:111], v[32:35], v[248:251]
ds_read_b64_tr_b16 v[26:27], v11 offset:25088
mf16 v[236:239], v[104:107], v[36:39], v[236:239]
ds_read_b64_tr_b16 v[28:29], v12 offset:24576
mf16 v[252:255], v[108:111], v[36:39], v[252:255]
ds_read_b64_tr_b16 v[30:31], v12 offset:25088
s_waitcnt lgkmcnt(4)
mf16 v[224:227], v[112:115], v[40:43], v[224:227]
ds_read_b64_tr_b16 v[32:33], v9 offset:28672
mf16 v[240:243], v[116:119], v[40:43], v[240:243]
ds_read_b64_tr_b16 v[34:35], v9 offset:29184
mf16 v[228:231], v[112:115], v[44:47], v[228:231]
ds_read_b64_tr_b16 v[36:37], v10 offset:28672
mf16 v[244:247], v[116:119], v[44:47], v[244:247]
ds_read_b64_tr_b16 v[38:39], v10 offset:29184
s_waitcnt lgkmcnt(4)
mf16 v[232:235], v[112:115], v[24:27], v[232:235]
ds_read_b64_tr_b16 v[40:41], v11 offset:28672
mf16 v[248:251], v[116:119], v[24:27], v[248:251]
ds_read_b64_tr_b16 v[42:43], v11 offset:29184
mf16 v[236:239], v[112:115], v[28:31], v[236:239]
ds_read_b64_tr_b16 v[44:45], v12 offset:28672
mf16 v[252:255], v[116:119], v[28:31], v[252:255]
ds_read_b64_tr_b16 v[46:47], v12 offset:29184
s_waitcnt lgkmcnt(4)
mf16 v[224:227], v[120:123], v[32:35], v[224:227]
s_waitcnt vmcnt(6)
s_barrier
ds_read_b64_tr_b16 v[24:25], v9 offset:32768
mf16 v[240:243], v[124:127], v[32:35], v[240:243]
ds_read_b64_tr_b16 v[26:27], v9 offset:33280
mf16 v[228:231], v[120:123], v[36:39], v[228:231]
ds_read_b64_tr_b16 v[28:29], v10 offset:32768
mf16 v[244:247], v[124:127], v[36:39], v[244:247]
ds_read_b64_tr_b16 v[30:31], v10 offset:33280
s_waitcnt lgkmcnt(4)
mf16 v[232:235], v[120:123], v[40:43], v[232:235]
ds_read_b64_tr_b16 v[32:33], v11 offset:32768
mf16 v[248:251], v[124:127], v[40:43], v[248:251]
ds_read_b64_tr_b16 v[34:35], v11 offset:33280
mf16 v[236:239], v[120:123], v[44:47], v[236:239]
ds_read_b64_tr_b16 v[36:37], v12 offset:32768
mf16 v[252:255], v[124:127], v[44:47], v[252:255]
ds_read_b64_tr_b16 v[38:39], v12 offset:33280
s_waitcnt lgkmcnt(4)
mf16 v[224:227], v[128:131], v[24:27], v[224:227]
ds_read_b64_tr_b16 v[40:41], v9 offset:36864
mf16 v[240:243], v[132:135], v[24:27], v[240:243]
ds_read_b64_tr_b16 v[42:43], v9 offset:37376
mf16 v[228:231], v[128:131], v[28:31], v[228:231]
ds_read_b64_tr_b16 v[44:45], v10 offset:36864
mf16 v[244:247], v[132:135], v[28:31], v[244:247]
ds_read_b64_tr_b16 v[46:47], v10 offset:37376
s_waitcnt lgkmcnt(4)
mf16 v[232:235], v[128:131], v[32:35], v[232:235]
ds_read_b64_tr_b16 v[24:25], v11 offset:36864
mf16 v[248:251], v[132:135], v[32:35], v[248:251]
ds_read_b64_tr_b16 v[26:27], v11 offset:37376
mf16 v[236:239], v[128:131], v[36:39], v[236:239]
ds_read_b64_tr_b16 v[28:29], v12 offset:36864
mf16 v[252:255], v[132:135], v[36:39], v[252:255]
ds_read_b64_tr_b16 v[30:31], v12 offset:37376
s_waitcnt lgkmcnt(4)
mf16 v[224:227], v[136:139], v[40:43], v[224:227]
ds_read_b64_tr_b16 v[32:33], v9 offset:40960
mf16 v[240:243], v[140:143], v[40:43], v[240:243]
ds_read_b64_tr_b16 v[34:35], v9 offset:41472
mf16 v[228:231], v[136:139], v[44:47], v[228:231]
ds_read_b64_tr_b16 v[36:37], v10 offset:40960
mf16 v[244:247], v[140:143], v[44:47], v[244:247]
ds_read_b64_tr_b16 v[38:39], v10 offset:41472
s_waitcnt lgkmcnt(4)
mf16 v[232:235], v[136:139], v[24:27], v[232:235]
ds_read_b64_tr_b16 v[40:41], v11 offset:40960
mf16 v[248:251], v[140:143], v[24:27], v[248:251]
ds_read_b64_tr_b16 v[42:43], v11 offset:41472
mf16 v[236:239], v[136:139], v[28:31], v[236:239]
ds_read_b64_tr_b16 v[44:45], v12 offset:40960
mf16 v[252:255], v[140:143], v[28:31], v[252:255]
ds_read_b64_tr_b16 v[46:47], v12 offset:41472
s_waitcnt lgkmcnt(4)
mf16 v[224:227], v[144:147], v[32:35], v[224:227]
ds_read_b64_tr_b16 v[24:25], v9 offset:45056
mf16 v[240:243], v[148:151], v[32:35], v[240:243]
ds_read_b64_tr_b16 v[26:27], v9 offset:45568
mf16 v[228:231], v[144:147], v[36:39], v[228:231]
ds_read_b64_tr_b16 v[28:29], v10 offset:45056
mf16 v[244:247], v[148:151], v[36:39], v[244:247]
ds_read_b64_tr_b16 v[30:31], v10 offset:45568
s_waitcnt lgkmcnt(4)
mf16 v[232:235], v[144:147], v[40:43], v[232:235]
ds_read_b64_tr_b16 v[32:33], v11 offset:45056
mf16 v[248:251], v[148:151], v[40:43], v[248:251]
ds_read_b64_tr_b16 v[34:35], v11 offset:45568
mf16 v[236:239], v[144:147], v[44:47], v[236:239]
ds_read_b64_tr_b16 v[36:37], v12 offset:45056
mf16 v[252:255], v[148:151], v[44:47], v[252:255]
ds_read_b64_tr_b16 v[38:39], v12 offset:45568
s_waitcnt lgkmcnt(4)
mf16 v[224:227], v[152:155], v[24:27], v[224:227]
ds_read_b64_tr_b16 v[40:41], v9 offset:49152
mf16 v[240:243], v[156:159], v[24:27], v[240:243]
ds_read_b64_tr_b16 v[42:43], v9 offset:49664
mf16 v[228:231], v[152:155], v[28:31], v[228:231]
ds_read_b64_tr_b16 v[24:25], v10 offset:49152
mf16 v[244:247], v[156:159], v[28:31], v[244:247]
ds_read_b64_tr_b16 v[26:27], v10 offset:49664
s_waitcnt lgkmcnt(4)
mf16 v[232:235], v[152:155], v[32:35], v[232:235]
ds_read_b64_tr_b16 v[28:29], v11 offset:49152
mf16 v[248:251], v[156:159], v[32:35], v[248:251]
ds_read_b64_tr_b16 v[30:31], v11 offset:49664
mf16 v[236:239], v[152:155], v[36:39], v[236:239]
ds_read_b64_tr_b16 v[32:33], v12 offset:49152
mf16 v[252:255], v[156:159], v[36:39], v[252:255]
ds_read_b64_tr_b16 v[34:35], v12 offset:49664
s_waitcnt lgkmcnt(4)
mf16 v[224:227], v[160:163], v[40:43], v[224:227]
ds_read_b64_tr_b16 v[36:37], v9 offset:53248
mf16 v[240:243], v[164:167], v[40:43], v[240:243]
ds_read_b64_tr_b16 v[38:39], v9 offset:53760
mf16 v[228:231], v[160:163], v[24:27], v[228:231]
ds_read_b64_tr_b16 v[40:41], v10 offset:53248
mf16 v[244:247], v[164:167], v[24:27], v[244:247]
ds_read_b64_tr_b16 v[42:43], v10 offset:53760
s_waitcnt lgkmcnt(4)
mf16 v[232:235], v[160:163], v[28:31], v[232:235]
ds_read_b64_tr_b16 v[24:25], v11 offset:53248
mf16 v[248:251], v[164:167], v[28:31], v[248:251]
ds_read_b64_tr_b16 v[26:27], v11 offset:53760
mf16 v[236:239], v[160:163], v[32:35], v[236:239]
ds_read_b64_tr_b16 v[28:29], v12 offset:53248
mf16 v[252:255], v[164:167], v[32:35], v[252:255]
ds_read_b64_tr_b16 v[30:31], v12 offset:53760
s_waitcnt lgkmcnt(4)
mf16 v[224:227], v[168:171], v[36:39], v[224:227]
ds_read_b64_tr_b16 v[32:33], v9 offset:57344
mf16 v[240:243], v[172:175], v[36:39], v[240:243]
ds_read_b64_tr_b16 v[34:35], v9 offset:57856
mf16 v[228:231], v[168:171], v[40:43], v[228:231]
ds_read_b64_tr_b16 v[36:37], v10 offset:57344
mf16 v[244:247], v[172:175], v[40:43], v[244:247]
ds_read_b64_tr_b16 v[38:39], v10 offset:57856
s_waitcnt lgkmcnt(4)
mf16 v[232:235], v[168:171], v[24:27], v[232:235]
ds_read_b64_tr_b16 v[40:41], v11 offset:57344
mf16 v[248:251], v[172:175], v[24:27], v[248:251]
ds_read_b64_tr_b16 v[42:43], v11 offset:57856
mf16 v[236:239], v[168:171], v[28:31], v[236:239]
ds_read_b64_tr_b16 v[24:25], v12 offset:57344
mf16 v[252:255], v[172:175], v[28:31], v[252:255]
ds_read_b64_tr_b16 v[26:27], v12 offset:57856
s_waitcnt lgkmcnt(4)
mf16 v[224:227], v[176:179], v[32:35], v[224:227]
ds_read_b64_tr_b16 v[28:29], v9 offset:61440
mf16 v[240:243], v[180:183], v[32:35], v[240:243]
ds_read_b64_tr_b16 v[30:31], v9 offset:61952
mf16 v[228:231], v[176:179], v[36:39], v[228:231]
ds_read_b64_tr_b16 v[32:33], v10 offset:61440
mf16 v[244:247], v[180:183], v[36:39], v[244:247]
ds_read_b64_tr_b16 v[34:35], v10 offset:61952
s_waitcnt lgkmcnt(4)
mf16 v[232:235], v[176:179], v[40:43], v[232:235]
ds_read_b64_tr_b16 v[36:37], v11 offset:61440
mf16 v[248:251], v[180:183], v[40:43], v[248:251]
ds_read_b64_tr_b16 v[38:39], v11 offset:61952
mf16 v[236:239], v[176:179], v[24:27], v[236:239]
ds_read_b64_tr_b16 v[40:41], v12 offset:61440
mf16 v[252:255], v[180:183], v[24:27], v[252:255]
ds_read_b64_tr_b16 v[42:43], v12 offset:61952
s_waitcnt lgkmcnt(4)
mf16 v[224:227], v[184:187], v[28:31], v[224:227]
mf16 v[240:243], v[188:191], v[28:31], v[240:243]
mf16 v[228:231], v[184:187], v[32:35], v[228:231]
mf16 v[244:247], v[188:191], v[32:35], v[244:247]
s_waitcnt lgkmcnt(0)
mf16 v[232:235], v[184:187], v[36:39], v[232:235]
mf16 v[248:251], v[188:191], v[36:39], v[248:251]
mf16 v[236:239], v[184:187], v[40:43], v[236:239]
mf16 v[252:255], v[188:191], v[40:43], v[252:255]
v_mov_b32 v48, v52
v_mov_b32 v49, v53
v_mov_b32 v50, v54
v_mov_b32 v51, v55
s_add_u32 s66, s66, 0x400000
s_nop 7
s_add_u32 s55, s43, 4096
cvtpk v56, v224, v225
cvtpk v57, v226, v227
cvtpk v58, v240, v241
cvtpk v59, v242, v243
buffer_store_dwordx4 v[56:59], v22, s[36:39], s55 offen offset:0 sc1
cvtpk v60, v228, v229
cvtpk v61, v230, v231
cvtpk v62, v244, v245
cvtpk v63, v246, v247
buffer_store_dwordx4 v[60:63], v22, s[36:39], s55 offen offset:256 sc1
cvtpk v56, v232, v233
cvtpk v57, v234, v235
cvtpk v58, v248, v249
cvtpk v59, v250, v251
buffer_store_dwordx4 v[56:59], v22, s[36:39], s55 offen offset:2048 sc1
cvtpk v60, v236, v237
cvtpk v61, v238, v239
cvtpk v62, v252, v253
cvtpk v63, v254, v255
buffer_store_dwordx4 v[60:63], v22, s[36:39], s55 offen offset:2304 sc1
s_endpgm
l1_kernel_B:
s_waitcnt lgkmcnt(0)
s_waitcnt vmcnt(12)
ds_read_b128 v[64:67], v7 offset:0
ds_read_b128 v[68:71], v8 offset:1024
ds_read_b128 v[72:75], v8 offset:0
ds_read_b128 v[76:79], v7 offset:1024
s_waitcnt vmcnt(8)
s_barrier
ds_read_b128 v[48:51], v56
ds_read_b64_tr_b16 v[24:25], v13 offset:0
ds_read_b64_tr_b16 v[26:27], v13 offset:512
ds_read_b64_tr_b16 v[28:29], v14 offset:0
ds_read_b64_tr_b16 v[30:31], v14 offset:512
ds_read_b64_tr_b16 v[32:33], v15 offset:0
ds_read_b64_tr_b16 v[34:35], v15 offset:512
ds_read_b64_tr_b16 v[36:37], v16 offset:0
ds_read_b64_tr_b16 v[38:39], v16 offset:512
s_waitcnt lgkmcnt(4)
mf16 v[192:195], v[64:67], v[24:27], 0
ds_read_b64_tr_b16 v[40:41], v13 offset:16384
mf16 v[208:211], v[68:71], v[24:27], 0
ds_read_b64_tr_b16 v[42:43], v13 offset:16896
s_add_u32 m0, s46, 0x0
s_mov_b32 s45, 256
buffer_load_dwordx4 v3, s[20:23], s45 offen offset:0 lds
mf16 v[196:199], v[64:67], v[28:31], 0
ds_read_b64_tr_b16 v[44:45], v14 offset:16384
mf16 v[212:215], v[68:71], v[28:31], 0
ds_read_b64_tr_b16 v[46:47], v14 offset:16896
s_waitcnt lgkmcnt(4)
mf16 v[200:203], v[64:67], v[32:35], 0
ds_read_b64_tr_b16 v[24:25], v15 offset:16384
mf16 v[216:219], v[68:71], v[32:35], 0
ds_read_b64_tr_b16 v[26:27], v15 offset:16896
buffer_load_dwordx4 v4, s[20:23], s45 offen offset:1024 lds
mf16 v[204:207], v[64:67], v[36:39], 0
ds_read_b64_tr_b16 v[28:29], v16 offset:16384
mf16 v[220:223], v[68:71], v[36:39], 0
ds_read_b64_tr_b16 v[30:31], v16 offset:16896
s_waitcnt lgkmcnt(4)
mf16 v[224:227], v[64:67], v[40:43], 0
ds_read_b64_tr_b16 v[32:33], v13 offset:4096
mf16 v[240:243], v[68:71], v[40:43], 0
ds_read_b64_tr_b16 v[34:35], v13 offset:4608
buffer_load_dwordx4 v5, s[20:23], s45 offen offset:2048 lds
mf16 v[228:231], v[64:67], v[44:47], 0
ds_read_b64_tr_b16 v[36:37], v14 offset:4096
mf16 v[244:247], v[68:71], v[44:47], 0
ds_read_b64_tr_b16 v[38:39], v14 offset:4608
s_waitcnt lgkmcnt(4)
mf16 v[232:235], v[64:67], v[24:27], 0
ds_read_b64_tr_b16 v[40:41], v15 offset:4096
mf16 v[248:251], v[68:71], v[24:27], 0
ds_read_b64_tr_b16 v[42:43], v15 offset:4608
buffer_load_dwordx4 v6, s[20:23], s45 offen offset:3072 lds
mf16 v[236:239], v[64:67], v[28:31], 0
ds_read_b64_tr_b16 v[44:45], v16 offset:4096
mf16 v[252:255], v[68:71], v[28:31], 0
ds_read_b64_tr_b16 v[46:47], v16 offset:4608
s_waitcnt lgkmcnt(4)
mf16 v[192:195], v[72:75], v[32:35], v[192:195]
ds_read_b64_tr_b16 v[24:25], v13 offset:20480
mf16 v[208:211], v[76:79], v[32:35], v[208:211]
ds_read_b64_tr_b16 v[26:27], v13 offset:20992
s_add_u32 m0, s47, 0x20000
s_add_u32 s45, s48, 0x200000
buffer_load_dwordx4 v1, s[24:27], s45 offen offset:0 lds
mf16 v[196:199], v[72:75], v[36:39], v[196:199]
ds_read_b64_tr_b16 v[28:29], v14 offset:20480
mf16 v[212:215], v[76:79], v[36:39], v[212:215]
ds_read_b64_tr_b16 v[30:31], v14 offset:20992
s_waitcnt lgkmcnt(4)
mf16 v[200:203], v[72:75], v[40:43], v[200:203]
ds_read_b64_tr_b16 v[32:33], v15 offset:20480
mf16 v[216:219], v[76:79], v[40:43], v[216:219]
ds_read_b64_tr_b16 v[34:35], v15 offset:20992
buffer_load_dwordx4 v2, s[24:27], s45 offen offset:1024 lds
mf16 v[204:207], v[72:75], v[44:47], v[204:207]
ds_read_b64_tr_b16 v[36:37], v16 offset:20480
mf16 v[220:223], v[76:79], v[44:47], v[220:223]
ds_read_b64_tr_b16 v[38:39], v16 offset:20992
s_waitcnt lgkmcnt(4)
mf16 v[224:227], v[72:75], v[24:27], v[224:227]
s_waitcnt vmcnt(10)
ds_read_b128 v[80:83], v7 offset:4096
ds_read_b128 v[84:87], v8 offset:5120
ds_read_b128 v[88:91], v8 offset:4096
ds_read_b128 v[92:95], v7 offset:5120
ds_read_b64_tr_b16 v[40:41], v13 offset:8192
mf16 v[240:243], v[76:79], v[24:27], v[240:243]
ds_read_b64_tr_b16 v[42:43], v13 offset:8704
mf16 v[228:231], v[72:75], v[28:31], v[228:231]
ds_read_b64_tr_b16 v[44:45], v14 offset:8192
mf16 v[244:247], v[76:79], v[28:31], v[244:247]
ds_read_b64_tr_b16 v[46:47], v14 offset:8704
s_waitcnt lgkmcnt(8)
mf16 v[232:235], v[72:75], v[32:35], v[232:235]
ds_read_b64_tr_b16 v[24:25], v15 offset:8192
mf16 v[248:251], v[76:79], v[32:35], v[248:251]
ds_read_b64_tr_b16 v[26:27], v15 offset:8704
mf16 v[236:239], v[72:75], v[36:39], v[236:239]
ds_read_b64_tr_b16 v[28:29], v16 offset:8192
mf16 v[252:255], v[76:79], v[36:39], v[252:255]
ds_read_b64_tr_b16 v[30:31], v16 offset:8704
s_waitcnt lgkmcnt(4)
mf16 v[192:195], v[80:83], v[40:43], v[192:195]
ds_read_b64_tr_b16 v[32:33], v13 offset:24576
mf16 v[208:211], v[84:87], v[40:43], v[208:211]
ds_read_b64_tr_b16 v[34:35], v13 offset:25088
s_add_u32 m0, s46, 0x1000
s_mov_b32 s45, 384
buffer_load_dwordx4 v3, s[20:23], s45 offen offset:0 lds
mf16 v[196:199], v[80:83], v[44:47], v[196:199]
ds_read_b64_tr_b16 v[36:37], v14 offset:24576
mf16 v[212:215], v[84:87], v[44:47], v[212:215]
ds_read_b64_tr_b16 v[38:39], v14 offset:25088
s_waitcnt lgkmcnt(4)
mf16 v[200:203], v[80:83], v[24:27], v[200:203]
ds_read_b64_tr_b16 v[40:41], v15 offset:24576
mf16 v[216:219], v[84:87], v[24:27], v[216:219]
ds_read_b64_tr_b16 v[42:43], v15 offset:25088
buffer_load_dwordx4 v4, s[20:23], s45 offen offset:1024 lds
mf16 v[204:207], v[80:83], v[28:31], v[204:207]
ds_read_b64_tr_b16 v[44:45], v16 offset:24576
mf16 v[220:223], v[84:87], v[28:31], v[220:223]
ds_read_b64_tr_b16 v[46:47], v16 offset:25088
s_waitcnt lgkmcnt(4)
mf16 v[224:227], v[80:83], v[32:35], v[224:227]
ds_read_b64_tr_b16 v[24:25], v13 offset:12288
mf16 v[240:243], v[84:87], v[32:35], v[240:243]
ds_read_b64_tr_b16 v[26:27], v13 offset:12800
buffer_load_dwordx4 v5, s[20:23], s45 offen offset:2048 lds
mf16 v[228:231], v[80:83], v[36:39], v[228:231]
ds_read_b64_tr_b16 v[28:29], v14 offset:12288
mf16 v[244:247], v[84:87], v[36:39], v[244:247]
ds_read_b64_tr_b16 v[30:31], v14 offset:12800
s_waitcnt lgkmcnt(4)
mf16 v[232:235], v[80:83], v[40:43], v[232:235]
ds_read_b64_tr_b16 v[32:33], v15 offset:12288
mf16 v[248:251], v[84:87], v[40:43], v[248:251]
ds_read_b64_tr_b16 v[34:35], v15 offset:12800
buffer_load_dwordx4 v6, s[20:23], s45 offen offset:3072 lds
mf16 v[236:239], v[80:83], v[44:47], v[236:239]
ds_read_b64_tr_b16 v[36:37], v16 offset:12288
mf16 v[252:255], v[84:87], v[44:47], v[252:255]
ds_read_b64_tr_b16 v[38:39], v16 offset:12800
s_waitcnt lgkmcnt(4)
mf16 v[192:195], v[88:91], v[24:27], v[192:195]
ds_read_b64_tr_b16 v[40:41], v13 offset:28672
mf16 v[208:211], v[92:95], v[24:27], v[208:211]
ds_read_b64_tr_b16 v[42:43], v13 offset:29184
mf16 v[196:199], v[88:91], v[28:31], v[196:199]
ds_read_b64_tr_b16 v[44:45], v14 offset:28672
mf16 v[212:215], v[92:95], v[28:31], v[212:215]
ds_read_b64_tr_b16 v[46:47], v14 offset:29184
s_waitcnt lgkmcnt(4)
mf16 v[200:203], v[88:91], v[32:35], v[200:203]
ds_read_b64_tr_b16 v[24:25], v15 offset:28672
mf16 v[216:219], v[92:95], v[32:35], v[216:219]
ds_read_b64_tr_b16 v[26:27], v15 offset:29184
mf16 v[204:207], v[88:91], v[36:39], v[204:207]
ds_read_b64_tr_b16 v[28:29], v16 offset:28672
mf16 v[220:223], v[92:95], v[36:39], v[220:223]
ds_read_b64_tr_b16 v[30:31], v16 offset:29184
s_waitcnt lgkmcnt(4)
mf16 v[224:227], v[88:91], v[40:43], v[224:227]
s_waitcnt vmcnt(10)
s_barrier
s_waitcnt vmcnt(6)
ds_read_b128 v[96:99], v7 offset:0
ds_read_b128 v[100:103], v8 offset:1024
ds_read_b128 v[104:107], v8 offset:0
ds_read_b128 v[108:111], v7 offset:1024
ds_read_b64_tr_b16 v[32:33], v13 offset:32768
mf16 v[240:243], v[92:95], v[40:43], v[240:243]
ds_read_b64_tr_b16 v[34:35], v13 offset:33280
s_add_u32 m0, s47, 0x24000
s_add_u32 s45, s48, 0x200080
buffer_load_dwordx4 v1, s[24:27], s45 offen offset:0 lds
mf16 v[228:231], v[88:91], v[44:47], v[228:231]
ds_read_b64_tr_b16 v[36:37], v14 offset:32768
mf16 v[244:247], v[92:95], v[44:47], v[244:247]
ds_read_b64_tr_b16 v[38:39], v14 offset:33280
s_waitcnt lgkmcnt(8)
mf16 v[232:235], v[88:91], v[24:27], v[232:235]
ds_read_b64_tr_b16 v[40:41], v15 offset:32768
mf16 v[248:251], v[92:95], v[24:27], v[248:251]
ds_read_b64_tr_b16 v[42:43], v15 offset:33280
buffer_load_dwordx4 v2, s[24:27], s45 offen offset:1024 lds
mf16 v[236:239], v[88:91], v[28:31], v[236:239]
ds_read_b64_tr_b16 v[44:45], v16 offset:32768
mf16 v[252:255], v[92:95], v[28:31], v[252:255]
ds_read_b64_tr_b16 v[46:47], v16 offset:33280
s_waitcnt lgkmcnt(4)
mf16 v[192:195], v[96:99], v[32:35], v[192:195]
ds_read_b64_tr_b16 v[24:25], v13 offset:49152
mf16 v[208:211], v[100:103], v[32:35], v[208:211]
ds_read_b64_tr_b16 v[26:27], v13 offset:49664
s_add_u32 m0, s46, 0x0
s_mov_b32 s45, 512
buffer_load_dwordx4 v3, s[20:23], s45 offen offset:0 lds
mf16 v[196:199], v[96:99], v[36:39], v[196:199]
ds_read_b64_tr_b16 v[28:29], v14 offset:49152
mf16 v[212:215], v[100:103], v[36:39], v[212:215]
ds_read_b64_tr_b16 v[30:31], v14 offset:49664
s_waitcnt lgkmcnt(4)
mf16 v[200:203], v[96:99], v[40:43], v[200:203]
ds_read_b64_tr_b16 v[32:33], v15 offset:49152
mf16 v[216:219], v[100:103], v[40:43], v[216:219]
ds_read_b64_tr_b16 v[34:35], v15 offset:49664
buffer_load_dwordx4 v4, s[20:23], s45 offen offset:1024 lds
mf16 v[204:207], v[96:99], v[44:47], v[204:207]
ds_read_b64_tr_b16 v[36:37], v16 offset:49152
mf16 v[220:223], v[100:103], v[44:47], v[220:223]
ds_read_b64_tr_b16 v[38:39], v16 offset:49664
s_waitcnt lgkmcnt(4)
mf16 v[224:227], v[96:99], v[24:27], v[224:227]
ds_read_b64_tr_b16 v[40:41], v13 offset:36864
mf16 v[240:243], v[100:103], v[24:27], v[240:243]
ds_read_b64_tr_b16 v[42:43], v13 offset:37376
buffer_load_dwordx4 v5, s[20:23], s45 offen offset:2048 lds
mf16 v[228:231], v[96:99], v[28:31], v[228:231]
ds_read_b64_tr_b16 v[44:45], v14 offset:36864
mf16 v[244:247], v[100:103], v[28:31], v[244:247]
ds_read_b64_tr_b16 v[46:47], v14 offset:37376
s_waitcnt lgkmcnt(4)
mf16 v[232:235], v[96:99], v[32:35], v[232:235]
ds_read_b64_tr_b16 v[24:25], v15 offset:36864
mf16 v[248:251], v[100:103], v[32:35], v[248:251]
ds_read_b64_tr_b16 v[26:27], v15 offset:37376
buffer_load_dwordx4 v6, s[20:23], s45 offen offset:3072 lds
mf16 v[236:239], v[96:99], v[36:39], v[236:239]
ds_read_b64_tr_b16 v[28:29], v16 offset:36864
mf16 v[252:255], v[100:103], v[36:39], v[252:255]
ds_read_b64_tr_b16 v[30:31], v16 offset:37376
s_waitcnt lgkmcnt(4)
mf16 v[192:195], v[104:107], v[40:43], v[192:195]
ds_read_b64_tr_b16 v[32:33], v13 offset:53248
mf16 v[208:211], v[108:111], v[40:43], v[208:211]
ds_read_b64_tr_b16 v[34:35], v13 offset:53760
s_add_u32 s12, s19, 0
buffer_load_ushort v56, v52, s[8:11], s12 offen nt
mf16 v[196:199], v[104:107], v[44:47], v[196:199]
ds_read_b64_tr_b16 v[36:37], v14 offset:53248
mf16 v[212:215], v[108:111], v[44:47], v[212:215]
ds_read_b64_tr_b16 v[38:39], v14 offset:53760
s_waitcnt lgkmcnt(4)
mf16 v[200:203], v[104:107], v[24:27], v[200:203]
ds_read_b64_tr_b16 v[40:41], v15 offset:53248
mf16 v[216:219], v[108:111], v[24:27], v[216:219]
ds_read_b64_tr_b16 v[42:43], v15 offset:53760
s_add_u32 s12, s19, 16448
buffer_load_ushort v57, v52, s[8:11], s12 offen nt
mf16 v[204:207], v[104:107], v[28:31], v[204:207]
ds_read_b64_tr_b16 v[44:45], v16 offset:53248
mf16 v[220:223], v[108:111], v[28:31], v[220:223]
ds_read_b64_tr_b16 v[46:47], v16 offset:53760
s_waitcnt lgkmcnt(4)
mf16 v[224:227], v[104:107], v[32:35], v[224:227]
s_waitcnt vmcnt(8)
ds_read_b128 v[112:115], v7 offset:4096
ds_read_b128 v[116:119], v8 offset:5120
ds_read_b128 v[120:123], v8 offset:4096
ds_read_b128 v[124:127], v7 offset:5120
ds_read_b64_tr_b16 v[24:25], v13 offset:40960
mf16 v[240:243], v[108:111], v[32:35], v[240:243]
ds_read_b64_tr_b16 v[26:27], v13 offset:41472
s_add_u32 s12, s19, 32896
buffer_load_ushort v58, v52, s[8:11], s12 offen nt
mf16 v[228:231], v[104:107], v[36:39], v[228:231]
ds_read_b64_tr_b16 v[28:29], v14 offset:40960
mf16 v[244:247], v[108:111], v[36:39], v[244:247]
ds_read_b64_tr_b16 v[30:31], v14 offset:41472
s_waitcnt lgkmcnt(8)
mf16 v[232:235], v[104:107], v[40:43], v[232:235]
ds_read_b64_tr_b16 v[32:33], v15 offset:40960
mf16 v[248:251], v[108:111], v[40:43], v[248:251]
ds_read_b64_tr_b16 v[34:35], v15 offset:41472
s_add_u32 s12, s19, 49344
buffer_load_ushort v59, v52, s[8:11], s12 offen nt
mf16 v[236:239], v[104:107], v[44:47], v[236:239]
ds_read_b64_tr_b16 v[36:37], v16 offset:40960
mf16 v[252:255], v[108:111], v[44:47], v[252:255]
ds_read_b64_tr_b16 v[38:39], v16 offset:41472
s_waitcnt lgkmcnt(4)
mf16 v[192:195], v[112:115], v[24:27], v[192:195]
ds_read_b64_tr_b16 v[40:41], v13 offset:57344
mf16 v[208:211], v[116:119], v[24:27], v[208:211]
ds_read_b64_tr_b16 v[42:43], v13 offset:57856
s_add_u32 m0, s46, 0x1000
s_mov_b32 s45, 640
buffer_load_dwordx4 v3, s[20:23], s45 offen offset:0 lds
mf16 v[196:199], v[112:115], v[28:31], v[196:199]
ds_read_b64_tr_b16 v[44:45], v14 offset:57344
mf16 v[212:215], v[116:119], v[28:31], v[212:215]
ds_read_b64_tr_b16 v[46:47], v14 offset:57856
s_waitcnt lgkmcnt(4)
mf16 v[200:203], v[112:115], v[32:35], v[200:203]
ds_read_b64_tr_b16 v[24:25], v15 offset:57344
mf16 v[216:219], v[116:119], v[32:35], v[216:219]
ds_read_b64_tr_b16 v[26:27], v15 offset:57856
buffer_load_dwordx4 v4, s[20:23], s45 offen offset:1024 lds
mf16 v[204:207], v[112:115], v[36:39], v[204:207]
ds_read_b64_tr_b16 v[28:29], v16 offset:57344
mf16 v[220:223], v[116:119], v[36:39], v[220:223]
ds_read_b64_tr_b16 v[30:31], v16 offset:57856
s_waitcnt lgkmcnt(4)
mf16 v[224:227], v[112:115], v[40:43], v[224:227]
ds_read_b64_tr_b16 v[32:33], v13 offset:45056
mf16 v[240:243], v[116:119], v[40:43], v[240:243]
ds_read_b64_tr_b16 v[34:35], v13 offset:45568
buffer_load_dwordx4 v5, s[20:23], s45 offen offset:2048 lds
mf16 v[228:231], v[112:115], v[44:47], v[228:231]
ds_read_b64_tr_b16 v[36:37], v14 offset:45056
mf16 v[244:247], v[116:119], v[44:47], v[244:247]
ds_read_b64_tr_b16 v[38:39], v14 offset:45568
s_waitcnt lgkmcnt(4)
mf16 v[232:235], v[112:115], v[24:27], v[232:235]
ds_read_b64_tr_b16 v[40:41], v15 offset:45056
mf16 v[248:251], v[116:119], v[24:27], v[248:251]
ds_read_b64_tr_b16 v[42:43], v15 offset:45568
buffer_load_dwordx4 v6, s[20:23], s45 offen offset:3072 lds
mf16 v[236:239], v[112:115], v[28:31], v[236:239]
ds_read_b64_tr_b16 v[44:45], v16 offset:45056
mf16 v[252:255], v[116:119], v[28:31], v[252:255]
ds_read_b64_tr_b16 v[46:47], v16 offset:45568
s_waitcnt lgkmcnt(4)
mf16 v[192:195], v[120:123], v[32:35], v[192:195]
ds_read_b64_tr_b16 v[24:25], v13 offset:61440
mf16 v[208:211], v[124:127], v[32:35], v[208:211]
ds_read_b64_tr_b16 v[26:27], v13 offset:61952
s_add_u32 s12, s19, 131584
buffer_load_ushort v60, v52, s[8:11], s12 offen nt
mf16 v[196:199], v[120:123], v[36:39], v[196:199]
ds_read_b64_tr_b16 v[28:29], v14 offset:61440
mf16 v[212:215], v[124:127], v[36:39], v[212:215]
ds_read_b64_tr_b16 v[30:31], v14 offset:61952
s_waitcnt lgkmcnt(4)
mf16 v[200:203], v[120:123], v[40:43], v[200:203]
ds_read_b64_tr_b16 v[32:33], v15 offset:61440
mf16 v[216:219], v[124:127], v[40:43], v[216:219]
ds_read_b64_tr_b16 v[34:35], v15 offset:61952
s_add_u32 s12, s19, 148032
buffer_load_ushort v61, v52, s[8:11], s12 offen nt
mf16 v[204:207], v[120:123], v[44:47], v[204:207]
ds_read_b64_tr_b16 v[36:37], v16 offset:61440
mf16 v[220:223], v[124:127], v[44:47], v[220:223]
ds_read_b64_tr_b16 v[38:39], v16 offset:61952
s_waitcnt lgkmcnt(4)
mf16 v[224:227], v[120:123], v[24:27], v[224:227]
s_waitcnt vmcnt(14)
s_barrier
s_waitcnt vmcnt(10)
ds_read_b128 v[128:131], v7 offset:0
ds_read_b128 v[132:135], v8 offset:1024
ds_read_b128 v[136:139], v8 offset:0
ds_read_b128 v[140:143], v7 offset:1024
ds_read_b64_tr_b16 v[40:41], v17 offset:0
mf16 v[240:243], v[124:127], v[24:27], v[240:243]
ds_read_b64_tr_b16 v[42:43], v17 offset:512
s_add_u32 m0, s47, 0x10000
s_add_u32 s45, s48, 0x300000
buffer_load_dwordx4 v1, s[24:27], s45 offen offset:0 lds
mf16 v[228:231], v[120:123], v[28:31], v[228:231]
ds_read_b64_tr_b16 v[44:45], v18 offset:0
mf16 v[244:247], v[124:127], v[28:31], v[244:247]
ds_read_b64_tr_b16 v[46:47], v18 offset:512
s_waitcnt lgkmcnt(8)
mf16 v[232:235], v[120:123], v[32:35], v[232:235]
ds_read_b64_tr_b16 v[24:25], v19 offset:0
mf16 v[248:251], v[124:127], v[32:35], v[248:251]
ds_read_b64_tr_b16 v[26:27], v19 offset:512
buffer_load_dwordx4 v2, s[24:27], s45 offen offset:1024 lds
mf16 v[236:239], v[120:123], v[36:39], v[236:239]
ds_read_b64_tr_b16 v[28:29], v20 offset:0
mf16 v[252:255], v[124:127], v[36:39], v[252:255]
ds_read_b64_tr_b16 v[30:31], v20 offset:512
s_waitcnt lgkmcnt(4)
mf16 v[192:195], v[128:131], v[40:43], v[192:195]
ds_read_b64_tr_b16 v[32:33], v17 offset:16384
mf16 v[208:211], v[132:135], v[40:43], v[208:211]
ds_read_b64_tr_b16 v[34:35], v17 offset:16896
s_add_u32 m0, s46, 0x0
s_mov_b32 s45, 768
buffer_load_dwordx4 v3, s[20:23], s45 offen offset:0 lds
mf16 v[196:199], v[128:131], v[44:47], v[196:199]
ds_read_b64_tr_b16 v[36:37], v18 offset:16384
mf16 v[212:215], v[132:135], v[44:47], v[212:215]
ds_read_b64_tr_b16 v[38:39], v18 offset:16896
s_waitcnt lgkmcnt(4)
mf16 v[200:203], v[128:131], v[24:27], v[200:203]
ds_read_b64_tr_b16 v[40:41], v19 offset:16384
mf16 v[216:219], v[132:135], v[24:27], v[216:219]
ds_read_b64_tr_b16 v[42:43], v19 offset:16896
buffer_load_dwordx4 v4, s[20:23], s45 offen offset:1024 lds
mf16 v[204:207], v[128:131], v[28:31], v[204:207]
ds_read_b64_tr_b16 v[44:45], v20 offset:16384
mf16 v[220:223], v[132:135], v[28:31], v[220:223]
ds_read_b64_tr_b16 v[46:47], v20 offset:16896
s_waitcnt lgkmcnt(4)
mf16 v[224:227], v[128:131], v[32:35], v[224:227]
ds_read_b64_tr_b16 v[24:25], v17 offset:4096
mf16 v[240:243], v[132:135], v[32:35], v[240:243]
ds_read_b64_tr_b16 v[26:27], v17 offset:4608
buffer_load_dwordx4 v5, s[20:23], s45 offen offset:2048 lds
mf16 v[228:231], v[128:131], v[36:39], v[228:231]
ds_read_b64_tr_b16 v[28:29], v18 offset:4096
mf16 v[244:247], v[132:135], v[36:39], v[244:247]
ds_read_b64_tr_b16 v[30:31], v18 offset:4608
s_waitcnt lgkmcnt(4)
mf16 v[232:235], v[128:131], v[40:43], v[232:235]
ds_read_b64_tr_b16 v[32:33], v19 offset:4096
mf16 v[248:251], v[132:135], v[40:43], v[248:251]
ds_read_b64_tr_b16 v[34:35], v19 offset:4608
buffer_load_dwordx4 v6, s[20:23], s45 offen offset:3072 lds
mf16 v[236:239], v[128:131], v[44:47], v[236:239]
ds_read_b64_tr_b16 v[36:37], v20 offset:4096
s_add_u32 m0, s47, 0x14000
s_add_u32 s45, s48, 0x300080
buffer_load_dwordx4 v1, s[24:27], s45 offen offset:0 lds
buffer_load_dwordx4 v2, s[24:27], s45 offen offset:1024 lds
s_add_u32 s12, s19, 164480
buffer_load_ushort v62, v52, s[8:11], s12 offen nt
s_add_u32 s12, s19, 180928
buffer_load_ushort v63, v52, s[8:11], s12 offen nt
buffer_load_ushort v55, v53, s[8:11], s19 offen nt
s_waitcnt vmcnt(0)
v_lshlrev_b32 v54, 1, v0
mf16 v[252:255], v[132:135], v[44:47], v[252:255]
ds_read_b64_tr_b16 v[38:39], v20 offset:4608
s_waitcnt lgkmcnt(4)
mf16 v[192:195], v[136:139], v[24:27], v[192:195]
ds_read_b64_tr_b16 v[40:41], v17 offset:20480
s_mov_b64 exec, 0xff
buffer_store_short v55, v54, s[60:63], s67 offen
s_mov_b64 exec, -1
mf16 v[208:211], v[140:143], v[24:27], v[208:211]
ds_read_b64_tr_b16 v[42:43], v17 offset:20992
v_lshl_or_b32 v52, v57, 16, v56
mf16 v[196:199], v[136:139], v[28:31], v[196:199]
ds_read_b64_tr_b16 v[44:45], v18 offset:20480
v_lshl_or_b32 v53, v59, 16, v58
mf16 v[212:215], v[140:143], v[28:31], v[212:215]
ds_read_b64_tr_b16 v[46:47], v18 offset:20992
s_waitcnt lgkmcnt(4)
mf16 v[200:203], v[136:139], v[32:35], v[200:203]
ds_read_b64_tr_b16 v[24:25], v19 offset:20480
v_lshl_or_b32 v54, v61, 16, v60
mf16 v[216:219], v[140:143], v[32:35], v[216:219]
ds_read_b64_tr_b16 v[26:27], v19 offset:20992
v_lshl_or_b32 v55, v63, 16, v62
mf16 v[204:207], v[136:139], v[36:39], v[204:207]
ds_read_b64_tr_b16 v[28:29], v20 offset:20480
mf16 v[220:223], v[140:143], v[36:39], v[220:223]
ds_read_b64_tr_b16 v[30:31], v20 offset:20992
s_waitcnt lgkmcnt(4)
mf16 v[224:227], v[136:139], v[40:43], v[224:227]
ds_read_b128 v[144:147], v7 offset:4096
ds_read_b128 v[148:151], v8 offset:5120
ds_read_b128 v[152:155], v8 offset:4096
ds_read_b128 v[156:159], v7 offset:5120
ds_read_b64_tr_b16 v[32:33], v17 offset:8192
mf16 v[240:243], v[140:143], v[40:43], v[240:243]
ds_read_b64_tr_b16 v[34:35], v17 offset:8704
mf16 v[228:231], v[136:139], v[44:47], v[228:231]
ds_read_b64_tr_b16 v[36:37], v18 offset:8192
mf16 v[244:247], v[140:143], v[44:47], v[244:247]
ds_read_b64_tr_b16 v[38:39], v18 offset:8704
s_waitcnt lgkmcnt(8)
mf16 v[232:235], v[136:139], v[24:27], v[232:235]
ds_read_b64_tr_b16 v[40:41], v19 offset:8192
mf16 v[248:251], v[140:143], v[24:27], v[248:251]
ds_read_b64_tr_b16 v[42:43], v19 offset:8704
mf16 v[236:239], v[136:139], v[28:31], v[236:239]
ds_read_b64_tr_b16 v[44:45], v20 offset:8192
mf16 v[252:255], v[140:143], v[28:31], v[252:255]
ds_read_b64_tr_b16 v[46:47], v20 offset:8704
s_waitcnt lgkmcnt(4)
mf16 v[192:195], v[144:147], v[32:35], v[192:195]
ds_read_b64_tr_b16 v[24:25], v17 offset:24576
mf16 v[208:211], v[148:151], v[32:35], v[208:211]
ds_read_b64_tr_b16 v[26:27], v17 offset:25088
s_add_u32 m0, s46, 0x1000
s_mov_b32 s45, 896
buffer_load_dwordx4 v3, s[20:23], s45 offen offset:0 lds
mf16 v[196:199], v[144:147], v[36:39], v[196:199]
ds_read_b64_tr_b16 v[28:29], v18 offset:24576
mf16 v[212:215], v[148:151], v[36:39], v[212:215]
ds_read_b64_tr_b16 v[30:31], v18 offset:25088
s_waitcnt lgkmcnt(4)
mf16 v[200:203], v[144:147], v[40:43], v[200:203]
ds_read_b64_tr_b16 v[32:33], v19 offset:24576
mf16 v[216:219], v[148:151], v[40:43], v[216:219]
ds_read_b64_tr_b16 v[34:35], v19 offset:25088
buffer_load_dwordx4 v4, s[20:23], s45 offen offset:1024 lds
mf16 v[204:207], v[144:147], v[44:47], v[204:207]
ds_read_b64_tr_b16 v[36:37], v20 offset:24576
mf16 v[220:223], v[148:151], v[44:47], v[220:223]
ds_read_b64_tr_b16 v[38:39], v20 offset:25088
s_waitcnt lgkmcnt(4)
mf16 v[224:227], v[144:147], v[24:27], v[224:227]
ds_read_b64_tr_b16 v[40:41], v17 offset:12288
mf16 v[240:243], v[148:151], v[24:27], v[240:243]
ds_read_b64_tr_b16 v[42:43], v17 offset:12800
buffer_load_dwordx4 v5, s[20:23], s45 offen offset:2048 lds
mf16 v[228:231], v[144:147], v[28:31], v[228:231]
ds_read_b64_tr_b16 v[44:45], v18 offset:12288
mf16 v[244:247], v[148:151], v[28:31], v[244:247]
ds_read_b64_tr_b16 v[46:47], v18 offset:12800
s_waitcnt lgkmcnt(4)
mf16 v[232:235], v[144:147], v[32:35], v[232:235]
ds_read_b64_tr_b16 v[24:25], v19 offset:12288
mf16 v[248:251], v[148:151], v[32:35], v[248:251]
ds_read_b64_tr_b16 v[26:27], v19 offset:12800
buffer_load_dwordx4 v6, s[20:23], s45 offen offset:3072 lds
mf16 v[236:239], v[144:147], v[36:39], v[236:239]
ds_read_b64_tr_b16 v[28:29], v20 offset:12288
mf16 v[252:255], v[148:151], v[36:39], v[252:255]
ds_read_b64_tr_b16 v[30:31], v20 offset:12800
s_waitcnt lgkmcnt(4)
mf16 v[192:195], v[152:155], v[40:43], v[192:195]
ds_read_b64_tr_b16 v[32:33], v17 offset:28672
mf16 v[208:211], v[156:159], v[40:43], v[208:211]
ds_read_b64_tr_b16 v[34:35], v17 offset:29184
s_mov_b64 exec, 0xffff
buffer_load_dword v56, v23, s[4:7], s13 offen
s_mov_b64 exec, -1
mf16 v[196:199], v[152:155], v[44:47], v[196:199]
ds_read_b64_tr_b16 v[36:37], v18 offset:28672
mf16 v[212:215], v[156:159], v[44:47], v[212:215]
ds_read_b64_tr_b16 v[38:39], v18 offset:29184
s_waitcnt lgkmcnt(4)
mf16 v[200:203], v[152:155], v[24:27], v[200:203]
ds_read_b64_tr_b16 v[40:41], v19 offset:28672
mf16 v[216:219], v[156:159], v[24:27], v[216:219]
ds_read_b64_tr_b16 v[42:43], v19 offset:29184
s_mov_b64 exec, 0xffff
buffer_load_dword v57, v23, s[32:35], s17 offen
s_mov_b64 exec, -1
mf16 v[204:207], v[152:155], v[28:31], v[204:207]
ds_read_b64_tr_b16 v[44:45], v20 offset:28672
mf16 v[220:223], v[156:159], v[28:31], v[220:223]
ds_read_b64_tr_b16 v[46:47], v20 offset:29184
s_waitcnt lgkmcnt(4)
mf16 v[224:227], v[152:155], v[32:35], v[224:227]
s_barrier
ds_read_b128 v[160:163], v7 offset:0
ds_read_b128 v[164:167], v8 offset:1024
ds_read_b128 v[168:171], v8 offset:0
ds_read_b128 v[172:175], v7 offset:1024
ds_read_b64_tr_b16 v[24:25], v13 offset:0
mf16 v[240:243], v[156:159], v[32:35], v[240:243]
ds_read_b64_tr_b16 v[26:27], v13 offset:512
s_add_u32 m0, s47, 0x18000
s_add_u32 s45, s48, 0x100
buffer_load_dwordx4 v1, s[24:27], s45 offen offset:0 lds
mf16 v[228:231], v[152:155], v[36:39], v[228:231]
ds_read_b64_tr_b16 v[28:29], v14 offset:0
mf16 v[244:247], v[156:159], v[36:39], v[244:247]
ds_read_b64_tr_b16 v[30:31], v14 offset:512
s_waitcnt lgkmcnt(8)
mf16 v[232:235], v[152:155], v[40:43], v[232:235]
ds_read_b64_tr_b16 v[32:33], v15 offset:0
mf16 v[248:251], v[156:159], v[40:43], v[248:251]
ds_read_b64_tr_b16 v[34:35], v15 offset:512
buffer_load_dwordx4 v2, s[24:27], s45 offen offset:1024 lds
mf16 v[236:239], v[152:155], v[44:47], v[236:239]
ds_read_b64_tr_b16 v[36:37], v16 offset:0
mf16 v[252:255], v[156:159], v[44:47], v[252:255]
ds_read_b64_tr_b16 v[38:39], v16 offset:512
s_waitcnt lgkmcnt(4)
mf16 v[192:195], v[160:163], v[24:27], v[192:195]
ds_read_b64_tr_b16 v[40:41], v13 offset:16384
mf16 v[208:211], v[164:167], v[24:27], v[208:211]
ds_read_b64_tr_b16 v[42:43], v13 offset:16896
s_add_u32 m0, s47, 0x1c000
s_add_u32 s45, s48, 0x100100
buffer_load_dwordx4 v1, s[24:27], s45 offen offset:0 lds
mf16 v[196:199], v[160:163], v[28:31], v[196:199]
ds_read_b64_tr_b16 v[44:45], v14 offset:16384
mf16 v[212:215], v[164:167], v[28:31], v[212:215]
ds_read_b64_tr_b16 v[46:47], v14 offset:16896
s_waitcnt lgkmcnt(4)
mf16 v[200:203], v[160:163], v[32:35], v[200:203]
ds_read_b64_tr_b16 v[24:25], v15 offset:16384
mf16 v[216:219], v[164:167], v[32:35], v[216:219]
ds_read_b64_tr_b16 v[26:27], v15 offset:16896
buffer_load_dwordx4 v2, s[24:27], s45 offen offset:1024 lds
mf16 v[204:207], v[160:163], v[36:39], v[204:207]
ds_read_b64_tr_b16 v[28:29], v16 offset:16384
mf16 v[220:223], v[164:167], v[36:39], v[220:223]
ds_read_b64_tr_b16 v[30:31], v16 offset:16896
s_waitcnt lgkmcnt(4)
mf16 v[224:227], v[160:163], v[40:43], v[224:227]
ds_read_b64_tr_b16 v[32:33], v13 offset:4096
mf16 v[240:243], v[164:167], v[40:43], v[240:243]
ds_read_b64_tr_b16 v[34:35], v13 offset:4608
mf16 v[228:231], v[160:163], v[44:47], v[228:231]
ds_read_b64_tr_b16 v[36:37], v14 offset:4096
mf16 v[244:247], v[164:167], v[44:47], v[244:247]
ds_read_b64_tr_b16 v[38:39], v14 offset:4608
s_waitcnt lgkmcnt(4)
mf16 v[232:235], v[160:163], v[24:27], v[232:235]
ds_read_b64_tr_b16 v[40:41], v15 offset:4096
mf16 v[248:251], v[164:167], v[24:27], v[248:251]
ds_read_b64_tr_b16 v[42:43], v15 offset:4608
mf16 v[236:239], v[160:163], v[28:31], v[236:239]
ds_read_b64_tr_b16 v[44:45], v16 offset:4096
mf16 v[252:255], v[164:167], v[28:31], v[252:255]
ds_read_b64_tr_b16 v[46:47], v16 offset:4608
s_waitcnt lgkmcnt(4)
mf16 v[192:195], v[168:171], v[32:35], v[192:195]
ds_read_b64_tr_b16 v[24:25], v13 offset:20480
mf16 v[208:211], v[172:175], v[32:35], v[208:211]
ds_read_b64_tr_b16 v[26:27], v13 offset:20992
mf16 v[196:199], v[168:171], v[36:39], v[196:199]
ds_read_b64_tr_b16 v[28:29], v14 offset:20480
mf16 v[212:215], v[172:175], v[36:39], v[212:215]
ds_read_b64_tr_b16 v[30:31], v14 offset:20992
s_waitcnt lgkmcnt(4)
mf16 v[200:203], v[168:171], v[40:43], v[200:203]
ds_read_b64_tr_b16 v[32:33], v15 offset:20480
mf16 v[216:219], v[172:175], v[40:43], v[216:219]
ds_read_b64_tr_b16 v[34:35], v15 offset:20992
mf16 v[204:207], v[168:171], v[44:47], v[204:207]
ds_read_b64_tr_b16 v[36:37], v16 offset:20480
mf16 v[220:223], v[172:175], v[44:47], v[220:223]
ds_read_b64_tr_b16 v[38:39], v16 offset:20992
s_waitcnt lgkmcnt(4)
mf16 v[224:227], v[168:171], v[24:27], v[224:227]
s_waitcnt vmcnt(6)
ds_read_b128 v[176:179], v7 offset:4096
ds_read_b128 v[180:183], v8 offset:5120
ds_read_b128 v[184:187], v8 offset:4096
ds_read_b128 v[188:191], v7 offset:5120
ds_read_b64_tr_b16 v[40:41], v13 offset:8192
mf16 v[240:243], v[172:175], v[24:27], v[240:243]
ds_read_b64_tr_b16 v[42:43], v13 offset:8704
mf16 v[228:231], v[168:171], v[28:31], v[228:231]
ds_read_b64_tr_b16 v[24:25], v14 offset:8192
mf16 v[244:247], v[172:175], v[28:31], v[244:247]
ds_read_b64_tr_b16 v[26:27], v14 offset:8704
s_waitcnt lgkmcnt(8)
mf16 v[232:235], v[168:171], v[32:35], v[232:235]
ds_read_b64_tr_b16 v[28:29], v15 offset:8192
mf16 v[248:251], v[172:175], v[32:35], v[248:251]
ds_read_b64_tr_b16 v[30:31], v15 offset:8704
mf16 v[236:239], v[168:171], v[36:39], v[236:239]
ds_read_b64_tr_b16 v[32:33], v16 offset:8192
mf16 v[252:255], v[172:175], v[36:39], v[252:255]
ds_read_b64_tr_b16 v[34:35], v16 offset:8704
s_waitcnt lgkmcnt(4)
mf16 v[192:195], v[176:179], v[40:43], v[192:195]
ds_read_b64_tr_b16 v[36:37], v13 offset:24576
mf16 v[208:211], v[180:183], v[40:43], v[208:211]
ds_read_b64_tr_b16 v[38:39], v13 offset:25088
mf16 v[196:199], v[176:179], v[24:27], v[196:199]
ds_read_b64_tr_b16 v[40:41], v14 offset:24576
mf16 v[212:215], v[180:183], v[24:27], v[212:215]
ds_read_b64_tr_b16 v[42:43], v14 offset:25088
s_waitcnt lgkmcnt(4)
mf16 v[200:203], v[176:179], v[28:31], v[200:203]
ds_read_b64_tr_b16 v[24:25], v15 offset:24576
mf16 v[216:219], v[180:183], v[28:31], v[216:219]
ds_read_b64_tr_b16 v[26:27], v15 offset:25088
mf16 v[204:207], v[176:179], v[32:35], v[204:207]
ds_read_b64_tr_b16 v[28:29], v16 offset:24576
mf16 v[220:223], v[180:183], v[32:35], v[220:223]
ds_read_b64_tr_b16 v[30:31], v16 offset:25088
s_waitcnt lgkmcnt(4)
mf16 v[224:227], v[176:179], v[36:39], v[224:227]
ds_read_b64_tr_b16 v[32:33], v13 offset:12288
mf16 v[240:243], v[180:183], v[36:39], v[240:243]
ds_read_b64_tr_b16 v[34:35], v13 offset:12800
mf16 v[228:231], v[176:179], v[40:43], v[228:231]
ds_read_b64_tr_b16 v[36:37], v14 offset:12288
mf16 v[244:247], v[180:183], v[40:43], v[244:247]
ds_read_b64_tr_b16 v[38:39], v14 offset:12800
s_waitcnt lgkmcnt(4)
mf16 v[232:235], v[176:179], v[24:27], v[232:235]
ds_read_b64_tr_b16 v[40:41], v15 offset:12288
mf16 v[248:251], v[180:183], v[24:27], v[248:251]
ds_read_b64_tr_b16 v[42:43], v15 offset:12800
mf16 v[236:239], v[176:179], v[28:31], v[236:239]
ds_read_b64_tr_b16 v[24:25], v16 offset:12288
mf16 v[252:255], v[180:183], v[28:31], v[252:255]
ds_read_b64_tr_b16 v[26:27], v16 offset:12800
s_waitcnt lgkmcnt(4)
mf16 v[192:195], v[184:187], v[32:35], v[192:195]
ds_read_b64_tr_b16 v[28:29], v13 offset:28672
mf16 v[208:211], v[188:191], v[32:35], v[208:211]
ds_read_b64_tr_b16 v[30:31], v13 offset:29184
mf16 v[196:199], v[184:187], v[36:39], v[196:199]
ds_read_b64_tr_b16 v[32:33], v14 offset:28672
mf16 v[212:215], v[188:191], v[36:39], v[212:215]
ds_read_b64_tr_b16 v[34:35], v14 offset:29184
s_waitcnt lgkmcnt(4)
mf16 v[200:203], v[184:187], v[40:43], v[200:203]
ds_read_b64_tr_b16 v[36:37], v15 offset:28672
mf16 v[216:219], v[188:191], v[40:43], v[216:219]
ds_read_b64_tr_b16 v[38:39], v15 offset:29184
mf16 v[204:207], v[184:187], v[24:27], v[204:207]
ds_read_b64_tr_b16 v[40:41], v16 offset:28672
mf16 v[220:223], v[188:191], v[24:27], v[220:223]
ds_read_b64_tr_b16 v[42:43], v16 offset:29184
s_waitcnt lgkmcnt(4)
mf16 v[224:227], v[184:187], v[28:31], v[224:227]
s_waitcnt vmcnt(0)
s_barrier
ds_read_b64_tr_b16 v[24:25], v13 offset:32768
mf16 v[240:243], v[188:191], v[28:31], v[240:243]
ds_read_b64_tr_b16 v[26:27], v13 offset:33280
s_add_u32 m0, s47, 0x20000
s_add_u32 s45, s48, 0x200100
buffer_load_dwordx4 v1, s[24:27], s45 offen offset:0 lds
mf16 v[228:231], v[184:187], v[32:35], v[228:231]
ds_read_b64_tr_b16 v[28:29], v14 offset:32768
mf16 v[244:247], v[188:191], v[32:35], v[244:247]
ds_read_b64_tr_b16 v[30:31], v14 offset:33280
s_waitcnt lgkmcnt(4)
mf16 v[232:235], v[184:187], v[36:39], v[232:235]
ds_read_b64_tr_b16 v[32:33], v15 offset:32768
mf16 v[248:251], v[188:191], v[36:39], v[248:251]
ds_read_b64_tr_b16 v[34:35], v15 offset:33280
buffer_load_dwordx4 v2, s[24:27], s45 offen offset:1024 lds
mf16 v[236:239], v[184:187], v[40:43], v[236:239]
ds_read_b64_tr_b16 v[36:37], v16 offset:32768
mf16 v[252:255], v[188:191], v[40:43], v[252:255]
ds_read_b64_tr_b16 v[38:39], v16 offset:33280
s_add_u32 m0, s47, 0x24000
s_add_u32 s45, s48, 0x300100
buffer_load_dwordx4 v1, s[24:27], s45 offen offset:0 lds
buffer_load_dwordx4 v2, s[24:27], s45 offen offset:1024 lds
s_add_u32 m0, s47, 0x0
s_add_u32 s45, s48, 0x180
buffer_load_dwordx4 v1, s[24:27], s45 offen offset:0 lds
buffer_load_dwordx4 v2, s[24:27], s45 offen offset:1024 lds
s_add_u32 m0, s47, 0x4000
s_add_u32 s45, s48, 0x100180
buffer_load_dwordx4 v1, s[24:27], s45 offen offset:0 lds
buffer_load_dwordx4 v2, s[24:27], s45 offen offset:1024 lds
s_and_b32 s12, s16, 3
s_lshl_b32 s12, s12, 19
v_lshlrev_b32 v23, 13, v0
v_add_u32 v23, s12, v23
s_nop 2
s_add_u32 s54, s50, 0
cvtpk v56, v192, v193
cvtpk v57, v194, v195
cvtpk v58, v208, v209
cvtpk v59, v210, v211
buffer_store_dwordx4 v[56:59], v22, s[28:31], s54 offen offset:0 sc1
cvtpk v60, v196, v197
cvtpk v61, v198, v199
cvtpk v62, v212, v213
cvtpk v63, v214, v215
buffer_store_dwordx4 v[60:63], v22, s[28:31], s54 offen offset:256 sc1
cvtpk v56, v200, v201
cvtpk v57, v202, v203
cvtpk v58, v216, v217
cvtpk v59, v218, v219
buffer_store_dwordx4 v[56:59], v22, s[28:31], s54 offen offset:2048 sc1
cvtpk v60, v204, v205
cvtpk v61, v206, v207
cvtpk v62, v220, v221
cvtpk v63, v222, v223
buffer_store_dwordx4 v[60:63], v22, s[28:31], s54 offen offset:2304 sc1
s_mov_b32 s8, s90
s_mov_b32 s9, s91
s_mov_b32 s10, 0x400000
s_mov_b32 s11, 0x20000
s_lshl_b32 s12, s2, 14
s_lshl_b32 s13, s16, 7
s_add_u32 s12, s12, s13
s_add_u32 s13, s12, 7168
s_add_u32 s17, s47, 65536
s_mov_b32 m0, s17
v_lshrrev_b32 v3, 3, v0
v_lshlrev_b32 v3, 10, v3
v_and_b32 v4, 7, v0
v_lshl_add_u32 v3, v4, 4, v3
buffer_load_dwordx4 v3, s[8:11], s12 offen nt lds
buffer_load_dwordx4 v3, s[8:11], s13 offen offset:1024 nt lds
v_lshrrev_b32 v4, 5, v0
v_bfe_u32 v5, v0, 2, 2
v_lshl_add_u32 v4, v4, 2, v5
v_lshlrev_b32 v4, 7, v4
v_bfe_u32 v5, v0, 4, 1
v_lshl_add_u32 v4, v5, 5, v4
v_and_b32 v5, 3, v0
v_lshl_add_u32 v4, v5, 3, v4
v_add_u32 v4, s17, v4
v_lshlrev_b32 v5, 4, v0
s_lshl_b32 s17, s16, 19
s_lshl_b32 s13, s2, 11
s_add_u32 s17, s17, s13
s_add_u32 s48, s48, 256
s_add_u32 s50, s50, s92
s_mov_b32 s44, 0
l1_kernel_B2_loop:
s_waitcnt lgkmcnt(4)
mf16 v[192:195], v[64:67], v[24:27], 0
ds_read_b64_tr_b16 v[40:41], v13 offset:36864
mf16 v[208:211], v[68:71], v[24:27], 0
ds_read_b64_tr_b16 v[42:43], v13 offset:37376
mf16 v[196:199], v[64:67], v[28:31], 0
ds_read_b64_tr_b16 v[44:45], v14 offset:36864
mf16 v[212:215], v[68:71], v[28:31], 0
ds_read_b64_tr_b16 v[46:47], v14 offset:37376
s_waitcnt lgkmcnt(4)
mf16 v[200:203], v[64:67], v[32:35], 0
ds_read_b64_tr_b16 v[24:25], v15 offset:36864
mf16 v[216:219], v[68:71], v[32:35], 0
ds_read_b64_tr_b16 v[26:27], v15 offset:37376
mf16 v[204:207], v[64:67], v[36:39], 0
ds_read_b64_tr_b16 v[28:29], v16 offset:36864
mf16 v[220:223], v[68:71], v[36:39], 0
ds_read_b64_tr_b16 v[30:31], v16 offset:37376
s_waitcnt lgkmcnt(4)
mf16 v[192:195], v[72:75], v[40:43], v[192:195]
ds_read_b64_tr_b16 v[32:33], v13 offset:40960
s_add_u32 s55, s50, 4096
s_sub_u32 s55, s55, s92
mf16 v[208:211], v[76:79], v[40:43], v[208:211]
ds_read_b64_tr_b16 v[34:35], v13 offset:41472
cvtpk v56, v224, v225
mf16 v[196:199], v[72:75], v[44:47], v[196:199]
ds_read_b64_tr_b16 v[36:37], v14 offset:40960
cvtpk v57, v226, v227
mf16 v[212:215], v[76:79], v[44:47], v[212:215]
ds_read_b64_tr_b16 v[38:39], v14 offset:41472
s_waitcnt lgkmcnt(4)
mf16 v[200:203], v[72:75], v[24:27], v[200:203]
ds_read_b64_tr_b16 v[40:41], v15 offset:40960
cvtpk v58, v240, v241
mf16 v[216:219], v[76:79], v[24:27], v[216:219]
ds_read_b64_tr_b16 v[42:43], v15 offset:41472
cvtpk v59, v242, v243
mf16 v[204:207], v[72:75], v[28:31], v[204:207]
ds_read_b64_tr_b16 v[44:45], v16 offset:40960
buffer_store_dwordx4 v[56:59], v22, s[28:31], s55 offen offset:0 sc1
mf16 v[220:223], v[76:79], v[28:31], v[220:223]
ds_read_b64_tr_b16 v[46:47], v16 offset:41472
s_waitcnt lgkmcnt(4)
mf16 v[192:195], v[80:83], v[32:35], v[192:195]
ds_read_b64_tr_b16 v[24:25], v13 offset:45056
cvtpk v60, v228, v229
mf16 v[208:211], v[84:87], v[32:35], v[208:211]
ds_read_b64_tr_b16 v[26:27], v13 offset:45568
cvtpk v61, v230, v231
mf16 v[196:199], v[80:83], v[36:39], v[196:199]
ds_read_b64_tr_b16 v[28:29], v14 offset:45056
cvtpk v62, v244, v245
mf16 v[212:215], v[84:87], v[36:39], v[212:215]
ds_read_b64_tr_b16 v[30:31], v14 offset:45568
s_waitcnt lgkmcnt(4)
mf16 v[200:203], v[80:83], v[40:43], v[200:203]
ds_read_b64_tr_b16 v[32:33], v15 offset:45056
cvtpk v63, v246, v247
mf16 v[216:219], v[84:87], v[40:43], v[216:219]
ds_read_b64_tr_b16 v[34:35], v15 offset:45568
buffer_store_dwordx4 v[60:63], v22, s[28:31], s55 offen offset:256 sc1
mf16 v[204:207], v[80:83], v[44:47], v[204:207]
ds_read_b64_tr_b16 v[36:37], v16 offset:45056
cvtpk v56, v232, v233
mf16 v[220:223], v[84:87], v[44:47], v[220:223]
ds_read_b64_tr_b16 v[38:39], v16 offset:45568
s_waitcnt lgkmcnt(4)
mf16 v[192:195], v[88:91], v[24:27], v[192:195]
ds_read_b64_tr_b16 v[40:41], v13 offset:49152
cvtpk v57, v234, v235
mf16 v[208:211], v[92:95], v[24:27], v[208:211]
ds_read_b64_tr_b16 v[42:43], v13 offset:49664
cvtpk v58, v248, v249
mf16 v[196:199], v[88:91], v[28:31], v[196:199]
ds_read_b64_tr_b16 v[44:45], v14 offset:49152
cvtpk v59, v250, v251
mf16 v[212:215], v[92:95], v[28:31], v[212:215]
ds_read_b64_tr_b16 v[46:47], v14 offset:49664
s_waitcnt lgkmcnt(4)
mf16 v[200:203], v[88:91], v[32:35], v[200:203]
ds_read_b64_tr_b16 v[24:25], v15 offset:49152
buffer_store_dwordx4 v[56:59], v22, s[28:31], s55 offen offset:2048 sc1
mf16 v[216:219], v[92:95], v[32:35], v[216:219]
ds_read_b64_tr_b16 v[26:27], v15 offset:49664
cvtpk v60, v236, v237
mf16 v[204:207], v[88:91], v[36:39], v[204:207]
ds_read_b64_tr_b16 v[28:29], v16 offset:49152
cvtpk v61, v238, v239
mf16 v[220:223], v[92:95], v[36:39], v[220:223]
ds_read_b64_tr_b16 v[30:31], v16 offset:49664
s_waitcnt lgkmcnt(4)
mf16 v[192:195], v[96:99], v[40:43], v[192:195]
ds_read_b64_tr_b16 v[32:33], v13 offset:53248
cvtpk v62, v252, v253
mf16 v[208:211], v[100:103], v[40:43], v[208:211]
ds_read_b64_tr_b16 v[34:35], v13 offset:53760
cvtpk v63, v254, v255
mf16 v[196:199], v[96:99], v[44:47], v[196:199]
ds_read_b64_tr_b16 v[36:37], v14 offset:53248
buffer_store_dwordx4 v[60:63], v22, s[28:31], s55 offen offset:2304 sc1
mf16 v[212:215], v[100:103], v[44:47], v[212:215]
ds_read_b64_tr_b16 v[38:39], v14 offset:53760
s_waitcnt lgkmcnt(4)
mf16 v[200:203], v[96:99], v[24:27], v[200:203]
ds_read_b64_tr_b16 v[40:41], v15 offset:53248
mf16 v[216:219], v[100:103], v[24:27], v[216:219]
ds_read_b64_tr_b16 v[42:43], v15 offset:53760
mf16 v[204:207], v[96:99], v[28:31], v[204:207]
ds_read_b64_tr_b16 v[44:45], v16 offset:53248
mf16 v[220:223], v[100:103], v[28:31], v[220:223]
ds_read_b64_tr_b16 v[46:47], v16 offset:53760
s_waitcnt lgkmcnt(4)
mf16 v[192:195], v[104:107], v[32:35], v[192:195]
ds_read_b64_tr_b16 v[24:25], v13 offset:57344
mf16 v[208:211], v[108:111], v[32:35], v[208:211]
ds_read_b64_tr_b16 v[26:27], v13 offset:57856
mf16 v[196:199], v[104:107], v[36:39], v[196:199]
ds_read_b64_tr_b16 v[28:29], v14 offset:57344
mf16 v[212:215], v[108:111], v[36:39], v[212:215]
ds_read_b64_tr_b16 v[30:31], v14 offset:57856
s_waitcnt lgkmcnt(4)
mf16 v[200:203], v[104:107], v[40:43], v[200:203]
ds_read_b64_tr_b16 v[32:33], v15 offset:57344
mf16 v[216:219], v[108:111], v[40:43], v[216:219]
ds_read_b64_tr_b16 v[34:35], v15 offset:57856
mf16 v[204:207], v[104:107], v[44:47], v[204:207]
ds_read_b64_tr_b16 v[36:37], v16 offset:57344
mf16 v[220:223], v[108:111], v[44:47], v[220:223]
ds_read_b64_tr_b16 v[38:39], v16 offset:57856
s_waitcnt lgkmcnt(4)
mf16 v[192:195], v[112:115], v[24:27], v[192:195]
ds_read_b64_tr_b16 v[40:41], v13 offset:61440
mf16 v[208:211], v[116:119], v[24:27], v[208:211]
ds_read_b64_tr_b16 v[42:43], v13 offset:61952
mf16 v[196:199], v[112:115], v[28:31], v[196:199]
ds_read_b64_tr_b16 v[44:45], v14 offset:61440
mf16 v[212:215], v[116:119], v[28:31], v[212:215]
ds_read_b64_tr_b16 v[46:47], v14 offset:61952
s_waitcnt lgkmcnt(4)
mf16 v[200:203], v[112:115], v[32:35], v[200:203]
ds_read_b64_tr_b16 v[24:25], v15 offset:61440
mf16 v[216:219], v[116:119], v[32:35], v[216:219]
ds_read_b64_tr_b16 v[26:27], v15 offset:61952
mf16 v[204:207], v[112:115], v[36:39], v[204:207]
ds_read_b64_tr_b16 v[28:29], v16 offset:61440
mf16 v[220:223], v[116:119], v[36:39], v[220:223]
ds_read_b64_tr_b16 v[30:31], v16 offset:61952
s_waitcnt lgkmcnt(4)
mf16 v[192:195], v[120:123], v[40:43], v[192:195]
s_waitcnt vmcnt(8)
s_barrier
ds_read_b64_tr_b16 v[32:33], v17 offset:0
mf16 v[208:211], v[124:127], v[40:43], v[208:211]
ds_read_b64_tr_b16 v[34:35], v17 offset:512
s_add_u32 m0, s47, 0x8000
s_add_u32 s45, s48, 0x200080
buffer_load_dwordx4 v1, s[24:27], s45 offen offset:0 lds
mf16 v[196:199], v[120:123], v[44:47], v[196:199]
ds_read_b64_tr_b16 v[36:37], v18 offset:0
mf16 v[212:215], v[124:127], v[44:47], v[212:215]
ds_read_b64_tr_b16 v[38:39], v18 offset:512
s_waitcnt lgkmcnt(4)
mf16 v[200:203], v[120:123], v[24:27], v[200:203]
ds_read_b64_tr_b16 v[40:41], v19 offset:0
mf16 v[216:219], v[124:127], v[24:27], v[216:219]
ds_read_b64_tr_b16 v[42:43], v19 offset:512
buffer_load_dwordx4 v2, s[24:27], s45 offen offset:1024 lds
mf16 v[204:207], v[120:123], v[28:31], v[204:207]
ds_read_b64_tr_b16 v[44:45], v20 offset:0
mf16 v[220:223], v[124:127], v[28:31], v[220:223]
ds_read_b64_tr_b16 v[46:47], v20 offset:512
s_waitcnt lgkmcnt(4)
mf16 v[192:195], v[128:131], v[32:35], v[192:195]
ds_read_b64_tr_b16 v[24:25], v17 offset:4096
mf16 v[208:211], v[132:135], v[32:35], v[208:211]
ds_read_b64_tr_b16 v[26:27], v17 offset:4608
s_add_u32 m0, s47, 0xc000
s_add_u32 s45, s48, 0x300080
buffer_load_dwordx4 v1, s[24:27], s45 offen offset:0 lds
mf16 v[196:199], v[128:131], v[36:39], v[196:199]
ds_read_b64_tr_b16 v[28:29], v18 offset:4096
mf16 v[212:215], v[132:135], v[36:39], v[212:215]
ds_read_b64_tr_b16 v[30:31], v18 offset:4608
s_waitcnt lgkmcnt(4)
mf16 v[200:203], v[128:131], v[40:43], v[200:203]
ds_read_b64_tr_b16 v[32:33], v19 offset:4096
mf16 v[216:219], v[132:135], v[40:43], v[216:219]
ds_read_b64_tr_b16 v[34:35], v19 offset:4608
buffer_load_dwordx4 v2, s[24:27], s45 offen offset:1024 lds
mf16 v[204:207], v[128:131], v[44:47], v[204:207]
ds_read_b64_tr_b16 v[36:37], v20 offset:4096
mf16 v[220:223], v[132:135], v[44:47], v[220:223]
ds_read_b64_tr_b16 v[38:39], v20 offset:4608
s_waitcnt lgkmcnt(4)
mf16 v[192:195], v[136:139], v[24:27], v[192:195]
ds_read_b64_tr_b16 v[40:41], v17 offset:8192
mf16 v[208:211], v[140:143], v[24:27], v[208:211]
ds_read_b64_tr_b16 v[42:43], v17 offset:8704
mf16 v[196:199], v[136:139], v[28:31], v[196:199]
ds_read_b64_tr_b16 v[44:45], v18 offset:8192
mf16 v[212:215], v[140:143], v[28:31], v[212:215]
ds_read_b64_tr_b16 v[46:47], v18 offset:8704
s_waitcnt lgkmcnt(4)
mf16 v[200:203], v[136:139], v[32:35], v[200:203]
ds_read_b64_tr_b16 v[24:25], v19 offset:8192
mf16 v[216:219], v[140:143], v[32:35], v[216:219]
ds_read_b64_tr_b16 v[26:27], v19 offset:8704
mf16 v[204:207], v[136:139], v[36:39], v[204:207]
ds_read_b64_tr_b16 v[28:29], v20 offset:8192
mf16 v[220:223], v[140:143], v[36:39], v[220:223]
ds_read_b64_tr_b16 v[30:31], v20 offset:8704
s_waitcnt lgkmcnt(4)
mf16 v[192:195], v[144:147], v[40:43], v[192:195]
ds_read_b64_tr_b16 v[32:33], v17 offset:12288
mf16 v[208:211], v[148:151], v[40:43], v[208:211]
ds_read_b64_tr_b16 v[34:35], v17 offset:12800
mf16 v[196:199], v[144:147], v[44:47], v[196:199]
ds_read_b64_tr_b16 v[36:37], v18 offset:12288
mf16 v[212:215], v[148:151], v[44:47], v[212:215]
ds_read_b64_tr_b16 v[38:39], v18 offset:12800
s_waitcnt lgkmcnt(4)
mf16 v[200:203], v[144:147], v[24:27], v[200:203]
ds_read_b64_tr_b16 v[40:41], v19 offset:12288
mf16 v[216:219], v[148:151], v[24:27], v[216:219]
ds_read_b64_tr_b16 v[42:43], v19 offset:12800
mf16 v[204:207], v[144:147], v[28:31], v[204:207]
ds_read_b64_tr_b16 v[44:45], v20 offset:12288
mf16 v[220:223], v[148:151], v[28:31], v[220:223]
ds_read_b64_tr_b16 v[46:47], v20 offset:12800
s_waitcnt lgkmcnt(4)
mf16 v[192:195], v[152:155], v[32:35], v[192:195]
ds_read_b64_tr_b16 v[24:25], v17 offset:16384
mf16 v[208:211], v[156:159], v[32:35], v[208:211]
ds_read_b64_tr_b16 v[26:27], v17 offset:16896
mf16 v[196:199], v[152:155], v[36:39], v[196:199]
ds_read_b64_tr_b16 v[28:29], v18 offset:16384
mf16 v[212:215], v[156:159], v[36:39], v[212:215]
ds_read_b64_tr_b16 v[30:31], v18 offset:16896
s_waitcnt lgkmcnt(4)
mf16 v[200:203], v[152:155], v[40:43], v[200:203]
ds_read_b64_tr_b16 v[32:33], v19 offset:16384
mf16 v[216:219], v[156:159], v[40:43], v[216:219]
ds_read_b64_tr_b16 v[34:35], v19 offset:16896
mf16 v[204:207], v[152:155], v[44:47], v[204:207]
ds_read_b64_tr_b16 v[36:37], v20 offset:16384
mf16 v[220:223], v[156:159], v[44:47], v[220:223]
ds_read_b64_tr_b16 v[38:39], v20 offset:16896
s_waitcnt lgkmcnt(4)
mf16 v[192:195], v[160:163], v[24:27], v[192:195]
ds_read_b64_tr_b16 v[40:41], v17 offset:20480
mf16 v[208:211], v[164:167], v[24:27], v[208:211]
ds_read_b64_tr_b16 v[42:43], v17 offset:20992
mf16 v[196:199], v[160:163], v[28:31], v[196:199]
ds_read_b64_tr_b16 v[44:45], v18 offset:20480
mf16 v[212:215], v[164:167], v[28:31], v[212:215]
ds_read_b64_tr_b16 v[46:47], v18 offset:20992
s_waitcnt lgkmcnt(4)
mf16 v[200:203], v[160:163], v[32:35], v[200:203]
ds_read_b64_tr_b16 v[24:25], v19 offset:20480
mf16 v[216:219], v[164:167], v[32:35], v[216:219]
ds_read_b64_tr_b16 v[26:27], v19 offset:20992
mf16 v[204:207], v[160:163], v[36:39], v[204:207]
ds_read_b64_tr_b16 v[28:29], v20 offset:20480
mf16 v[220:223], v[164:167], v[36:39], v[220:223]
ds_read_b64_tr_b16 v[30:31], v20 offset:20992
s_waitcnt lgkmcnt(4)
mf16 v[192:195], v[168:171], v[40:43], v[192:195]
ds_read_b64_tr_b16 v[32:33], v17 offset:24576
mf16 v[208:211], v[172:175], v[40:43], v[208:211]
ds_read_b64_tr_b16 v[34:35], v17 offset:25088
buffer_store_dwordx4 v[48:51], v23, s[60:63], s66 offen
mf16 v[196:199], v[168:171], v[44:47], v[196:199]
ds_read_b64_tr_b16 v[36:37], v18 offset:24576
mf16 v[212:215], v[172:175], v[44:47], v[212:215]
ds_read_b64_tr_b16 v[38:39], v18 offset:25088
s_waitcnt lgkmcnt(4)
mf16 v[200:203], v[168:171], v[24:27], v[200:203]
ds_read_b64_tr_b16 v[40:41], v19 offset:24576
mf16 v[216:219], v[172:175], v[24:27], v[216:219]
ds_read_b64_tr_b16 v[42:43], v19 offset:25088
mf16 v[204:207], v[168:171], v[28:31], v[204:207]
ds_read_b64_tr_b16 v[44:45], v20 offset:24576
mf16 v[220:223], v[172:175], v[28:31], v[220:223]
ds_read_b64_tr_b16 v[46:47], v20 offset:25088
s_waitcnt lgkmcnt(4)
mf16 v[192:195], v[176:179], v[32:35], v[192:195]
ds_read_b64_tr_b16 v[24:25], v17 offset:28672
mf16 v[208:211], v[180:183], v[32:35], v[208:211]
ds_read_b64_tr_b16 v[26:27], v17 offset:29184
mf16 v[196:199], v[176:179], v[36:39], v[196:199]
ds_read_b64_tr_b16 v[28:29], v18 offset:28672
mf16 v[212:215], v[180:183], v[36:39], v[212:215]
ds_read_b64_tr_b16 v[30:31], v18 offset:29184
s_waitcnt lgkmcnt(4)
mf16 v[200:203], v[176:179], v[40:43], v[200:203]
ds_read_b64_tr_b16 v[32:33], v19 offset:28672
mf16 v[216:219], v[180:183], v[40:43], v[216:219]
ds_read_b64_tr_b16 v[34:35], v19 offset:29184
mf16 v[204:207], v[176:179], v[44:47], v[204:207]
ds_read_b64_tr_b16 v[36:37], v20 offset:28672
mf16 v[220:223], v[180:183], v[44:47], v[220:223]
ds_read_b64_tr_b16 v[38:39], v20 offset:29184
s_waitcnt lgkmcnt(4)
mf16 v[192:195], v[184:187], v[24:27], v[192:195]
s_waitcnt vmcnt(9)
s_barrier
ds_read_b64_tr_b16 v[40:41], v9 offset:0
mf16 v[208:211], v[188:191], v[24:27], v[208:211]
ds_read_b64_tr_b16 v[42:43], v9 offset:512
s_add_u32 m0, s47, 0x18000
s_add_u32 s45, s53, 0x0
buffer_load_dwordx4 v1, s[32:35], s45 offen offset:0 lds
mf16 v[196:199], v[184:187], v[28:31], v[196:199]
ds_read_b64_tr_b16 v[44:45], v10 offset:0
mf16 v[212:215], v[188:191], v[28:31], v[212:215]
ds_read_b64_tr_b16 v[46:47], v10 offset:512
s_waitcnt lgkmcnt(4)
mf16 v[200:203], v[184:187], v[32:35], v[200:203]
ds_read_b64_tr_b16 v[24:25], v11 offset:0
mf16 v[216:219], v[188:191], v[32:35], v[216:219]
ds_read_b64_tr_b16 v[26:27], v11 offset:512
buffer_load_dwordx4 v2, s[32:35], s45 offen offset:1024 lds
mf16 v[204:207], v[184:187], v[36:39], v[204:207]
ds_read_b64_tr_b16 v[28:29], v12 offset:0
mf16 v[220:223], v[188:191], v[36:39], v[220:223]
ds_read_b64_tr_b16 v[30:31], v12 offset:512
s_waitcnt lgkmcnt(4)
mf16 v[224:227], v[64:67], v[40:43], 0
ds_read_b64_tr_b16 v[32:33], v9 offset:4096
mf16 v[240:243], v[68:71], v[40:43], 0
ds_read_b64_tr_b16 v[34:35], v9 offset:4608
s_add_u32 m0, s47, 0x1c000
s_add_u32 s45, s53, 0x100000
buffer_load_dwordx4 v1, s[32:35], s45 offen offset:0 lds
mf16 v[228:231], v[64:67], v[44:47], 0
ds_read_b64_tr_b16 v[36:37], v10 offset:4096
mf16 v[244:247], v[68:71], v[44:47], 0
ds_read_b64_tr_b16 v[38:39], v10 offset:4608
s_waitcnt lgkmcnt(4)
mf16 v[232:235], v[64:67], v[24:27], 0
ds_read_b64_tr_b16 v[40:41], v11 offset:4096
mf16 v[248:251], v[68:71], v[24:27], 0
ds_read_b64_tr_b16 v[42:43], v11 offset:4608
buffer_load_dwordx4 v2, s[32:35], s45 offen offset:1024 lds
mf16 v[236:239], v[64:67], v[28:31], 0
ds_read_b64_tr_b16 v[44:45], v12 offset:4096
mf16 v[252:255], v[68:71], v[28:31], 0
ds_read_b64_tr_b16 v[46:47], v12 offset:4608
s_waitcnt lgkmcnt(4)
mf16 v[224:227], v[72:75], v[32:35], v[224:227]
ds_read_b64_tr_b16 v[24:25], v9 offset:8192
s_add_u32 s54, s50, 0
mf16 v[240:243], v[76:79], v[32:35], v[240:243]
ds_read_b64_tr_b16 v[26:27], v9 offset:8704
cvtpk v56, v192, v193
mf16 v[228:231], v[72:75], v[36:39], v[228:231]
ds_read_b64_tr_b16 v[28:29], v10 offset:8192
cvtpk v57, v194, v195
mf16 v[244:247], v[76:79], v[36:39], v[244:247]
ds_read_b64_tr_b16 v[30:31], v10 offset:8704
s_waitcnt lgkmcnt(4)
mf16 v[232:235], v[72:75], v[40:43], v[232:235]
ds_read_b64_tr_b16 v[32:33], v11 offset:8192
cvtpk v58, v208, v209
mf16 v[248:251], v[76:79], v[40:43], v[248:251]
ds_read_b64_tr_b16 v[34:35], v11 offset:8704
cvtpk v59, v210, v211
mf16 v[236:239], v[72:75], v[44:47], v[236:239]
ds_read_b64_tr_b16 v[36:37], v12 offset:8192
buffer_store_dwordx4 v[56:59], v22, s[28:31], s54 offen offset:0 sc1
mf16 v[252:255], v[76:79], v[44:47], v[252:255]
ds_read_b64_tr_b16 v[38:39], v12 offset:8704
s_waitcnt lgkmcnt(4)
mf16 v[224:227], v[80:83], v[24:27], v[224:227]
ds_read_b64_tr_b16 v[40:41], v9 offset:12288
cvtpk v60, v196, v197
mf16 v[240:243], v[84:87], v[24:27], v[240:243]
ds_read_b64_tr_b16 v[42:43], v9 offset:12800
cvtpk v61, v198, v199
mf16 v[228:231], v[80:83], v[28:31], v[228:231]
ds_read_b64_tr_b16 v[44:45], v10 offset:12288
cvtpk v62, v212, v213
mf16 v[244:247], v[84:87], v[28:31], v[244:247]
ds_read_b64_tr_b16 v[46:47], v10 offset:12800
s_waitcnt lgkmcnt(4)
mf16 v[232:235], v[80:83], v[32:35], v[232:235]
ds_read_b64_tr_b16 v[24:25], v11 offset:12288
cvtpk v63, v214, v215
mf16 v[248:251], v[84:87], v[32:35], v[248:251]
ds_read_b64_tr_b16 v[26:27], v11 offset:12800
buffer_store_dwordx4 v[60:63], v22, s[28:31], s54 offen offset:256 sc1
mf16 v[236:239], v[80:83], v[36:39], v[236:239]
ds_read_b64_tr_b16 v[28:29], v12 offset:12288
cvtpk v56, v200, v201
mf16 v[252:255], v[84:87], v[36:39], v[252:255]
ds_read_b64_tr_b16 v[30:31], v12 offset:12800
s_waitcnt lgkmcnt(4)
mf16 v[224:227], v[88:91], v[40:43], v[224:227]
ds_read_b64_tr_b16 v[32:33], v9 offset:16384
cvtpk v57, v202, v203
mf16 v[240:243], v[92:95], v[40:43], v[240:243]
ds_read_b64_tr_b16 v[34:35], v9 offset:16896
cvtpk v58, v216, v217
mf16 v[228:231], v[88:91], v[44:47], v[228:231]
ds_read_b64_tr_b16 v[36:37], v10 offset:16384
cvtpk v59, v218, v219
mf16 v[244:247], v[92:95], v[44:47], v[244:247]
ds_read_b64_tr_b16 v[38:39], v10 offset:16896
s_waitcnt lgkmcnt(4)
mf16 v[232:235], v[88:91], v[24:27], v[232:235]
ds_read_b64_tr_b16 v[40:41], v11 offset:16384
buffer_store_dwordx4 v[56:59], v22, s[28:31], s54 offen offset:2048 sc1
mf16 v[248:251], v[92:95], v[24:27], v[248:251]
ds_read_b64_tr_b16 v[42:43], v11 offset:16896
cvtpk v60, v204, v205
mf16 v[236:239], v[88:91], v[28:31], v[236:239]
ds_read_b64_tr_b16 v[44:45], v12 offset:16384
cvtpk v61, v206, v207
mf16 v[252:255], v[92:95], v[28:31], v[252:255]
ds_read_b64_tr_b16 v[46:47], v12 offset:16896
s_waitcnt lgkmcnt(4)
mf16 v[224:227], v[96:99], v[32:35], v[224:227]
ds_read_b64_tr_b16 v[24:25], v9 offset:20480
cvtpk v62, v220, v221
mf16 v[240:243], v[100:103], v[32:35], v[240:243]
ds_read_b64_tr_b16 v[26:27], v9 offset:20992
cvtpk v63, v222, v223
s_getpc_b64 s[8:9]
s_add_u32 s8, s8, cs_attn_kernel@rel32@lo+4
s_addc_u32 s9, s9, cs_attn_kernel@rel32@hi+12
s_mov_b32 s10, attn_kernel_end - attn_kernel
s_mov_b32 s11, 0x20000
s_lshr_b32 s12, s2, 3
s_lshl_b32 s12, s12, 3
s_add_u32 s12, s12, s16
s_lshl_b32 s12, s12, 9
v_lshlrev_b32 v7, 7, v0
s_mov_b64 exec, 15
buffer_load_dword v8, v7, s[8:11], s12 offen
s_mov_b64 exec, -1
mf16 v[228:231], v[96:99], v[36:39], v[228:231]
ds_read_b64_tr_b16 v[28:29], v10 offset:20480
buffer_store_dwordx4 v[60:63], v22, s[28:31], s54 offen offset:2304 sc1
mf16 v[244:247], v[100:103], v[36:39], v[244:247]
ds_read_b64_tr_b16 v[30:31], v10 offset:20992
s_waitcnt lgkmcnt(4)
mf16 v[232:235], v[96:99], v[40:43], v[232:235]
ds_read_b64_tr_b16 v[32:33], v11 offset:20480
mf16 v[248:251], v[100:103], v[40:43], v[248:251]
ds_read_b64_tr_b16 v[34:35], v11 offset:20992
mf16 v[236:239], v[96:99], v[44:47], v[236:239]
ds_read_b64_tr_b16 v[36:37], v12 offset:20480
mf16 v[252:255], v[100:103], v[44:47], v[252:255]
ds_read_b64_tr_b16 v[38:39], v12 offset:20992
s_waitcnt lgkmcnt(4)
mf16 v[224:227], v[104:107], v[24:27], v[224:227]
ds_read_b64_tr_b16 v[40:41], v9 offset:24576
mf16 v[240:243], v[108:111], v[24:27], v[240:243]
ds_read_b64_tr_b16 v[42:43], v9 offset:25088
mf16 v[228:231], v[104:107], v[28:31], v[228:231]
ds_read_b64_tr_b16 v[44:45], v10 offset:24576
mf16 v[244:247], v[108:111], v[28:31], v[244:247]
ds_read_b64_tr_b16 v[46:47], v10 offset:25088
s_waitcnt lgkmcnt(4)
mf16 v[232:235], v[104:107], v[32:35], v[232:235]
ds_read_b64_tr_b16 v[24:25], v11 offset:24576
mf16 v[248:251], v[108:111], v[32:35], v[248:251]
ds_read_b64_tr_b16 v[26:27], v11 offset:25088
mf16 v[236:239], v[104:107], v[36:39], v[236:239]
ds_read_b64_tr_b16 v[28:29], v12 offset:24576
mf16 v[252:255], v[108:111], v[36:39], v[252:255]
ds_read_b64_tr_b16 v[30:31], v12 offset:25088
s_waitcnt lgkmcnt(4)
mf16 v[224:227], v[112:115], v[40:43], v[224:227]
ds_read_b64_tr_b16 v[32:33], v9 offset:28672
mf16 v[240:243], v[116:119], v[40:43], v[240:243]
ds_read_b64_tr_b16 v[34:35], v9 offset:29184
mf16 v[228:231], v[112:115], v[44:47], v[228:231]
ds_read_b64_tr_b16 v[36:37], v10 offset:28672
mf16 v[244:247], v[116:119], v[44:47], v[244:247]
ds_read_b64_tr_b16 v[38:39], v10 offset:29184
s_waitcnt lgkmcnt(4)
mf16 v[232:235], v[112:115], v[24:27], v[232:235]
ds_read_b64_tr_b16 v[40:41], v11 offset:28672
mf16 v[248:251], v[116:119], v[24:27], v[248:251]
ds_read_b64_tr_b16 v[42:43], v11 offset:29184
mf16 v[236:239], v[112:115], v[28:31], v[236:239]
ds_read_b64_tr_b16 v[44:45], v12 offset:28672
mf16 v[252:255], v[116:119], v[28:31], v[252:255]
ds_read_b64_tr_b16 v[46:47], v12 offset:29184
s_waitcnt lgkmcnt(4)
mf16 v[224:227], v[120:123], v[32:35], v[224:227]
s_waitcnt vmcnt(9)
s_barrier
ds_read_b64_tr_b16 v[24:25], v9 offset:32768
mf16 v[240:243], v[124:127], v[32:35], v[240:243]
ds_read_b64_tr_b16 v[26:27], v9 offset:33280
s_add_u32 m0, s47, 0x20000
s_add_u32 s45, s53, 0x200000
buffer_load_dwordx4 v1, s[32:35], s45 offen offset:0 lds
mf16 v[228:231], v[120:123], v[36:39], v[228:231]
ds_read_b64_tr_b16 v[28:29], v10 offset:32768
mf16 v[244:247], v[124:127], v[36:39], v[244:247]
ds_read_b64_tr_b16 v[30:31], v10 offset:33280
s_waitcnt lgkmcnt(4)
mf16 v[232:235], v[120:123], v[40:43], v[232:235]
ds_read_b64_tr_b16 v[32:33], v11 offset:32768
mf16 v[248:251], v[124:127], v[40:43], v[248:251]
ds_read_b64_tr_b16 v[34:35], v11 offset:33280
buffer_load_dwordx4 v2, s[32:35], s45 offen offset:1024 lds
mf16 v[236:239], v[120:123], v[44:47], v[236:239]
ds_read_b64_tr_b16 v[36:37], v12 offset:32768
mf16 v[252:255], v[124:127], v[44:47], v[252:255]
ds_read_b64_tr_b16 v[38:39], v12 offset:33280
s_waitcnt lgkmcnt(4)
mf16 v[224:227], v[128:131], v[24:27], v[224:227]
ds_read_b64_tr_b16 v[40:41], v9 offset:36864
mf16 v[240:243], v[132:135], v[24:27], v[240:243]
ds_read_b64_tr_b16 v[42:43], v9 offset:37376
s_add_u32 m0, s47, 0x24000
s_add_u32 s45, s53, 0x300000
buffer_load_dwordx4 v1, s[32:35], s45 offen offset:0 lds
mf16 v[228:231], v[128:131], v[28:31], v[228:231]
ds_read_b64_tr_b16 v[44:45], v10 offset:36864
mf16 v[244:247], v[132:135], v[28:31], v[244:247]
ds_read_b64_tr_b16 v[46:47], v10 offset:37376
s_waitcnt lgkmcnt(4)
mf16 v[232:235], v[128:131], v[32:35], v[232:235]
ds_read_b64_tr_b16 v[24:25], v11 offset:36864
mf16 v[248:251], v[132:135], v[32:35], v[248:251]
ds_read_b64_tr_b16 v[26:27], v11 offset:37376
buffer_load_dwordx4 v2, s[32:35], s45 offen offset:1024 lds
mf16 v[236:239], v[128:131], v[36:39], v[236:239]
ds_read_b64_tr_b16 v[28:29], v12 offset:36864
mf16 v[252:255], v[132:135], v[36:39], v[252:255]
ds_read_b64_tr_b16 v[30:31], v12 offset:37376
s_waitcnt lgkmcnt(4)
mf16 v[224:227], v[136:139], v[40:43], v[224:227]
ds_read_b64_tr_b16 v[32:33], v9 offset:40960
mf16 v[240:243], v[140:143], v[40:43], v[240:243]
ds_read_b64_tr_b16 v[34:35], v9 offset:41472
mf16 v[228:231], v[136:139], v[44:47], v[228:231]
ds_read_b64_tr_b16 v[36:37], v10 offset:40960
mf16 v[244:247], v[140:143], v[44:47], v[244:247]
ds_read_b64_tr_b16 v[38:39], v10 offset:41472
s_waitcnt lgkmcnt(4)
mf16 v[232:235], v[136:139], v[24:27], v[232:235]
ds_read_b64_tr_b16 v[40:41], v11 offset:40960
mf16 v[248:251], v[140:143], v[24:27], v[248:251]
ds_read_b64_tr_b16 v[42:43], v11 offset:41472
mf16 v[236:239], v[136:139], v[28:31], v[236:239]
ds_read_b64_tr_b16 v[44:45], v12 offset:40960
mf16 v[252:255], v[140:143], v[28:31], v[252:255]
ds_read_b64_tr_b16 v[46:47], v12 offset:41472
s_waitcnt lgkmcnt(4)
mf16 v[224:227], v[144:147], v[32:35], v[224:227]
ds_read_b64_tr_b16 v[24:25], v9 offset:45056
mf16 v[240:243], v[148:151], v[32:35], v[240:243]
ds_read_b64_tr_b16 v[26:27], v9 offset:45568
mf16 v[228:231], v[144:147], v[36:39], v[228:231]
ds_read_b64_tr_b16 v[28:29], v10 offset:45056
mf16 v[244:247], v[148:151], v[36:39], v[244:247]
ds_read_b64_tr_b16 v[30:31], v10 offset:45568
s_waitcnt lgkmcnt(4)
mf16 v[232:235], v[144:147], v[40:43], v[232:235]
ds_read_b64_tr_b16 v[32:33], v11 offset:45056
mf16 v[248:251], v[148:151], v[40:43], v[248:251]
ds_read_b64_tr_b16 v[34:35], v11 offset:45568
mf16 v[236:239], v[144:147], v[44:47], v[236:239]
ds_read_b64_tr_b16 v[36:37], v12 offset:45056
mf16 v[252:255], v[148:151], v[44:47], v[252:255]
ds_read_b64_tr_b16 v[38:39], v12 offset:45568
s_waitcnt lgkmcnt(4)
mf16 v[224:227], v[152:155], v[24:27], v[224:227]
ds_read_b64_tr_b16 v[40:41], v9 offset:49152
mf16 v[240:243], v[156:159], v[24:27], v[240:243]
ds_read_b64_tr_b16 v[42:43], v9 offset:49664
mf16 v[228:231], v[152:155], v[28:31], v[228:231]
ds_read_b64_tr_b16 v[24:25], v10 offset:49152
mf16 v[244:247], v[156:159], v[28:31], v[244:247]
ds_read_b64_tr_b16 v[26:27], v10 offset:49664
s_waitcnt lgkmcnt(4)
mf16 v[232:235], v[152:155], v[32:35], v[232:235]
ds_read_b64_tr_b16 v[28:29], v11 offset:49152
mf16 v[248:251], v[156:159], v[32:35], v[248:251]
ds_read_b64_tr_b16 v[30:31], v11 offset:49664
mf16 v[236:239], v[152:155], v[36:39], v[236:239]
ds_read_b64_tr_b16 v[32:33], v12 offset:49152
mf16 v[252:255], v[156:159], v[36:39], v[252:255]
ds_read_b64_tr_b16 v[34:35], v12 offset:49664
s_waitcnt lgkmcnt(4)
mf16 v[224:227], v[160:163], v[40:43], v[224:227]
ds_read_b64_tr_b16 v[36:37], v9 offset:53248
mf16 v[240:243], v[164:167], v[40:43], v[240:243]
ds_read_b64_tr_b16 v[38:39], v9 offset:53760
mf16 v[228:231], v[160:163], v[24:27], v[228:231]
ds_read_b64_tr_b16 v[40:41], v10 offset:53248
mf16 v[244:247], v[164:167], v[24:27], v[244:247]
ds_read_b64_tr_b16 v[42:43], v10 offset:53760
s_waitcnt lgkmcnt(4)
mf16 v[232:235], v[160:163], v[28:31], v[232:235]
ds_read_b64_tr_b16 v[24:25], v11 offset:53248
mf16 v[248:251], v[164:167], v[28:31], v[248:251]
ds_read_b64_tr_b16 v[26:27], v11 offset:53760
mf16 v[236:239], v[160:163], v[32:35], v[236:239]
ds_read_b64_tr_b16 v[28:29], v12 offset:53248
mf16 v[252:255], v[164:167], v[32:35], v[252:255]
ds_read_b64_tr_b16 v[30:31], v12 offset:53760
s_waitcnt lgkmcnt(4)
mf16 v[224:227], v[168:171], v[36:39], v[224:227]
ds_read_b64_tr_b16 v[32:33], v9 offset:57344
mf16 v[240:243], v[172:175], v[36:39], v[240:243]
ds_read_b64_tr_b16 v[34:35], v9 offset:57856
mf16 v[228:231], v[168:171], v[40:43], v[228:231]
ds_read_b64_tr_b16 v[36:37], v10 offset:57344
mf16 v[244:247], v[172:175], v[40:43], v[244:247]
ds_read_b64_tr_b16 v[38:39], v10 offset:57856
s_waitcnt lgkmcnt(4)
mf16 v[232:235], v[168:171], v[24:27], v[232:235]
ds_read_b64_tr_b16 v[40:41], v11 offset:57344
mf16 v[248:251], v[172:175], v[24:27], v[248:251]
ds_read_b64_tr_b16 v[42:43], v11 offset:57856
s_cmp_lg_u32 s44, 0
s_cbranch_scc1 l1_kernel_wosV
ds_read_b64_tr_b16 v[56:57], v4 offset:0
ds_read_b64_tr_b16 v[58:59], v4 offset:1024
ds_read_b64_tr_b16 v[60:61], v4 offset:64
ds_read_b64_tr_b16 v[62:63], v4 offset:1088
s_add_u32 s8, s14, 0x3c00000
s_addc_u32 s9, s15, 0
s_mov_b32 s10, 0x400000
s_mov_b32 s11, 0x20000
s_waitcnt lgkmcnt(0)
buffer_store_dwordx4 v[56:59], v5, s[8:11], s17 offen offset:0 sc1
buffer_store_dwordx4 v[60:63], v5, s[8:11], s17 offen offset:1024 sc1
l1_kernel_wosV:
mf16 v[236:239], v[168:171], v[28:31], v[236:239]
ds_read_b64_tr_b16 v[24:25], v12 offset:57344
mf16 v[252:255], v[172:175], v[28:31], v[252:255]
ds_read_b64_tr_b16 v[26:27], v12 offset:57856
s_waitcnt lgkmcnt(4)
mf16 v[224:227], v[176:179], v[32:35], v[224:227]
ds_read_b64_tr_b16 v[28:29], v9 offset:61440
mf16 v[240:243], v[180:183], v[32:35], v[240:243]
ds_read_b64_tr_b16 v[30:31], v9 offset:61952
mf16 v[228:231], v[176:179], v[36:39], v[228:231]
ds_read_b64_tr_b16 v[32:33], v10 offset:61440
mf16 v[244:247], v[180:183], v[36:39], v[244:247]
ds_read_b64_tr_b16 v[34:35], v10 offset:61952
s_waitcnt lgkmcnt(4)
mf16 v[232:235], v[176:179], v[40:43], v[232:235]
ds_read_b64_tr_b16 v[36:37], v11 offset:61440
mf16 v[248:251], v[180:183], v[40:43], v[248:251]
ds_read_b64_tr_b16 v[38:39], v11 offset:61952
mf16 v[236:239], v[176:179], v[24:27], v[236:239]
ds_read_b64_tr_b16 v[40:41], v12 offset:61440
mf16 v[252:255], v[180:183], v[24:27], v[252:255]
ds_read_b64_tr_b16 v[42:43], v12 offset:61952
s_waitcnt lgkmcnt(4)
mf16 v[224:227], v[184:187], v[28:31], v[224:227]
s_waitcnt vmcnt(8)
s_barrier
ds_read_b64_tr_b16 v[24:25], v13 offset:32768
mf16 v[240:243], v[188:191], v[28:31], v[240:243]
ds_read_b64_tr_b16 v[26:27], v13 offset:33280
s_add_u32 m0, s47, 0x0
s_add_u32 s45, s53, 0x80
buffer_load_dwordx4 v1, s[32:35], s45 offen offset:0 lds
mf16 v[228:231], v[184:187], v[32:35], v[228:231]
ds_read_b64_tr_b16 v[28:29], v14 offset:32768
mf16 v[244:247], v[188:191], v[32:35], v[244:247]
ds_read_b64_tr_b16 v[30:31], v14 offset:33280
s_waitcnt lgkmcnt(4)
mf16 v[232:235], v[184:187], v[36:39], v[232:235]
ds_read_b64_tr_b16 v[32:33], v15 offset:32768
mf16 v[248:251], v[188:191], v[36:39], v[248:251]
ds_read_b64_tr_b16 v[34:35], v15 offset:33280
buffer_load_dwordx4 v2, s[32:35], s45 offen offset:1024 lds
mf16 v[236:239], v[184:187], v[40:43], v[236:239]
ds_read_b64_tr_b16 v[36:37], v16 offset:32768
mf16 v[252:255], v[188:191], v[40:43], v[252:255]
ds_read_b64_tr_b16 v[38:39], v16 offset:33280
v_mov_b32 v48, v52
v_mov_b32 v49, v53
v_mov_b32 v50, v54
v_mov_b32 v51, v55
s_add_u32 s66, s66, 0x400000
s_add_u32 m0, s47, 0x4000
s_add_u32 s45, s53, 0x100080
buffer_load_dwordx4 v1, s[32:35], s45 offen offset:0 lds
buffer_load_dwordx4 v2, s[32:35], s45 offen offset:1024 lds
s_mov_b32 s48, s53
s_mov_b32 s34, 0
s_add_u32 s50, s50, s92
s_add_u32 s44, s44, 1
s_cmp_lt_u32 s44, 2
s_cbranch_scc1 l1_kernel_B2_loop
s_nop 7
s_add_u32 s55, s50, 4096
s_sub_u32 s55, s55, s92
cvtpk v56, v224, v225
cvtpk v57, v226, v227
cvtpk v58, v240, v241
cvtpk v59, v242, v243
buffer_store_dwordx4 v[56:59], v22, s[28:31], s55 offen offset:0 sc1
cvtpk v60, v228, v229
cvtpk v61, v230, v231
cvtpk v62, v244, v245
cvtpk v63, v246, v247
buffer_store_dwordx4 v[60:63], v22, s[28:31], s55 offen offset:256 sc1
cvtpk v56, v232, v233
cvtpk v57, v234, v235
cvtpk v58, v248, v249
cvtpk v59, v250, v251
buffer_store_dwordx4 v[56:59], v22, s[28:31], s55 offen offset:2048 sc1
cvtpk v60, v236, v237
cvtpk v61, v238, v239
cvtpk v62, v252, v253
cvtpk v63, v254, v255
buffer_store_dwordx4 v[60:63], v22, s[28:31], s55 offen offset:2304 sc1
s_endpgm
l1_kernel_D:
s_waitcnt lgkmcnt(0)
s_waitcnt vmcnt(12)
ds_read_b128 v[64:67], v7 offset:0
ds_read_b128 v[68:71], v8 offset:1024
ds_read_b128 v[72:75], v8 offset:0
ds_read_b128 v[76:79], v7 offset:1024
s_waitcnt vmcnt(8)
s_barrier
ds_read_b128 v[48:51], v56
ds_read_b64_tr_b16 v[24:25], v13 offset:0
ds_read_b64_tr_b16 v[26:27], v13 offset:512
ds_read_b64_tr_b16 v[28:29], v14 offset:0
ds_read_b64_tr_b16 v[30:31], v14 offset:512
ds_read_b64_tr_b16 v[32:33], v15 offset:0
ds_read_b64_tr_b16 v[34:35], v15 offset:512
ds_read_b64_tr_b16 v[36:37], v16 offset:0
ds_read_b64_tr_b16 v[38:39], v16 offset:512
s_waitcnt lgkmcnt(4)
mf16 v[192:195], v[64:67], v[24:27], 0
ds_read_b64_tr_b16 v[40:41], v13 offset:16384
mf16 v[208:211], v[68:71], v[24:27], 0
ds_read_b64_tr_b16 v[42:43], v13 offset:16896
s_add_u32 m0, s46, 0x0
s_mov_b32 s45, 256
buffer_load_dwordx4 v3, s[20:23], s45 offen offset:0 lds
mf16 v[196:199], v[64:67], v[28:31], 0
ds_read_b64_tr_b16 v[44:45], v14 offset:16384
mf16 v[212:215], v[68:71], v[28:31], 0
ds_read_b64_tr_b16 v[46:47], v14 offset:16896
s_waitcnt lgkmcnt(4)
mf16 v[200:203], v[64:67], v[32:35], 0
ds_read_b64_tr_b16 v[24:25], v15 offset:16384
mf16 v[216:219], v[68:71], v[32:35], 0
ds_read_b64_tr_b16 v[26:27], v15 offset:16896
buffer_load_dwordx4 v4, s[20:23], s45 offen offset:1024 lds
mf16 v[204:207], v[64:67], v[36:39], 0
ds_read_b64_tr_b16 v[28:29], v16 offset:16384
mf16 v[220:223], v[68:71], v[36:39], 0
ds_read_b64_tr_b16 v[30:31], v16 offset:16896
s_waitcnt lgkmcnt(4)
mf16 v[224:227], v[64:67], v[40:43], 0
ds_read_b64_tr_b16 v[32:33], v13 offset:4096
mf16 v[240:243], v[68:71], v[40:43], 0
ds_read_b64_tr_b16 v[34:35], v13 offset:4608
buffer_load_dwordx4 v5, s[20:23], s45 offen offset:2048 lds
mf16 v[228:231], v[64:67], v[44:47], 0
ds_read_b64_tr_b16 v[36:37], v14 offset:4096
mf16 v[244:247], v[68:71], v[44:47], 0
ds_read_b64_tr_b16 v[38:39], v14 offset:4608
s_waitcnt lgkmcnt(4)
mf16 v[232:235], v[64:67], v[24:27], 0
ds_read_b64_tr_b16 v[40:41], v15 offset:4096
mf16 v[248:251], v[68:71], v[24:27], 0
ds_read_b64_tr_b16 v[42:43], v15 offset:4608
buffer_load_dwordx4 v6, s[20:23], s45 offen offset:3072 lds
mf16 v[236:239], v[64:67], v[28:31], 0
ds_read_b64_tr_b16 v[44:45], v16 offset:4096
mf16 v[252:255], v[68:71], v[28:31], 0
ds_read_b64_tr_b16 v[46:47], v16 offset:4608
s_waitcnt lgkmcnt(4)
mf16 v[192:195], v[72:75], v[32:35], v[192:195]
ds_read_b64_tr_b16 v[24:25], v13 offset:20480
mf16 v[208:211], v[76:79], v[32:35], v[208:211]
ds_read_b64_tr_b16 v[26:27], v13 offset:20992
s_add_u32 m0, s47, 0x20000
s_add_u32 s45, s48, 0x200000
buffer_load_dwordx4 v1, s[24:27], s45 offen offset:0 lds
mf16 v[196:199], v[72:75], v[36:39], v[196:199]
ds_read_b64_tr_b16 v[28:29], v14 offset:20480
mf16 v[212:215], v[76:79], v[36:39], v[212:215]
ds_read_b64_tr_b16 v[30:31], v14 offset:20992
s_waitcnt lgkmcnt(4)
mf16 v[200:203], v[72:75], v[40:43], v[200:203]
ds_read_b64_tr_b16 v[32:33], v15 offset:20480
mf16 v[216:219], v[76:79], v[40:43], v[216:219]
ds_read_b64_tr_b16 v[34:35], v15 offset:20992
buffer_load_dwordx4 v2, s[24:27], s45 offen offset:1024 lds
mf16 v[204:207], v[72:75], v[44:47], v[204:207]
ds_read_b64_tr_b16 v[36:37], v16 offset:20480
mf16 v[220:223], v[76:79], v[44:47], v[220:223]
ds_read_b64_tr_b16 v[38:39], v16 offset:20992
s_waitcnt lgkmcnt(4)
mf16 v[224:227], v[72:75], v[24:27], v[224:227]
s_waitcnt vmcnt(10)
ds_read_b128 v[80:83], v7 offset:4096
ds_read_b128 v[84:87], v8 offset:5120
ds_read_b128 v[88:91], v8 offset:4096
ds_read_b128 v[92:95], v7 offset:5120
ds_read_b64_tr_b16 v[40:41], v13 offset:8192
mf16 v[240:243], v[76:79], v[24:27], v[240:243]
ds_read_b64_tr_b16 v[42:43], v13 offset:8704
mf16 v[228:231], v[72:75], v[28:31], v[228:231]
ds_read_b64_tr_b16 v[44:45], v14 offset:8192
mf16 v[244:247], v[76:79], v[28:31], v[244:247]
ds_read_b64_tr_b16 v[46:47], v14 offset:8704
s_waitcnt lgkmcnt(8)
mf16 v[232:235], v[72:75], v[32:35], v[232:235]
ds_read_b64_tr_b16 v[24:25], v15 offset:8192
mf16 v[248:251], v[76:79], v[32:35], v[248:251]
ds_read_b64_tr_b16 v[26:27], v15 offset:8704
mf16 v[236:239], v[72:75], v[36:39], v[236:239]
ds_read_b64_tr_b16 v[28:29], v16 offset:8192
mf16 v[252:255], v[76:79], v[36:39], v[252:255]
ds_read_b64_tr_b16 v[30:31], v16 offset:8704
s_waitcnt lgkmcnt(4)
mf16 v[192:195], v[80:83], v[40:43], v[192:195]
ds_read_b64_tr_b16 v[32:33], v13 offset:24576
mf16 v[208:211], v[84:87], v[40:43], v[208:211]
ds_read_b64_tr_b16 v[34:35], v13 offset:25088
s_add_u32 m0, s46, 0x1000
s_mov_b32 s45, 384
buffer_load_dwordx4 v3, s[20:23], s45 offen offset:0 lds
mf16 v[196:199], v[80:83], v[44:47], v[196:199]
ds_read_b64_tr_b16 v[36:37], v14 offset:24576
mf16 v[212:215], v[84:87], v[44:47], v[212:215]
ds_read_b64_tr_b16 v[38:39], v14 offset:25088
s_waitcnt lgkmcnt(4)
mf16 v[200:203], v[80:83], v[24:27], v[200:203]
ds_read_b64_tr_b16 v[40:41], v15 offset:24576
mf16 v[216:219], v[84:87], v[24:27], v[216:219]
ds_read_b64_tr_b16 v[42:43], v15 offset:25088
buffer_load_dwordx4 v4, s[20:23], s45 offen offset:1024 lds
mf16 v[204:207], v[80:83], v[28:31], v[204:207]
ds_read_b64_tr_b16 v[44:45], v16 offset:24576
mf16 v[220:223], v[84:87], v[28:31], v[220:223]
ds_read_b64_tr_b16 v[46:47], v16 offset:25088
s_waitcnt lgkmcnt(4)
mf16 v[224:227], v[80:83], v[32:35], v[224:227]
ds_read_b64_tr_b16 v[24:25], v13 offset:12288
mf16 v[240:243], v[84:87], v[32:35], v[240:243]
ds_read_b64_tr_b16 v[26:27], v13 offset:12800
buffer_load_dwordx4 v5, s[20:23], s45 offen offset:2048 lds
mf16 v[228:231], v[80:83], v[36:39], v[228:231]
ds_read_b64_tr_b16 v[28:29], v14 offset:12288
mf16 v[244:247], v[84:87], v[36:39], v[244:247]
ds_read_b64_tr_b16 v[30:31], v14 offset:12800
s_waitcnt lgkmcnt(4)
mf16 v[232:235], v[80:83], v[40:43], v[232:235]
ds_read_b64_tr_b16 v[32:33], v15 offset:12288
mf16 v[248:251], v[84:87], v[40:43], v[248:251]
ds_read_b64_tr_b16 v[34:35], v15 offset:12800
buffer_load_dwordx4 v6, s[20:23], s45 offen offset:3072 lds
mf16 v[236:239], v[80:83], v[44:47], v[236:239]
ds_read_b64_tr_b16 v[36:37], v16 offset:12288
mf16 v[252:255], v[84:87], v[44:47], v[252:255]
ds_read_b64_tr_b16 v[38:39], v16 offset:12800
s_waitcnt lgkmcnt(4)
mf16 v[192:195], v[88:91], v[24:27], v[192:195]
ds_read_b64_tr_b16 v[40:41], v13 offset:28672
mf16 v[208:211], v[92:95], v[24:27], v[208:211]
ds_read_b64_tr_b16 v[42:43], v13 offset:29184
mf16 v[196:199], v[88:91], v[28:31], v[196:199]
ds_read_b64_tr_b16 v[44:45], v14 offset:28672
mf16 v[212:215], v[92:95], v[28:31], v[212:215]
ds_read_b64_tr_b16 v[46:47], v14 offset:29184
s_waitcnt lgkmcnt(4)
mf16 v[200:203], v[88:91], v[32:35], v[200:203]
ds_read_b64_tr_b16 v[24:25], v15 offset:28672
mf16 v[216:219], v[92:95], v[32:35], v[216:219]
ds_read_b64_tr_b16 v[26:27], v15 offset:29184
mf16 v[204:207], v[88:91], v[36:39], v[204:207]
ds_read_b64_tr_b16 v[28:29], v16 offset:28672
mf16 v[220:223], v[92:95], v[36:39], v[220:223]
ds_read_b64_tr_b16 v[30:31], v16 offset:29184
s_waitcnt lgkmcnt(4)
mf16 v[224:227], v[88:91], v[40:43], v[224:227]
s_waitcnt vmcnt(10)
s_barrier
s_waitcnt vmcnt(6)
ds_read_b128 v[96:99], v7 offset:0
ds_read_b128 v[100:103], v8 offset:1024
ds_read_b128 v[104:107], v8 offset:0
ds_read_b128 v[108:111], v7 offset:1024
ds_read_b64_tr_b16 v[32:33], v13 offset:32768
mf16 v[240:243], v[92:95], v[40:43], v[240:243]
ds_read_b64_tr_b16 v[34:35], v13 offset:33280
s_add_u32 m0, s47, 0x24000
s_add_u32 s45, s48, 0x200080
buffer_load_dwordx4 v1, s[24:27], s45 offen offset:0 lds
mf16 v[228:231], v[88:91], v[44:47], v[228:231]
ds_read_b64_tr_b16 v[36:37], v14 offset:32768
mf16 v[244:247], v[92:95], v[44:47], v[244:247]
ds_read_b64_tr_b16 v[38:39], v14 offset:33280
s_waitcnt lgkmcnt(8)
mf16 v[232:235], v[88:91], v[24:27], v[232:235]
ds_read_b64_tr_b16 v[40:41], v15 offset:32768
mf16 v[248:251], v[92:95], v[24:27], v[248:251]
ds_read_b64_tr_b16 v[42:43], v15 offset:33280
buffer_load_dwordx4 v2, s[24:27], s45 offen offset:1024 lds
mf16 v[236:239], v[88:91], v[28:31], v[236:239]
ds_read_b64_tr_b16 v[44:45], v16 offset:32768
mf16 v[252:255], v[92:95], v[28:31], v[252:255]
ds_read_b64_tr_b16 v[46:47], v16 offset:33280
s_waitcnt lgkmcnt(4)
mf16 v[192:195], v[96:99], v[32:35], v[192:195]
ds_read_b64_tr_b16 v[24:25], v13 offset:49152
mf16 v[208:211], v[100:103], v[32:35], v[208:211]
ds_read_b64_tr_b16 v[26:27], v13 offset:49664
s_add_u32 m0, s46, 0x0
s_mov_b32 s45, 512
buffer_load_dwordx4 v3, s[20:23], s45 offen offset:0 lds
mf16 v[196:199], v[96:99], v[36:39], v[196:199]
ds_read_b64_tr_b16 v[28:29], v14 offset:49152
mf16 v[212:215], v[100:103], v[36:39], v[212:215]
ds_read_b64_tr_b16 v[30:31], v14 offset:49664
s_waitcnt lgkmcnt(4)
mf16 v[200:203], v[96:99], v[40:43], v[200:203]
ds_read_b64_tr_b16 v[32:33], v15 offset:49152
mf16 v[216:219], v[100:103], v[40:43], v[216:219]
ds_read_b64_tr_b16 v[34:35], v15 offset:49664
buffer_load_dwordx4 v4, s[20:23], s45 offen offset:1024 lds
mf16 v[204:207], v[96:99], v[44:47], v[204:207]
ds_read_b64_tr_b16 v[36:37], v16 offset:49152
mf16 v[220:223], v[100:103], v[44:47], v[220:223]
ds_read_b64_tr_b16 v[38:39], v16 offset:49664
s_waitcnt lgkmcnt(4)
mf16 v[224:227], v[96:99], v[24:27], v[224:227]
ds_read_b64_tr_b16 v[40:41], v13 offset:36864
mf16 v[240:243], v[100:103], v[24:27], v[240:243]
ds_read_b64_tr_b16 v[42:43], v13 offset:37376
buffer_load_dwordx4 v5, s[20:23], s45 offen offset:2048 lds
mf16 v[228:231], v[96:99], v[28:31], v[228:231]
ds_read_b64_tr_b16 v[44:45], v14 offset:36864
mf16 v[244:247], v[100:103], v[28:31], v[244:247]
ds_read_b64_tr_b16 v[46:47], v14 offset:37376
s_waitcnt lgkmcnt(4)
mf16 v[232:235], v[96:99], v[32:35], v[232:235]
ds_read_b64_tr_b16 v[24:25], v15 offset:36864
mf16 v[248:251], v[100:103], v[32:35], v[248:251]
ds_read_b64_tr_b16 v[26:27], v15 offset:37376
buffer_load_dwordx4 v6, s[20:23], s45 offen offset:3072 lds
mf16 v[236:239], v[96:99], v[36:39], v[236:239]
ds_read_b64_tr_b16 v[28:29], v16 offset:36864
mf16 v[252:255], v[100:103], v[36:39], v[252:255]
ds_read_b64_tr_b16 v[30:31], v16 offset:37376
s_waitcnt lgkmcnt(4)
mf16 v[192:195], v[104:107], v[40:43], v[192:195]
ds_read_b64_tr_b16 v[32:33], v13 offset:53248
mf16 v[208:211], v[108:111], v[40:43], v[208:211]
ds_read_b64_tr_b16 v[34:35], v13 offset:53760
s_add_u32 s12, s19, 0
buffer_load_ushort v56, v52, s[8:11], s12 offen nt
mf16 v[196:199], v[104:107], v[44:47], v[196:199]
ds_read_b64_tr_b16 v[36:37], v14 offset:53248
mf16 v[212:215], v[108:111], v[44:47], v[212:215]
ds_read_b64_tr_b16 v[38:39], v14 offset:53760
s_waitcnt lgkmcnt(4)
mf16 v[200:203], v[104:107], v[24:27], v[200:203]
ds_read_b64_tr_b16 v[40:41], v15 offset:53248
mf16 v[216:219], v[108:111], v[24:27], v[216:219]
ds_read_b64_tr_b16 v[42:43], v15 offset:53760
s_add_u32 s12, s19, 16448
buffer_load_ushort v57, v52, s[8:11], s12 offen nt
mf16 v[204:207], v[104:107], v[28:31], v[204:207]
ds_read_b64_tr_b16 v[44:45], v16 offset:53248
mf16 v[220:223], v[108:111], v[28:31], v[220:223]
ds_read_b64_tr_b16 v[46:47], v16 offset:53760
s_waitcnt lgkmcnt(4)
mf16 v[224:227], v[104:107], v[32:35], v[224:227]
s_waitcnt vmcnt(8)
ds_read_b128 v[112:115], v7 offset:4096
ds_read_b128 v[116:119], v8 offset:5120
ds_read_b128 v[120:123], v8 offset:4096
ds_read_b128 v[124:127], v7 offset:5120
ds_read_b64_tr_b16 v[24:25], v13 offset:40960
mf16 v[240:243], v[108:111], v[32:35], v[240:243]
ds_read_b64_tr_b16 v[26:27], v13 offset:41472
s_add_u32 s12, s19, 32896
buffer_load_ushort v58, v52, s[8:11], s12 offen nt
mf16 v[228:231], v[104:107], v[36:39], v[228:231]
ds_read_b64_tr_b16 v[28:29], v14 offset:40960
mf16 v[244:247], v[108:111], v[36:39], v[244:247]
ds_read_b64_tr_b16 v[30:31], v14 offset:41472
s_waitcnt lgkmcnt(8)
mf16 v[232:235], v[104:107], v[40:43], v[232:235]
ds_read_b64_tr_b16 v[32:33], v15 offset:40960
mf16 v[248:251], v[108:111], v[40:43], v[248:251]
ds_read_b64_tr_b16 v[34:35], v15 offset:41472
s_add_u32 s12, s19, 49344
buffer_load_ushort v59, v52, s[8:11], s12 offen nt
mf16 v[236:239], v[104:107], v[44:47], v[236:239]
ds_read_b64_tr_b16 v[36:37], v16 offset:40960
mf16 v[252:255], v[108:111], v[44:47], v[252:255]
ds_read_b64_tr_b16 v[38:39], v16 offset:41472
s_waitcnt lgkmcnt(4)
mf16 v[192:195], v[112:115], v[24:27], v[192:195]
ds_read_b64_tr_b16 v[40:41], v13 offset:57344
mf16 v[208:211], v[116:119], v[24:27], v[208:211]
ds_read_b64_tr_b16 v[42:43], v13 offset:57856
s_add_u32 m0, s46, 0x1000
s_mov_b32 s45, 640
buffer_load_dwordx4 v3, s[20:23], s45 offen offset:0 lds
mf16 v[196:199], v[112:115], v[28:31], v[196:199]
ds_read_b64_tr_b16 v[44:45], v14 offset:57344
mf16 v[212:215], v[116:119], v[28:31], v[212:215]
ds_read_b64_tr_b16 v[46:47], v14 offset:57856
s_waitcnt lgkmcnt(4)
mf16 v[200:203], v[112:115], v[32:35], v[200:203]
ds_read_b64_tr_b16 v[24:25], v15 offset:57344
mf16 v[216:219], v[116:119], v[32:35], v[216:219]
ds_read_b64_tr_b16 v[26:27], v15 offset:57856
buffer_load_dwordx4 v4, s[20:23], s45 offen offset:1024 lds
mf16 v[204:207], v[112:115], v[36:39], v[204:207]
ds_read_b64_tr_b16 v[28:29], v16 offset:57344
mf16 v[220:223], v[116:119], v[36:39], v[220:223]
ds_read_b64_tr_b16 v[30:31], v16 offset:57856
s_waitcnt lgkmcnt(4)
mf16 v[224:227], v[112:115], v[40:43], v[224:227]
ds_read_b64_tr_b16 v[32:33], v13 offset:45056
mf16 v[240:243], v[116:119], v[40:43], v[240:243]
ds_read_b64_tr_b16 v[34:35], v13 offset:45568
buffer_load_dwordx4 v5, s[20:23], s45 offen offset:2048 lds
mf16 v[228:231], v[112:115], v[44:47], v[228:231]
ds_read_b64_tr_b16 v[36:37], v14 offset:45056
mf16 v[244:247], v[116:119], v[44:47], v[244:247]
ds_read_b64_tr_b16 v[38:39], v14 offset:45568
s_waitcnt lgkmcnt(4)
mf16 v[232:235], v[112:115], v[24:27], v[232:235]
ds_read_b64_tr_b16 v[40:41], v15 offset:45056
mf16 v[248:251], v[116:119], v[24:27], v[248:251]
ds_read_b64_tr_b16 v[42:43], v15 offset:45568
buffer_load_dwordx4 v6, s[20:23], s45 offen offset:3072 lds
mf16 v[236:239], v[112:115], v[28:31], v[236:239]
ds_read_b64_tr_b16 v[44:45], v16 offset:45056
mf16 v[252:255], v[116:119], v[28:31], v[252:255]
ds_read_b64_tr_b16 v[46:47], v16 offset:45568
s_waitcnt lgkmcnt(4)
mf16 v[192:195], v[120:123], v[32:35], v[192:195]
ds_read_b64_tr_b16 v[24:25], v13 offset:61440
mf16 v[208:211], v[124:127], v[32:35], v[208:211]
ds_read_b64_tr_b16 v[26:27], v13 offset:61952
s_add_u32 s12, s19, 131584
buffer_load_ushort v60, v52, s[8:11], s12 offen nt
mf16 v[196:199], v[120:123], v[36:39], v[196:199]
ds_read_b64_tr_b16 v[28:29], v14 offset:61440
mf16 v[212:215], v[124:127], v[36:39], v[212:215]
ds_read_b64_tr_b16 v[30:31], v14 offset:61952
s_waitcnt lgkmcnt(4)
mf16 v[200:203], v[120:123], v[40:43], v[200:203]
ds_read_b64_tr_b16 v[32:33], v15 offset:61440
mf16 v[216:219], v[124:127], v[40:43], v[216:219]
ds_read_b64_tr_b16 v[34:35], v15 offset:61952
s_add_u32 s12, s19, 148032
buffer_load_ushort v61, v52, s[8:11], s12 offen nt
mf16 v[204:207], v[120:123], v[44:47], v[204:207]
ds_read_b64_tr_b16 v[36:37], v16 offset:61440
mf16 v[220:223], v[124:127], v[44:47], v[220:223]
ds_read_b64_tr_b16 v[38:39], v16 offset:61952
s_waitcnt lgkmcnt(4)
mf16 v[224:227], v[120:123], v[24:27], v[224:227]
s_waitcnt vmcnt(14)
s_barrier
s_waitcnt vmcnt(10)
ds_read_b128 v[128:131], v7 offset:0
ds_read_b128 v[132:135], v8 offset:1024
ds_read_b128 v[136:139], v8 offset:0
ds_read_b128 v[140:143], v7 offset:1024
ds_read_b64_tr_b16 v[40:41], v17 offset:0
mf16 v[240:243], v[124:127], v[24:27], v[240:243]
ds_read_b64_tr_b16 v[42:43], v17 offset:512
s_add_u32 m0, s47, 0x10000
s_add_u32 s45, s48, 0x300000
buffer_load_dwordx4 v1, s[24:27], s45 offen offset:0 lds
mf16 v[228:231], v[120:123], v[28:31], v[228:231]
ds_read_b64_tr_b16 v[44:45], v18 offset:0
mf16 v[244:247], v[124:127], v[28:31], v[244:247]
ds_read_b64_tr_b16 v[46:47], v18 offset:512
s_waitcnt lgkmcnt(8)
mf16 v[232:235], v[120:123], v[32:35], v[232:235]
ds_read_b64_tr_b16 v[24:25], v19 offset:0
mf16 v[248:251], v[124:127], v[32:35], v[248:251]
ds_read_b64_tr_b16 v[26:27], v19 offset:512
buffer_load_dwordx4 v2, s[24:27], s45 offen offset:1024 lds
mf16 v[236:239], v[120:123], v[36:39], v[236:239]
ds_read_b64_tr_b16 v[28:29], v20 offset:0
mf16 v[252:255], v[124:127], v[36:39], v[252:255]
ds_read_b64_tr_b16 v[30:31], v20 offset:512
s_waitcnt lgkmcnt(4)
mf16 v[192:195], v[128:131], v[40:43], v[192:195]
ds_read_b64_tr_b16 v[32:33], v17 offset:16384
mf16 v[208:211], v[132:135], v[40:43], v[208:211]
ds_read_b64_tr_b16 v[34:35], v17 offset:16896
s_add_u32 m0, s46, 0x0
s_mov_b32 s45, 768
buffer_load_dwordx4 v3, s[20:23], s45 offen offset:0 lds
mf16 v[196:199], v[128:131], v[44:47], v[196:199]
ds_read_b64_tr_b16 v[36:37], v18 offset:16384
mf16 v[212:215], v[132:135], v[44:47], v[212:215]
ds_read_b64_tr_b16 v[38:39], v18 offset:16896
s_waitcnt lgkmcnt(4)
mf16 v[200:203], v[128:131], v[24:27], v[200:203]
ds_read_b64_tr_b16 v[40:41], v19 offset:16384
mf16 v[216:219], v[132:135], v[24:27], v[216:219]
ds_read_b64_tr_b16 v[42:43], v19 offset:16896
buffer_load_dwordx4 v4, s[20:23], s45 offen offset:1024 lds
mf16 v[204:207], v[128:131], v[28:31], v[204:207]
ds_read_b64_tr_b16 v[44:45], v20 offset:16384
mf16 v[220:223], v[132:135], v[28:31], v[220:223]
ds_read_b64_tr_b16 v[46:47], v20 offset:16896
s_waitcnt lgkmcnt(4)
mf16 v[224:227], v[128:131], v[32:35], v[224:227]
ds_read_b64_tr_b16 v[24:25], v17 offset:4096
mf16 v[240:243], v[132:135], v[32:35], v[240:243]
ds_read_b64_tr_b16 v[26:27], v17 offset:4608
buffer_load_dwordx4 v5, s[20:23], s45 offen offset:2048 lds
mf16 v[228:231], v[128:131], v[36:39], v[228:231]
ds_read_b64_tr_b16 v[28:29], v18 offset:4096
mf16 v[244:247], v[132:135], v[36:39], v[244:247]
ds_read_b64_tr_b16 v[30:31], v18 offset:4608
s_waitcnt lgkmcnt(4)
mf16 v[232:235], v[128:131], v[40:43], v[232:235]
ds_read_b64_tr_b16 v[32:33], v19 offset:4096
mf16 v[248:251], v[132:135], v[40:43], v[248:251]
ds_read_b64_tr_b16 v[34:35], v19 offset:4608
buffer_load_dwordx4 v6, s[20:23], s45 offen offset:3072 lds
mf16 v[236:239], v[128:131], v[44:47], v[236:239]
ds_read_b64_tr_b16 v[36:37], v20 offset:4096
s_add_u32 m0, s47, 0x14000
s_add_u32 s45, s48, 0x300080
buffer_load_dwordx4 v1, s[24:27], s45 offen offset:0 lds
buffer_load_dwordx4 v2, s[24:27], s45 offen offset:1024 lds
s_add_u32 s12, s19, 164480
buffer_load_ushort v62, v52, s[8:11], s12 offen nt
s_add_u32 s12, s19, 180928
buffer_load_ushort v63, v52, s[8:11], s12 offen nt
buffer_load_ushort v55, v53, s[8:11], s19 offen nt
s_waitcnt vmcnt(0)
v_lshlrev_b32 v54, 1, v0
mf16 v[252:255], v[132:135], v[44:47], v[252:255]
ds_read_b64_tr_b16 v[38:39], v20 offset:4608
s_waitcnt lgkmcnt(4)
mf16 v[192:195], v[136:139], v[24:27], v[192:195]
ds_read_b64_tr_b16 v[40:41], v17 offset:20480
s_mov_b64 exec, 0xff
buffer_store_short v55, v54, s[60:63], s67 offen
s_mov_b64 exec, -1
mf16 v[208:211], v[140:143], v[24:27], v[208:211]
ds_read_b64_tr_b16 v[42:43], v17 offset:20992
v_lshl_or_b32 v52, v57, 16, v56
mf16 v[196:199], v[136:139], v[28:31], v[196:199]
ds_read_b64_tr_b16 v[44:45], v18 offset:20480
v_lshl_or_b32 v53, v59, 16, v58
mf16 v[212:215], v[140:143], v[28:31], v[212:215]
ds_read_b64_tr_b16 v[46:47], v18 offset:20992
s_waitcnt lgkmcnt(4)
mf16 v[200:203], v[136:139], v[32:35], v[200:203]
ds_read_b64_tr_b16 v[24:25], v19 offset:20480
v_lshl_or_b32 v54, v61, 16, v60
mf16 v[216:219], v[140:143], v[32:35], v[216:219]
ds_read_b64_tr_b16 v[26:27], v19 offset:20992
v_lshl_or_b32 v55, v63, 16, v62
mf16 v[204:207], v[136:139], v[36:39], v[204:207]
ds_read_b64_tr_b16 v[28:29], v20 offset:20480
mf16 v[220:223], v[140:143], v[36:39], v[220:223]
ds_read_b64_tr_b16 v[30:31], v20 offset:20992
s_waitcnt lgkmcnt(4)
mf16 v[224:227], v[136:139], v[40:43], v[224:227]
ds_read_b128 v[144:147], v7 offset:4096
ds_read_b128 v[148:151], v8 offset:5120
ds_read_b128 v[152:155], v8 offset:4096
ds_read_b128 v[156:159], v7 offset:5120
ds_read_b64_tr_b16 v[32:33], v17 offset:8192
mf16 v[240:243], v[140:143], v[40:43], v[240:243]
ds_read_b64_tr_b16 v[34:35], v17 offset:8704
mf16 v[228:231], v[136:139], v[44:47], v[228:231]
ds_read_b64_tr_b16 v[36:37], v18 offset:8192
mf16 v[244:247], v[140:143], v[44:47], v[244:247]
ds_read_b64_tr_b16 v[38:39], v18 offset:8704
s_waitcnt lgkmcnt(8)
mf16 v[232:235], v[136:139], v[24:27], v[232:235]
ds_read_b64_tr_b16 v[40:41], v19 offset:8192
mf16 v[248:251], v[140:143], v[24:27], v[248:251]
ds_read_b64_tr_b16 v[42:43], v19 offset:8704
mf16 v[236:239], v[136:139], v[28:31], v[236:239]
ds_read_b64_tr_b16 v[44:45], v20 offset:8192
mf16 v[252:255], v[140:143], v[28:31], v[252:255]
ds_read_b64_tr_b16 v[46:47], v20 offset:8704
s_waitcnt lgkmcnt(4)
mf16 v[192:195], v[144:147], v[32:35], v[192:195]
ds_read_b64_tr_b16 v[24:25], v17 offset:24576
mf16 v[208:211], v[148:151], v[32:35], v[208:211]
ds_read_b64_tr_b16 v[26:27], v17 offset:25088
s_add_u32 m0, s46, 0x1000
s_mov_b32 s45, 896
buffer_load_dwordx4 v3, s[20:23], s45 offen offset:0 lds
mf16 v[196:199], v[144:147], v[36:39], v[196:199]
ds_read_b64_tr_b16 v[28:29], v18 offset:24576
mf16 v[212:215], v[148:151], v[36:39], v[212:215]
ds_read_b64_tr_b16 v[30:31], v18 offset:25088
s_waitcnt lgkmcnt(4)
mf16 v[200:203], v[144:147], v[40:43], v[200:203]
ds_read_b64_tr_b16 v[32:33], v19 offset:24576
mf16 v[216:219], v[148:151], v[40:43], v[216:219]
ds_read_b64_tr_b16 v[34:35], v19 offset:25088
buffer_load_dwordx4 v4, s[20:23], s45 offen offset:1024 lds
mf16 v[204:207], v[144:147], v[44:47], v[204:207]
ds_read_b64_tr_b16 v[36:37], v20 offset:24576
mf16 v[220:223], v[148:151], v[44:47], v[220:223]
ds_read_b64_tr_b16 v[38:39], v20 offset:25088
s_waitcnt lgkmcnt(4)
mf16 v[224:227], v[144:147], v[24:27], v[224:227]
ds_read_b64_tr_b16 v[40:41], v17 offset:12288
mf16 v[240:243], v[148:151], v[24:27], v[240:243]
ds_read_b64_tr_b16 v[42:43], v17 offset:12800
buffer_load_dwordx4 v5, s[20:23], s45 offen offset:2048 lds
mf16 v[228:231], v[144:147], v[28:31], v[228:231]
ds_read_b64_tr_b16 v[44:45], v18 offset:12288
mf16 v[244:247], v[148:151], v[28:31], v[244:247]
ds_read_b64_tr_b16 v[46:47], v18 offset:12800
s_waitcnt lgkmcnt(4)
mf16 v[232:235], v[144:147], v[32:35], v[232:235]
ds_read_b64_tr_b16 v[24:25], v19 offset:12288
mf16 v[248:251], v[148:151], v[32:35], v[248:251]
ds_read_b64_tr_b16 v[26:27], v19 offset:12800
buffer_load_dwordx4 v6, s[20:23], s45 offen offset:3072 lds
mf16 v[236:239], v[144:147], v[36:39], v[236:239]
ds_read_b64_tr_b16 v[28:29], v20 offset:12288
mf16 v[252:255], v[148:151], v[36:39], v[252:255]
ds_read_b64_tr_b16 v[30:31], v20 offset:12800
s_waitcnt lgkmcnt(4)
mf16 v[192:195], v[152:155], v[40:43], v[192:195]
ds_read_b64_tr_b16 v[32:33], v17 offset:28672
mf16 v[208:211], v[156:159], v[40:43], v[208:211]
ds_read_b64_tr_b16 v[34:35], v17 offset:29184
s_mov_b64 exec, 0xffff
buffer_load_dword v56, v23, s[4:7], s13 offen
s_mov_b64 exec, -1
mf16 v[196:199], v[152:155], v[44:47], v[196:199]
ds_read_b64_tr_b16 v[36:37], v18 offset:28672
mf16 v[212:215], v[156:159], v[44:47], v[212:215]
ds_read_b64_tr_b16 v[38:39], v18 offset:29184
s_waitcnt lgkmcnt(4)
mf16 v[200:203], v[152:155], v[24:27], v[200:203]
ds_read_b64_tr_b16 v[40:41], v19 offset:28672
mf16 v[216:219], v[156:159], v[24:27], v[216:219]
ds_read_b64_tr_b16 v[42:43], v19 offset:29184
s_mov_b64 exec, 0xffff
buffer_load_dword v57, v23, s[32:35], s17 offen
s_mov_b64 exec, -1
mf16 v[204:207], v[152:155], v[28:31], v[204:207]
ds_read_b64_tr_b16 v[44:45], v20 offset:28672
mf16 v[220:223], v[156:159], v[28:31], v[220:223]
ds_read_b64_tr_b16 v[46:47], v20 offset:29184
s_waitcnt lgkmcnt(4)
mf16 v[224:227], v[152:155], v[32:35], v[224:227]
s_barrier
ds_read_b128 v[160:163], v7 offset:0
ds_read_b128 v[164:167], v8 offset:1024
ds_read_b128 v[168:171], v8 offset:0
ds_read_b128 v[172:175], v7 offset:1024
ds_read_b64_tr_b16 v[24:25], v13 offset:0
mf16 v[240:243], v[156:159], v[32:35], v[240:243]
ds_read_b64_tr_b16 v[26:27], v13 offset:512
s_add_u32 m0, s47, 0x18000
s_add_u32 s45, s53, 0x0
buffer_load_dwordx4 v1, s[32:35], s45 offen offset:0 lds
mf16 v[228:231], v[152:155], v[36:39], v[228:231]
ds_read_b64_tr_b16 v[28:29], v14 offset:0
mf16 v[244:247], v[156:159], v[36:39], v[244:247]
ds_read_b64_tr_b16 v[30:31], v14 offset:512
s_waitcnt lgkmcnt(8)
mf16 v[232:235], v[152:155], v[40:43], v[232:235]
ds_read_b64_tr_b16 v[32:33], v15 offset:0
mf16 v[248:251], v[156:159], v[40:43], v[248:251]
ds_read_b64_tr_b16 v[34:35], v15 offset:512
buffer_load_dwordx4 v2, s[32:35], s45 offen offset:1024 lds
mf16 v[236:239], v[152:155], v[44:47], v[236:239]
ds_read_b64_tr_b16 v[36:37], v16 offset:0
mf16 v[252:255], v[156:159], v[44:47], v[252:255]
ds_read_b64_tr_b16 v[38:39], v16 offset:512
s_waitcnt lgkmcnt(4)
mf16 v[192:195], v[160:163], v[24:27], v[192:195]
ds_read_b64_tr_b16 v[40:41], v13 offset:16384
mf16 v[208:211], v[164:167], v[24:27], v[208:211]
ds_read_b64_tr_b16 v[42:43], v13 offset:16896
s_add_u32 m0, s46, 0x0
s_mov_b32 s45, 0
buffer_load_dwordx4 v3, s[56:59], s45 offen offset:0 lds
mf16 v[196:199], v[160:163], v[28:31], v[196:199]
ds_read_b64_tr_b16 v[44:45], v14 offset:16384
mf16 v[212:215], v[164:167], v[28:31], v[212:215]
ds_read_b64_tr_b16 v[46:47], v14 offset:16896
s_waitcnt lgkmcnt(4)
mf16 v[200:203], v[160:163], v[32:35], v[200:203]
ds_read_b64_tr_b16 v[24:25], v15 offset:16384
mf16 v[216:219], v[164:167], v[32:35], v[216:219]
ds_read_b64_tr_b16 v[26:27], v15 offset:16896
buffer_load_dwordx4 v4, s[56:59], s45 offen offset:1024 lds
mf16 v[204:207], v[160:163], v[36:39], v[204:207]
ds_read_b64_tr_b16 v[28:29], v16 offset:16384
mf16 v[220:223], v[164:167], v[36:39], v[220:223]
ds_read_b64_tr_b16 v[30:31], v16 offset:16896
s_waitcnt lgkmcnt(4)
mf16 v[224:227], v[160:163], v[40:43], v[224:227]
ds_read_b64_tr_b16 v[32:33], v13 offset:4096
mf16 v[240:243], v[164:167], v[40:43], v[240:243]
ds_read_b64_tr_b16 v[34:35], v13 offset:4608
buffer_load_dwordx4 v5, s[56:59], s45 offen offset:2048 lds
mf16 v[228:231], v[160:163], v[44:47], v[228:231]
ds_read_b64_tr_b16 v[36:37], v14 offset:4096
mf16 v[244:247], v[164:167], v[44:47], v[244:247]
ds_read_b64_tr_b16 v[38:39], v14 offset:4608
s_waitcnt lgkmcnt(4)
mf16 v[232:235], v[160:163], v[24:27], v[232:235]
ds_read_b64_tr_b16 v[40:41], v15 offset:4096
mf16 v[248:251], v[164:167], v[24:27], v[248:251]
ds_read_b64_tr_b16 v[42:43], v15 offset:4608
buffer_load_dwordx4 v6, s[56:59], s45 offen offset:3072 lds
mf16 v[236:239], v[160:163], v[28:31], v[236:239]
ds_read_b64_tr_b16 v[44:45], v16 offset:4096
mf16 v[252:255], v[164:167], v[28:31], v[252:255]
ds_read_b64_tr_b16 v[46:47], v16 offset:4608
s_waitcnt lgkmcnt(4)
mf16 v[192:195], v[168:171], v[32:35], v[192:195]
ds_read_b64_tr_b16 v[24:25], v13 offset:20480
mf16 v[208:211], v[172:175], v[32:35], v[208:211]
ds_read_b64_tr_b16 v[26:27], v13 offset:20992
s_add_u32 m0, s47, 0x1c000
s_add_u32 s45, s53, 0x80
buffer_load_dwordx4 v1, s[32:35], s45 offen offset:0 lds
mf16 v[196:199], v[168:171], v[36:39], v[196:199]
ds_read_b64_tr_b16 v[28:29], v14 offset:20480
mf16 v[212:215], v[172:175], v[36:39], v[212:215]
ds_read_b64_tr_b16 v[30:31], v14 offset:20992
s_waitcnt lgkmcnt(4)
mf16 v[200:203], v[168:171], v[40:43], v[200:203]
ds_read_b64_tr_b16 v[32:33], v15 offset:20480
mf16 v[216:219], v[172:175], v[40:43], v[216:219]
ds_read_b64_tr_b16 v[34:35], v15 offset:20992
buffer_load_dwordx4 v2, s[32:35], s45 offen offset:1024 lds
mf16 v[204:207], v[168:171], v[44:47], v[204:207]
ds_read_b64_tr_b16 v[36:37], v16 offset:20480
mf16 v[220:223], v[172:175], v[44:47], v[220:223]
ds_read_b64_tr_b16 v[38:39], v16 offset:20992
s_waitcnt lgkmcnt(4)
mf16 v[224:227], v[168:171], v[24:27], v[224:227]
s_waitcnt vmcnt(10)
ds_read_b128 v[176:179], v7 offset:4096
ds_read_b128 v[180:183], v8 offset:5120
ds_read_b128 v[184:187], v8 offset:4096
ds_read_b128 v[188:191], v7 offset:5120
ds_read_b64_tr_b16 v[40:41], v13 offset:8192
mf16 v[240:243], v[172:175], v[24:27], v[240:243]
ds_read_b64_tr_b16 v[42:43], v13 offset:8704
mf16 v[228:231], v[168:171], v[28:31], v[228:231]
ds_read_b64_tr_b16 v[24:25], v14 offset:8192
mf16 v[244:247], v[172:175], v[28:31], v[244:247]
ds_read_b64_tr_b16 v[26:27], v14 offset:8704
s_waitcnt lgkmcnt(8)
mf16 v[232:235], v[168:171], v[32:35], v[232:235]
ds_read_b64_tr_b16 v[28:29], v15 offset:8192
mf16 v[248:251], v[172:175], v[32:35], v[248:251]
ds_read_b64_tr_b16 v[30:31], v15 offset:8704
mf16 v[236:239], v[168:171], v[36:39], v[236:239]
ds_read_b64_tr_b16 v[32:33], v16 offset:8192
mf16 v[252:255], v[172:175], v[36:39], v[252:255]
ds_read_b64_tr_b16 v[34:35], v16 offset:8704
s_waitcnt lgkmcnt(4)
mf16 v[192:195], v[176:179], v[40:43], v[192:195]
ds_read_b64_tr_b16 v[36:37], v13 offset:24576
mf16 v[208:211], v[180:183], v[40:43], v[208:211]
ds_read_b64_tr_b16 v[38:39], v13 offset:25088
s_add_u32 m0, s46, 0x1000
s_mov_b32 s45, 128
buffer_load_dwordx4 v3, s[56:59], s45 offen offset:0 lds
mf16 v[196:199], v[176:179], v[24:27], v[196:199]
ds_read_b64_tr_b16 v[40:41], v14 offset:24576
mf16 v[212:215], v[180:183], v[24:27], v[212:215]
ds_read_b64_tr_b16 v[42:43], v14 offset:25088
s_waitcnt lgkmcnt(4)
mf16 v[200:203], v[176:179], v[28:31], v[200:203]
ds_read_b64_tr_b16 v[24:25], v15 offset:24576
mf16 v[216:219], v[180:183], v[28:31], v[216:219]
ds_read_b64_tr_b16 v[26:27], v15 offset:25088
buffer_load_dwordx4 v4, s[56:59], s45 offen offset:1024 lds
mf16 v[204:207], v[176:179], v[32:35], v[204:207]
ds_read_b64_tr_b16 v[28:29], v16 offset:24576
mf16 v[220:223], v[180:183], v[32:35], v[220:223]
ds_read_b64_tr_b16 v[30:31], v16 offset:25088
s_waitcnt lgkmcnt(4)
mf16 v[224:227], v[176:179], v[36:39], v[224:227]
ds_read_b64_tr_b16 v[32:33], v13 offset:12288
mf16 v[240:243], v[180:183], v[36:39], v[240:243]
ds_read_b64_tr_b16 v[34:35], v13 offset:12800
buffer_load_dwordx4 v5, s[56:59], s45 offen offset:2048 lds
mf16 v[228:231], v[176:179], v[40:43], v[228:231]
ds_read_b64_tr_b16 v[36:37], v14 offset:12288
mf16 v[244:247], v[180:183], v[40:43], v[244:247]
ds_read_b64_tr_b16 v[38:39], v14 offset:12800
s_waitcnt lgkmcnt(4)
mf16 v[232:235], v[176:179], v[24:27], v[232:235]
ds_read_b64_tr_b16 v[40:41], v15 offset:12288
mf16 v[248:251], v[180:183], v[24:27], v[248:251]
ds_read_b64_tr_b16 v[42:43], v15 offset:12800
buffer_load_dwordx4 v6, s[56:59], s45 offen offset:3072 lds
mf16 v[236:239], v[176:179], v[28:31], v[236:239]
ds_read_b64_tr_b16 v[24:25], v16 offset:12288
mf16 v[252:255], v[180:183], v[28:31], v[252:255]
ds_read_b64_tr_b16 v[26:27], v16 offset:12800
s_waitcnt lgkmcnt(4)
mf16 v[192:195], v[184:187], v[32:35], v[192:195]
ds_read_b64_tr_b16 v[28:29], v13 offset:28672
mf16 v[208:211], v[188:191], v[32:35], v[208:211]
ds_read_b64_tr_b16 v[30:31], v13 offset:29184
mf16 v[196:199], v[184:187], v[36:39], v[196:199]
ds_read_b64_tr_b16 v[32:33], v14 offset:28672
mf16 v[212:215], v[188:191], v[36:39], v[212:215]
ds_read_b64_tr_b16 v[34:35], v14 offset:29184
s_waitcnt lgkmcnt(4)
mf16 v[200:203], v[184:187], v[40:43], v[200:203]
ds_read_b64_tr_b16 v[36:37], v15 offset:28672
mf16 v[216:219], v[188:191], v[40:43], v[216:219]
ds_read_b64_tr_b16 v[38:39], v15 offset:29184
mf16 v[204:207], v[184:187], v[24:27], v[204:207]
ds_read_b64_tr_b16 v[40:41], v16 offset:28672
mf16 v[220:223], v[188:191], v[24:27], v[220:223]
ds_read_b64_tr_b16 v[42:43], v16 offset:29184
s_waitcnt lgkmcnt(4)
mf16 v[224:227], v[184:187], v[28:31], v[224:227]
s_waitcnt vmcnt(4)
s_barrier
ds_read_b128 v[64:67], v7 offset:0
ds_read_b128 v[68:71], v8 offset:1024
ds_read_b128 v[72:75], v8 offset:0
ds_read_b128 v[76:79], v7 offset:1024
ds_read_b64_tr_b16 v[24:25], v13 offset:32768
mf16 v[240:243], v[188:191], v[28:31], v[240:243]
ds_read_b64_tr_b16 v[26:27], v13 offset:33280
s_add_u32 m0, s47, 0x20000
s_add_u32 s45, s53, 0x100000
buffer_load_dwordx4 v1, s[32:35], s45 offen offset:0 lds
mf16 v[228:231], v[184:187], v[32:35], v[228:231]
ds_read_b64_tr_b16 v[28:29], v14 offset:32768
mf16 v[244:247], v[188:191], v[32:35], v[244:247]
ds_read_b64_tr_b16 v[30:31], v14 offset:33280
s_waitcnt lgkmcnt(8)
mf16 v[232:235], v[184:187], v[36:39], v[232:235]
ds_read_b64_tr_b16 v[32:33], v15 offset:32768
mf16 v[248:251], v[188:191], v[36:39], v[248:251]
ds_read_b64_tr_b16 v[34:35], v15 offset:33280
buffer_load_dwordx4 v2, s[32:35], s45 offen offset:1024 lds
mf16 v[236:239], v[184:187], v[40:43], v[236:239]
ds_read_b64_tr_b16 v[36:37], v16 offset:32768
mf16 v[252:255], v[188:191], v[40:43], v[252:255]
ds_read_b64_tr_b16 v[38:39], v16 offset:33280
s_add_u32 m0, s47, 0x24000
s_add_u32 s45, s53, 0x100080
buffer_load_dwordx4 v1, s[32:35], s45 offen offset:0 lds
buffer_load_dwordx4 v2, s[32:35], s45 offen offset:1024 lds
s_and_b32 s12, s16, 3
s_lshl_b32 s12, s12, 19
v_lshlrev_b32 v23, 13, v0
v_add_u32 v23, s12, v23
s_nop 2
s_add_u32 s54, s50, 0
cvtpk v56, v192, v193
cvtpk v57, v194, v195
cvtpk v58, v208, v209
cvtpk v59, v210, v211
buffer_store_dwordx4 v[56:59], v22, s[28:31], s54 offen offset:0 sc1
cvtpk v60, v196, v197
cvtpk v61, v198, v199
cvtpk v62, v212, v213
cvtpk v63, v214, v215
buffer_store_dwordx4 v[60:63], v22, s[28:31], s54 offen offset:256 sc1
cvtpk v56, v200, v201
cvtpk v57, v202, v203
cvtpk v58, v216, v217
cvtpk v59, v218, v219
buffer_store_dwordx4 v[56:59], v22, s[28:31], s54 offen offset:2048 sc1
cvtpk v60, v204, v205
cvtpk v61, v206, v207
cvtpk v62, v220, v221
cvtpk v63, v222, v223
buffer_store_dwordx4 v[60:63], v22, s[28:31], s54 offen offset:2304 sc1
s_add_u32 s55, s50, 4096
cvtpk v56, v224, v225
cvtpk v57, v226, v227
cvtpk v58, v240, v241
cvtpk v59, v242, v243
buffer_store_dwordx4 v[56:59], v22, s[28:31], s55 offen offset:0 sc1
cvtpk v60, v228, v229
cvtpk v61, v230, v231
cvtpk v62, v244, v245
cvtpk v63, v246, v247
buffer_store_dwordx4 v[60:63], v22, s[28:31], s55 offen offset:256 sc1
cvtpk v56, v232, v233
cvtpk v57, v234, v235
cvtpk v58, v248, v249
cvtpk v59, v250, v251
buffer_store_dwordx4 v[56:59], v22, s[28:31], s55 offen offset:2048 sc1
cvtpk v60, v236, v237
cvtpk v61, v238, v239
cvtpk v62, v252, v253
cvtpk v63, v254, v255
buffer_store_dwordx4 v[60:63], v22, s[28:31], s55 offen offset:2304 sc1
s_waitcnt lgkmcnt(4)
mf16 v[192:195], v[24:27], v[64:67], 0
ds_read_b64_tr_b16 v[40:41], v13 offset:49152
mf16 v[208:211], v[24:27], v[68:71], 0
ds_read_b64_tr_b16 v[42:43], v13 offset:49664
s_add_u32 m0, s46, 0x0
s_mov_b32 s45, 256
buffer_load_dwordx4 v3, s[56:59], s45 offen offset:0 lds
mf16 v[196:199], v[28:31], v[64:67], 0
ds_read_b64_tr_b16 v[44:45], v14 offset:49152
mf16 v[212:215], v[28:31], v[68:71], 0
ds_read_b64_tr_b16 v[46:47], v14 offset:49664
s_waitcnt lgkmcnt(4)
mf16 v[200:203], v[32:35], v[64:67], 0
ds_read_b64_tr_b16 v[24:25], v15 offset:49152
mf16 v[216:219], v[32:35], v[68:71], 0
ds_read_b64_tr_b16 v[26:27], v15 offset:49664
buffer_load_dwordx4 v4, s[56:59], s45 offen offset:1024 lds
mf16 v[204:207], v[36:39], v[64:67], 0
ds_read_b64_tr_b16 v[28:29], v16 offset:49152
mf16 v[220:223], v[36:39], v[68:71], 0
ds_read_b64_tr_b16 v[30:31], v16 offset:49664
s_waitcnt lgkmcnt(4)
mf16 v[224:227], v[40:43], v[64:67], 0
ds_read_b64_tr_b16 v[32:33], v13 offset:36864
mf16 v[240:243], v[40:43], v[68:71], 0
ds_read_b64_tr_b16 v[34:35], v13 offset:37376
buffer_load_dwordx4 v5, s[56:59], s45 offen offset:2048 lds
mf16 v[228:231], v[44:47], v[64:67], 0
ds_read_b64_tr_b16 v[36:37], v14 offset:36864
mf16 v[244:247], v[44:47], v[68:71], 0
ds_read_b64_tr_b16 v[38:39], v14 offset:37376
s_waitcnt lgkmcnt(4)
mf16 v[232:235], v[24:27], v[64:67], 0
ds_read_b64_tr_b16 v[40:41], v15 offset:36864
mf16 v[248:251], v[24:27], v[68:71], 0
ds_read_b64_tr_b16 v[42:43], v15 offset:37376
buffer_load_dwordx4 v6, s[56:59], s45 offen offset:3072 lds
mf16 v[236:239], v[28:31], v[64:67], 0
ds_read_b64_tr_b16 v[44:45], v16 offset:36864
mf16 v[252:255], v[28:31], v[68:71], 0
ds_read_b64_tr_b16 v[46:47], v16 offset:37376
s_waitcnt lgkmcnt(4)
mf16 v[192:195], v[32:35], v[72:75], v[192:195]
ds_read_b64_tr_b16 v[24:25], v13 offset:53248
mf16 v[208:211], v[32:35], v[76:79], v[208:211]
ds_read_b64_tr_b16 v[26:27], v13 offset:53760
mf16 v[196:199], v[36:39], v[72:75], v[196:199]
ds_read_b64_tr_b16 v[28:29], v14 offset:53248
mf16 v[212:215], v[36:39], v[76:79], v[212:215]
ds_read_b64_tr_b16 v[30:31], v14 offset:53760
s_waitcnt lgkmcnt(4)
mf16 v[200:203], v[40:43], v[72:75], v[200:203]
ds_read_b64_tr_b16 v[32:33], v15 offset:53248
mf16 v[216:219], v[40:43], v[76:79], v[216:219]
ds_read_b64_tr_b16 v[34:35], v15 offset:53760
mf16 v[204:207], v[44:47], v[72:75], v[204:207]
ds_read_b64_tr_b16 v[36:37], v16 offset:53248
mf16 v[220:223], v[44:47], v[76:79], v[220:223]
ds_read_b64_tr_b16 v[38:39], v16 offset:53760
s_waitcnt lgkmcnt(4)
mf16 v[224:227], v[24:27], v[72:75], v[224:227]
s_waitcnt vmcnt(16)
ds_read_b128 v[80:83], v7 offset:4096
ds_read_b128 v[84:87], v8 offset:5120
ds_read_b128 v[88:91], v8 offset:4096
ds_read_b128 v[92:95], v7 offset:5120
ds_read_b64_tr_b16 v[40:41], v13 offset:40960
mf16 v[240:243], v[24:27], v[76:79], v[240:243]
ds_read_b64_tr_b16 v[42:43], v13 offset:41472
mf16 v[228:231], v[28:31], v[72:75], v[228:231]
ds_read_b64_tr_b16 v[44:45], v14 offset:40960
mf16 v[244:247], v[28:31], v[76:79], v[244:247]
ds_read_b64_tr_b16 v[46:47], v14 offset:41472
s_waitcnt lgkmcnt(8)
mf16 v[232:235], v[32:35], v[72:75], v[232:235]
ds_read_b64_tr_b16 v[24:25], v15 offset:40960
mf16 v[248:251], v[32:35], v[76:79], v[248:251]
ds_read_b64_tr_b16 v[26:27], v15 offset:41472
mf16 v[236:239], v[36:39], v[72:75], v[236:239]
ds_read_b64_tr_b16 v[28:29], v16 offset:40960
mf16 v[252:255], v[36:39], v[76:79], v[252:255]
ds_read_b64_tr_b16 v[30:31], v16 offset:41472
s_waitcnt lgkmcnt(4)
mf16 v[192:195], v[40:43], v[80:83], v[192:195]
ds_read_b64_tr_b16 v[32:33], v13 offset:57344
mf16 v[208:211], v[40:43], v[84:87], v[208:211]
ds_read_b64_tr_b16 v[34:35], v13 offset:57856
s_add_u32 m0, s46, 0x1000
s_mov_b32 s45, 384
buffer_load_dwordx4 v3, s[56:59], s45 offen offset:0 lds
mf16 v[196:199], v[44:47], v[80:83], v[196:199]
ds_read_b64_tr_b16 v[36:37], v14 offset:57344
mf16 v[212:215], v[44:47], v[84:87], v[212:215]
ds_read_b64_tr_b16 v[38:39], v14 offset:57856
s_waitcnt lgkmcnt(4)
mf16 v[200:203], v[24:27], v[80:83], v[200:203]
ds_read_b64_tr_b16 v[40:41], v15 offset:57344
mf16 v[216:219], v[24:27], v[84:87], v[216:219]
ds_read_b64_tr_b16 v[42:43], v15 offset:57856
buffer_load_dwordx4 v4, s[56:59], s45 offen offset:1024 lds
mf16 v[204:207], v[28:31], v[80:83], v[204:207]
ds_read_b64_tr_b16 v[44:45], v16 offset:57344
mf16 v[220:223], v[28:31], v[84:87], v[220:223]
ds_read_b64_tr_b16 v[46:47], v16 offset:57856
s_waitcnt lgkmcnt(4)
mf16 v[224:227], v[32:35], v[80:83], v[224:227]
ds_read_b64_tr_b16 v[24:25], v13 offset:45056
mf16 v[240:243], v[32:35], v[84:87], v[240:243]
ds_read_b64_tr_b16 v[26:27], v13 offset:45568
buffer_load_dwordx4 v5, s[56:59], s45 offen offset:2048 lds
mf16 v[228:231], v[36:39], v[80:83], v[228:231]
ds_read_b64_tr_b16 v[28:29], v14 offset:45056
mf16 v[244:247], v[36:39], v[84:87], v[244:247]
ds_read_b64_tr_b16 v[30:31], v14 offset:45568
s_waitcnt lgkmcnt(4)
mf16 v[232:235], v[40:43], v[80:83], v[232:235]
ds_read_b64_tr_b16 v[32:33], v15 offset:45056
mf16 v[248:251], v[40:43], v[84:87], v[248:251]
ds_read_b64_tr_b16 v[34:35], v15 offset:45568
buffer_load_dwordx4 v6, s[56:59], s45 offen offset:3072 lds
mf16 v[236:239], v[44:47], v[80:83], v[236:239]
ds_read_b64_tr_b16 v[36:37], v16 offset:45056
mf16 v[252:255], v[44:47], v[84:87], v[252:255]
ds_read_b64_tr_b16 v[38:39], v16 offset:45568
s_waitcnt lgkmcnt(4)
mf16 v[192:195], v[24:27], v[88:91], v[192:195]
ds_read_b64_tr_b16 v[40:41], v13 offset:61440
mf16 v[208:211], v[24:27], v[92:95], v[208:211]
ds_read_b64_tr_b16 v[42:43], v13 offset:61952
mf16 v[196:199], v[28:31], v[88:91], v[196:199]
ds_read_b64_tr_b16 v[44:45], v14 offset:61440
mf16 v[212:215], v[28:31], v[92:95], v[212:215]
ds_read_b64_tr_b16 v[46:47], v14 offset:61952
s_waitcnt lgkmcnt(4)
mf16 v[200:203], v[32:35], v[88:91], v[200:203]
ds_read_b64_tr_b16 v[24:25], v15 offset:61440
mf16 v[216:219], v[32:35], v[92:95], v[216:219]
ds_read_b64_tr_b16 v[26:27], v15 offset:61952
mf16 v[204:207], v[36:39], v[88:91], v[204:207]
ds_read_b64_tr_b16 v[28:29], v16 offset:61440
mf16 v[220:223], v[36:39], v[92:95], v[220:223]
ds_read_b64_tr_b16 v[30:31], v16 offset:61952
s_waitcnt lgkmcnt(4)
mf16 v[224:227], v[40:43], v[88:91], v[224:227]
s_waitcnt vmcnt(16)
s_barrier
s_waitcnt vmcnt(4)
ds_read_b128 v[96:99], v7 offset:0
ds_read_b128 v[100:103], v8 offset:1024
ds_read_b128 v[104:107], v8 offset:0
ds_read_b128 v[108:111], v7 offset:1024
ds_read_b64_tr_b16 v[32:33], v17 offset:0
mf16 v[240:243], v[40:43], v[92:95], v[240:243]
ds_read_b64_tr_b16 v[34:35], v17 offset:512
s_add_u32 m0, s47, 0x10000
s_add_u32 s45, s53, 0x200000
buffer_load_dwordx4 v1, s[32:35], s45 offen offset:0 lds
mf16 v[228:231], v[44:47], v[88:91], v[228:231]
ds_read_b64_tr_b16 v[36:37], v18 offset:0
mf16 v[244:247], v[44:47], v[92:95], v[244:247]
ds_read_b64_tr_b16 v[38:39], v18 offset:512
s_waitcnt lgkmcnt(8)
mf16 v[232:235], v[24:27], v[88:91], v[232:235]
ds_read_b64_tr_b16 v[40:41], v19 offset:0
mf16 v[248:251], v[24:27], v[92:95], v[248:251]
ds_read_b64_tr_b16 v[42:43], v19 offset:512
buffer_load_dwordx4 v2, s[32:35], s45 offen offset:1024 lds
mf16 v[236:239], v[28:31], v[88:91], v[236:239]
ds_read_b64_tr_b16 v[44:45], v20 offset:0
mf16 v[252:255], v[28:31], v[92:95], v[252:255]
ds_read_b64_tr_b16 v[46:47], v20 offset:512
s_waitcnt lgkmcnt(4)
mf16 v[192:195], v[32:35], v[96:99], v[192:195]
ds_read_b64_tr_b16 v[24:25], v17 offset:16384
mf16 v[208:211], v[32:35], v[100:103], v[208:211]
ds_read_b64_tr_b16 v[26:27], v17 offset:16896
s_add_u32 m0, s46, 0x0
s_mov_b32 s45, 512
buffer_load_dwordx4 v3, s[56:59], s45 offen offset:0 lds
mf16 v[196:199], v[36:39], v[96:99], v[196:199]
ds_read_b64_tr_b16 v[28:29], v18 offset:16384
mf16 v[212:215], v[36:39], v[100:103], v[212:215]
ds_read_b64_tr_b16 v[30:31], v18 offset:16896
s_waitcnt lgkmcnt(4)
mf16 v[200:203], v[40:43], v[96:99], v[200:203]
ds_read_b64_tr_b16 v[32:33], v19 offset:16384
mf16 v[216:219], v[40:43], v[100:103], v[216:219]
ds_read_b64_tr_b16 v[34:35], v19 offset:16896
buffer_load_dwordx4 v4, s[56:59], s45 offen offset:1024 lds
mf16 v[204:207], v[44:47], v[96:99], v[204:207]
ds_read_b64_tr_b16 v[36:37], v20 offset:16384
mf16 v[220:223], v[44:47], v[100:103], v[220:223]
ds_read_b64_tr_b16 v[38:39], v20 offset:16896
s_waitcnt lgkmcnt(4)
mf16 v[224:227], v[24:27], v[96:99], v[224:227]
ds_read_b64_tr_b16 v[40:41], v17 offset:4096
mf16 v[240:243], v[24:27], v[100:103], v[240:243]
ds_read_b64_tr_b16 v[42:43], v17 offset:4608
buffer_load_dwordx4 v5, s[56:59], s45 offen offset:2048 lds
mf16 v[228:231], v[28:31], v[96:99], v[228:231]
ds_read_b64_tr_b16 v[44:45], v18 offset:4096
mf16 v[244:247], v[28:31], v[100:103], v[244:247]
ds_read_b64_tr_b16 v[46:47], v18 offset:4608
s_waitcnt lgkmcnt(4)
mf16 v[232:235], v[32:35], v[96:99], v[232:235]
ds_read_b64_tr_b16 v[24:25], v19 offset:4096
mf16 v[248:251], v[32:35], v[100:103], v[248:251]
ds_read_b64_tr_b16 v[26:27], v19 offset:4608
buffer_load_dwordx4 v6, s[56:59], s45 offen offset:3072 lds
mf16 v[236:239], v[36:39], v[96:99], v[236:239]
ds_read_b64_tr_b16 v[28:29], v20 offset:4096
mf16 v[252:255], v[36:39], v[100:103], v[252:255]
ds_read_b64_tr_b16 v[30:31], v20 offset:4608
s_waitcnt lgkmcnt(4)
mf16 v[192:195], v[40:43], v[104:107], v[192:195]
ds_read_b64_tr_b16 v[32:33], v17 offset:20480
mf16 v[208:211], v[40:43], v[108:111], v[208:211]
ds_read_b64_tr_b16 v[34:35], v17 offset:20992
s_add_u32 m0, s47, 0x14000
s_add_u32 s45, s53, 0x200080
buffer_load_dwordx4 v1, s[32:35], s45 offen offset:0 lds
mf16 v[196:199], v[44:47], v[104:107], v[196:199]
ds_read_b64_tr_b16 v[36:37], v18 offset:20480
mf16 v[212:215], v[44:47], v[108:111], v[212:215]
ds_read_b64_tr_b16 v[38:39], v18 offset:20992
s_waitcnt lgkmcnt(4)
mf16 v[200:203], v[24:27], v[104:107], v[200:203]
ds_read_b64_tr_b16 v[40:41], v19 offset:20480
mf16 v[216:219], v[24:27], v[108:111], v[216:219]
ds_read_b64_tr_b16 v[42:43], v19 offset:20992
buffer_load_dwordx4 v2, s[32:35], s45 offen offset:1024 lds
mf16 v[204:207], v[28:31], v[104:107], v[204:207]
ds_read_b64_tr_b16 v[44:45], v20 offset:20480
mf16 v[220:223], v[28:31], v[108:111], v[220:223]
ds_read_b64_tr_b16 v[46:47], v20 offset:20992
s_waitcnt lgkmcnt(4)
mf16 v[224:227], v[32:35], v[104:107], v[224:227]
s_waitcnt vmcnt(8)
ds_read_b128 v[112:115], v7 offset:4096
ds_read_b128 v[116:119], v8 offset:5120
ds_read_b128 v[120:123], v8 offset:4096
ds_read_b128 v[124:127], v7 offset:5120
ds_read_b64_tr_b16 v[24:25], v17 offset:8192
mf16 v[240:243], v[32:35], v[108:111], v[240:243]
ds_read_b64_tr_b16 v[26:27], v17 offset:8704
mf16 v[228:231], v[36:39], v[104:107], v[228:231]
ds_read_b64_tr_b16 v[28:29], v18 offset:8192
mf16 v[244:247], v[36:39], v[108:111], v[244:247]
ds_read_b64_tr_b16 v[30:31], v18 offset:8704
s_waitcnt lgkmcnt(8)
mf16 v[232:235], v[40:43], v[104:107], v[232:235]
ds_read_b64_tr_b16 v[32:33], v19 offset:8192
mf16 v[248:251], v[40:43], v[108:111], v[248:251]
ds_read_b64_tr_b16 v[34:35], v19 offset:8704
mf16 v[236:239], v[44:47], v[104:107], v[236:239]
ds_read_b64_tr_b16 v[36:37], v20 offset:8192
mf16 v[252:255], v[44:47], v[108:111], v[252:255]
ds_read_b64_tr_b16 v[38:39], v20 offset:8704
s_waitcnt lgkmcnt(4)
mf16 v[192:195], v[24:27], v[112:115], v[192:195]
ds_read_b64_tr_b16 v[40:41], v17 offset:24576
mf16 v[208:211], v[24:27], v[116:119], v[208:211]
ds_read_b64_tr_b16 v[42:43], v17 offset:25088
s_add_u32 m0, s46, 0x1000
s_mov_b32 s45, 640
buffer_load_dwordx4 v3, s[56:59], s45 offen offset:0 lds
mf16 v[196:199], v[28:31], v[112:115], v[196:199]
ds_read_b64_tr_b16 v[44:45], v18 offset:24576
mf16 v[212:215], v[28:31], v[116:119], v[212:215]
ds_read_b64_tr_b16 v[46:47], v18 offset:25088
s_waitcnt lgkmcnt(4)
mf16 v[200:203], v[32:35], v[112:115], v[200:203]
ds_read_b64_tr_b16 v[24:25], v19 offset:24576
mf16 v[216:219], v[32:35], v[116:119], v[216:219]
ds_read_b64_tr_b16 v[26:27], v19 offset:25088
buffer_load_dwordx4 v4, s[56:59], s45 offen offset:1024 lds
mf16 v[204:207], v[36:39], v[112:115], v[204:207]
ds_read_b64_tr_b16 v[28:29], v20 offset:24576
mf16 v[220:223], v[36:39], v[116:119], v[220:223]
ds_read_b64_tr_b16 v[30:31], v20 offset:25088
s_waitcnt lgkmcnt(4)
mf16 v[224:227], v[40:43], v[112:115], v[224:227]
ds_read_b64_tr_b16 v[32:33], v17 offset:12288
mf16 v[240:243], v[40:43], v[116:119], v[240:243]
ds_read_b64_tr_b16 v[34:35], v17 offset:12800
buffer_load_dwordx4 v5, s[56:59], s45 offen offset:2048 lds
buffer_store_dwordx4 v[48:51], v23, s[60:63], s66 offen
mf16 v[228:231], v[44:47], v[112:115], v[228:231]
ds_read_b64_tr_b16 v[36:37], v18 offset:12288
mf16 v[244:247], v[44:47], v[116:119], v[244:247]
ds_read_b64_tr_b16 v[38:39], v18 offset:12800
s_waitcnt lgkmcnt(4)
mf16 v[232:235], v[24:27], v[112:115], v[232:235]
ds_read_b64_tr_b16 v[40:41], v19 offset:12288
mf16 v[248:251], v[24:27], v[116:119], v[248:251]
ds_read_b64_tr_b16 v[42:43], v19 offset:12800
buffer_load_dwordx4 v6, s[56:59], s45 offen offset:3072 lds
mf16 v[236:239], v[28:31], v[112:115], v[236:239]
ds_read_b64_tr_b16 v[44:45], v20 offset:12288
mf16 v[252:255], v[28:31], v[116:119], v[252:255]
ds_read_b64_tr_b16 v[46:47], v20 offset:12800
s_waitcnt lgkmcnt(4)
mf16 v[192:195], v[32:35], v[120:123], v[192:195]
ds_read_b64_tr_b16 v[24:25], v17 offset:28672
mf16 v[208:211], v[32:35], v[124:127], v[208:211]
ds_read_b64_tr_b16 v[26:27], v17 offset:29184
mf16 v[196:199], v[36:39], v[120:123], v[196:199]
ds_read_b64_tr_b16 v[28:29], v18 offset:28672
mf16 v[212:215], v[36:39], v[124:127], v[212:215]
ds_read_b64_tr_b16 v[30:31], v18 offset:29184
s_waitcnt lgkmcnt(4)
mf16 v[200:203], v[40:43], v[120:123], v[200:203]
ds_read_b64_tr_b16 v[32:33], v19 offset:28672
mf16 v[216:219], v[40:43], v[124:127], v[216:219]
ds_read_b64_tr_b16 v[34:35], v19 offset:29184
mf16 v[204:207], v[44:47], v[120:123], v[204:207]
ds_read_b64_tr_b16 v[36:37], v20 offset:28672
mf16 v[220:223], v[44:47], v[124:127], v[220:223]
ds_read_b64_tr_b16 v[38:39], v20 offset:29184
s_waitcnt lgkmcnt(4)
mf16 v[224:227], v[24:27], v[120:123], v[224:227]
s_waitcnt vmcnt(5)
s_barrier
ds_read_b128 v[128:131], v7 offset:0
ds_read_b128 v[132:135], v8 offset:1024
ds_read_b128 v[136:139], v8 offset:0
ds_read_b128 v[140:143], v7 offset:1024
ds_read_b64_tr_b16 v[40:41], v13 offset:0
mf16 v[240:243], v[24:27], v[124:127], v[240:243]
ds_read_b64_tr_b16 v[42:43], v13 offset:512
s_add_u32 m0, s47, 0x18000
s_add_u32 s45, s53, 0x300000
buffer_load_dwordx4 v1, s[32:35], s45 offen offset:0 lds
mf16 v[228:231], v[28:31], v[120:123], v[228:231]
ds_read_b64_tr_b16 v[44:45], v14 offset:0
mf16 v[244:247], v[28:31], v[124:127], v[244:247]
ds_read_b64_tr_b16 v[46:47], v14 offset:512
s_waitcnt lgkmcnt(8)
mf16 v[232:235], v[32:35], v[120:123], v[232:235]
ds_read_b64_tr_b16 v[24:25], v15 offset:0
mf16 v[248:251], v[32:35], v[124:127], v[248:251]
ds_read_b64_tr_b16 v[26:27], v15 offset:512
buffer_load_dwordx4 v2, s[32:35], s45 offen offset:1024 lds
mf16 v[236:239], v[36:39], v[120:123], v[236:239]
ds_read_b64_tr_b16 v[28:29], v16 offset:0
mf16 v[252:255], v[36:39], v[124:127], v[252:255]
ds_read_b64_tr_b16 v[30:31], v16 offset:512
s_waitcnt lgkmcnt(4)
mf16 v[192:195], v[40:43], v[128:131], v[192:195]
ds_read_b64_tr_b16 v[32:33], v13 offset:16384
mf16 v[208:211], v[40:43], v[132:135], v[208:211]
ds_read_b64_tr_b16 v[34:35], v13 offset:16896
s_add_u32 m0, s46, 0x0
s_mov_b32 s45, 768
buffer_load_dwordx4 v3, s[56:59], s45 offen offset:0 lds
mf16 v[196:199], v[44:47], v[128:131], v[196:199]
ds_read_b64_tr_b16 v[36:37], v14 offset:16384
mf16 v[212:215], v[44:47], v[132:135], v[212:215]
ds_read_b64_tr_b16 v[38:39], v14 offset:16896
s_waitcnt lgkmcnt(4)
mf16 v[200:203], v[24:27], v[128:131], v[200:203]
ds_read_b64_tr_b16 v[40:41], v15 offset:16384
mf16 v[216:219], v[24:27], v[132:135], v[216:219]
ds_read_b64_tr_b16 v[42:43], v15 offset:16896
buffer_load_dwordx4 v4, s[56:59], s45 offen offset:1024 lds
mf16 v[204:207], v[28:31], v[128:131], v[204:207]
ds_read_b64_tr_b16 v[44:45], v16 offset:16384
mf16 v[220:223], v[28:31], v[132:135], v[220:223]
ds_read_b64_tr_b16 v[46:47], v16 offset:16896
s_waitcnt lgkmcnt(4)
mf16 v[224:227], v[32:35], v[128:131], v[224:227]
ds_read_b64_tr_b16 v[24:25], v13 offset:4096
mf16 v[240:243], v[32:35], v[132:135], v[240:243]
ds_read_b64_tr_b16 v[26:27], v13 offset:4608
buffer_load_dwordx4 v5, s[56:59], s45 offen offset:2048 lds
mf16 v[228:231], v[36:39], v[128:131], v[228:231]
ds_read_b64_tr_b16 v[28:29], v14 offset:4096
mf16 v[244:247], v[36:39], v[132:135], v[244:247]
ds_read_b64_tr_b16 v[30:31], v14 offset:4608
s_waitcnt lgkmcnt(4)
mf16 v[232:235], v[40:43], v[128:131], v[232:235]
ds_read_b64_tr_b16 v[32:33], v15 offset:4096
mf16 v[248:251], v[40:43], v[132:135], v[248:251]
ds_read_b64_tr_b16 v[34:35], v15 offset:4608
buffer_load_dwordx4 v6, s[56:59], s45 offen offset:3072 lds
mf16 v[236:239], v[44:47], v[128:131], v[236:239]
ds_read_b64_tr_b16 v[36:37], v16 offset:4096
mf16 v[252:255], v[44:47], v[132:135], v[252:255]
ds_read_b64_tr_b16 v[38:39], v16 offset:4608
s_waitcnt lgkmcnt(4)
mf16 v[192:195], v[24:27], v[136:139], v[192:195]
ds_read_b64_tr_b16 v[40:41], v13 offset:20480
mf16 v[208:211], v[24:27], v[140:143], v[208:211]
ds_read_b64_tr_b16 v[42:43], v13 offset:20992
s_add_u32 m0, s47, 0x1c000
s_add_u32 s45, s53, 0x300080
buffer_load_dwordx4 v1, s[32:35], s45 offen offset:0 lds
mf16 v[196:199], v[28:31], v[136:139], v[196:199]
ds_read_b64_tr_b16 v[44:45], v14 offset:20480
mf16 v[212:215], v[28:31], v[140:143], v[212:215]
ds_read_b64_tr_b16 v[46:47], v14 offset:20992
s_waitcnt lgkmcnt(4)
mf16 v[200:203], v[32:35], v[136:139], v[200:203]
ds_read_b64_tr_b16 v[24:25], v15 offset:20480
mf16 v[216:219], v[32:35], v[140:143], v[216:219]
ds_read_b64_tr_b16 v[26:27], v15 offset:20992
buffer_load_dwordx4 v2, s[32:35], s45 offen offset:1024 lds
mf16 v[204:207], v[36:39], v[136:139], v[204:207]
ds_read_b64_tr_b16 v[28:29], v16 offset:20480
mf16 v[220:223], v[36:39], v[140:143], v[220:223]
ds_read_b64_tr_b16 v[30:31], v16 offset:20992
s_waitcnt lgkmcnt(4)
mf16 v[224:227], v[40:43], v[136:139], v[224:227]
s_waitcnt vmcnt(8)
ds_read_b128 v[144:147], v7 offset:4096
ds_read_b128 v[148:151], v8 offset:5120
ds_read_b128 v[152:155], v8 offset:4096
ds_read_b128 v[156:159], v7 offset:5120
ds_read_b64_tr_b16 v[32:33], v13 offset:8192
mf16 v[240:243], v[40:43], v[140:143], v[240:243]
ds_read_b64_tr_b16 v[34:35], v13 offset:8704
mf16 v[228:231], v[44:47], v[136:139], v[228:231]
ds_read_b64_tr_b16 v[36:37], v14 offset:8192
mf16 v[244:247], v[44:47], v[140:143], v[244:247]
ds_read_b64_tr_b16 v[38:39], v14 offset:8704
s_waitcnt lgkmcnt(8)
mf16 v[232:235], v[24:27], v[136:139], v[232:235]
ds_read_b64_tr_b16 v[40:41], v15 offset:8192
mf16 v[248:251], v[24:27], v[140:143], v[248:251]
ds_read_b64_tr_b16 v[42:43], v15 offset:8704
mf16 v[236:239], v[28:31], v[136:139], v[236:239]
ds_read_b64_tr_b16 v[44:45], v16 offset:8192
mf16 v[252:255], v[28:31], v[140:143], v[252:255]
ds_read_b64_tr_b16 v[46:47], v16 offset:8704
s_waitcnt lgkmcnt(4)
mf16 v[192:195], v[32:35], v[144:147], v[192:195]
ds_read_b64_tr_b16 v[24:25], v13 offset:24576
mf16 v[208:211], v[32:35], v[148:151], v[208:211]
ds_read_b64_tr_b16 v[26:27], v13 offset:25088
s_add_u32 m0, s46, 0x1000
s_mov_b32 s45, 896
buffer_load_dwordx4 v3, s[56:59], s45 offen offset:0 lds
mf16 v[196:199], v[36:39], v[144:147], v[196:199]
ds_read_b64_tr_b16 v[28:29], v14 offset:24576
mf16 v[212:215], v[36:39], v[148:151], v[212:215]
ds_read_b64_tr_b16 v[30:31], v14 offset:25088
s_waitcnt lgkmcnt(4)
mf16 v[200:203], v[40:43], v[144:147], v[200:203]
ds_read_b64_tr_b16 v[32:33], v15 offset:24576
mf16 v[216:219], v[40:43], v[148:151], v[216:219]
ds_read_b64_tr_b16 v[34:35], v15 offset:25088
buffer_load_dwordx4 v4, s[56:59], s45 offen offset:1024 lds
mf16 v[204:207], v[44:47], v[144:147], v[204:207]
ds_read_b64_tr_b16 v[36:37], v16 offset:24576
mf16 v[220:223], v[44:47], v[148:151], v[220:223]
ds_read_b64_tr_b16 v[38:39], v16 offset:25088
s_waitcnt lgkmcnt(4)
mf16 v[224:227], v[24:27], v[144:147], v[224:227]
ds_read_b64_tr_b16 v[40:41], v13 offset:12288
mf16 v[240:243], v[24:27], v[148:151], v[240:243]
ds_read_b64_tr_b16 v[42:43], v13 offset:12800
buffer_load_dwordx4 v5, s[56:59], s45 offen offset:2048 lds
mf16 v[228:231], v[28:31], v[144:147], v[228:231]
ds_read_b64_tr_b16 v[44:45], v14 offset:12288
mf16 v[244:247], v[28:31], v[148:151], v[244:247]
ds_read_b64_tr_b16 v[46:47], v14 offset:12800
s_waitcnt lgkmcnt(4)
mf16 v[232:235], v[32:35], v[144:147], v[232:235]
ds_read_b64_tr_b16 v[24:25], v15 offset:12288
mf16 v[248:251], v[32:35], v[148:151], v[248:251]
ds_read_b64_tr_b16 v[26:27], v15 offset:12800
buffer_load_dwordx4 v6, s[56:59], s45 offen offset:3072 lds
mf16 v[236:239], v[36:39], v[144:147], v[236:239]
ds_read_b64_tr_b16 v[28:29], v16 offset:12288
mf16 v[252:255], v[36:39], v[148:151], v[252:255]
ds_read_b64_tr_b16 v[30:31], v16 offset:12800
s_waitcnt lgkmcnt(4)
mf16 v[192:195], v[40:43], v[152:155], v[192:195]
ds_read_b64_tr_b16 v[32:33], v13 offset:28672
mf16 v[208:211], v[40:43], v[156:159], v[208:211]
ds_read_b64_tr_b16 v[34:35], v13 offset:29184
mf16 v[196:199], v[44:47], v[152:155], v[196:199]
ds_read_b64_tr_b16 v[36:37], v14 offset:28672
mf16 v[212:215], v[44:47], v[156:159], v[212:215]
ds_read_b64_tr_b16 v[38:39], v14 offset:29184
s_waitcnt lgkmcnt(4)
mf16 v[200:203], v[24:27], v[152:155], v[200:203]
ds_read_b64_tr_b16 v[40:41], v15 offset:28672
mf16 v[216:219], v[24:27], v[156:159], v[216:219]
ds_read_b64_tr_b16 v[42:43], v15 offset:29184
mf16 v[204:207], v[28:31], v[152:155], v[204:207]
ds_read_b64_tr_b16 v[44:45], v16 offset:28672
mf16 v[220:223], v[28:31], v[156:159], v[220:223]
ds_read_b64_tr_b16 v[46:47], v16 offset:29184
s_waitcnt lgkmcnt(4)
mf16 v[224:227], v[32:35], v[152:155], v[224:227]
s_waitcnt vmcnt(4)
s_barrier
ds_read_b128 v[160:163], v7 offset:0
ds_read_b128 v[164:167], v8 offset:1024
ds_read_b128 v[168:171], v8 offset:0
ds_read_b128 v[172:175], v7 offset:1024
ds_read_b64_tr_b16 v[24:25], v13 offset:32768
mf16 v[240:243], v[32:35], v[156:159], v[240:243]
ds_read_b64_tr_b16 v[26:27], v13 offset:33280
s_add_u32 m0, s47, 0x20000
s_add_u32 s45, s53, 0x100
buffer_load_dwordx4 v1, s[32:35], s45 offen offset:0 lds
mf16 v[228:231], v[36:39], v[152:155], v[228:231]
ds_read_b64_tr_b16 v[28:29], v14 offset:32768
mf16 v[244:247], v[36:39], v[156:159], v[244:247]
ds_read_b64_tr_b16 v[30:31], v14 offset:33280
s_waitcnt lgkmcnt(8)
mf16 v[232:235], v[40:43], v[152:155], v[232:235]
ds_read_b64_tr_b16 v[32:33], v15 offset:32768
mf16 v[248:251], v[40:43], v[156:159], v[248:251]
ds_read_b64_tr_b16 v[34:35], v15 offset:33280
buffer_load_dwordx4 v2, s[32:35], s45 offen offset:1024 lds
mf16 v[236:239], v[44:47], v[152:155], v[236:239]
ds_read_b64_tr_b16 v[36:37], v16 offset:32768
mf16 v[252:255], v[44:47], v[156:159], v[252:255]
ds_read_b64_tr_b16 v[38:39], v16 offset:33280
s_waitcnt lgkmcnt(4)
mf16 v[192:195], v[24:27], v[160:163], v[192:195]
ds_read_b64_tr_b16 v[40:41], v13 offset:49152
mf16 v[208:211], v[24:27], v[164:167], v[208:211]
ds_read_b64_tr_b16 v[42:43], v13 offset:49664
s_add_u32 m0, s47, 0x24000
s_add_u32 s45, s53, 0x100100
buffer_load_dwordx4 v1, s[32:35], s45 offen offset:0 lds
mf16 v[196:199], v[28:31], v[160:163], v[196:199]
ds_read_b64_tr_b16 v[44:45], v14 offset:49152
mf16 v[212:215], v[28:31], v[164:167], v[212:215]
ds_read_b64_tr_b16 v[46:47], v14 offset:49664
s_waitcnt lgkmcnt(4)
mf16 v[200:203], v[32:35], v[160:163], v[200:203]
ds_read_b64_tr_b16 v[24:25], v15 offset:49152
mf16 v[216:219], v[32:35], v[164:167], v[216:219]
ds_read_b64_tr_b16 v[26:27], v15 offset:49664
buffer_load_dwordx4 v2, s[32:35], s45 offen offset:1024 lds
mf16 v[204:207], v[36:39], v[160:163], v[204:207]
ds_read_b64_tr_b16 v[28:29], v16 offset:49152
mf16 v[220:223], v[36:39], v[164:167], v[220:223]
ds_read_b64_tr_b16 v[30:31], v16 offset:49664
s_waitcnt lgkmcnt(4)
mf16 v[224:227], v[40:43], v[160:163], v[224:227]
ds_read_b64_tr_b16 v[32:33], v13 offset:36864
mf16 v[240:243], v[40:43], v[164:167], v[240:243]
ds_read_b64_tr_b16 v[34:35], v13 offset:37376
mf16 v[228:231], v[44:47], v[160:163], v[228:231]
ds_read_b64_tr_b16 v[36:37], v14 offset:36864
mf16 v[244:247], v[44:47], v[164:167], v[244:247]
ds_read_b64_tr_b16 v[38:39], v14 offset:37376
s_waitcnt lgkmcnt(4)
mf16 v[232:235], v[24:27], v[160:163], v[232:235]
ds_read_b64_tr_b16 v[40:41], v15 offset:36864
mf16 v[248:251], v[24:27], v[164:167], v[248:251]
ds_read_b64_tr_b16 v[42:43], v15 offset:37376
mf16 v[236:239], v[28:31], v[160:163], v[236:239]
ds_read_b64_tr_b16 v[44:45], v16 offset:36864
mf16 v[252:255], v[28:31], v[164:167], v[252:255]
ds_read_b64_tr_b16 v[46:47], v16 offset:37376
s_waitcnt lgkmcnt(4)
mf16 v[192:195], v[32:35], v[168:171], v[192:195]
ds_read_b64_tr_b16 v[24:25], v13 offset:53248
mf16 v[208:211], v[32:35], v[172:175], v[208:211]
ds_read_b64_tr_b16 v[26:27], v13 offset:53760
mf16 v[196:199], v[36:39], v[168:171], v[196:199]
ds_read_b64_tr_b16 v[28:29], v14 offset:53248
mf16 v[212:215], v[36:39], v[172:175], v[212:215]
ds_read_b64_tr_b16 v[30:31], v14 offset:53760
s_waitcnt lgkmcnt(4)
mf16 v[200:203], v[40:43], v[168:171], v[200:203]
ds_read_b64_tr_b16 v[32:33], v15 offset:53248
mf16 v[216:219], v[40:43], v[172:175], v[216:219]
ds_read_b64_tr_b16 v[34:35], v15 offset:53760
mf16 v[204:207], v[44:47], v[168:171], v[204:207]
ds_read_b64_tr_b16 v[36:37], v16 offset:53248
mf16 v[220:223], v[44:47], v[172:175], v[220:223]
ds_read_b64_tr_b16 v[38:39], v16 offset:53760
s_waitcnt lgkmcnt(4)
mf16 v[224:227], v[24:27], v[168:171], v[224:227]
s_waitcnt vmcnt(4)
ds_read_b128 v[176:179], v7 offset:4096
ds_read_b128 v[180:183], v8 offset:5120
ds_read_b128 v[184:187], v8 offset:4096
ds_read_b128 v[188:191], v7 offset:5120
ds_read_b64_tr_b16 v[40:41], v13 offset:40960
mf16 v[240:243], v[24:27], v[172:175], v[240:243]
ds_read_b64_tr_b16 v[42:43], v13 offset:41472
mf16 v[228:231], v[28:31], v[168:171], v[228:231]
ds_read_b64_tr_b16 v[24:25], v14 offset:40960
mf16 v[244:247], v[28:31], v[172:175], v[244:247]
ds_read_b64_tr_b16 v[26:27], v14 offset:41472
s_waitcnt lgkmcnt(8)
mf16 v[232:235], v[32:35], v[168:171], v[232:235]
ds_read_b64_tr_b16 v[28:29], v15 offset:40960
mf16 v[248:251], v[32:35], v[172:175], v[248:251]
ds_read_b64_tr_b16 v[30:31], v15 offset:41472
mf16 v[236:239], v[36:39], v[168:171], v[236:239]
ds_read_b64_tr_b16 v[32:33], v16 offset:40960
mf16 v[252:255], v[36:39], v[172:175], v[252:255]
ds_read_b64_tr_b16 v[34:35], v16 offset:41472
s_waitcnt lgkmcnt(4)
mf16 v[192:195], v[40:43], v[176:179], v[192:195]
ds_read_b64_tr_b16 v[36:37], v13 offset:57344
mf16 v[208:211], v[40:43], v[180:183], v[208:211]
ds_read_b64_tr_b16 v[38:39], v13 offset:57856
mf16 v[196:199], v[24:27], v[176:179], v[196:199]
ds_read_b64_tr_b16 v[40:41], v14 offset:57344
mf16 v[212:215], v[24:27], v[180:183], v[212:215]
ds_read_b64_tr_b16 v[42:43], v14 offset:57856
s_waitcnt lgkmcnt(4)
mf16 v[200:203], v[28:31], v[176:179], v[200:203]
ds_read_b64_tr_b16 v[24:25], v15 offset:57344
mf16 v[216:219], v[28:31], v[180:183], v[216:219]
ds_read_b64_tr_b16 v[26:27], v15 offset:57856
mf16 v[204:207], v[32:35], v[176:179], v[204:207]
ds_read_b64_tr_b16 v[28:29], v16 offset:57344
mf16 v[220:223], v[32:35], v[180:183], v[220:223]
ds_read_b64_tr_b16 v[30:31], v16 offset:57856
s_waitcnt lgkmcnt(4)
mf16 v[224:227], v[36:39], v[176:179], v[224:227]
ds_read_b64_tr_b16 v[32:33], v13 offset:45056
mf16 v[240:243], v[36:39], v[180:183], v[240:243]
ds_read_b64_tr_b16 v[34:35], v13 offset:45568
mf16 v[228:231], v[40:43], v[176:179], v[228:231]
ds_read_b64_tr_b16 v[36:37], v14 offset:45056
mf16 v[244:247], v[40:43], v[180:183], v[244:247]
ds_read_b64_tr_b16 v[38:39], v14 offset:45568
s_waitcnt lgkmcnt(4)
mf16 v[232:235], v[24:27], v[176:179], v[232:235]
ds_read_b64_tr_b16 v[40:41], v15 offset:45056
mf16 v[248:251], v[24:27], v[180:183], v[248:251]
ds_read_b64_tr_b16 v[42:43], v15 offset:45568
mf16 v[236:239], v[28:31], v[176:179], v[236:239]
ds_read_b64_tr_b16 v[24:25], v16 offset:45056
mf16 v[252:255], v[28:31], v[180:183], v[252:255]
ds_read_b64_tr_b16 v[26:27], v16 offset:45568
s_waitcnt lgkmcnt(4)
mf16 v[192:195], v[32:35], v[184:187], v[192:195]
ds_read_b64_tr_b16 v[28:29], v13 offset:61440
mf16 v[208:211], v[32:35], v[188:191], v[208:211]
ds_read_b64_tr_b16 v[30:31], v13 offset:61952
mf16 v[196:199], v[36:39], v[184:187], v[196:199]
ds_read_b64_tr_b16 v[32:33], v14 offset:61440
mf16 v[212:215], v[36:39], v[188:191], v[212:215]
ds_read_b64_tr_b16 v[34:35], v14 offset:61952
s_waitcnt lgkmcnt(4)
mf16 v[200:203], v[40:43], v[184:187], v[200:203]
ds_read_b64_tr_b16 v[36:37], v15 offset:61440
mf16 v[216:219], v[40:43], v[188:191], v[216:219]
ds_read_b64_tr_b16 v[38:39], v15 offset:61952
mf16 v[204:207], v[24:27], v[184:187], v[204:207]
ds_read_b64_tr_b16 v[40:41], v16 offset:61440
mf16 v[220:223], v[24:27], v[188:191], v[220:223]
ds_read_b64_tr_b16 v[42:43], v16 offset:61952
s_waitcnt lgkmcnt(4)
mf16 v[224:227], v[28:31], v[184:187], v[224:227]
s_waitcnt vmcnt(0)
s_barrier
ds_read_b64_tr_b16 v[24:25], v17 offset:0
mf16 v[240:243], v[28:31], v[188:191], v[240:243]
ds_read_b64_tr_b16 v[26:27], v17 offset:512
s_add_u32 m0, s47, 0x10000
s_add_u32 s45, s53, 0x200100
buffer_load_dwordx4 v1, s[32:35], s45 offen offset:0 lds
mf16 v[228:231], v[32:35], v[184:187], v[228:231]
ds_read_b64_tr_b16 v[28:29], v18 offset:0
mf16 v[244:247], v[32:35], v[188:191], v[244:247]
ds_read_b64_tr_b16 v[30:31], v18 offset:512
s_waitcnt lgkmcnt(4)
mf16 v[232:235], v[36:39], v[184:187], v[232:235]
ds_read_b64_tr_b16 v[32:33], v19 offset:0
mf16 v[248:251], v[36:39], v[188:191], v[248:251]
ds_read_b64_tr_b16 v[34:35], v19 offset:512
buffer_load_dwordx4 v2, s[32:35], s45 offen offset:1024 lds
mf16 v[236:239], v[40:43], v[184:187], v[236:239]
ds_read_b64_tr_b16 v[36:37], v20 offset:0
mf16 v[252:255], v[40:43], v[188:191], v[252:255]
ds_read_b64_tr_b16 v[38:39], v20 offset:512
v_mov_b32 v48, v52
v_mov_b32 v49, v53
v_mov_b32 v50, v54
v_mov_b32 v51, v55
s_add_u32 s66, s66, 0x400000
s_and_b32 s12, s16, 3
s_lshl_b32 s12, s12, 19
v_lshlrev_b32 v23, 13, v0
v_add_u32 v23, s12, v23
s_nop 2
s_add_u32 s54, s43, 0
v_mul_f32 v192, s52, v192
v_mul_f32 v193, s52, v193
cvtpk v56, v192, v193
v_mul_f32 v194, s52, v194
v_mul_f32 v195, s52, v195
cvtpk v57, v194, v195
v_mul_f32 v196, s52, v196
v_mul_f32 v197, s52, v197
cvtpk v58, v196, v197
v_mul_f32 v198, s52, v198
v_mul_f32 v199, s52, v199
cvtpk v59, v198, v199
buffer_store_dwordx4 v[56:59], v21, s[36:39], s54 offen offset:0 sc1
v_mul_f32 v200, s52, v200
v_mul_f32 v201, s52, v201
cvtpk v60, v200, v201
v_mul_f32 v202, s52, v202
v_mul_f32 v203, s52, v203
cvtpk v61, v202, v203
v_mul_f32 v204, s52, v204
v_mul_f32 v205, s52, v205
cvtpk v62, v204, v205
v_mul_f32 v206, s52, v206
v_mul_f32 v207, s52, v207
cvtpk v63, v206, v207
buffer_store_dwordx4 v[60:63], v21, s[36:39], s54 offen offset:2048 sc1
v_mul_f32 v208, s52, v208
v_mul_f32 v209, s52, v209
cvtpk v56, v208, v209
v_mul_f32 v210, s52, v210
v_mul_f32 v211, s52, v211
cvtpk v57, v210, v211
v_mul_f32 v212, s52, v212
v_mul_f32 v213, s52, v213
cvtpk v58, v212, v213
v_mul_f32 v214, s52, v214
v_mul_f32 v215, s52, v215
cvtpk v59, v214, v215
buffer_store_dwordx4 v[56:59], v21, s[36:39], s54 offen offset:128 sc1
v_mul_f32 v216, s52, v216
v_mul_f32 v217, s52, v217
cvtpk v60, v216, v217
v_mul_f32 v218, s52, v218
v_mul_f32 v219, s52, v219
cvtpk v61, v218, v219
v_mul_f32 v220, s52, v220
v_mul_f32 v221, s52, v221
cvtpk v62, v220, v221
v_mul_f32 v222, s52, v222
v_mul_f32 v223, s52, v223
cvtpk v63, v222, v223
buffer_store_dwordx4 v[60:63], v21, s[36:39], s54 offen offset:2176 sc1
s_waitcnt lgkmcnt(4)
mf16 v[192:195], v[24:27], v[64:67], 0
ds_read_b64_tr_b16 v[40:41], v17 offset:4096
mf16 v[208:211], v[24:27], v[68:71], 0
ds_read_b64_tr_b16 v[42:43], v17 offset:4608
s_add_u32 m0, s47, 0x14000
s_add_u32 s45, s53, 0x300100
buffer_load_dwordx4 v1, s[32:35], s45 offen offset:0 lds
mf16 v[196:199], v[28:31], v[64:67], 0
ds_read_b64_tr_b16 v[44:45], v18 offset:4096
mf16 v[212:215], v[28:31], v[68:71], 0
ds_read_b64_tr_b16 v[46:47], v18 offset:4608
s_waitcnt lgkmcnt(4)
mf16 v[200:203], v[32:35], v[64:67], 0
ds_read_b64_tr_b16 v[24:25], v19 offset:4096
mf16 v[216:219], v[32:35], v[68:71], 0
ds_read_b64_tr_b16 v[26:27], v19 offset:4608
buffer_load_dwordx4 v2, s[32:35], s45 offen offset:1024 lds
mf16 v[204:207], v[36:39], v[64:67], 0
ds_read_b64_tr_b16 v[28:29], v20 offset:4096
mf16 v[220:223], v[36:39], v[68:71], 0
ds_read_b64_tr_b16 v[30:31], v20 offset:4608
s_waitcnt lgkmcnt(4)
mf16 v[192:195], v[40:43], v[72:75], v[192:195]
ds_read_b64_tr_b16 v[32:33], v17 offset:8192
s_add_u32 s55, s43, 4096
mf16 v[208:211], v[40:43], v[76:79], v[208:211]
ds_read_b64_tr_b16 v[34:35], v17 offset:8704
s_add_u32 m0, s47, 0x0
s_add_u32 s45, s53, 0x180
buffer_load_dwordx4 v1, s[32:35], s45 offen offset:0 lds
mf16 v[196:199], v[44:47], v[72:75], v[196:199]
ds_read_b64_tr_b16 v[36:37], v18 offset:8192
v_mul_f32 v224, s52, v224
mf16 v[212:215], v[44:47], v[76:79], v[212:215]
ds_read_b64_tr_b16 v[38:39], v18 offset:8704
s_waitcnt lgkmcnt(4)
mf16 v[200:203], v[24:27], v[72:75], v[200:203]
ds_read_b64_tr_b16 v[40:41], v19 offset:8192
v_mul_f32 v225, s52, v225
mf16 v[216:219], v[24:27], v[76:79], v[216:219]
ds_read_b64_tr_b16 v[42:43], v19 offset:8704
buffer_load_dwordx4 v2, s[32:35], s45 offen offset:1024 lds
mf16 v[204:207], v[28:31], v[72:75], v[204:207]
ds_read_b64_tr_b16 v[44:45], v20 offset:8192
cvtpk v56, v224, v225
mf16 v[220:223], v[28:31], v[76:79], v[220:223]
ds_read_b64_tr_b16 v[46:47], v20 offset:8704
s_waitcnt lgkmcnt(4)
mf16 v[192:195], v[32:35], v[80:83], v[192:195]
ds_read_b64_tr_b16 v[24:25], v17 offset:12288
v_mul_f32 v226, s52, v226
mf16 v[208:211], v[32:35], v[84:87], v[208:211]
ds_read_b64_tr_b16 v[26:27], v17 offset:12800
s_add_u32 m0, s47, 0x4000
s_add_u32 s45, s53, 0x100180
buffer_load_dwordx4 v1, s[32:35], s45 offen offset:0 lds
mf16 v[196:199], v[36:39], v[80:83], v[196:199]
ds_read_b64_tr_b16 v[28:29], v18 offset:12288
v_mul_f32 v227, s52, v227
mf16 v[212:215], v[36:39], v[84:87], v[212:215]
ds_read_b64_tr_b16 v[30:31], v18 offset:12800
s_waitcnt lgkmcnt(4)
mf16 v[200:203], v[40:43], v[80:83], v[200:203]
ds_read_b64_tr_b16 v[32:33], v19 offset:12288
cvtpk v57, v226, v227
mf16 v[216:219], v[40:43], v[84:87], v[216:219]
ds_read_b64_tr_b16 v[34:35], v19 offset:12800
buffer_load_dwordx4 v2, s[32:35], s45 offen offset:1024 lds
mf16 v[204:207], v[44:47], v[80:83], v[204:207]
ds_read_b64_tr_b16 v[36:37], v20 offset:12288
v_mul_f32 v228, s52, v228
mf16 v[220:223], v[44:47], v[84:87], v[220:223]
ds_read_b64_tr_b16 v[38:39], v20 offset:12800
s_waitcnt lgkmcnt(4)
mf16 v[192:195], v[24:27], v[88:91], v[192:195]
ds_read_b64_tr_b16 v[40:41], v17 offset:16384
v_mul_f32 v229, s52, v229
mf16 v[208:211], v[24:27], v[92:95], v[208:211]
ds_read_b64_tr_b16 v[42:43], v17 offset:16896
cvtpk v58, v228, v229
mf16 v[196:199], v[28:31], v[88:91], v[196:199]
ds_read_b64_tr_b16 v[44:45], v18 offset:16384
v_mul_f32 v230, s52, v230
mf16 v[212:215], v[28:31], v[92:95], v[212:215]
ds_read_b64_tr_b16 v[46:47], v18 offset:16896
s_waitcnt lgkmcnt(4)
mf16 v[200:203], v[32:35], v[88:91], v[200:203]
ds_read_b64_tr_b16 v[24:25], v19 offset:16384
v_mul_f32 v231, s52, v231
mf16 v[216:219], v[32:35], v[92:95], v[216:219]
ds_read_b64_tr_b16 v[26:27], v19 offset:16896
cvtpk v59, v230, v231
mf16 v[204:207], v[36:39], v[88:91], v[204:207]
ds_read_b64_tr_b16 v[28:29], v20 offset:16384
buffer_store_dwordx4 v[56:59], v21, s[36:39], s55 offen offset:0 sc1
mf16 v[220:223], v[36:39], v[92:95], v[220:223]
ds_read_b64_tr_b16 v[30:31], v20 offset:16896
s_waitcnt lgkmcnt(4)
mf16 v[192:195], v[40:43], v[96:99], v[192:195]
ds_read_b64_tr_b16 v[32:33], v17 offset:20480
v_mul_f32 v232, s52, v232
mf16 v[208:211], v[40:43], v[100:103], v[208:211]
ds_read_b64_tr_b16 v[34:35], v17 offset:20992
v_mul_f32 v233, s52, v233
mf16 v[196:199], v[44:47], v[96:99], v[196:199]
ds_read_b64_tr_b16 v[36:37], v18 offset:20480
cvtpk v60, v232, v233
mf16 v[212:215], v[44:47], v[100:103], v[212:215]
ds_read_b64_tr_b16 v[38:39], v18 offset:20992
s_waitcnt lgkmcnt(4)
mf16 v[200:203], v[24:27], v[96:99], v[200:203]
ds_read_b64_tr_b16 v[40:41], v19 offset:20480
v_mul_f32 v234, s52, v234
mf16 v[216:219], v[24:27], v[100:103], v[216:219]
ds_read_b64_tr_b16 v[42:43], v19 offset:20992
v_mul_f32 v235, s52, v235
mf16 v[204:207], v[28:31], v[96:99], v[204:207]
ds_read_b64_tr_b16 v[44:45], v20 offset:20480
cvtpk v61, v234, v235
mf16 v[220:223], v[28:31], v[100:103], v[220:223]
ds_read_b64_tr_b16 v[46:47], v20 offset:20992
s_waitcnt lgkmcnt(4)
mf16 v[192:195], v[32:35], v[104:107], v[192:195]
ds_read_b64_tr_b16 v[24:25], v17 offset:24576
v_mul_f32 v236, s52, v236
mf16 v[208:211], v[32:35], v[108:111], v[208:211]
ds_read_b64_tr_b16 v[26:27], v17 offset:25088
v_mul_f32 v237, s52, v237
mf16 v[196:199], v[36:39], v[104:107], v[196:199]
ds_read_b64_tr_b16 v[28:29], v18 offset:24576
cvtpk v62, v236, v237
mf16 v[212:215], v[36:39], v[108:111], v[212:215]
ds_read_b64_tr_b16 v[30:31], v18 offset:25088
s_waitcnt lgkmcnt(4)
mf16 v[200:203], v[40:43], v[104:107], v[200:203]
ds_read_b64_tr_b16 v[32:33], v19 offset:24576
v_mul_f32 v238, s52, v238
mf16 v[216:219], v[40:43], v[108:111], v[216:219]
ds_read_b64_tr_b16 v[34:35], v19 offset:25088
v_mul_f32 v239, s52, v239
mf16 v[204:207], v[44:47], v[104:107], v[204:207]
ds_read_b64_tr_b16 v[36:37], v20 offset:24576
cvtpk v63, v238, v239
mf16 v[220:223], v[44:47], v[108:111], v[220:223]
ds_read_b64_tr_b16 v[38:39], v20 offset:25088
s_waitcnt lgkmcnt(4)
mf16 v[192:195], v[24:27], v[112:115], v[192:195]
ds_read_b64_tr_b16 v[40:41], v17 offset:28672
buffer_store_dwordx4 v[60:63], v21, s[36:39], s55 offen offset:2048 sc1
mf16 v[208:211], v[24:27], v[116:119], v[208:211]
ds_read_b64_tr_b16 v[42:43], v17 offset:29184
v_mul_f32 v240, s52, v240
mf16 v[196:199], v[28:31], v[112:115], v[196:199]
ds_read_b64_tr_b16 v[44:45], v18 offset:28672
v_mul_f32 v241, s52, v241
mf16 v[212:215], v[28:31], v[116:119], v[212:215]
ds_read_b64_tr_b16 v[46:47], v18 offset:29184
s_waitcnt lgkmcnt(4)
mf16 v[200:203], v[32:35], v[112:115], v[200:203]
ds_read_b64_tr_b16 v[24:25], v19 offset:28672
cvtpk v56, v240, v241
mf16 v[216:219], v[32:35], v[116:119], v[216:219]
ds_read_b64_tr_b16 v[26:27], v19 offset:29184
v_mul_f32 v242, s52, v242
mf16 v[204:207], v[36:39], v[112:115], v[204:207]
ds_read_b64_tr_b16 v[28:29], v20 offset:28672
v_mul_f32 v243, s52, v243
mf16 v[220:223], v[36:39], v[116:119], v[220:223]
ds_read_b64_tr_b16 v[30:31], v20 offset:29184
s_waitcnt lgkmcnt(4)
mf16 v[192:195], v[40:43], v[120:123], v[192:195]
s_waitcnt vmcnt(6)
s_barrier
ds_read_b64_tr_b16 v[32:33], v13 offset:0
cvtpk v57, v242, v243
mf16 v[208:211], v[40:43], v[124:127], v[208:211]
ds_read_b64_tr_b16 v[34:35], v13 offset:512
s_add_u32 m0, s47, 0x8000
s_add_u32 s45, s53, 0x200180
buffer_load_dwordx4 v1, s[32:35], s45 offen offset:0 lds
mf16 v[196:199], v[44:47], v[120:123], v[196:199]
ds_read_b64_tr_b16 v[36:37], v14 offset:0
v_mul_f32 v244, s52, v244
mf16 v[212:215], v[44:47], v[124:127], v[212:215]
ds_read_b64_tr_b16 v[38:39], v14 offset:512
s_waitcnt lgkmcnt(4)
mf16 v[200:203], v[24:27], v[120:123], v[200:203]
ds_read_b64_tr_b16 v[40:41], v15 offset:0
v_mul_f32 v245, s52, v245
mf16 v[216:219], v[24:27], v[124:127], v[216:219]
ds_read_b64_tr_b16 v[42:43], v15 offset:512
buffer_load_dwordx4 v2, s[32:35], s45 offen offset:1024 lds
mf16 v[204:207], v[28:31], v[120:123], v[204:207]
ds_read_b64_tr_b16 v[44:45], v16 offset:0
cvtpk v58, v244, v245
mf16 v[220:223], v[28:31], v[124:127], v[220:223]
ds_read_b64_tr_b16 v[46:47], v16 offset:512
s_waitcnt lgkmcnt(4)
mf16 v[192:195], v[32:35], v[128:131], v[192:195]
ds_read_b64_tr_b16 v[24:25], v13 offset:4096
v_mul_f32 v246, s52, v246
mf16 v[208:211], v[32:35], v[132:135], v[208:211]
ds_read_b64_tr_b16 v[26:27], v13 offset:4608
s_add_u32 m0, s47, 0xc000
s_add_u32 s45, s53, 0x300180
buffer_load_dwordx4 v1, s[32:35], s45 offen offset:0 lds
mf16 v[196:199], v[36:39], v[128:131], v[196:199]
ds_read_b64_tr_b16 v[28:29], v14 offset:4096
v_mul_f32 v247, s52, v247
mf16 v[212:215], v[36:39], v[132:135], v[212:215]
ds_read_b64_tr_b16 v[30:31], v14 offset:4608
s_waitcnt lgkmcnt(4)
mf16 v[200:203], v[40:43], v[128:131], v[200:203]
ds_read_b64_tr_b16 v[32:33], v15 offset:4096
cvtpk v59, v246, v247
mf16 v[216:219], v[40:43], v[132:135], v[216:219]
ds_read_b64_tr_b16 v[34:35], v15 offset:4608
buffer_load_dwordx4 v2, s[32:35], s45 offen offset:1024 lds
mf16 v[204:207], v[44:47], v[128:131], v[204:207]
ds_read_b64_tr_b16 v[36:37], v16 offset:4096
buffer_store_dwordx4 v[56:59], v21, s[36:39], s55 offen offset:128 sc1
mf16 v[220:223], v[44:47], v[132:135], v[220:223]
ds_read_b64_tr_b16 v[38:39], v16 offset:4608
s_waitcnt lgkmcnt(4)
mf16 v[192:195], v[24:27], v[136:139], v[192:195]
ds_read_b64_tr_b16 v[40:41], v13 offset:8192
v_mul_f32 v248, s52, v248
mf16 v[208:211], v[24:27], v[140:143], v[208:211]
ds_read_b64_tr_b16 v[42:43], v13 offset:8704
v_mul_f32 v249, s52, v249
mf16 v[196:199], v[28:31], v[136:139], v[196:199]
ds_read_b64_tr_b16 v[44:45], v14 offset:8192
cvtpk v60, v248, v249
mf16 v[212:215], v[28:31], v[140:143], v[212:215]
ds_read_b64_tr_b16 v[46:47], v14 offset:8704
s_waitcnt lgkmcnt(4)
mf16 v[200:203], v[32:35], v[136:139], v[200:203]
ds_read_b64_tr_b16 v[24:25], v15 offset:8192
v_mul_f32 v250, s52, v250
mf16 v[216:219], v[32:35], v[140:143], v[216:219]
ds_read_b64_tr_b16 v[26:27], v15 offset:8704
v_mul_f32 v251, s52, v251
mf16 v[204:207], v[36:39], v[136:139], v[204:207]
ds_read_b64_tr_b16 v[28:29], v16 offset:8192
cvtpk v61, v250, v251
mf16 v[220:223], v[36:39], v[140:143], v[220:223]
ds_read_b64_tr_b16 v[30:31], v16 offset:8704
s_waitcnt lgkmcnt(4)
mf16 v[192:195], v[40:43], v[144:147], v[192:195]
ds_read_b64_tr_b16 v[32:33], v13 offset:12288
v_mul_f32 v252, s52, v252
mf16 v[208:211], v[40:43], v[148:151], v[208:211]
ds_read_b64_tr_b16 v[34:35], v13 offset:12800
v_mul_f32 v253, s52, v253
mf16 v[196:199], v[44:47], v[144:147], v[196:199]
ds_read_b64_tr_b16 v[36:37], v14 offset:12288
cvtpk v62, v252, v253
mf16 v[212:215], v[44:47], v[148:151], v[212:215]
ds_read_b64_tr_b16 v[38:39], v14 offset:12800
s_waitcnt lgkmcnt(4)
mf16 v[200:203], v[24:27], v[144:147], v[200:203]
ds_read_b64_tr_b16 v[40:41], v15 offset:12288
v_mul_f32 v254, s52, v254
mf16 v[216:219], v[24:27], v[148:151], v[216:219]
ds_read_b64_tr_b16 v[42:43], v15 offset:12800
v_mul_f32 v255, s52, v255
mf16 v[204:207], v[28:31], v[144:147], v[204:207]
ds_read_b64_tr_b16 v[44:45], v16 offset:12288
cvtpk v63, v254, v255
mf16 v[220:223], v[28:31], v[148:151], v[220:223]
ds_read_b64_tr_b16 v[46:47], v16 offset:12800
s_waitcnt lgkmcnt(4)
mf16 v[192:195], v[32:35], v[152:155], v[192:195]
ds_read_b64_tr_b16 v[24:25], v13 offset:16384
buffer_store_dwordx4 v[60:63], v21, s[36:39], s55 offen offset:2176 sc1
mf16 v[208:211], v[32:35], v[156:159], v[208:211]
ds_read_b64_tr_b16 v[26:27], v13 offset:16896
mf16 v[196:199], v[36:39], v[152:155], v[196:199]
ds_read_b64_tr_b16 v[28:29], v14 offset:16384
mf16 v[212:215], v[36:39], v[156:159], v[212:215]
ds_read_b64_tr_b16 v[30:31], v14 offset:16896
s_waitcnt lgkmcnt(4)
mf16 v[200:203], v[40:43], v[152:155], v[200:203]
ds_read_b64_tr_b16 v[32:33], v15 offset:16384
mf16 v[216:219], v[40:43], v[156:159], v[216:219]
ds_read_b64_tr_b16 v[34:35], v15 offset:16896
mf16 v[204:207], v[44:47], v[152:155], v[204:207]
ds_read_b64_tr_b16 v[36:37], v16 offset:16384
mf16 v[220:223], v[44:47], v[156:159], v[220:223]
ds_read_b64_tr_b16 v[38:39], v16 offset:16896
s_waitcnt lgkmcnt(4)
mf16 v[192:195], v[24:27], v[160:163], v[192:195]
ds_read_b64_tr_b16 v[40:41], v13 offset:20480
mf16 v[208:211], v[24:27], v[164:167], v[208:211]
ds_read_b64_tr_b16 v[42:43], v13 offset:20992
mf16 v[196:199], v[28:31], v[160:163], v[196:199]
ds_read_b64_tr_b16 v[44:45], v14 offset:20480
mf16 v[212:215], v[28:31], v[164:167], v[212:215]
ds_read_b64_tr_b16 v[46:47], v14 offset:20992
s_waitcnt lgkmcnt(4)
mf16 v[200:203], v[32:35], v[160:163], v[200:203]
ds_read_b64_tr_b16 v[24:25], v15 offset:20480
mf16 v[216:219], v[32:35], v[164:167], v[216:219]
ds_read_b64_tr_b16 v[26:27], v15 offset:20992
mf16 v[204:207], v[36:39], v[160:163], v[204:207]
ds_read_b64_tr_b16 v[28:29], v16 offset:20480
mf16 v[220:223], v[36:39], v[164:167], v[220:223]
ds_read_b64_tr_b16 v[30:31], v16 offset:20992
s_waitcnt lgkmcnt(4)
mf16 v[192:195], v[40:43], v[168:171], v[192:195]
ds_read_b64_tr_b16 v[32:33], v13 offset:24576
mf16 v[208:211], v[40:43], v[172:175], v[208:211]
ds_read_b64_tr_b16 v[34:35], v13 offset:25088
buffer_store_dwordx4 v[48:51], v23, s[60:63], s66 offen
mf16 v[196:199], v[44:47], v[168:171], v[196:199]
ds_read_b64_tr_b16 v[36:37], v14 offset:24576
mf16 v[212:215], v[44:47], v[172:175], v[212:215]
ds_read_b64_tr_b16 v[38:39], v14 offset:25088
s_waitcnt lgkmcnt(4)
mf16 v[200:203], v[24:27], v[168:171], v[200:203]
ds_read_b64_tr_b16 v[40:41], v15 offset:24576
mf16 v[216:219], v[24:27], v[172:175], v[216:219]
ds_read_b64_tr_b16 v[42:43], v15 offset:25088
mf16 v[204:207], v[28:31], v[168:171], v[204:207]
ds_read_b64_tr_b16 v[44:45], v16 offset:24576
mf16 v[220:223], v[28:31], v[172:175], v[220:223]
ds_read_b64_tr_b16 v[46:47], v16 offset:25088
s_waitcnt lgkmcnt(4)
mf16 v[192:195], v[32:35], v[176:179], v[192:195]
ds_read_b64_tr_b16 v[24:25], v13 offset:28672
mf16 v[208:211], v[32:35], v[180:183], v[208:211]
ds_read_b64_tr_b16 v[26:27], v13 offset:29184
mf16 v[196:199], v[36:39], v[176:179], v[196:199]
ds_read_b64_tr_b16 v[28:29], v14 offset:28672
mf16 v[212:215], v[36:39], v[180:183], v[212:215]
ds_read_b64_tr_b16 v[30:31], v14 offset:29184
s_waitcnt lgkmcnt(4)
mf16 v[200:203], v[40:43], v[176:179], v[200:203]
ds_read_b64_tr_b16 v[32:33], v15 offset:28672
mf16 v[216:219], v[40:43], v[180:183], v[216:219]
ds_read_b64_tr_b16 v[34:35], v15 offset:29184
mf16 v[204:207], v[44:47], v[176:179], v[204:207]
ds_read_b64_tr_b16 v[36:37], v16 offset:28672
mf16 v[220:223], v[44:47], v[180:183], v[220:223]
ds_read_b64_tr_b16 v[38:39], v16 offset:29184
s_waitcnt lgkmcnt(4)
mf16 v[192:195], v[24:27], v[184:187], v[192:195]
s_waitcnt vmcnt(9)
s_barrier
ds_read_b64_tr_b16 v[40:41], v9 offset:0
mf16 v[208:211], v[24:27], v[188:191], v[208:211]
ds_read_b64_tr_b16 v[42:43], v9 offset:512
mf16 v[196:199], v[28:31], v[184:187], v[196:199]
ds_read_b64_tr_b16 v[44:45], v10 offset:0
mf16 v[212:215], v[28:31], v[188:191], v[212:215]
ds_read_b64_tr_b16 v[46:47], v10 offset:512
s_waitcnt lgkmcnt(4)
mf16 v[200:203], v[32:35], v[184:187], v[200:203]
ds_read_b64_tr_b16 v[24:25], v11 offset:0
mf16 v[216:219], v[32:35], v[188:191], v[216:219]
ds_read_b64_tr_b16 v[26:27], v11 offset:512
mf16 v[204:207], v[36:39], v[184:187], v[204:207]
ds_read_b64_tr_b16 v[28:29], v12 offset:0
mf16 v[220:223], v[36:39], v[188:191], v[220:223]
ds_read_b64_tr_b16 v[30:31], v12 offset:512
s_mov_b32 s8, s90
s_mov_b32 s9, s91
s_mov_b32 s10, 0x400000
s_mov_b32 s11, 0x20000
s_lshl_b32 s12, s2, 14
s_lshl_b32 s13, s16, 7
s_add_u32 s12, s12, s13
s_add_u32 s13, s12, 7168
s_add_u32 s17, s47, 98304
s_mov_b32 m0, s17
v_lshrrev_b32 v3, 3, v0
v_lshlrev_b32 v3, 10, v3
v_and_b32 v4, 7, v0
v_lshl_add_u32 v3, v4, 4, v3
buffer_load_dwordx4 v3, s[8:11], s12 offen nt lds
buffer_load_dwordx4 v3, s[8:11], s13 offen offset:1024 nt lds
v_lshrrev_b32 v4, 5, v0
v_bfe_u32 v5, v0, 2, 2
v_lshl_add_u32 v4, v4, 2, v5
v_lshlrev_b32 v4, 7, v4
v_bfe_u32 v5, v0, 4, 1
v_lshl_add_u32 v4, v5, 5, v4
v_and_b32 v5, 3, v0
v_lshl_add_u32 v4, v5, 3, v4
v_add_u32 v4, s17, v4
v_lshlrev_b32 v5, 4, v0
s_lshl_b32 s17, s16, 19
s_lshl_b32 s13, s2, 11
s_add_u32 s17, s17, s13
s_waitcnt lgkmcnt(4)
mf16 v[224:227], v[40:43], v[64:67], 0
ds_read_b64_tr_b16 v[32:33], v9 offset:4096
mf16 v[240:243], v[40:43], v[68:71], 0
ds_read_b64_tr_b16 v[34:35], v9 offset:4608
mf16 v[228:231], v[44:47], v[64:67], 0
ds_read_b64_tr_b16 v[36:37], v10 offset:4096
mf16 v[244:247], v[44:47], v[68:71], 0
ds_read_b64_tr_b16 v[38:39], v10 offset:4608
s_waitcnt lgkmcnt(4)
mf16 v[232:235], v[24:27], v[64:67], 0
ds_read_b64_tr_b16 v[40:41], v11 offset:4096
mf16 v[248:251], v[24:27], v[68:71], 0
ds_read_b64_tr_b16 v[42:43], v11 offset:4608
mf16 v[236:239], v[28:31], v[64:67], 0
ds_read_b64_tr_b16 v[44:45], v12 offset:4096
mf16 v[252:255], v[28:31], v[68:71], 0
ds_read_b64_tr_b16 v[46:47], v12 offset:4608
s_waitcnt lgkmcnt(4)
mf16 v[224:227], v[32:35], v[72:75], v[224:227]
ds_read_b64_tr_b16 v[24:25], v9 offset:8192
s_add_u32 s54, s43, 0
s_add_u32 s54, s54, s92
mf16 v[240:243], v[32:35], v[76:79], v[240:243]
ds_read_b64_tr_b16 v[26:27], v9 offset:8704
v_mul_f32 v192, s52, v192
mf16 v[228:231], v[36:39], v[72:75], v[228:231]
ds_read_b64_tr_b16 v[28:29], v10 offset:8192
v_mul_f32 v193, s52, v193
mf16 v[244:247], v[36:39], v[76:79], v[244:247]
ds_read_b64_tr_b16 v[30:31], v10 offset:8704
s_waitcnt lgkmcnt(4)
mf16 v[232:235], v[40:43], v[72:75], v[232:235]
ds_read_b64_tr_b16 v[32:33], v11 offset:8192
cvtpk v56, v192, v193
mf16 v[248:251], v[40:43], v[76:79], v[248:251]
ds_read_b64_tr_b16 v[34:35], v11 offset:8704
v_mul_f32 v194, s52, v194
mf16 v[236:239], v[44:47], v[72:75], v[236:239]
ds_read_b64_tr_b16 v[36:37], v12 offset:8192
v_mul_f32 v195, s52, v195
mf16 v[252:255], v[44:47], v[76:79], v[252:255]
ds_read_b64_tr_b16 v[38:39], v12 offset:8704
s_waitcnt lgkmcnt(4)
mf16 v[224:227], v[24:27], v[80:83], v[224:227]
ds_read_b64_tr_b16 v[40:41], v9 offset:12288
cvtpk v57, v194, v195
mf16 v[240:243], v[24:27], v[84:87], v[240:243]
ds_read_b64_tr_b16 v[42:43], v9 offset:12800
v_mul_f32 v196, s52, v196
mf16 v[228:231], v[28:31], v[80:83], v[228:231]
ds_read_b64_tr_b16 v[44:45], v10 offset:12288
v_mul_f32 v197, s52, v197
mf16 v[244:247], v[28:31], v[84:87], v[244:247]
ds_read_b64_tr_b16 v[46:47], v10 offset:12800
s_waitcnt lgkmcnt(4)
mf16 v[232:235], v[32:35], v[80:83], v[232:235]
ds_read_b64_tr_b16 v[24:25], v11 offset:12288
cvtpk v58, v196, v197
mf16 v[248:251], v[32:35], v[84:87], v[248:251]
ds_read_b64_tr_b16 v[26:27], v11 offset:12800
v_mul_f32 v198, s52, v198
mf16 v[236:239], v[36:39], v[80:83], v[236:239]
ds_read_b64_tr_b16 v[28:29], v12 offset:12288
v_mul_f32 v199, s52, v199
mf16 v[252:255], v[36:39], v[84:87], v[252:255]
ds_read_b64_tr_b16 v[30:31], v12 offset:12800
s_waitcnt lgkmcnt(4)
mf16 v[224:227], v[40:43], v[88:91], v[224:227]
ds_read_b64_tr_b16 v[32:33], v9 offset:16384
cvtpk v59, v198, v199
mf16 v[240:243], v[40:43], v[92:95], v[240:243]
ds_read_b64_tr_b16 v[34:35], v9 offset:16896
buffer_store_dwordx4 v[56:59], v21, s[36:39], s54 offen offset:0 sc1
mf16 v[228:231], v[44:47], v[88:91], v[228:231]
ds_read_b64_tr_b16 v[36:37], v10 offset:16384
v_mul_f32 v200, s52, v200
mf16 v[244:247], v[44:47], v[92:95], v[244:247]
ds_read_b64_tr_b16 v[38:39], v10 offset:16896
s_waitcnt lgkmcnt(4)
mf16 v[232:235], v[24:27], v[88:91], v[232:235]
ds_read_b64_tr_b16 v[40:41], v11 offset:16384
v_mul_f32 v201, s52, v201
mf16 v[248:251], v[24:27], v[92:95], v[248:251]
ds_read_b64_tr_b16 v[42:43], v11 offset:16896
cvtpk v60, v200, v201
mf16 v[236:239], v[28:31], v[88:91], v[236:239]
ds_read_b64_tr_b16 v[44:45], v12 offset:16384
v_mul_f32 v202, s52, v202
mf16 v[252:255], v[28:31], v[92:95], v[252:255]
ds_read_b64_tr_b16 v[46:47], v12 offset:16896
s_waitcnt lgkmcnt(4)
mf16 v[224:227], v[32:35], v[96:99], v[224:227]
ds_read_b64_tr_b16 v[24:25], v9 offset:20480
v_mul_f32 v203, s52, v203
mf16 v[240:243], v[32:35], v[100:103], v[240:243]
ds_read_b64_tr_b16 v[26:27], v9 offset:20992
cvtpk v61, v202, v203
s_getpc_b64 s[8:9]
s_add_u32 s8, s8, cs_attn_kernel@rel32@lo+4
s_addc_u32 s9, s9, cs_attn_kernel@rel32@hi+12
s_mov_b32 s10, attn_kernel_end - attn_kernel
s_mov_b32 s11, 0x20000
s_lshr_b32 s12, s2, 3
s_lshl_b32 s12, s12, 3
s_add_u32 s12, s12, s16
s_lshl_b32 s12, s12, 9
v_lshlrev_b32 v7, 7, v0
s_mov_b64 exec, 15
buffer_load_dword v8, v7, s[8:11], s12 offen
s_mov_b64 exec, -1
mf16 v[228:231], v[36:39], v[96:99], v[228:231]
ds_read_b64_tr_b16 v[28:29], v10 offset:20480
v_mul_f32 v204, s52, v204
mf16 v[244:247], v[36:39], v[100:103], v[244:247]
ds_read_b64_tr_b16 v[30:31], v10 offset:20992
s_waitcnt lgkmcnt(4)
mf16 v[232:235], v[40:43], v[96:99], v[232:235]
ds_read_b64_tr_b16 v[32:33], v11 offset:20480
v_mul_f32 v205, s52, v205
mf16 v[248:251], v[40:43], v[100:103], v[248:251]
ds_read_b64_tr_b16 v[34:35], v11 offset:20992
cvtpk v62, v204, v205
mf16 v[236:239], v[44:47], v[96:99], v[236:239]
ds_read_b64_tr_b16 v[36:37], v12 offset:20480
v_mul_f32 v206, s52, v206
mf16 v[252:255], v[44:47], v[100:103], v[252:255]
ds_read_b64_tr_b16 v[38:39], v12 offset:20992
s_waitcnt lgkmcnt(4)
mf16 v[224:227], v[24:27], v[104:107], v[224:227]
ds_read_b64_tr_b16 v[40:41], v9 offset:24576
v_mul_f32 v207, s52, v207
mf16 v[240:243], v[24:27], v[108:111], v[240:243]
ds_read_b64_tr_b16 v[42:43], v9 offset:25088
cvtpk v63, v206, v207
mf16 v[228:231], v[28:31], v[104:107], v[228:231]
ds_read_b64_tr_b16 v[44:45], v10 offset:24576
buffer_store_dwordx4 v[60:63], v21, s[36:39], s54 offen offset:2048 sc1
mf16 v[244:247], v[28:31], v[108:111], v[244:247]
ds_read_b64_tr_b16 v[46:47], v10 offset:25088
s_waitcnt lgkmcnt(4)
mf16 v[232:235], v[32:35], v[104:107], v[232:235]
ds_read_b64_tr_b16 v[24:25], v11 offset:24576
v_mul_f32 v208, s52, v208
mf16 v[248:251], v[32:35], v[108:111], v[248:251]
ds_read_b64_tr_b16 v[26:27], v11 offset:25088
v_mul_f32 v209, s52, v209
mf16 v[236:239], v[36:39], v[104:107], v[236:239]
ds_read_b64_tr_b16 v[28:29], v12 offset:24576
cvtpk v56, v208, v209
mf16 v[252:255], v[36:39], v[108:111], v[252:255]
ds_read_b64_tr_b16 v[30:31], v12 offset:25088
s_waitcnt lgkmcnt(4)
mf16 v[224:227], v[40:43], v[112:115], v[224:227]
ds_read_b64_tr_b16 v[32:33], v9 offset:28672
v_mul_f32 v210, s52, v210
mf16 v[240:243], v[40:43], v[116:119], v[240:243]
ds_read_b64_tr_b16 v[34:35], v9 offset:29184
v_mul_f32 v211, s52, v211
mf16 v[228:231], v[44:47], v[112:115], v[228:231]
ds_read_b64_tr_b16 v[36:37], v10 offset:28672
cvtpk v57, v210, v211
mf16 v[244:247], v[44:47], v[116:119], v[244:247]
ds_read_b64_tr_b16 v[38:39], v10 offset:29184
s_waitcnt lgkmcnt(4)
mf16 v[232:235], v[24:27], v[112:115], v[232:235]
ds_read_b64_tr_b16 v[40:41], v11 offset:28672
v_mul_f32 v212, s52, v212
mf16 v[248:251], v[24:27], v[116:119], v[248:251]
ds_read_b64_tr_b16 v[42:43], v11 offset:29184
v_mul_f32 v213, s52, v213
mf16 v[236:239], v[28:31], v[112:115], v[236:239]
ds_read_b64_tr_b16 v[44:45], v12 offset:28672
cvtpk v58, v212, v213
mf16 v[252:255], v[28:31], v[116:119], v[252:255]
ds_read_b64_tr_b16 v[46:47], v12 offset:29184
s_waitcnt lgkmcnt(4)
mf16 v[224:227], v[32:35], v[120:123], v[224:227]
s_waitcnt vmcnt(7)
s_barrier
ds_read_b64_tr_b16 v[24:25], v9 offset:32768
v_mul_f32 v214, s52, v214
mf16 v[240:243], v[32:35], v[124:127], v[240:243]
ds_read_b64_tr_b16 v[26:27], v9 offset:33280
v_mul_f32 v215, s52, v215
mf16 v[228:231], v[36:39], v[120:123], v[228:231]
ds_read_b64_tr_b16 v[28:29], v10 offset:32768
cvtpk v59, v214, v215
mf16 v[244:247], v[36:39], v[124:127], v[244:247]
ds_read_b64_tr_b16 v[30:31], v10 offset:33280
s_waitcnt lgkmcnt(4)
mf16 v[232:235], v[40:43], v[120:123], v[232:235]
ds_read_b64_tr_b16 v[32:33], v11 offset:32768
buffer_store_dwordx4 v[56:59], v21, s[36:39], s54 offen offset:128 sc1
mf16 v[248:251], v[40:43], v[124:127], v[248:251]
ds_read_b64_tr_b16 v[34:35], v11 offset:33280
v_mul_f32 v216, s52, v216
mf16 v[236:239], v[44:47], v[120:123], v[236:239]
ds_read_b64_tr_b16 v[36:37], v12 offset:32768
v_mul_f32 v217, s52, v217
mf16 v[252:255], v[44:47], v[124:127], v[252:255]
ds_read_b64_tr_b16 v[38:39], v12 offset:33280
s_waitcnt lgkmcnt(4)
mf16 v[224:227], v[24:27], v[128:131], v[224:227]
ds_read_b64_tr_b16 v[40:41], v9 offset:36864
cvtpk v60, v216, v217
mf16 v[240:243], v[24:27], v[132:135], v[240:243]
ds_read_b64_tr_b16 v[42:43], v9 offset:37376
v_mul_f32 v218, s52, v218
mf16 v[228:231], v[28:31], v[128:131], v[228:231]
ds_read_b64_tr_b16 v[44:45], v10 offset:36864
v_mul_f32 v219, s52, v219
mf16 v[244:247], v[28:31], v[132:135], v[244:247]
ds_read_b64_tr_b16 v[46:47], v10 offset:37376
s_waitcnt lgkmcnt(4)
mf16 v[232:235], v[32:35], v[128:131], v[232:235]
ds_read_b64_tr_b16 v[24:25], v11 offset:36864
cvtpk v61, v218, v219
mf16 v[248:251], v[32:35], v[132:135], v[248:251]
ds_read_b64_tr_b16 v[26:27], v11 offset:37376
v_mul_f32 v220, s52, v220
mf16 v[236:239], v[36:39], v[128:131], v[236:239]
ds_read_b64_tr_b16 v[28:29], v12 offset:36864
v_mul_f32 v221, s52, v221
mf16 v[252:255], v[36:39], v[132:135], v[252:255]
ds_read_b64_tr_b16 v[30:31], v12 offset:37376
s_waitcnt lgkmcnt(4)
mf16 v[224:227], v[40:43], v[136:139], v[224:227]
ds_read_b64_tr_b16 v[32:33], v9 offset:40960
cvtpk v62, v220, v221
mf16 v[240:243], v[40:43], v[140:143], v[240:243]
ds_read_b64_tr_b16 v[34:35], v9 offset:41472
v_mul_f32 v222, s52, v222
mf16 v[228:231], v[44:47], v[136:139], v[228:231]
ds_read_b64_tr_b16 v[36:37], v10 offset:40960
v_mul_f32 v223, s52, v223
mf16 v[244:247], v[44:47], v[140:143], v[244:247]
ds_read_b64_tr_b16 v[38:39], v10 offset:41472
s_waitcnt lgkmcnt(4)
mf16 v[232:235], v[24:27], v[136:139], v[232:235]
ds_read_b64_tr_b16 v[40:41], v11 offset:40960
cvtpk v63, v222, v223
mf16 v[248:251], v[24:27], v[140:143], v[248:251]
ds_read_b64_tr_b16 v[42:43], v11 offset:41472
buffer_store_dwordx4 v[60:63], v21, s[36:39], s54 offen offset:2176 sc1
mf16 v[236:239], v[28:31], v[136:139], v[236:239]
ds_read_b64_tr_b16 v[44:45], v12 offset:40960
mf16 v[252:255], v[28:31], v[140:143], v[252:255]
ds_read_b64_tr_b16 v[46:47], v12 offset:41472
s_waitcnt lgkmcnt(4)
mf16 v[224:227], v[32:35], v[144:147], v[224:227]
ds_read_b64_tr_b16 v[24:25], v9 offset:45056
mf16 v[240:243], v[32:35], v[148:151], v[240:243]
ds_read_b64_tr_b16 v[26:27], v9 offset:45568
mf16 v[228:231], v[36:39], v[144:147], v[228:231]
ds_read_b64_tr_b16 v[28:29], v10 offset:45056
mf16 v[244:247], v[36:39], v[148:151], v[244:247]
ds_read_b64_tr_b16 v[30:31], v10 offset:45568
s_waitcnt lgkmcnt(4)
mf16 v[232:235], v[40:43], v[144:147], v[232:235]
ds_read_b64_tr_b16 v[32:33], v11 offset:45056
mf16 v[248:251], v[40:43], v[148:151], v[248:251]
ds_read_b64_tr_b16 v[34:35], v11 offset:45568
mf16 v[236:239], v[44:47], v[144:147], v[236:239]
ds_read_b64_tr_b16 v[36:37], v12 offset:45056
mf16 v[252:255], v[44:47], v[148:151], v[252:255]
ds_read_b64_tr_b16 v[38:39], v12 offset:45568
s_waitcnt lgkmcnt(4)
mf16 v[224:227], v[24:27], v[152:155], v[224:227]
ds_read_b64_tr_b16 v[40:41], v9 offset:49152
mf16 v[240:243], v[24:27], v[156:159], v[240:243]
ds_read_b64_tr_b16 v[42:43], v9 offset:49664
mf16 v[228:231], v[28:31], v[152:155], v[228:231]
ds_read_b64_tr_b16 v[24:25], v10 offset:49152
mf16 v[244:247], v[28:31], v[156:159], v[244:247]
ds_read_b64_tr_b16 v[26:27], v10 offset:49664
s_waitcnt lgkmcnt(4)
mf16 v[232:235], v[32:35], v[152:155], v[232:235]
ds_read_b64_tr_b16 v[28:29], v11 offset:49152
mf16 v[248:251], v[32:35], v[156:159], v[248:251]
ds_read_b64_tr_b16 v[30:31], v11 offset:49664
mf16 v[236:239], v[36:39], v[152:155], v[236:239]
ds_read_b64_tr_b16 v[32:33], v12 offset:49152
mf16 v[252:255], v[36:39], v[156:159], v[252:255]
ds_read_b64_tr_b16 v[34:35], v12 offset:49664
s_waitcnt lgkmcnt(4)
mf16 v[224:227], v[40:43], v[160:163], v[224:227]
ds_read_b64_tr_b16 v[36:37], v9 offset:53248
mf16 v[240:243], v[40:43], v[164:167], v[240:243]
ds_read_b64_tr_b16 v[38:39], v9 offset:53760
mf16 v[228:231], v[24:27], v[160:163], v[228:231]
ds_read_b64_tr_b16 v[40:41], v10 offset:53248
mf16 v[244:247], v[24:27], v[164:167], v[244:247]
ds_read_b64_tr_b16 v[42:43], v10 offset:53760
s_waitcnt lgkmcnt(4)
mf16 v[232:235], v[28:31], v[160:163], v[232:235]
ds_read_b64_tr_b16 v[24:25], v11 offset:53248
mf16 v[248:251], v[28:31], v[164:167], v[248:251]
ds_read_b64_tr_b16 v[26:27], v11 offset:53760
mf16 v[236:239], v[32:35], v[160:163], v[236:239]
ds_read_b64_tr_b16 v[28:29], v12 offset:53248
mf16 v[252:255], v[32:35], v[164:167], v[252:255]
ds_read_b64_tr_b16 v[30:31], v12 offset:53760
s_waitcnt lgkmcnt(4)
mf16 v[224:227], v[36:39], v[168:171], v[224:227]
ds_read_b64_tr_b16 v[32:33], v9 offset:57344
mf16 v[240:243], v[36:39], v[172:175], v[240:243]
ds_read_b64_tr_b16 v[34:35], v9 offset:57856
mf16 v[228:231], v[40:43], v[168:171], v[228:231]
ds_read_b64_tr_b16 v[36:37], v10 offset:57344
mf16 v[244:247], v[40:43], v[172:175], v[244:247]
ds_read_b64_tr_b16 v[38:39], v10 offset:57856
s_waitcnt lgkmcnt(4)
mf16 v[232:235], v[24:27], v[168:171], v[232:235]
ds_read_b64_tr_b16 v[40:41], v11 offset:57344
mf16 v[248:251], v[24:27], v[172:175], v[248:251]
ds_read_b64_tr_b16 v[42:43], v11 offset:57856
s_waitcnt vmcnt(4)
ds_read_b64_tr_b16 v[56:57], v4 offset:0
ds_read_b64_tr_b16 v[58:59], v4 offset:1024
ds_read_b64_tr_b16 v[60:61], v4 offset:64
ds_read_b64_tr_b16 v[62:63], v4 offset:1088
s_add_u32 s8, s14, 0x3c00000
s_addc_u32 s9, s15, 0
s_mov_b32 s10, 0x400000
s_mov_b32 s11, 0x20000
s_waitcnt lgkmcnt(0)
buffer_store_dwordx4 v[56:59], v5, s[8:11], s17 offen offset:0 sc1
buffer_store_dwordx4 v[60:63], v5, s[8:11], s17 offen offset:1024 sc1
l1_kernel_wosD:
mf16 v[236:239], v[28:31], v[168:171], v[236:239]
ds_read_b64_tr_b16 v[24:25], v12 offset:57344
mf16 v[252:255], v[28:31], v[172:175], v[252:255]
ds_read_b64_tr_b16 v[26:27], v12 offset:57856
s_waitcnt lgkmcnt(4)
mf16 v[224:227], v[32:35], v[176:179], v[224:227]
ds_read_b64_tr_b16 v[28:29], v9 offset:61440
mf16 v[240:243], v[32:35], v[180:183], v[240:243]
ds_read_b64_tr_b16 v[30:31], v9 offset:61952
mf16 v[228:231], v[36:39], v[176:179], v[228:231]
ds_read_b64_tr_b16 v[32:33], v10 offset:61440
mf16 v[244:247], v[36:39], v[180:183], v[244:247]
ds_read_b64_tr_b16 v[34:35], v10 offset:61952
s_waitcnt lgkmcnt(4)
mf16 v[232:235], v[40:43], v[176:179], v[232:235]
ds_read_b64_tr_b16 v[36:37], v11 offset:61440
mf16 v[248:251], v[40:43], v[180:183], v[248:251]
ds_read_b64_tr_b16 v[38:39], v11 offset:61952
mf16 v[236:239], v[24:27], v[176:179], v[236:239]
ds_read_b64_tr_b16 v[40:41], v12 offset:61440
mf16 v[252:255], v[24:27], v[180:183], v[252:255]
ds_read_b64_tr_b16 v[42:43], v12 offset:61952
s_waitcnt lgkmcnt(4)
mf16 v[224:227], v[28:31], v[184:187], v[224:227]
mf16 v[240:243], v[28:31], v[188:191], v[240:243]
mf16 v[228:231], v[32:35], v[184:187], v[228:231]
mf16 v[244:247], v[32:35], v[188:191], v[244:247]
s_waitcnt lgkmcnt(0)
mf16 v[232:235], v[36:39], v[184:187], v[232:235]
mf16 v[248:251], v[36:39], v[188:191], v[248:251]
mf16 v[236:239], v[40:43], v[184:187], v[236:239]
mf16 v[252:255], v[40:43], v[188:191], v[252:255]
v_mov_b32 v48, v52
v_mov_b32 v49, v53
v_mov_b32 v50, v54
v_mov_b32 v51, v55
s_add_u32 s66, s66, 0x400000
s_nop 7
s_add_u32 s55, s43, 4096
s_add_u32 s55, s55, s92
v_mul_f32 v224, s52, v224
v_mul_f32 v225, s52, v225
cvtpk v56, v224, v225
v_mul_f32 v226, s52, v226
v_mul_f32 v227, s52, v227
cvtpk v57, v226, v227
v_mul_f32 v228, s52, v228
v_mul_f32 v229, s52, v229
cvtpk v58, v228, v229
v_mul_f32 v230, s52, v230
v_mul_f32 v231, s52, v231
cvtpk v59, v230, v231
buffer_store_dwordx4 v[56:59], v21, s[36:39], s55 offen offset:0 sc1
v_mul_f32 v232, s52, v232
v_mul_f32 v233, s52, v233
cvtpk v60, v232, v233
v_mul_f32 v234, s52, v234
v_mul_f32 v235, s52, v235
cvtpk v61, v234, v235
v_mul_f32 v236, s52, v236
v_mul_f32 v237, s52, v237
cvtpk v62, v236, v237
v_mul_f32 v238, s52, v238
v_mul_f32 v239, s52, v239
cvtpk v63, v238, v239
buffer_store_dwordx4 v[60:63], v21, s[36:39], s55 offen offset:2048 sc1
v_mul_f32 v240, s52, v240
v_mul_f32 v241, s52, v241
cvtpk v56, v240, v241
v_mul_f32 v242, s52, v242
v_mul_f32 v243, s52, v243
cvtpk v57, v242, v243
v_mul_f32 v244, s52, v244
v_mul_f32 v245, s52, v245
cvtpk v58, v244, v245
v_mul_f32 v246, s52, v246
v_mul_f32 v247, s52, v247
cvtpk v59, v246, v247
buffer_store_dwordx4 v[56:59], v21, s[36:39], s55 offen offset:128 sc1
v_mul_f32 v248, s52, v248
v_mul_f32 v249, s52, v249
cvtpk v60, v248, v249
v_mul_f32 v250, s52, v250
v_mul_f32 v251, s52, v251
cvtpk v61, v250, v251
v_mul_f32 v252, s52, v252
v_mul_f32 v253, s52, v253
cvtpk v62, v252, v253
v_mul_f32 v254, s52, v254
v_mul_f32 v255, s52, v255
cvtpk v63, v254, v255
buffer_store_dwordx4 v[60:63], v21, s[36:39], s55 offen offset:2176 sc1
s_endpgm
l1_kernel_end:
s_endpgm
.text
.globl attn_kernel
.p2align 8
.type attn_kernel,@function
attn_kernel:
cs_attn_kernel:
s_cmp_ge_u32 s2, 256
s_cbranch_scc1 attn_kernel_end
s_load_dwordx2 s[4:5], s[0:1], 88
s_load_dwordx2 s[14:15], s[0:1], 40
v_lshrrev_b32 v1, 6, v0
v_and_b32 v0, 63, v0
s_and_b32 s6, s2, 7
v_readfirstlane_b32 s16, v1
s_lshr_b32 s7, s2, 3
s_and_b32 s8, s7, 3
s_lshl_b32 s6, s6, 2
s_add_u32 s17, s6, s8
s_lshr_b32 s18, s7, 2
s_lshl_b32 s6, s18, 2
s_sub_u32 s7, 60, s6
s_add_u32 s7, s7, s16
s_add_u32 s8, s6, 7
s_sub_u32 s8, s8, s16
s_cmp_ge_u32 s16, 4
s_cselect_b32 s45, s8, s7
s_add_u32 s19, s45, 1
s_sub_u32 s9, 64, s6
s_lshr_b32 s41, s9, 1
s_lshl_b32 s9, s9, 13
s_lshl_b32 s10, s17, 19
v_lshlrev_b32 v1, 4, v0
s_and_b32 s11, s16, 3
s_lshl_b32 s11, s11, 11
v_add_u32 v10, s11, v1
v_add_u32 v11, 0x2000, v10
v_and_b32 v13, 31, v0
v_lshrrev_b32 v14, 5, v0
v_lshlrev_b32 v14, 2, v14
v_sub_u32 v12, v13, v14
v_mov_b32 v48, 0xff800000
s_mov_b32 s40, 0x46800000
v_mov_b32 v124, 122880
v_mov_b32 v56, 0
v_mov_b32 v57, 0
v_mov_b32 v58, 0
v_mov_b32 v59, 0
ds_write_b128 v124, v[56:59]
s_and_b32 s60, s2, 7
s_lshl_b32 s60, s60, 5
s_lshr_b32 s61, s2, 3
s_add_u32 s60, s60, s61
s_cmp_eq_u32 s2, 248
s_cselect_b32 s61, 4, 2
s_cmp_lt_u32 s16, s61
s_cselect_b32 s23, 1, 0
s_cmp_ge_u32 s16, 2
s_cselect_b32 s60, 0x100, s60
s_mov_b32 s61, 131072
s_cselect_b32 s61, 147456, s61
s_and_b32 s67, s16, 1
s_waitcnt lgkmcnt(0)
s_add_u32 s24, s4, s10
s_addc_u32 s25, s5, 0
s_mov_b32 s26, s9
s_mov_b32 s27, 0x20000
s_add_u32 s12, s10, 0xffa000
s_add_u32 s13, s9, 24576
s_add_u32 s28, s4, s12
s_addc_u32 s29, s5, 0
s_mov_b32 s30, s13
s_mov_b32 s31, 0x20000
s_add_u32 s32, s4, 0x4000000
s_addc_u32 s33, s5, 0
s_mov_b32 s34, 0x1000000
s_mov_b32 s35, 0x20000
s_add_u32 s36, s4, 0x2000000
s_addc_u32 s37, s5, 0
s_mov_b32 s38, 0x1000000
s_mov_b32 s39, 0x20000
s_lshl_b32 s12, s45, 18
s_lshl_b32 s13, s17, 13
s_add_u32 s12, s12, s13
s_add_u32 s13, s12, 4096
s_cmp_eq_u32 s23, 0
s_cbranch_scc1 attn_kernel_nob2l
s_lshl_b32 s62, s60, 13
s_lshl_b32 s67, s67, 10
s_add_u32 s62, s62, s67
s_add_u32 s63, s62, 4096
s_add_u32 s64, s62, s67
s_add_u32 s65, s64, 4096
s_add_u32 s48, s4, 0x3000000
s_addc_u32 s49, s5, 0
s_mov_b32 s50, 0x202000
s_mov_b32 s51, 0x20000
buffer_load_dwordx4 v[16:19], v1, s[48:51], s62 offen offset:0
buffer_load_dwordx4 v[20:23], v1, s[48:51], s62 offen offset:2048
buffer_load_dwordx4 v[24:27], v1, s[48:51], s63 offen offset:0
buffer_load_dwordx4 v[28:31], v1, s[48:51], s63 offen offset:2048
s_add_u32 s52, s4, 0x3400000
s_addc_u32 s53, s5, 0
s_mov_b32 s54, 0x202000
s_mov_b32 s55, 0x20000
buffer_load_dwordx4 v[32:35], v1, s[52:55], s64 offen offset:0
buffer_load_dwordx4 v[36:39], v1, s[52:55], s64 offen offset:1024
buffer_load_dwordx4 v[40:43], v1, s[52:55], s65 offen offset:0
buffer_load_dwordx4 v[44:47], v1, s[52:55], s65 offen offset:1024
buffer_load_dwordx4 v[128:131], v1, s[32:35], s12 offen offset:0
buffer_load_dwordx4 v[132:135], v1, s[32:35], s12 offen offset:1024
buffer_load_dwordx4 v[136:139], v1, s[32:35], s12 offen offset:2048
buffer_load_dwordx4 v[140:143], v1, s[32:35], s12 offen offset:3072
buffer_load_dwordx4 v[144:147], v1, s[32:35], s13 offen offset:0
buffer_load_dwordx4 v[148:151], v1, s[32:35], s13 offen offset:1024
buffer_load_dwordx4 v[152:155], v1, s[32:35], s13 offen offset:2048
buffer_load_dwordx4 v[156:159], v1, s[32:35], s13 offen offset:3072
attn_kernel_nob2l:
s_barrier
s_lshl_b32 s46, s45, 18
s_lshl_b32 s6, s17, 13
s_add_u32 s46, s46, s6
s_add_u32 s47, s46, 4096
s_mov_b32 s43, s11
s_mov_b32 s42, 0
s_cmp_ge_u32 s16, 4
s_cbranch_scc1 attn_kernel_short
s_cmp_eq_u32 s23, 0
s_cbranch_scc1 attn_kernel_b2no
s_and_b32 s67, s16, 2
s_lshl_b32 s67, s67, 2
s_add_u32 s67, s67, 122880
v_mov_b32 v124, s67
s_bitcmp1_b32 s16, 0
s_cbranch_scc1 attn_kernel_b2w1
v_lshlrev_b32 v56, 4, v0
s_add_u32 s56, s4, 0x3800000
s_addc_u32 s57, s5, 0
s_mov_b32 s58, 0x202000
s_mov_b32 s59, 0x20000
s_mov_b32 s66, 0x36000000
s_and_b32 s67, s60, 255
s_cmp_eq_u32 s67, 0
s_cselect_b32 s66, 0x35800000, s66
v_lshrrev_b32 v57, 5, v0
v_cvt_f32_u32 v57, v57
v_mul_f32 v57, 4.0, v57
v_and_b32 v60, 31, v0
v_cvt_f32_u32 v60, v60
v_add_f32 v63, 0x00000000, v60
v_mul_f32 v58, 0x3d000000, v60
v_mul_f32 v59, v58, v57
v_fmamk_f32 v120, v58, 0x00000000, v59
v_fmamk_f32 v121, v58, 0x3f800000, v59
v_fmamk_f32 v122, v58, 0x40000000, v59
v_fmamk_f32 v123, v58, 0x40400000, v59
v_cos_f32 v120, v120
v_cos_f32 v121, v121
v_cos_f32 v122, v122
v_cos_f32 v123, v123
s_nop 0
cvtpk v64, v120, v121
cvtpk v65, v122, v123
v_fmamk_f32 v120, v58, 0x41000000, v59
v_fmamk_f32 v121, v58, 0x41100000, v59
v_fmamk_f32 v122, v58, 0x41200000, v59
v_fmamk_f32 v123, v58, 0x41300000, v59
v_cos_f32 v120, v120
v_cos_f32 v121, v121
v_cos_f32 v122, v122
v_cos_f32 v123, v123
s_nop 0
cvtpk v66, v120, v121
cvtpk v67, v122, v123
v_fmamk_f32 v120, v58, 0x41800000, v59
v_fmamk_f32 v121, v58, 0x41880000, v59
v_fmamk_f32 v122, v58, 0x41900000, v59
v_fmamk_f32 v123, v58, 0x41980000, v59
v_cos_f32 v120, v120
v_cos_f32 v121, v121
v_cos_f32 v122, v122
v_cos_f32 v123, v123
s_nop 0
cvtpk v68, v120, v121
cvtpk v69, v122, v123
v_fmamk_f32 v120, v58, 0x41c00000, v59
v_fmamk_f32 v121, v58, 0x41c80000, v59
v_fmamk_f32 v122, v58, 0x41d00000, v59
v_fmamk_f32 v123, v58, 0x41d80000, v59
v_cos_f32 v120, v120
v_cos_f32 v121, v121
v_cos_f32 v122, v122
v_cos_f32 v123, v123
s_nop 0
cvtpk v70, v120, v121
cvtpk v71, v122, v123
v_add_f32 v59, 0xbe800000, v59
v_fmamk_f32 v120, v58, 0x00000000, v59
v_fmamk_f32 v121, v58, 0x3f800000, v59
v_fmamk_f32 v122, v58, 0x40000000, v59
v_fmamk_f32 v123, v58, 0x40400000, v59
v_cos_f32 v120, v120
v_cos_f32 v121, v121
v_cos_f32 v122, v122
v_cos_f32 v123, v123
s_nop 0
cvtpk v72, v120, v121
cvtpk v73, v122, v123
v_fmamk_f32 v120, v58, 0x41000000, v59
v_fmamk_f32 v121, v58, 0x41100000, v59
v_fmamk_f32 v122, v58, 0x41200000, v59
v_fmamk_f32 v123, v58, 0x41300000, v59
v_cos_f32 v120, v120
v_cos_f32 v121, v121
v_cos_f32 v122, v122
v_cos_f32 v123, v123
s_nop 0
cvtpk v74, v120, v121
cvtpk v75, v122, v123
v_fmamk_f32 v120, v58, 0x41800000, v59
v_fmamk_f32 v121, v58, 0x41880000, v59
v_fmamk_f32 v122, v58, 0x41900000, v59
v_fmamk_f32 v123, v58, 0x41980000, v59
v_cos_f32 v120, v120
v_cos_f32 v121, v121
v_cos_f32 v122, v122
v_cos_f32 v123, v123
s_nop 0
cvtpk v76, v120, v121
cvtpk v77, v122, v123
v_fmamk_f32 v120, v58, 0x41c00000, v59
v_fmamk_f32 v121, v58, 0x41c80000, v59
v_fmamk_f32 v122, v58, 0x41d00000, v59
v_fmamk_f32 v123, v58, 0x41d80000, v59
v_cos_f32 v120, v120
v_cos_f32 v121, v121
v_cos_f32 v122, v122
v_cos_f32 v123, v123
s_nop 0
cvtpk v78, v120, v121
cvtpk v79, v122, v123
v_xor_b32 v80, 0x80008000, v72
v_xor_b32 v81, 0x80008000, v73
v_xor_b32 v82, 0x80008000, v74
v_xor_b32 v83, 0x80008000, v75
v_xor_b32 v84, 0x80008000, v76
v_xor_b32 v85, 0x80008000, v77
v_xor_b32 v86, 0x80008000, v78
v_xor_b32 v87, 0x80008000, v79
v_mul_f32 v58, 0x3c800000, v63
v_mul_f32 v59, v58, v57
v_fmamk_f32 v120, v58, 0x00000000, v59
v_fmamk_f32 v121, v58, 0x3f800000, v59
v_fmamk_f32 v122, v58, 0x40000000, v59
v_fmamk_f32 v123, v58, 0x40400000, v59
v_cos_f32 v120, v120
v_cos_f32 v121, v121
v_cos_f32 v122, v122
v_cos_f32 v123, v123
s_nop 0
cvtpk v88, v120, v121
cvtpk v89, v122, v123
v_fmamk_f32 v120, v58, 0x41000000, v59
v_fmamk_f32 v121, v58, 0x41100000, v59
v_fmamk_f32 v122, v58, 0x41200000, v59
v_fmamk_f32 v123, v58, 0x41300000, v59
v_cos_f32 v120, v120
v_cos_f32 v121, v121
v_cos_f32 v122, v122
v_cos_f32 v123, v123
s_nop 0
cvtpk v90, v120, v121
cvtpk v91, v122, v123
v_fmamk_f32 v120, v58, 0x41800000, v59
v_fmamk_f32 v121, v58, 0x41880000, v59
v_fmamk_f32 v122, v58, 0x41900000, v59
v_fmamk_f32 v123, v58, 0x41980000, v59
v_cos_f32 v120, v120
v_cos_f32 v121, v121
v_cos_f32 v122, v122
v_cos_f32 v123, v123
s_nop 0
cvtpk v92, v120, v121
cvtpk v93, v122, v123
v_fmamk_f32 v120, v58, 0x41c00000, v59
v_fmamk_f32 v121, v58, 0x41c80000, v59
v_fmamk_f32 v122, v58, 0x41d00000, v59
v_fmamk_f32 v123, v58, 0x41d80000, v59
v_cos_f32 v120, v120
v_cos_f32 v121, v121
v_cos_f32 v122, v122
v_cos_f32 v123, v123
s_nop 0
cvtpk v94, v120, v121
cvtpk v95, v122, v123
v_fmamk_f32 v120, v58, 0x42000000, v59
v_fmamk_f32 v121, v58, 0x42040000, v59
v_fmamk_f32 v122, v58, 0x42080000, v59
v_fmamk_f32 v123, v58, 0x420c0000, v59
v_cos_f32 v120, v120
v_cos_f32 v121, v121
v_cos_f32 v122, v122
v_cos_f32 v123, v123
s_nop 0
cvtpk v96, v120, v121
cvtpk v97, v122, v123
v_fmamk_f32 v120, v58, 0x42200000, v59
v_fmamk_f32 v121, v58, 0x42240000, v59
v_fmamk_f32 v122, v58, 0x42280000, v59
v_fmamk_f32 v123, v58, 0x422c0000, v59
v_cos_f32 v120, v120
v_cos_f32 v121, v121
v_cos_f32 v122, v122
v_cos_f32 v123, v123
s_nop 0
cvtpk v98, v120, v121
cvtpk v99, v122, v123
v_fmamk_f32 v120, v58, 0x42400000, v59
v_fmamk_f32 v121, v58, 0x42440000, v59
v_fmamk_f32 v122, v58, 0x42480000, v59
v_fmamk_f32 v123, v58, 0x424c0000, v59
v_cos_f32 v120, v120
v_cos_f32 v121, v121
v_cos_f32 v122, v122
v_cos_f32 v123, v123
s_nop 0
cvtpk v100, v120, v121
cvtpk v101, v122, v123
v_fmamk_f32 v120, v58, 0x42600000, v59
v_fmamk_f32 v121, v58, 0x42640000, v59
v_fmamk_f32 v122, v58, 0x42680000, v59
v_fmamk_f32 v123, v58, 0x426c0000, v59
v_cos_f32 v120, v120
v_cos_f32 v121, v121
v_cos_f32 v122, v122
v_cos_f32 v123, v123
s_nop 0
cvtpk v102, v120, v121
cvtpk v103, v122, v123
v_add_f32 v59, 0xbe800000, v59
v_fmamk_f32 v120, v58, 0x00000000, v59
v_fmamk_f32 v121, v58, 0x3f800000, v59
v_fmamk_f32 v122, v58, 0x40000000, v59
v_fmamk_f32 v123, v58, 0x40400000, v59
v_cos_f32 v120, v120
v_cos_f32 v121, v121
v_cos_f32 v122, v122
v_cos_f32 v123, v123
s_nop 0
cvtpk v104, v120, v121
cvtpk v105, v122, v123
v_fmamk_f32 v120, v58, 0x41000000, v59
v_fmamk_f32 v121, v58, 0x41100000, v59
v_fmamk_f32 v122, v58, 0x41200000, v59
v_fmamk_f32 v123, v58, 0x41300000, v59
v_cos_f32 v120, v120
v_cos_f32 v121, v121
v_cos_f32 v122, v122
v_cos_f32 v123, v123
s_nop 0
cvtpk v106, v120, v121
cvtpk v107, v122, v123
v_fmamk_f32 v120, v58, 0x41800000, v59
v_fmamk_f32 v121, v58, 0x41880000, v59
v_fmamk_f32 v122, v58, 0x41900000, v59
v_fmamk_f32 v123, v58, 0x41980000, v59
v_cos_f32 v120, v120
v_cos_f32 v121, v121
v_cos_f32 v122, v122
v_cos_f32 v123, v123
s_nop 0
cvtpk v108, v120, v121
cvtpk v109, v122, v123
v_fmamk_f32 v120, v58, 0x41c00000, v59
v_fmamk_f32 v121, v58, 0x41c80000, v59
v_fmamk_f32 v122, v58, 0x41d00000, v59
v_fmamk_f32 v123, v58, 0x41d80000, v59
v_cos_f32 v120, v120
v_cos_f32 v121, v121
v_cos_f32 v122, v122
v_cos_f32 v123, v123
s_nop 0
cvtpk v110, v120, v121
cvtpk v111, v122, v123
v_fmamk_f32 v120, v58, 0x42000000, v59
v_fmamk_f32 v121, v58, 0x42040000, v59
v_fmamk_f32 v122, v58, 0x42080000, v59
v_fmamk_f32 v123, v58, 0x420c0000, v59
v_cos_f32 v120, v120
v_cos_f32 v121, v121
v_cos_f32 v122, v122
v_cos_f32 v123, v123
s_nop 0
cvtpk v112, v120, v121
cvtpk v113, v122, v123
v_fmamk_f32 v120, v58, 0x42200000, v59
v_fmamk_f32 v121, v58, 0x42240000, v59
v_fmamk_f32 v122, v58, 0x42280000, v59
v_fmamk_f32 v123, v58, 0x422c0000, v59
v_cos_f32 v120, v120
v_cos_f32 v121, v121
v_cos_f32 v122, v122
v_cos_f32 v123, v123
s_nop 0
cvtpk v114, v120, v121
cvtpk v115, v122, v123
v_fmamk_f32 v120, v58, 0x42400000, v59
v_fmamk_f32 v121, v58, 0x42440000, v59
v_fmamk_f32 v122, v58, 0x42480000, v59
v_fmamk_f32 v123, v58, 0x424c0000, v59
v_cos_f32 v120, v120
v_cos_f32 v121, v121
v_cos_f32 v122, v122
v_cos_f32 v123, v123
s_nop 0
cvtpk v116, v120, v121
cvtpk v117, v122, v123
v_fmamk_f32 v120, v58, 0x42600000, v59
v_fmamk_f32 v121, v58, 0x42640000, v59
v_fmamk_f32 v122, v58, 0x42680000, v59
v_fmamk_f32 v123, v58, 0x426c0000, v59
v_cos_f32 v120, v120
v_cos_f32 v121, v121
v_cos_f32 v122, v122
v_cos_f32 v123, v123
s_nop 0
cvtpk v118, v120, v121
cvtpk v119, v122, v123
v_add_u32 v61, s61, v56
v_add_u32 v62, 4096, v61
v_add_u32 v61, 0, v61
v_mul_f32 v58, 0x3a000000, v60
v_add_f32 v59, 0x00000000, v57
v_mul_f32 v59, v58, v59
v_fmamk_f32 v120, v58, 0x00000000, v59
v_cos_f32 v224, v120
v_sin_f32 v200, v120
v_fmamk_f32 v121, v58, 0x3f800000, v59
v_cos_f32 v225, v121
v_sin_f32 v201, v121
v_fmamk_f32 v120, v58, 0x40000000, v59
v_cos_f32 v226, v120
v_sin_f32 v202, v120
v_fmamk_f32 v121, v58, 0x40400000, v59
v_cos_f32 v227, v121
v_sin_f32 v203, v121
v_fmamk_f32 v120, v58, 0x41000000, v59
v_cos_f32 v228, v120
v_sin_f32 v204, v120
v_fmamk_f32 v121, v58, 0x41100000, v59
v_cos_f32 v229, v121
v_sin_f32 v205, v121
v_fmamk_f32 v120, v58, 0x41200000, v59
v_cos_f32 v230, v120
v_sin_f32 v206, v120
v_fmamk_f32 v121, v58, 0x41300000, v59
v_cos_f32 v231, v121
v_sin_f32 v207, v121
v_fmamk_f32 v120, v58, 0x41800000, v59
v_cos_f32 v232, v120
v_sin_f32 v216, v120
v_fmamk_f32 v121, v58, 0x41880000, v59
v_cos_f32 v233, v121
v_sin_f32 v217, v121
v_fmamk_f32 v120, v58, 0x41900000, v59
v_cos_f32 v234, v120
v_sin_f32 v218, v120
v_fmamk_f32 v121, v58, 0x41980000, v59
v_cos_f32 v235, v121
v_sin_f32 v219, v121
v_fmamk_f32 v120, v58, 0x41c00000, v59
v_cos_f32 v236, v120
v_sin_f32 v220, v120
v_fmamk_f32 v121, v58, 0x41c80000, v59
v_cos_f32 v237, v121
v_sin_f32 v221, v121
v_fmamk_f32 v120, v58, 0x41d00000, v59
v_cos_f32 v238, v120
v_sin_f32 v222, v120
v_fmamk_f32 v121, v58, 0x41d80000, v59
v_cos_f32 v239, v121
v_sin_f32 v223, v121
v_mul_f32 v58, 0x3a000000, v63
v_mul_f32 v59, v58, v57
s_waitcnt vmcnt(12)
mf32 v[160:175], v[16:19], v[64:67], 0
mf32 v[160:175], v[20:23], v[68:71], v[160:175]
mf32 v[160:175], v[24:27], v[72:75], v[160:175]
mf32 v[160:175], v[28:31], v[76:79], v[160:175]
mf32 v[176:191], v[24:27], v[64:67], 0
mf32 v[176:191], v[28:31], v[68:71], v[176:191]
mf32 v[176:191], v[16:19], v[80:83], v[176:191]
mf32 v[176:191], v[20:23], v[84:87], v[176:191]
s_nop 11
v_mul_f32 v120, v160, v200
v_mul_f32 v160, v160, v224
v_fma_f32 v160, v176, v200, v160
v_fma_f32 v176, v176, v224, -v120
v_mul_f32 v120, v161, v201
v_mul_f32 v161, v161, v225
v_fma_f32 v161, v177, v201, v161
v_fma_f32 v177, v177, v225, -v120
v_mul_f32 v120, v162, v202
v_mul_f32 v162, v162, v226
v_fma_f32 v162, v178, v202, v162
v_fma_f32 v178, v178, v226, -v120
v_mul_f32 v120, v163, v203
v_mul_f32 v163, v163, v227
v_fma_f32 v163, v179, v203, v163
v_fma_f32 v179, v179, v227, -v120
v_mul_f32 v120, v164, v204
v_mul_f32 v164, v164, v228
v_fma_f32 v164, v180, v204, v164
v_fma_f32 v180, v180, v228, -v120
v_mul_f32 v120, v165, v205
v_mul_f32 v165, v165, v229
v_fma_f32 v165, v181, v205, v165
v_fma_f32 v181, v181, v229, -v120
v_mul_f32 v120, v166, v206
v_mul_f32 v166, v166, v230
v_fma_f32 v166, v182, v206, v166
v_fma_f32 v182, v182, v230, -v120
v_mul_f32 v120, v167, v207
v_mul_f32 v167, v167, v231
v_fma_f32 v167, v183, v207, v167
v_fma_f32 v183, v183, v231, -v120
v_mul_f32 v120, v168, v216
v_mul_f32 v168, v168, v232
v_fma_f32 v168, v184, v216, v168
v_fma_f32 v184, v184, v232, -v120
v_mul_f32 v120, v169, v217
v_mul_f32 v169, v169, v233
v_fma_f32 v169, v185, v217, v169
v_fma_f32 v185, v185, v233, -v120
v_mul_f32 v120, v170, v218
v_mul_f32 v170, v170, v234
v_fma_f32 v170, v186, v218, v170
v_fma_f32 v186, v186, v234, -v120
v_mul_f32 v120, v171, v219
v_mul_f32 v171, v171, v235
v_fma_f32 v171, v187, v219, v171
v_fma_f32 v187, v187, v235, -v120
v_mul_f32 v120, v172, v220
v_mul_f32 v172, v172, v236
v_fma_f32 v172, v188, v220, v172
v_fma_f32 v188, v188, v236, -v120
v_mul_f32 v120, v173, v221
v_mul_f32 v173, v173, v237
v_fma_f32 v173, v189, v221, v173
v_fma_f32 v189, v189, v237, -v120
v_mul_f32 v120, v174, v222
v_mul_f32 v174, v174, v238
v_fma_f32 v174, v190, v222, v174
v_fma_f32 v190, v190, v238, -v120
v_mul_f32 v120, v175, v223
v_mul_f32 v175, v175, v239
v_fma_f32 v175, v191, v223, v175
v_fma_f32 v191, v191, v239, -v120
cvtpk v192, v160, v161
cvtpk v193, v162, v163
cvtpk v194, v164, v165
cvtpk v195, v166, v167
cvtpk v196, v168, v169
cvtpk v197, v170, v171
cvtpk v198, v172, v173
cvtpk v199, v174, v175
cvtpk v208, v176, v177
cvtpk v209, v178, v179
cvtpk v210, v180, v181
cvtpk v211, v182, v183
cvtpk v212, v184, v185
cvtpk v213, v186, v187
cvtpk v214, v188, v189
cvtpk v215, v190, v191
ds_write_b128 v61, v[192:195] offset:0
ds_write_b128 v61, v[196:199] offset:1024
ds_write_b128 v61, v[208:211] offset:2048
ds_write_b128 v61, v[212:215] offset:3072
s_waitcnt lgkmcnt(0)
v_mov_b32 v125, 1
ds_write_b32 v124, v125 offset:0
attn_kernel_spin_1:
ds_read_b32 v126, v124 offset:4
s_waitcnt lgkmcnt(0)
v_readfirstlane_b32 s67, v126
s_nop 0
s_cmp_lt_u32 s67, 1
s_cbranch_scc1 attn_kernel_spin_1
ds_read_b128 v[200:203], v62 offset:0
ds_read_b128 v[204:207], v62 offset:1024
ds_read_b128 v[216:219], v62 offset:2048
ds_read_b128 v[220:223], v62 offset:3072
v_xor_b32 v224, 0x80008000, v192
v_xor_b32 v225, 0x80008000, v193
v_xor_b32 v226, 0x80008000, v194
v_xor_b32 v227, 0x80008000, v195
v_xor_b32 v228, 0x80008000, v196
v_xor_b32 v229, 0x80008000, v197
v_xor_b32 v230, 0x80008000, v198
v_xor_b32 v231, 0x80008000, v199
s_waitcnt lgkmcnt(0)
v_xor_b32 v232, 0x80008000, v200
v_xor_b32 v233, 0x80008000, v201
v_xor_b32 v234, 0x80008000, v202
v_xor_b32 v235, 0x80008000, v203
v_xor_b32 v236, 0x80008000, v204
v_xor_b32 v237, 0x80008000, v205
v_xor_b32 v238, 0x80008000, v206
v_xor_b32 v239, 0x80008000, v207
s_nop 1
mf32 v[160:175], v[88:91], v[192:195], 0
v_fmamk_f32 v120, v58, 0x00000000, v59
v_cos_f32 v16, v120
v_sin_f32 v240, v120
mf32 v[160:175], v[92:95], v[196:199], v[160:175]
v_fmamk_f32 v121, v58, 0x3f800000, v59
v_cos_f32 v17, v121
v_sin_f32 v241, v121
mf32 v[160:175], v[96:99], v[200:203], v[160:175]
v_fmamk_f32 v120, v58, 0x40000000, v59
v_cos_f32 v18, v120
v_sin_f32 v242, v120
mf32 v[160:175], v[100:103], v[204:207], v[160:175]
v_fmamk_f32 v121, v58, 0x40400000, v59
v_cos_f32 v19, v121
v_sin_f32 v243, v121
mf32 v[160:175], v[104:107], v[208:211], v[160:175]
v_fmamk_f32 v120, v58, 0x41000000, v59
v_cos_f32 v20, v120
v_sin_f32 v244, v120
mf32 v[160:175], v[108:111], v[212:215], v[160:175]
v_fmamk_f32 v121, v58, 0x41100000, v59
v_cos_f32 v21, v121
v_sin_f32 v245, v121
mf32 v[160:175], v[112:115], v[216:219], v[160:175]
v_fmamk_f32 v120, v58, 0x41200000, v59
v_cos_f32 v22, v120
v_sin_f32 v246, v120
mf32 v[160:175], v[116:119], v[220:223], v[160:175]
v_fmamk_f32 v121, v58, 0x41300000, v59
v_cos_f32 v23, v121
v_sin_f32 v247, v121
mf32 v[176:191], v[88:91], v[208:211], 0
v_fmamk_f32 v120, v58, 0x41800000, v59
v_cos_f32 v24, v120
v_sin_f32 v248, v120
mf32 v[176:191], v[92:95], v[212:215], v[176:191]
v_fmamk_f32 v121, v58, 0x41880000, v59
v_cos_f32 v25, v121
v_sin_f32 v249, v121
mf32 v[176:191], v[96:99], v[216:219], v[176:191]
v_fmamk_f32 v120, v58, 0x41900000, v59
v_cos_f32 v26, v120
v_sin_f32 v250, v120
mf32 v[176:191], v[100:103], v[220:223], v[176:191]
v_fmamk_f32 v121, v58, 0x41980000, v59
v_cos_f32 v27, v121
v_sin_f32 v251, v121
mf32 v[176:191], v[104:107], v[224:227], v[176:191]
v_fmamk_f32 v120, v58, 0x41c00000, v59
v_cos_f32 v28, v120
v_sin_f32 v252, v120
mf32 v[176:191], v[108:111], v[228:231], v[176:191]
v_fmamk_f32 v121, v58, 0x41c80000, v59
v_cos_f32 v29, v121
v_sin_f32 v253, v121
mf32 v[176:191], v[112:115], v[232:235], v[176:191]
v_fmamk_f32 v120, v58, 0x41d00000, v59
v_cos_f32 v30, v120
v_sin_f32 v254, v120
mf32 v[176:191], v[116:119], v[236:239], v[176:191]
v_fmamk_f32 v121, v58, 0x41d80000, v59
v_cos_f32 v31, v121
v_sin_f32 v255, v121
s_waitcnt vmcnt(8)
v_mul_f32 v16, s66, v16
v_mul_f32 v17, s66, v17
v_mul_f32 v18, s66, v18
v_mul_f32 v19, s66, v19
v_mul_f32 v20, s66, v20
v_mul_f32 v21, s66, v21
v_mul_f32 v22, s66, v22
v_mul_f32 v23, s66, v23
v_mul_f32 v24, s66, v24
v_mul_f32 v25, s66, v25
v_mul_f32 v26, s66, v26
v_mul_f32 v27, s66, v27
v_lshlrev_b32 v120, 16, v32
v_lshlrev_b32 v121, 16, v40
v_mul_f32 v122, v160, v121
v_mul_f32 v160, v160, v120
v_fma_f32 v160, -v176, v121, v160
v_fma_f32 v176, v176, v120, v122
v_and_b32 v120, 0xffff0000, v32
v_and_b32 v121, 0xffff0000, v40
v_mul_f32 v122, v161, v121
v_mul_f32 v161, v161, v120
v_fma_f32 v161, -v177, v121, v161
v_fma_f32 v177, v177, v120, v122
v_lshlrev_b32 v120, 16, v33
v_lshlrev_b32 v121, 16, v41
v_mul_f32 v122, v162, v121
v_mul_f32 v162, v162, v120
v_fma_f32 v162, -v178, v121, v162
v_fma_f32 v178, v178, v120, v122
v_and_b32 v120, 0xffff0000, v33
v_and_b32 v121, 0xffff0000, v41
v_mul_f32 v122, v163, v121
v_mul_f32 v163, v163, v120
v_fma_f32 v163, -v179, v121, v163
v_fma_f32 v179, v179, v120, v122
v_lshlrev_b32 v120, 16, v34
v_lshlrev_b32 v121, 16, v42
v_mul_f32 v122, v164, v121
v_mul_f32 v164, v164, v120
v_fma_f32 v164, -v180, v121, v164
v_fma_f32 v180, v180, v120, v122
v_and_b32 v120, 0xffff0000, v34
v_and_b32 v121, 0xffff0000, v42
v_mul_f32 v122, v165, v121
v_mul_f32 v165, v165, v120
v_fma_f32 v165, -v181, v121, v165
v_fma_f32 v181, v181, v120, v122
v_lshlrev_b32 v120, 16, v35
v_lshlrev_b32 v121, 16, v43
v_mul_f32 v122, v166, v121
v_mul_f32 v166, v166, v120
v_fma_f32 v166, -v182, v121, v166
v_fma_f32 v182, v182, v120, v122
v_and_b32 v120, 0xffff0000, v35
v_and_b32 v121, 0xffff0000, v43
v_mul_f32 v122, v167, v121
v_mul_f32 v167, v167, v120
v_fma_f32 v167, -v183, v121, v167
v_fma_f32 v183, v183, v120, v122
v_lshlrev_b32 v120, 16, v36
v_lshlrev_b32 v121, 16, v44
v_mul_f32 v122, v168, v121
v_mul_f32 v168, v168, v120
v_fma_f32 v168, -v184, v121, v168
v_fma_f32 v184, v184, v120, v122
v_and_b32 v120, 0xffff0000, v36
v_and_b32 v121, 0xffff0000, v44
v_mul_f32 v122, v169, v121
v_mul_f32 v169, v169, v120
v_fma_f32 v169, -v185, v121, v169
v_fma_f32 v185, v185, v120, v122
v_lshlrev_b32 v120, 16, v37
v_lshlrev_b32 v121, 16, v45
v_mul_f32 v122, v170, v121
v_mul_f32 v170, v170, v120
v_fma_f32 v170, -v186, v121, v170
v_fma_f32 v186, v186, v120, v122
v_and_b32 v120, 0xffff0000, v37
v_and_b32 v121, 0xffff0000, v45
v_mul_f32 v122, v171, v121
v_mul_f32 v171, v171, v120
v_fma_f32 v171, -v187, v121, v171
v_fma_f32 v187, v187, v120, v122
v_lshlrev_b32 v120, 16, v38
v_lshlrev_b32 v121, 16, v46
v_mul_f32 v122, v172, v121
v_mul_f32 v172, v172, v120
v_fma_f32 v172, -v188, v121, v172
v_fma_f32 v188, v188, v120, v122
v_and_b32 v120, 0xffff0000, v38
v_and_b32 v121, 0xffff0000, v46
v_mul_f32 v122, v173, v121
v_mul_f32 v173, v173, v120
v_fma_f32 v173, -v189, v121, v173
v_fma_f32 v189, v189, v120, v122
v_lshlrev_b32 v120, 16, v39
v_lshlrev_b32 v121, 16, v47
v_mul_f32 v122, v174, v121
v_mul_f32 v174, v174, v120
v_fma_f32 v174, -v190, v121, v174
v_fma_f32 v190, v190, v120, v122
v_and_b32 v120, 0xffff0000, v39
v_and_b32 v121, 0xffff0000, v47
v_mul_f32 v122, v175, v121
v_mul_f32 v175, v175, v120
v_fma_f32 v175, -v191, v121, v175
v_fma_f32 v191, v191, v120, v122
cvtpk v192, v160, v161
cvtpk v193, v162, v163
cvtpk v194, v164, v165
cvtpk v195, v166, v167
cvtpk v196, v168, v169
cvtpk v197, v170, v171
cvtpk v198, v172, v173
cvtpk v199, v174, v175
cvtpk v208, v176, v177
cvtpk v209, v178, v179
cvtpk v210, v180, v181
cvtpk v211, v182, v183
cvtpk v212, v184, v185
cvtpk v213, v186, v187
cvtpk v214, v188, v189
cvtpk v215, v190, v191
ds_write_b128 v61, v[192:195] offset:8192
ds_write_b128 v61, v[196:199] offset:9216
ds_write_b128 v61, v[208:211] offset:10240
ds_write_b128 v61, v[212:215] offset:11264
s_waitcnt lgkmcnt(0)
v_mov_b32 v125, 2
ds_write_b32 v124, v125 offset:0
attn_kernel_spin_2:
ds_read_b32 v126, v124 offset:4
s_waitcnt lgkmcnt(0)
v_readfirstlane_b32 s67, v126
s_nop 0
s_cmp_lt_u32 s67, 2
s_cbranch_scc1 attn_kernel_spin_2
ds_read_b128 v[200:203], v62 offset:8192
ds_read_b128 v[204:207], v62 offset:9216
ds_read_b128 v[216:219], v62 offset:10240
ds_read_b128 v[220:223], v62 offset:11264
v_xor_b32 v224, 0x80008000, v208
v_xor_b32 v225, 0x80008000, v209
v_xor_b32 v226, 0x80008000, v210
v_xor_b32 v227, 0x80008000, v211
v_xor_b32 v228, 0x80008000, v212
v_xor_b32 v229, 0x80008000, v213
v_xor_b32 v230, 0x80008000, v214
v_xor_b32 v231, 0x80008000, v215
s_waitcnt lgkmcnt(0)
v_xor_b32 v232, 0x80008000, v216
v_xor_b32 v233, 0x80008000, v217
v_xor_b32 v234, 0x80008000, v218
v_xor_b32 v235, 0x80008000, v219
v_xor_b32 v236, 0x80008000, v220
v_xor_b32 v237, 0x80008000, v221
v_xor_b32 v238, 0x80008000, v222
v_xor_b32 v239, 0x80008000, v223
s_nop 1
mf32 v[160:175], v[192:195], v[88:91], 0
v_mul_f32 v28, s66, v28
v_mul_f32 v29, s66, v29
v_mul_f32 v30, s66, v30
mf32 v[160:175], v[196:199], v[92:95], v[160:175]
v_mul_f32 v31, s66, v31
v_mul_f32 v240, s66, v240
v_mul_f32 v241, s66, v241
mf32 v[160:175], v[200:203], v[96:99], v[160:175]
v_mul_f32 v242, s66, v242
v_mul_f32 v243, s66, v243
v_mul_f32 v244, s66, v244
mf32 v[160:175], v[204:207], v[100:103], v[160:175]
v_mul_f32 v245, s66, v245
v_mul_f32 v246, s66, v246
v_mul_f32 v247, s66, v247
mf32 v[160:175], v[224:227], v[104:107], v[160:175]
v_mul_f32 v248, s66, v248
v_mul_f32 v249, s66, v249
v_mul_f32 v250, s66, v250
mf32 v[160:175], v[228:231], v[108:111], v[160:175]
v_mul_f32 v251, s66, v251
v_mul_f32 v252, s66, v252
v_mul_f32 v253, s66, v253
mf32 v[160:175], v[232:235], v[112:115], v[160:175]
v_mul_f32 v254, s66, v254
v_mul_f32 v255, s66, v255
mf32 v[160:175], v[236:239], v[116:119], v[160:175]
mf32 v[176:191], v[208:211], v[88:91], 0
mf32 v[176:191], v[212:215], v[92:95], v[176:191]
mf32 v[176:191], v[216:219], v[96:99], v[176:191]
mf32 v[176:191], v[220:223], v[100:103], v[176:191]
mf32 v[176:191], v[192:195], v[104:107], v[176:191]
mf32 v[176:191], v[196:199], v[108:111], v[176:191]
mf32 v[176:191], v[200:203], v[112:115], v[176:191]
mf32 v[176:191], v[204:207], v[116:119], v[176:191]
s_nop 11
v_mul_f32 v120, v160, v240
v_mul_f32 v160, v160, v16
v_fma_f32 v160, -v176, v240, v160
v_fma_f32 v176, v176, v16, v120
v_mul_f32 v120, v161, v241
v_mul_f32 v161, v161, v17
v_fma_f32 v161, -v177, v241, v161
v_fma_f32 v177, v177, v17, v120
v_mul_f32 v120, v162, v242
v_mul_f32 v162, v162, v18
v_fma_f32 v162, -v178, v242, v162
v_fma_f32 v178, v178, v18, v120
v_mul_f32 v120, v163, v243
v_mul_f32 v163, v163, v19
v_fma_f32 v163, -v179, v243, v163
v_fma_f32 v179, v179, v19, v120
v_mul_f32 v120, v164, v244
v_mul_f32 v164, v164, v20
v_fma_f32 v164, -v180, v244, v164
v_fma_f32 v180, v180, v20, v120
v_mul_f32 v120, v165, v245
v_mul_f32 v165, v165, v21
v_fma_f32 v165, -v181, v245, v165
v_fma_f32 v181, v181, v21, v120
v_mul_f32 v120, v166, v246
v_mul_f32 v166, v166, v22
v_fma_f32 v166, -v182, v246, v166
v_fma_f32 v182, v182, v22, v120
v_mul_f32 v120, v167, v247
v_mul_f32 v167, v167, v23
v_fma_f32 v167, -v183, v247, v167
v_fma_f32 v183, v183, v23, v120
v_mul_f32 v120, v168, v248
v_mul_f32 v168, v168, v24
v_fma_f32 v168, -v184, v248, v168
v_fma_f32 v184, v184, v24, v120
v_mul_f32 v120, v169, v249
v_mul_f32 v169, v169, v25
v_fma_f32 v169, -v185, v249, v169
v_fma_f32 v185, v185, v25, v120
v_mul_f32 v120, v170, v250
v_mul_f32 v170, v170, v26
v_fma_f32 v170, -v186, v250, v170
v_fma_f32 v186, v186, v26, v120
v_mul_f32 v120, v171, v251
v_mul_f32 v171, v171, v27
v_fma_f32 v171, -v187, v251, v171
v_fma_f32 v187, v187, v27, v120
v_mul_f32 v120, v172, v252
v_mul_f32 v172, v172, v28
v_fma_f32 v172, -v188, v252, v172
v_fma_f32 v188, v188, v28, v120
v_mul_f32 v120, v173, v253
v_mul_f32 v173, v173, v29
v_fma_f32 v173, -v189, v253, v173
v_fma_f32 v189, v189, v29, v120
v_mul_f32 v120, v174, v254
v_mul_f32 v174, v174, v30
v_fma_f32 v174, -v190, v254, v174
v_fma_f32 v190, v190, v30, v120
v_mul_f32 v120, v175, v255
v_mul_f32 v175, v175, v31
v_fma_f32 v175, -v191, v255, v175
v_fma_f32 v191, v191, v31, v120
cvtpk v192, v160, v161
cvtpk v193, v162, v163
cvtpk v194, v164, v165
cvtpk v195, v166, v167
cvtpk v196, v168, v169
cvtpk v197, v170, v171
cvtpk v198, v172, v173
cvtpk v199, v174, v175
cvtpk v208, v176, v177
cvtpk v209, v178, v179
cvtpk v210, v180, v181
cvtpk v211, v182, v183
cvtpk v212, v184, v185
cvtpk v213, v186, v187
cvtpk v214, v188, v189
cvtpk v215, v190, v191
s_nop 1
mf32 v[160:175], v[64:67], v[192:195], 0
mf32 v[160:175], v[68:71], v[196:199], v[160:175]
mf32 v[160:175], v[80:83], v[208:211], v[160:175]
mf32 v[160:175], v[84:87], v[212:215], v[160:175]
mf32 v[176:191], v[64:67], v[208:211], 0
mf32 v[176:191], v[68:71], v[212:215], v[176:191]
mf32 v[176:191], v[72:75], v[192:195], v[176:191]
mf32 v[176:191], v[76:79], v[196:199], v[176:191]
s_nop 7
cvtpk v16, v160, v161
cvtpk v17, v162, v163
cvtpk v18, v164, v165
cvtpk v19, v166, v167
cvtpk v20, v168, v169
cvtpk v21, v170, v171
cvtpk v22, v172, v173
cvtpk v23, v174, v175
s_nop 3
cvtpk v24, v176, v177
cvtpk v25, v178, v179
cvtpk v26, v180, v181
cvtpk v27, v182, v183
cvtpk v28, v184, v185
cvtpk v29, v186, v187
cvtpk v30, v188, v189
cvtpk v31, v190, v191
buffer_store_dwordx4 v[16:19], v56, s[56:59], s64 offen offset:0
buffer_store_dwordx4 v[20:23], v56, s[56:59], s64 offen offset:1024
buffer_store_dwordx4 v[24:27], v56, s[56:59], s65 offen offset:0
buffer_store_dwordx4 v[28:31], v56, s[56:59], s65 offen offset:1024
s_branch attn_kernel_b2done
attn_kernel_b2w1:
v_lshlrev_b32 v56, 4, v0
s_add_u32 s56, s4, 0x3800000
s_addc_u32 s57, s5, 0
s_mov_b32 s58, 0x202000
s_mov_b32 s59, 0x20000
s_mov_b32 s66, 0x36000000
s_and_b32 s67, s60, 255
s_cmp_eq_u32 s67, 0
s_cselect_b32 s66, 0x35800000, s66
v_lshrrev_b32 v57, 5, v0
v_cvt_f32_u32 v57, v57
v_mul_f32 v57, 4.0, v57
v_and_b32 v60, 31, v0
v_cvt_f32_u32 v60, v60
v_add_f32 v63, 0x42000000, v60
v_mul_f32 v58, 0x3d000000, v60
v_mul_f32 v59, v58, v57
v_fmamk_f32 v120, v58, 0x00000000, v59
v_fmamk_f32 v121, v58, 0x3f800000, v59
v_fmamk_f32 v122, v58, 0x40000000, v59
v_fmamk_f32 v123, v58, 0x40400000, v59
v_cos_f32 v120, v120
v_cos_f32 v121, v121
v_cos_f32 v122, v122
v_cos_f32 v123, v123
s_nop 0
cvtpk v64, v120, v121
cvtpk v65, v122, v123
v_fmamk_f32 v120, v58, 0x41000000, v59
v_fmamk_f32 v121, v58, 0x41100000, v59
v_fmamk_f32 v122, v58, 0x41200000, v59
v_fmamk_f32 v123, v58, 0x41300000, v59
v_cos_f32 v120, v120
v_cos_f32 v121, v121
v_cos_f32 v122, v122
v_cos_f32 v123, v123
s_nop 0
cvtpk v66, v120, v121
cvtpk v67, v122, v123
v_fmamk_f32 v120, v58, 0x41800000, v59
v_fmamk_f32 v121, v58, 0x41880000, v59
v_fmamk_f32 v122, v58, 0x41900000, v59
v_fmamk_f32 v123, v58, 0x41980000, v59
v_cos_f32 v120, v120
v_cos_f32 v121, v121
v_cos_f32 v122, v122
v_cos_f32 v123, v123
s_nop 0
cvtpk v68, v120, v121
cvtpk v69, v122, v123
v_fmamk_f32 v120, v58, 0x41c00000, v59
v_fmamk_f32 v121, v58, 0x41c80000, v59
v_fmamk_f32 v122, v58, 0x41d00000, v59
v_fmamk_f32 v123, v58, 0x41d80000, v59
v_cos_f32 v120, v120
v_cos_f32 v121, v121
v_cos_f32 v122, v122
v_cos_f32 v123, v123
s_nop 0
cvtpk v70, v120, v121
cvtpk v71, v122, v123
v_add_f32 v59, 0xbe800000, v59
v_fmamk_f32 v120, v58, 0x00000000, v59
v_fmamk_f32 v121, v58, 0x3f800000, v59
v_fmamk_f32 v122, v58, 0x40000000, v59
v_fmamk_f32 v123, v58, 0x40400000, v59
v_cos_f32 v120, v120
v_cos_f32 v121, v121
v_cos_f32 v122, v122
v_cos_f32 v123, v123
s_nop 0
cvtpk v72, v120, v121
cvtpk v73, v122, v123
v_fmamk_f32 v120, v58, 0x41000000, v59
v_fmamk_f32 v121, v58, 0x41100000, v59
v_fmamk_f32 v122, v58, 0x41200000, v59
v_fmamk_f32 v123, v58, 0x41300000, v59
v_cos_f32 v120, v120
v_cos_f32 v121, v121
v_cos_f32 v122, v122
v_cos_f32 v123, v123
s_nop 0
cvtpk v74, v120, v121
cvtpk v75, v122, v123
v_fmamk_f32 v120, v58, 0x41800000, v59
v_fmamk_f32 v121, v58, 0x41880000, v59
v_fmamk_f32 v122, v58, 0x41900000, v59
v_fmamk_f32 v123, v58, 0x41980000, v59
v_cos_f32 v120, v120
v_cos_f32 v121, v121
v_cos_f32 v122, v122
v_cos_f32 v123, v123
s_nop 0
cvtpk v76, v120, v121
cvtpk v77, v122, v123
v_fmamk_f32 v120, v58, 0x41c00000, v59
v_fmamk_f32 v121, v58, 0x41c80000, v59
v_fmamk_f32 v122, v58, 0x41d00000, v59
v_fmamk_f32 v123, v58, 0x41d80000, v59
v_cos_f32 v120, v120
v_cos_f32 v121, v121
v_cos_f32 v122, v122
v_cos_f32 v123, v123
s_nop 0
cvtpk v78, v120, v121
cvtpk v79, v122, v123
v_xor_b32 v80, 0x80008000, v72
v_xor_b32 v81, 0x80008000, v73
v_xor_b32 v82, 0x80008000, v74
v_xor_b32 v83, 0x80008000, v75
v_xor_b32 v84, 0x80008000, v76
v_xor_b32 v85, 0x80008000, v77
v_xor_b32 v86, 0x80008000, v78
v_xor_b32 v87, 0x80008000, v79
v_mul_f32 v58, 0x3c800000, v63
v_mul_f32 v59, v58, v57
v_fmamk_f32 v120, v58, 0x00000000, v59
v_fmamk_f32 v121, v58, 0x3f800000, v59
v_fmamk_f32 v122, v58, 0x40000000, v59
v_fmamk_f32 v123, v58, 0x40400000, v59
v_cos_f32 v120, v120
v_cos_f32 v121, v121
v_cos_f32 v122, v122
v_cos_f32 v123, v123
s_nop 0
cvtpk v88, v120, v121
cvtpk v89, v122, v123
v_fmamk_f32 v120, v58, 0x41000000, v59
v_fmamk_f32 v121, v58, 0x41100000, v59
v_fmamk_f32 v122, v58, 0x41200000, v59
v_fmamk_f32 v123, v58, 0x41300000, v59
v_cos_f32 v120, v120
v_cos_f32 v121, v121
v_cos_f32 v122, v122
v_cos_f32 v123, v123
s_nop 0
cvtpk v90, v120, v121
cvtpk v91, v122, v123
v_fmamk_f32 v120, v58, 0x41800000, v59
v_fmamk_f32 v121, v58, 0x41880000, v59
v_fmamk_f32 v122, v58, 0x41900000, v59
v_fmamk_f32 v123, v58, 0x41980000, v59
v_cos_f32 v120, v120
v_cos_f32 v121, v121
v_cos_f32 v122, v122
v_cos_f32 v123, v123
s_nop 0
cvtpk v92, v120, v121
cvtpk v93, v122, v123
v_fmamk_f32 v120, v58, 0x41c00000, v59
v_fmamk_f32 v121, v58, 0x41c80000, v59
v_fmamk_f32 v122, v58, 0x41d00000, v59
v_fmamk_f32 v123, v58, 0x41d80000, v59
v_cos_f32 v120, v120
v_cos_f32 v121, v121
v_cos_f32 v122, v122
v_cos_f32 v123, v123
s_nop 0
cvtpk v94, v120, v121
cvtpk v95, v122, v123
v_fmamk_f32 v120, v58, 0x42000000, v59
v_fmamk_f32 v121, v58, 0x42040000, v59
v_fmamk_f32 v122, v58, 0x42080000, v59
v_fmamk_f32 v123, v58, 0x420c0000, v59
v_cos_f32 v120, v120
v_cos_f32 v121, v121
v_cos_f32 v122, v122
v_cos_f32 v123, v123
s_nop 0
cvtpk v96, v120, v121
cvtpk v97, v122, v123
v_fmamk_f32 v120, v58, 0x42200000, v59
v_fmamk_f32 v121, v58, 0x42240000, v59
v_fmamk_f32 v122, v58, 0x42280000, v59
v_fmamk_f32 v123, v58, 0x422c0000, v59
v_cos_f32 v120, v120
v_cos_f32 v121, v121
v_cos_f32 v122, v122
v_cos_f32 v123, v123
s_nop 0
cvtpk v98, v120, v121
cvtpk v99, v122, v123
v_fmamk_f32 v120, v58, 0x42400000, v59
v_fmamk_f32 v121, v58, 0x42440000, v59
v_fmamk_f32 v122, v58, 0x42480000, v59
v_fmamk_f32 v123, v58, 0x424c0000, v59
v_cos_f32 v120, v120
v_cos_f32 v121, v121
v_cos_f32 v122, v122
v_cos_f32 v123, v123
s_nop 0
cvtpk v100, v120, v121
cvtpk v101, v122, v123
v_fmamk_f32 v120, v58, 0x42600000, v59
v_fmamk_f32 v121, v58, 0x42640000, v59
v_fmamk_f32 v122, v58, 0x42680000, v59
v_fmamk_f32 v123, v58, 0x426c0000, v59
v_cos_f32 v120, v120
v_cos_f32 v121, v121
v_cos_f32 v122, v122
v_cos_f32 v123, v123
s_nop 0
cvtpk v102, v120, v121
cvtpk v103, v122, v123
v_add_f32 v59, 0xbe800000, v59
v_fmamk_f32 v120, v58, 0x00000000, v59
v_fmamk_f32 v121, v58, 0x3f800000, v59
v_fmamk_f32 v122, v58, 0x40000000, v59
v_fmamk_f32 v123, v58, 0x40400000, v59
v_cos_f32 v120, v120
v_cos_f32 v121, v121
v_cos_f32 v122, v122
v_cos_f32 v123, v123
s_nop 0
cvtpk v104, v120, v121
cvtpk v105, v122, v123
v_fmamk_f32 v120, v58, 0x41000000, v59
v_fmamk_f32 v121, v58, 0x41100000, v59
v_fmamk_f32 v122, v58, 0x41200000, v59
v_fmamk_f32 v123, v58, 0x41300000, v59
v_cos_f32 v120, v120
v_cos_f32 v121, v121
v_cos_f32 v122, v122
v_cos_f32 v123, v123
s_nop 0
cvtpk v106, v120, v121
cvtpk v107, v122, v123
v_fmamk_f32 v120, v58, 0x41800000, v59
v_fmamk_f32 v121, v58, 0x41880000, v59
v_fmamk_f32 v122, v58, 0x41900000, v59
v_fmamk_f32 v123, v58, 0x41980000, v59
v_cos_f32 v120, v120
v_cos_f32 v121, v121
v_cos_f32 v122, v122
v_cos_f32 v123, v123
s_nop 0
cvtpk v108, v120, v121
cvtpk v109, v122, v123
v_fmamk_f32 v120, v58, 0x41c00000, v59
v_fmamk_f32 v121, v58, 0x41c80000, v59
v_fmamk_f32 v122, v58, 0x41d00000, v59
v_fmamk_f32 v123, v58, 0x41d80000, v59
v_cos_f32 v120, v120
v_cos_f32 v121, v121
v_cos_f32 v122, v122
v_cos_f32 v123, v123
s_nop 0
cvtpk v110, v120, v121
cvtpk v111, v122, v123
v_fmamk_f32 v120, v58, 0x42000000, v59
v_fmamk_f32 v121, v58, 0x42040000, v59
v_fmamk_f32 v122, v58, 0x42080000, v59
v_fmamk_f32 v123, v58, 0x420c0000, v59
v_cos_f32 v120, v120
v_cos_f32 v121, v121
v_cos_f32 v122, v122
v_cos_f32 v123, v123
s_nop 0
cvtpk v112, v120, v121
cvtpk v113, v122, v123
v_fmamk_f32 v120, v58, 0x42200000, v59
v_fmamk_f32 v121, v58, 0x42240000, v59
v_fmamk_f32 v122, v58, 0x42280000, v59
v_fmamk_f32 v123, v58, 0x422c0000, v59
v_cos_f32 v120, v120
v_cos_f32 v121, v121
v_cos_f32 v122, v122
v_cos_f32 v123, v123
s_nop 0
cvtpk v114, v120, v121
cvtpk v115, v122, v123
v_fmamk_f32 v120, v58, 0x42400000, v59
v_fmamk_f32 v121, v58, 0x42440000, v59
v_fmamk_f32 v122, v58, 0x42480000, v59
v_fmamk_f32 v123, v58, 0x424c0000, v59
v_cos_f32 v120, v120
v_cos_f32 v121, v121
v_cos_f32 v122, v122
v_cos_f32 v123, v123
s_nop 0
cvtpk v116, v120, v121
cvtpk v117, v122, v123
v_fmamk_f32 v120, v58, 0x42600000, v59
v_fmamk_f32 v121, v58, 0x42640000, v59
v_fmamk_f32 v122, v58, 0x42680000, v59
v_fmamk_f32 v123, v58, 0x426c0000, v59
v_cos_f32 v120, v120
v_cos_f32 v121, v121
v_cos_f32 v122, v122
v_cos_f32 v123, v123
s_nop 0
cvtpk v118, v120, v121
cvtpk v119, v122, v123
v_add_u32 v61, s61, v56
v_add_u32 v62, 0, v61
v_add_u32 v61, 4096, v61
v_mul_f32 v58, 0x3a000000, v60
v_add_f32 v59, 0x42000000, v57
v_mul_f32 v59, v58, v59
v_fmamk_f32 v120, v58, 0x00000000, v59
v_cos_f32 v224, v120
v_sin_f32 v192, v120
v_fmamk_f32 v121, v58, 0x3f800000, v59
v_cos_f32 v225, v121
v_sin_f32 v193, v121
v_fmamk_f32 v120, v58, 0x40000000, v59
v_cos_f32 v226, v120
v_sin_f32 v194, v120
v_fmamk_f32 v121, v58, 0x40400000, v59
v_cos_f32 v227, v121
v_sin_f32 v195, v121
v_fmamk_f32 v120, v58, 0x41000000, v59
v_cos_f32 v228, v120
v_sin_f32 v196, v120
v_fmamk_f32 v121, v58, 0x41100000, v59
v_cos_f32 v229, v121
v_sin_f32 v197, v121
v_fmamk_f32 v120, v58, 0x41200000, v59
v_cos_f32 v230, v120
v_sin_f32 v198, v120
v_fmamk_f32 v121, v58, 0x41300000, v59
v_cos_f32 v231, v121
v_sin_f32 v199, v121
v_fmamk_f32 v120, v58, 0x41800000, v59
v_cos_f32 v232, v120
v_sin_f32 v208, v120
v_fmamk_f32 v121, v58, 0x41880000, v59
v_cos_f32 v233, v121
v_sin_f32 v209, v121
v_fmamk_f32 v120, v58, 0x41900000, v59
v_cos_f32 v234, v120
v_sin_f32 v210, v120
v_fmamk_f32 v121, v58, 0x41980000, v59
v_cos_f32 v235, v121
v_sin_f32 v211, v121
v_fmamk_f32 v120, v58, 0x41c00000, v59
v_cos_f32 v236, v120
v_sin_f32 v212, v120
v_fmamk_f32 v121, v58, 0x41c80000, v59
v_cos_f32 v237, v121
v_sin_f32 v213, v121
v_fmamk_f32 v120, v58, 0x41d00000, v59
v_cos_f32 v238, v120
v_sin_f32 v214, v120
v_fmamk_f32 v121, v58, 0x41d80000, v59
v_cos_f32 v239, v121
v_sin_f32 v215, v121
v_mul_f32 v58, 0x3a000000, v63
v_mul_f32 v59, v58, v57
s_waitcnt vmcnt(12)
mf32 v[160:175], v[16:19], v[64:67], 0
mf32 v[160:175], v[20:23], v[68:71], v[160:175]
mf32 v[160:175], v[24:27], v[72:75], v[160:175]
mf32 v[160:175], v[28:31], v[76:79], v[160:175]
mf32 v[176:191], v[24:27], v[64:67], 0
mf32 v[176:191], v[28:31], v[68:71], v[176:191]
mf32 v[176:191], v[16:19], v[80:83], v[176:191]
mf32 v[176:191], v[20:23], v[84:87], v[176:191]
s_nop 11
v_mul_f32 v120, v160, v192
v_mul_f32 v160, v160, v224
v_fma_f32 v160, v176, v192, v160
v_fma_f32 v176, v176, v224, -v120
v_mul_f32 v120, v161, v193
v_mul_f32 v161, v161, v225
v_fma_f32 v161, v177, v193, v161
v_fma_f32 v177, v177, v225, -v120
v_mul_f32 v120, v162, v194
v_mul_f32 v162, v162, v226
v_fma_f32 v162, v178, v194, v162
v_fma_f32 v178, v178, v226, -v120
v_mul_f32 v120, v163, v195
v_mul_f32 v163, v163, v227
v_fma_f32 v163, v179, v195, v163
v_fma_f32 v179, v179, v227, -v120
v_mul_f32 v120, v164, v196
v_mul_f32 v164, v164, v228
v_fma_f32 v164, v180, v196, v164
v_fma_f32 v180, v180, v228, -v120
v_mul_f32 v120, v165, v197
v_mul_f32 v165, v165, v229
v_fma_f32 v165, v181, v197, v165
v_fma_f32 v181, v181, v229, -v120
v_mul_f32 v120, v166, v198
v_mul_f32 v166, v166, v230
v_fma_f32 v166, v182, v198, v166
v_fma_f32 v182, v182, v230, -v120
v_mul_f32 v120, v167, v199
v_mul_f32 v167, v167, v231
v_fma_f32 v167, v183, v199, v167
v_fma_f32 v183, v183, v231, -v120
v_mul_f32 v120, v168, v208
v_mul_f32 v168, v168, v232
v_fma_f32 v168, v184, v208, v168
v_fma_f32 v184, v184, v232, -v120
v_mul_f32 v120, v169, v209
v_mul_f32 v169, v169, v233
v_fma_f32 v169, v185, v209, v169
v_fma_f32 v185, v185, v233, -v120
v_mul_f32 v120, v170, v210
v_mul_f32 v170, v170, v234
v_fma_f32 v170, v186, v210, v170
v_fma_f32 v186, v186, v234, -v120
v_mul_f32 v120, v171, v211
v_mul_f32 v171, v171, v235
v_fma_f32 v171, v187, v211, v171
v_fma_f32 v187, v187, v235, -v120
v_mul_f32 v120, v172, v212
v_mul_f32 v172, v172, v236
v_fma_f32 v172, v188, v212, v172
v_fma_f32 v188, v188, v236, -v120
v_mul_f32 v120, v173, v213
v_mul_f32 v173, v173, v237
v_fma_f32 v173, v189, v213, v173
v_fma_f32 v189, v189, v237, -v120
v_mul_f32 v120, v174, v214
v_mul_f32 v174, v174, v238
v_fma_f32 v174, v190, v214, v174
v_fma_f32 v190, v190, v238, -v120
v_mul_f32 v120, v175, v215
v_mul_f32 v175, v175, v239
v_fma_f32 v175, v191, v215, v175
v_fma_f32 v191, v191, v239, -v120
cvtpk v200, v160, v161
cvtpk v201, v162, v163
cvtpk v202, v164, v165
cvtpk v203, v166, v167
cvtpk v204, v168, v169
cvtpk v205, v170, v171
cvtpk v206, v172, v173
cvtpk v207, v174, v175
cvtpk v216, v176, v177
cvtpk v217, v178, v179
cvtpk v218, v180, v181
cvtpk v219, v182, v183
cvtpk v220, v184, v185
cvtpk v221, v186, v187
cvtpk v222, v188, v189
cvtpk v223, v190, v191
ds_write_b128 v61, v[200:203] offset:0
ds_write_b128 v61, v[204:207] offset:1024
ds_write_b128 v61, v[216:219] offset:2048
ds_write_b128 v61, v[220:223] offset:3072
s_waitcnt lgkmcnt(0)
v_mov_b32 v125, 1
ds_write_b32 v124, v125 offset:4
attn_kernel_spin_3:
ds_read_b32 v126, v124 offset:0
s_waitcnt lgkmcnt(0)
v_readfirstlane_b32 s67, v126
s_nop 0
s_cmp_lt_u32 s67, 1
s_cbranch_scc1 attn_kernel_spin_3
ds_read_b128 v[192:195], v62 offset:0
ds_read_b128 v[196:199], v62 offset:1024
ds_read_b128 v[208:211], v62 offset:2048
ds_read_b128 v[212:215], v62 offset:3072
v_xor_b32 v232, 0x80008000, v200
v_xor_b32 v233, 0x80008000, v201
v_xor_b32 v234, 0x80008000, v202
v_xor_b32 v235, 0x80008000, v203
v_xor_b32 v236, 0x80008000, v204
v_xor_b32 v237, 0x80008000, v205
v_xor_b32 v238, 0x80008000, v206
v_xor_b32 v239, 0x80008000, v207
s_waitcnt lgkmcnt(0)
v_xor_b32 v224, 0x80008000, v192
v_xor_b32 v225, 0x80008000, v193
v_xor_b32 v226, 0x80008000, v194
v_xor_b32 v227, 0x80008000, v195
v_xor_b32 v228, 0x80008000, v196
v_xor_b32 v229, 0x80008000, v197
v_xor_b32 v230, 0x80008000, v198
v_xor_b32 v231, 0x80008000, v199
s_nop 1
mf32 v[160:175], v[88:91], v[192:195], 0
v_fmamk_f32 v120, v58, 0x00000000, v59
v_cos_f32 v16, v120
v_sin_f32 v240, v120
mf32 v[160:175], v[92:95], v[196:199], v[160:175]
v_fmamk_f32 v121, v58, 0x3f800000, v59
v_cos_f32 v17, v121
v_sin_f32 v241, v121
mf32 v[160:175], v[96:99], v[200:203], v[160:175]
v_fmamk_f32 v120, v58, 0x40000000, v59
v_cos_f32 v18, v120
v_sin_f32 v242, v120
mf32 v[160:175], v[100:103], v[204:207], v[160:175]
v_fmamk_f32 v121, v58, 0x40400000, v59
v_cos_f32 v19, v121
v_sin_f32 v243, v121
mf32 v[160:175], v[104:107], v[208:211], v[160:175]
v_fmamk_f32 v120, v58, 0x41000000, v59
v_cos_f32 v20, v120
v_sin_f32 v244, v120
mf32 v[160:175], v[108:111], v[212:215], v[160:175]
v_fmamk_f32 v121, v58, 0x41100000, v59
v_cos_f32 v21, v121
v_sin_f32 v245, v121
mf32 v[160:175], v[112:115], v[216:219], v[160:175]
v_fmamk_f32 v120, v58, 0x41200000, v59
v_cos_f32 v22, v120
v_sin_f32 v246, v120
mf32 v[160:175], v[116:119], v[220:223], v[160:175]
v_fmamk_f32 v121, v58, 0x41300000, v59
v_cos_f32 v23, v121
v_sin_f32 v247, v121
mf32 v[176:191], v[88:91], v[208:211], 0
v_fmamk_f32 v120, v58, 0x41800000, v59
v_cos_f32 v24, v120
v_sin_f32 v248, v120
mf32 v[176:191], v[92:95], v[212:215], v[176:191]
v_fmamk_f32 v121, v58, 0x41880000, v59
v_cos_f32 v25, v121
v_sin_f32 v249, v121
mf32 v[176:191], v[96:99], v[216:219], v[176:191]
v_fmamk_f32 v120, v58, 0x41900000, v59
v_cos_f32 v26, v120
v_sin_f32 v250, v120
mf32 v[176:191], v[100:103], v[220:223], v[176:191]
v_fmamk_f32 v121, v58, 0x41980000, v59
v_cos_f32 v27, v121
v_sin_f32 v251, v121
mf32 v[176:191], v[104:107], v[224:227], v[176:191]
v_fmamk_f32 v120, v58, 0x41c00000, v59
v_cos_f32 v28, v120
v_sin_f32 v252, v120
mf32 v[176:191], v[108:111], v[228:231], v[176:191]
v_fmamk_f32 v121, v58, 0x41c80000, v59
v_cos_f32 v29, v121
v_sin_f32 v253, v121
mf32 v[176:191], v[112:115], v[232:235], v[176:191]
v_fmamk_f32 v120, v58, 0x41d00000, v59
v_cos_f32 v30, v120
v_sin_f32 v254, v120
mf32 v[176:191], v[116:119], v[236:239], v[176:191]
v_fmamk_f32 v121, v58, 0x41d80000, v59
v_cos_f32 v31, v121
v_sin_f32 v255, v121
s_waitcnt vmcnt(8)
v_mul_f32 v16, s66, v16
v_mul_f32 v17, s66, v17
v_mul_f32 v18, s66, v18
v_mul_f32 v19, s66, v19
v_mul_f32 v20, s66, v20
v_mul_f32 v21, s66, v21
v_mul_f32 v22, s66, v22
v_mul_f32 v23, s66, v23
v_mul_f32 v24, s66, v24
v_mul_f32 v25, s66, v25
v_mul_f32 v26, s66, v26
v_mul_f32 v27, s66, v27
v_lshlrev_b32 v120, 16, v32
v_lshlrev_b32 v121, 16, v40
v_mul_f32 v122, v160, v121
v_mul_f32 v160, v160, v120
v_fma_f32 v160, -v176, v121, v160
v_fma_f32 v176, v176, v120, v122
v_and_b32 v120, 0xffff0000, v32
v_and_b32 v121, 0xffff0000, v40
v_mul_f32 v122, v161, v121
v_mul_f32 v161, v161, v120
v_fma_f32 v161, -v177, v121, v161
v_fma_f32 v177, v177, v120, v122
v_lshlrev_b32 v120, 16, v33
v_lshlrev_b32 v121, 16, v41
v_mul_f32 v122, v162, v121
v_mul_f32 v162, v162, v120
v_fma_f32 v162, -v178, v121, v162
v_fma_f32 v178, v178, v120, v122
v_and_b32 v120, 0xffff0000, v33
v_and_b32 v121, 0xffff0000, v41
v_mul_f32 v122, v163, v121
v_mul_f32 v163, v163, v120
v_fma_f32 v163, -v179, v121, v163
v_fma_f32 v179, v179, v120, v122
v_lshlrev_b32 v120, 16, v34
v_lshlrev_b32 v121, 16, v42
v_mul_f32 v122, v164, v121
v_mul_f32 v164, v164, v120
v_fma_f32 v164, -v180, v121, v164
v_fma_f32 v180, v180, v120, v122
v_and_b32 v120, 0xffff0000, v34
v_and_b32 v121, 0xffff0000, v42
v_mul_f32 v122, v165, v121
v_mul_f32 v165, v165, v120
v_fma_f32 v165, -v181, v121, v165
v_fma_f32 v181, v181, v120, v122
v_lshlrev_b32 v120, 16, v35
v_lshlrev_b32 v121, 16, v43
v_mul_f32 v122, v166, v121
v_mul_f32 v166, v166, v120
v_fma_f32 v166, -v182, v121, v166
v_fma_f32 v182, v182, v120, v122
v_and_b32 v120, 0xffff0000, v35
v_and_b32 v121, 0xffff0000, v43
v_mul_f32 v122, v167, v121
v_mul_f32 v167, v167, v120
v_fma_f32 v167, -v183, v121, v167
v_fma_f32 v183, v183, v120, v122
v_lshlrev_b32 v120, 16, v36
v_lshlrev_b32 v121, 16, v44
v_mul_f32 v122, v168, v121
v_mul_f32 v168, v168, v120
v_fma_f32 v168, -v184, v121, v168
v_fma_f32 v184, v184, v120, v122
v_and_b32 v120, 0xffff0000, v36
v_and_b32 v121, 0xffff0000, v44
v_mul_f32 v122, v169, v121
v_mul_f32 v169, v169, v120
v_fma_f32 v169, -v185, v121, v169
v_fma_f32 v185, v185, v120, v122
v_lshlrev_b32 v120, 16, v37
v_lshlrev_b32 v121, 16, v45
v_mul_f32 v122, v170, v121
v_mul_f32 v170, v170, v120
v_fma_f32 v170, -v186, v121, v170
v_fma_f32 v186, v186, v120, v122
v_and_b32 v120, 0xffff0000, v37
v_and_b32 v121, 0xffff0000, v45
v_mul_f32 v122, v171, v121
v_mul_f32 v171, v171, v120
v_fma_f32 v171, -v187, v121, v171
v_fma_f32 v187, v187, v120, v122
v_lshlrev_b32 v120, 16, v38
v_lshlrev_b32 v121, 16, v46
v_mul_f32 v122, v172, v121
v_mul_f32 v172, v172, v120
v_fma_f32 v172, -v188, v121, v172
v_fma_f32 v188, v188, v120, v122
v_and_b32 v120, 0xffff0000, v38
v_and_b32 v121, 0xffff0000, v46
v_mul_f32 v122, v173, v121
v_mul_f32 v173, v173, v120
v_fma_f32 v173, -v189, v121, v173
v_fma_f32 v189, v189, v120, v122
v_lshlrev_b32 v120, 16, v39
v_lshlrev_b32 v121, 16, v47
v_mul_f32 v122, v174, v121
v_mul_f32 v174, v174, v120
v_fma_f32 v174, -v190, v121, v174
v_fma_f32 v190, v190, v120, v122
v_and_b32 v120, 0xffff0000, v39
v_and_b32 v121, 0xffff0000, v47
v_mul_f32 v122, v175, v121
v_mul_f32 v175, v175, v120
v_fma_f32 v175, -v191, v121, v175
v_fma_f32 v191, v191, v120, v122
cvtpk v200, v160, v161
cvtpk v201, v162, v163
cvtpk v202, v164, v165
cvtpk v203, v166, v167
cvtpk v204, v168, v169
cvtpk v205, v170, v171
cvtpk v206, v172, v173
cvtpk v207, v174, v175
cvtpk v216, v176, v177
cvtpk v217, v178, v179
cvtpk v218, v180, v181
cvtpk v219, v182, v183
cvtpk v220, v184, v185
cvtpk v221, v186, v187
cvtpk v222, v188, v189
cvtpk v223, v190, v191
ds_write_b128 v61, v[200:203] offset:8192
ds_write_b128 v61, v[204:207] offset:9216
ds_write_b128 v61, v[216:219] offset:10240
ds_write_b128 v61, v[220:223] offset:11264
s_waitcnt lgkmcnt(0)
v_mov_b32 v125, 2
ds_write_b32 v124, v125 offset:4
attn_kernel_spin_4:
ds_read_b32 v126, v124 offset:0
s_waitcnt lgkmcnt(0)
v_readfirstlane_b32 s67, v126
s_nop 0
s_cmp_lt_u32 s67, 2
s_cbranch_scc1 attn_kernel_spin_4
ds_read_b128 v[192:195], v62 offset:8192
ds_read_b128 v[196:199], v62 offset:9216
ds_read_b128 v[208:211], v62 offset:10240
ds_read_b128 v[212:215], v62 offset:11264
v_xor_b32 v232, 0x80008000, v216
v_xor_b32 v233, 0x80008000, v217
v_xor_b32 v234, 0x80008000, v218
v_xor_b32 v235, 0x80008000, v219
v_xor_b32 v236, 0x80008000, v220
v_xor_b32 v237, 0x80008000, v221
v_xor_b32 v238, 0x80008000, v222
v_xor_b32 v239, 0x80008000, v223
s_waitcnt lgkmcnt(0)
v_xor_b32 v224, 0x80008000, v208
v_xor_b32 v225, 0x80008000, v209
v_xor_b32 v226, 0x80008000, v210
v_xor_b32 v227, 0x80008000, v211
v_xor_b32 v228, 0x80008000, v212
v_xor_b32 v229, 0x80008000, v213
v_xor_b32 v230, 0x80008000, v214
v_xor_b32 v231, 0x80008000, v215
s_nop 1
mf32 v[160:175], v[192:195], v[88:91], 0
v_mul_f32 v28, s66, v28
v_mul_f32 v29, s66, v29
v_mul_f32 v30, s66, v30
mf32 v[160:175], v[196:199], v[92:95], v[160:175]
v_mul_f32 v31, s66, v31
v_mul_f32 v240, s66, v240
v_mul_f32 v241, s66, v241
mf32 v[160:175], v[200:203], v[96:99], v[160:175]
v_mul_f32 v242, s66, v242
v_mul_f32 v243, s66, v243
v_mul_f32 v244, s66, v244
mf32 v[160:175], v[204:207], v[100:103], v[160:175]
v_mul_f32 v245, s66, v245
v_mul_f32 v246, s66, v246
v_mul_f32 v247, s66, v247
mf32 v[160:175], v[224:227], v[104:107], v[160:175]
v_mul_f32 v248, s66, v248
v_mul_f32 v249, s66, v249
v_mul_f32 v250, s66, v250
mf32 v[160:175], v[228:231], v[108:111], v[160:175]
v_mul_f32 v251, s66, v251
v_mul_f32 v252, s66, v252
v_mul_f32 v253, s66, v253
mf32 v[160:175], v[232:235], v[112:115], v[160:175]
v_mul_f32 v254, s66, v254
v_mul_f32 v255, s66, v255
mf32 v[160:175], v[236:239], v[116:119], v[160:175]
mf32 v[176:191], v[208:211], v[88:91], 0
mf32 v[176:191], v[212:215], v[92:95], v[176:191]
mf32 v[176:191], v[216:219], v[96:99], v[176:191]
mf32 v[176:191], v[220:223], v[100:103], v[176:191]
mf32 v[176:191], v[192:195], v[104:107], v[176:191]
mf32 v[176:191], v[196:199], v[108:111], v[176:191]
mf32 v[176:191], v[200:203], v[112:115], v[176:191]
mf32 v[176:191], v[204:207], v[116:119], v[176:191]
s_nop 11
v_mul_f32 v120, v160, v240
v_mul_f32 v160, v160, v16
v_fma_f32 v160, -v176, v240, v160
v_fma_f32 v176, v176, v16, v120
v_mul_f32 v120, v161, v241
v_mul_f32 v161, v161, v17
v_fma_f32 v161, -v177, v241, v161
v_fma_f32 v177, v177, v17, v120
v_mul_f32 v120, v162, v242
v_mul_f32 v162, v162, v18
v_fma_f32 v162, -v178, v242, v162
v_fma_f32 v178, v178, v18, v120
v_mul_f32 v120, v163, v243
v_mul_f32 v163, v163, v19
v_fma_f32 v163, -v179, v243, v163
v_fma_f32 v179, v179, v19, v120
v_mul_f32 v120, v164, v244
v_mul_f32 v164, v164, v20
v_fma_f32 v164, -v180, v244, v164
v_fma_f32 v180, v180, v20, v120
v_mul_f32 v120, v165, v245
v_mul_f32 v165, v165, v21
v_fma_f32 v165, -v181, v245, v165
v_fma_f32 v181, v181, v21, v120
v_mul_f32 v120, v166, v246
v_mul_f32 v166, v166, v22
v_fma_f32 v166, -v182, v246, v166
v_fma_f32 v182, v182, v22, v120
v_mul_f32 v120, v167, v247
v_mul_f32 v167, v167, v23
v_fma_f32 v167, -v183, v247, v167
v_fma_f32 v183, v183, v23, v120
v_mul_f32 v120, v168, v248
v_mul_f32 v168, v168, v24
v_fma_f32 v168, -v184, v248, v168
v_fma_f32 v184, v184, v24, v120
v_mul_f32 v120, v169, v249
v_mul_f32 v169, v169, v25
v_fma_f32 v169, -v185, v249, v169
v_fma_f32 v185, v185, v25, v120
v_mul_f32 v120, v170, v250
v_mul_f32 v170, v170, v26
v_fma_f32 v170, -v186, v250, v170
v_fma_f32 v186, v186, v26, v120
v_mul_f32 v120, v171, v251
v_mul_f32 v171, v171, v27
v_fma_f32 v171, -v187, v251, v171
v_fma_f32 v187, v187, v27, v120
v_mul_f32 v120, v172, v252
v_mul_f32 v172, v172, v28
v_fma_f32 v172, -v188, v252, v172
v_fma_f32 v188, v188, v28, v120
v_mul_f32 v120, v173, v253
v_mul_f32 v173, v173, v29
v_fma_f32 v173, -v189, v253, v173
v_fma_f32 v189, v189, v29, v120
v_mul_f32 v120, v174, v254
v_mul_f32 v174, v174, v30
v_fma_f32 v174, -v190, v254, v174
v_fma_f32 v190, v190, v30, v120
v_mul_f32 v120, v175, v255
v_mul_f32 v175, v175, v31
v_fma_f32 v175, -v191, v255, v175
v_fma_f32 v191, v191, v31, v120
cvtpk v192, v160, v161
cvtpk v193, v162, v163
cvtpk v194, v164, v165
cvtpk v195, v166, v167
cvtpk v196, v168, v169
cvtpk v197, v170, v171
cvtpk v198, v172, v173
cvtpk v199, v174, v175
cvtpk v208, v176, v177
cvtpk v209, v178, v179
cvtpk v210, v180, v181
cvtpk v211, v182, v183
cvtpk v212, v184, v185
cvtpk v213, v186, v187
cvtpk v214, v188, v189
cvtpk v215, v190, v191
s_nop 1
mf32 v[160:175], v[64:67], v[192:195], 0
mf32 v[160:175], v[68:71], v[196:199], v[160:175]
mf32 v[160:175], v[80:83], v[208:211], v[160:175]
mf32 v[160:175], v[84:87], v[212:215], v[160:175]
mf32 v[176:191], v[64:67], v[208:211], 0
mf32 v[176:191], v[68:71], v[212:215], v[176:191]
mf32 v[176:191], v[72:75], v[192:195], v[176:191]
mf32 v[176:191], v[76:79], v[196:199], v[176:191]
s_nop 7
cvtpk v16, v160, v161
cvtpk v17, v162, v163
cvtpk v18, v164, v165
cvtpk v19, v166, v167
cvtpk v20, v168, v169
cvtpk v21, v170, v171
cvtpk v22, v172, v173
cvtpk v23, v174, v175
s_nop 3
cvtpk v24, v176, v177
cvtpk v25, v178, v179
cvtpk v26, v180, v181
cvtpk v27, v182, v183
cvtpk v28, v184, v185
cvtpk v29, v186, v187
cvtpk v30, v188, v189
cvtpk v31, v190, v191
buffer_store_dwordx4 v[16:19], v56, s[56:59], s64 offen offset:0
buffer_store_dwordx4 v[20:23], v56, s[56:59], s64 offen offset:1024
buffer_store_dwordx4 v[24:27], v56, s[56:59], s65 offen offset:0
buffer_store_dwordx4 v[28:31], v56, s[56:59], s65 offen offset:1024
s_branch attn_kernel_b2done
attn_kernel_b2no:
v_mov_b32 v208, 0
v_mov_b32 v209, 0
v_mov_b32 v210, 0
v_mov_b32 v211, 0
v_mov_b32 v212, 0
v_mov_b32 v213, 0
v_mov_b32 v214, 0
v_mov_b32 v215, 0
v_mov_b32 v216, 0
v_mov_b32 v217, 0
v_mov_b32 v218, 0
v_mov_b32 v219, 0
v_mov_b32 v220, 0
v_mov_b32 v221, 0
v_mov_b32 v222, 0
v_mov_b32 v223, 0
s_cmp_lg_u32 s19, 1
s_cbranch_scc1 attn_kernel_L_nm1a
v_cmp_le_i32 vcc, 0, v12
s_nop 1
v_cndmask_b32 v208, v48, v208, vcc
v_cmp_le_i32 vcc, 1, v12
s_nop 1
v_cndmask_b32 v209, v48, v209, vcc
v_cmp_le_i32 vcc, 2, v12
s_nop 1
v_cndmask_b32 v210, v48, v210, vcc
v_cmp_le_i32 vcc, 3, v12
s_nop 1
v_cndmask_b32 v211, v48, v211, vcc
v_cmp_le_i32 vcc, 8, v12
s_nop 1
v_cndmask_b32 v212, v48, v212, vcc
v_cmp_le_i32 vcc, 9, v12
s_nop 1
v_cndmask_b32 v213, v48, v213, vcc
v_cmp_le_i32 vcc, 10, v12
s_nop 1
v_cndmask_b32 v214, v48, v214, vcc
v_cmp_le_i32 vcc, 11, v12
s_nop 1
v_cndmask_b32 v215, v48, v215, vcc
v_cmp_le_i32 vcc, 16, v12
s_nop 1
v_cndmask_b32 v216, v48, v216, vcc
v_cmp_le_i32 vcc, 17, v12
s_nop 1
v_cndmask_b32 v217, v48, v217, vcc
v_cmp_le_i32 vcc, 18, v12
s_nop 1
v_cndmask_b32 v218, v48, v218, vcc
v_cmp_le_i32 vcc, 19, v12
s_nop 1
v_cndmask_b32 v219, v48, v219, vcc
v_cmp_le_i32 vcc, 24, v12
s_nop 1
v_cndmask_b32 v220, v48, v220, vcc
v_cmp_le_i32 vcc, 25, v12
s_nop 1
v_cndmask_b32 v221, v48, v221, vcc
v_cmp_le_i32 vcc, 26, v12
s_nop 1
v_cndmask_b32 v222, v48, v222, vcc
v_cmp_le_i32 vcc, 27, v12
s_nop 1
v_cndmask_b32 v223, v48, v223, vcc
s_nop 1
attn_kernel_L_nm1a:
buffer_load_dwordx4 v[128:131], v1, s[32:35], s12 offen offset:0
buffer_load_dwordx4 v[132:135], v1, s[32:35], s12 offen offset:1024
buffer_load_dwordx4 v[136:139], v1, s[32:35], s12 offen offset:2048
buffer_load_dwordx4 v[140:143], v1, s[32:35], s12 offen offset:3072
buffer_load_dwordx4 v[144:147], v1, s[32:35], s13 offen offset:0
buffer_load_dwordx4 v[148:151], v1, s[32:35], s13 offen offset:1024
buffer_load_dwordx4 v[152:155], v1, s[32:35], s13 offen offset:2048
buffer_load_dwordx4 v[156:159], v1, s[32:35], s13 offen offset:3072
s_waitcnt vmcnt(0)
s_branch attn_kernel_b2join
attn_kernel_b2done:
v_mov_b32 v208, 0
v_mov_b32 v209, 0
v_mov_b32 v210, 0
v_mov_b32 v211, 0
v_mov_b32 v212, 0
v_mov_b32 v213, 0
v_mov_b32 v214, 0
v_mov_b32 v215, 0
v_mov_b32 v216, 0
v_mov_b32 v217, 0
v_mov_b32 v218, 0
v_mov_b32 v219, 0
v_mov_b32 v220, 0
v_mov_b32 v221, 0
v_mov_b32 v222, 0
v_mov_b32 v223, 0
s_cmp_lg_u32 s19, 1
s_cbranch_scc1 attn_kernel_L_nm1b
v_cmp_le_i32 vcc, 0, v12
s_nop 1
v_cndmask_b32 v208, v48, v208, vcc
v_cmp_le_i32 vcc, 1, v12
s_nop 1
v_cndmask_b32 v209, v48, v209, vcc
v_cmp_le_i32 vcc, 2, v12
s_nop 1
v_cndmask_b32 v210, v48, v210, vcc
v_cmp_le_i32 vcc, 3, v12
s_nop 1
v_cndmask_b32 v211, v48, v211, vcc
v_cmp_le_i32 vcc, 8, v12
s_nop 1
v_cndmask_b32 v212, v48, v212, vcc
v_cmp_le_i32 vcc, 9, v12
s_nop 1
v_cndmask_b32 v213, v48, v213, vcc
v_cmp_le_i32 vcc, 10, v12
s_nop 1
v_cndmask_b32 v214, v48, v214, vcc
v_cmp_le_i32 vcc, 11, v12
s_nop 1
v_cndmask_b32 v215, v48, v215, vcc
v_cmp_le_i32 vcc, 16, v12
s_nop 1
v_cndmask_b32 v216, v48, v216, vcc
v_cmp_le_i32 vcc, 17, v12
s_nop 1
v_cndmask_b32 v217, v48, v217, vcc
v_cmp_le_i32 vcc, 18, v12
s_nop 1
v_cndmask_b32 v218, v48, v218, vcc
v_cmp_le_i32 vcc, 19, v12
s_nop 1
v_cndmask_b32 v219, v48, v219, vcc
v_cmp_le_i32 vcc, 24, v12
s_nop 1
v_cndmask_b32 v220, v48, v220, vcc
v_cmp_le_i32 vcc, 25, v12
s_nop 1
v_cndmask_b32 v221, v48, v221, vcc
v_cmp_le_i32 vcc, 26, v12
s_nop 1
v_cndmask_b32 v222, v48, v222, vcc
v_cmp_le_i32 vcc, 27, v12
s_nop 1
v_cndmask_b32 v223, v48, v223, vcc
s_nop 1
attn_kernel_L_nm1b:
s_waitcnt vmcnt(4)
attn_kernel_b2join:
v_mov_b32 v4, 0
v_mov_b32 v5, 0
v_add_u32 v2, 0x8000, v1
v_mov_b32 v3, v1
s_barrier
ds_read_b128 v[224:227], v1 offset:0
ds_read_b128 v[228:231], v1 offset:1024
ds_read_b128 v[232:235], v1 offset:2048
ds_read_b128 v[236:239], v1 offset:3072
ds_read_b128 v[240:243], v1 offset:4096
ds_read_b128 v[244:247], v1 offset:5120
ds_read_b128 v[248:251], v1 offset:6144
ds_read_b128 v[252:255], v1 offset:7168
s_waitcnt lgkmcnt(4)
mf32 v[160:175], v[224:227], v[128:131], v[208:223]
ds_read_b128 v[224:227], v1 offset:16384
v_mov_b32 v64, 0
v_mov_b32 v65, 0
v_mov_b32 v66, 0
v_mov_b32 v67, 0
v_mov_b32 v68, 0
mf32 v[160:175], v[228:231], v[132:135], v[160:175]
ds_read_b128 v[228:231], v1 offset:17408
v_mov_b32 v69, 0
v_mov_b32 v70, 0
v_mov_b32 v71, 0
v_mov_b32 v72, 0
v_mov_b32 v73, 0
mf32 v[160:175], v[232:235], v[136:139], v[160:175]
ds_read_b128 v[232:235], v1 offset:18432
v_mov_b32 v74, 0
v_mov_b32 v75, 0
v_mov_b32 v76, 0
v_mov_b32 v77, 0
v_mov_b32 v78, 0
mf32 v[160:175], v[236:239], v[140:143], v[160:175]
ds_read_b128 v[236:239], v1 offset:19456
v_mov_b32 v79, 0
v_mov_b32 v80, 0
v_mov_b32 v81, 0
v_mov_b32 v82, 0
v_mov_b32 v83, 0
s_waitcnt lgkmcnt(4)
mf32 v[160:175], v[240:243], v[144:147], v[160:175]
ds_read_b128 v[240:243], v1 offset:20480
v_mov_b32 v84, 0
v_mov_b32 v85, 0
v_mov_b32 v86, 0
v_mov_b32 v87, 0
v_mov_b32 v88, 0
mf32 v[160:175], v[244:247], v[148:151], v[160:175]
ds_read_b128 v[244:247], v1 offset:21504
v_mov_b32 v89, 0
v_mov_b32 v90, 0
v_mov_b32 v91, 0
v_mov_b32 v92, 0
v_mov_b32 v93, 0
mf32 v[160:175], v[248:251], v[152:155], v[160:175]
ds_read_b128 v[248:251], v1 offset:22528
v_mov_b32 v94, 0
v_mov_b32 v95, 0
v_mov_b32 v96, 0
v_mov_b32 v97, 0
v_mov_b32 v98, 0
mf32 v[160:175], v[252:255], v[156:159], v[160:175]
ds_read_b128 v[252:255], v1 offset:23552
v_mov_b32 v99, 0
v_mov_b32 v100, 0
v_mov_b32 v101, 0
v_mov_b32 v102, 0
v_mov_b32 v103, 0
v_mov_b32 v104, 0
v_mov_b32 v105, 0
v_mov_b32 v106, 0
v_mov_b32 v107, 0
v_mov_b32 v108, 0
v_mov_b32 v109, 0
v_mov_b32 v110, 0
v_mov_b32 v111, 0
v_mov_b32 v112, 0
v_mov_b32 v113, 0
v_mov_b32 v114, 0
v_mov_b32 v115, 0
v_mov_b32 v116, 0
v_mov_b32 v117, 0
v_mov_b32 v118, 0
v_mov_b32 v119, 0
v_mov_b32 v120, 0
v_mov_b32 v121, 0
v_mov_b32 v122, 0
v_mov_b32 v123, 0
v_mov_b32 v124, 0
v_mov_b32 v125, 0
v_mov_b32 v126, 0
v_mov_b32 v127, 0
v_max3_f32 v13, v160, v161, v162
v_max3_f32 v13, v13, v163, v164
v_max3_f32 v13, v13, v165, v166
v_max3_f32 v13, v13, v167, v168
v_max3_f32 v13, v13, v169, v170
v_max3_f32 v13, v13, v171, v172
v_max3_f32 v13, v13, v173, v174
v_max_f32 v13, v13, v175
v_mov_b32 v15, v13
s_nop 1
v_permlane32_swap_b32 v13, v15
v_max_f32 v13, v13, v15
v_sub_f32 v160, v160, v13
v_sub_f32 v161, v161, v13
v_sub_f32 v162, v162, v13
v_sub_f32 v163, v163, v13
v_sub_f32 v164, v164, v13
v_sub_f32 v165, v165, v13
v_sub_f32 v166, v166, v13
v_sub_f32 v167, v167, v13
v_sub_f32 v168, v168, v13
v_sub_f32 v169, v169, v13
v_sub_f32 v170, v170, v13
v_sub_f32 v171, v171, v13
v_sub_f32 v172, v172, v13
v_sub_f32 v173, v173, v13
v_sub_f32 v174, v174, v13
v_sub_f32 v175, v175, v13
v_sub_f32 v208, 0, v13
v_sub_f32 v209, 0, v13
v_sub_f32 v210, 0, v13
v_sub_f32 v211, 0, v13
v_sub_f32 v212, 0, v13
v_sub_f32 v213, 0, v13
v_sub_f32 v214, 0, v13
v_sub_f32 v215, 0, v13
v_sub_f32 v216, 0, v13
v_sub_f32 v217, 0, v13
v_sub_f32 v218, 0, v13
v_sub_f32 v219, 0, v13
v_sub_f32 v220, 0, v13
v_sub_f32 v221, 0, v13
v_sub_f32 v222, 0, v13
v_sub_f32 v223, 0, v13
s_mov_b32 s21, 0
s_sub_u32 s20, s19, 3
s_cbranch_scc0 attn_kernel_L_first
s_mov_b32 s21, 3
s_mov_b32 s20, 0
s_cmp_lg_u32 s19, 2
s_cbranch_scc1 attn_kernel_L_first
s_mov_b32 s21, 1
v_cmp_le_i32 vcc, 0, v12
s_nop 1
v_cndmask_b32 v208, v48, v208, vcc
v_cmp_le_i32 vcc, 1, v12
s_nop 1
v_cndmask_b32 v209, v48, v209, vcc
v_cmp_le_i32 vcc, 2, v12
s_nop 1
v_cndmask_b32 v210, v48, v210, vcc
v_cmp_le_i32 vcc, 3, v12
s_nop 1
v_cndmask_b32 v211, v48, v211, vcc
v_cmp_le_i32 vcc, 8, v12
s_nop 1
v_cndmask_b32 v212, v48, v212, vcc
v_cmp_le_i32 vcc, 9, v12
s_nop 1
v_cndmask_b32 v213, v48, v213, vcc
v_cmp_le_i32 vcc, 10, v12
s_nop 1
v_cndmask_b32 v214, v48, v214, vcc
v_cmp_le_i32 vcc, 11, v12
s_nop 1
v_cndmask_b32 v215, v48, v215, vcc
v_cmp_le_i32 vcc, 16, v12
s_nop 1
v_cndmask_b32 v216, v48, v216, vcc
v_cmp_le_i32 vcc, 17, v12
s_nop 1
v_cndmask_b32 v217, v48, v217, vcc
v_cmp_le_i32 vcc, 18, v12
s_nop 1
v_cndmask_b32 v218, v48, v218, vcc
v_cmp_le_i32 vcc, 19, v12
s_nop 1
v_cndmask_b32 v219, v48, v219, vcc
v_cmp_le_i32 vcc, 24, v12
s_nop 1
v_cndmask_b32 v220, v48, v220, vcc
v_cmp_le_i32 vcc, 25, v12
s_nop 1
v_cndmask_b32 v221, v48, v221, vcc
v_cmp_le_i32 vcc, 26, v12
s_nop 1
v_cndmask_b32 v222, v48, v222, vcc
v_cmp_le_i32 vcc, 27, v12
s_nop 1
v_cndmask_b32 v223, v48, v223, vcc
s_nop 1
attn_kernel_L_first:
s_waitcnt lgkmcnt(0)
s_barrier
s_sub_u32 s41, s41, 1
mf32 v[176:191], v[224:227], v[128:131], v[208:223]
ds_read_b128 v[224:227], v2 offset:0
v_exp_f32 v50, v160
v_exp_f32 v51, v161
s_nop 0
v_add_f32 v5, v5, v50
v_add_f32 v5, v5, v51
cvtpk v192, v50, v51
mf32 v[176:191], v[228:231], v[132:135], v[176:191]
ds_read_b128 v[228:231], v2 offset:1024
v_exp_f32 v52, v162
v_exp_f32 v53, v163
s_nop 0
v_add_f32 v5, v5, v52
v_add_f32 v5, v5, v53
cvtpk v193, v52, v53
mf32 v[176:191], v[232:235], v[136:139], v[176:191]
ds_read_b128 v[232:235], v2 offset:2048
v_exp_f32 v54, v164
v_exp_f32 v55, v165
s_nop 0
v_add_f32 v5, v5, v54
v_add_f32 v5, v5, v55
cvtpk v194, v54, v55
mf32 v[176:191], v[236:239], v[140:143], v[176:191]
ds_read_b128 v[236:239], v2 offset:3072
v_exp_f32 v50, v166
v_exp_f32 v51, v167
s_nop 0
v_add_f32 v5, v5, v50
v_add_f32 v5, v5, v51
cvtpk v195, v50, v51
mf32 v[176:191], v[240:243], v[144:147], v[176:191]
ds_read_b128 v[240:243], v2 offset:4096
v_exp_f32 v52, v168
v_exp_f32 v53, v169
s_nop 0
v_add_f32 v5, v5, v52
v_add_f32 v5, v5, v53
cvtpk v196, v52, v53
mf32 v[176:191], v[244:247], v[148:151], v[176:191]
ds_read_b128 v[244:247], v2 offset:5120
v_exp_f32 v54, v170
v_exp_f32 v55, v171
s_nop 0
v_add_f32 v5, v5, v54
v_add_f32 v5, v5, v55
cvtpk v197, v54, v55
mf32 v[176:191], v[248:251], v[152:155], v[176:191]
ds_read_b128 v[248:251], v2 offset:6144
v_exp_f32 v50, v172
v_exp_f32 v51, v173
s_nop 0
v_add_f32 v5, v5, v50
v_add_f32 v5, v5, v51
cvtpk v198, v50, v51
mf32 v[176:191], v[252:255], v[156:159], v[176:191]
ds_read_b128 v[252:255], v2 offset:7168
v_exp_f32 v52, v174
v_exp_f32 v53, v175
s_nop 0
v_add_f32 v5, v5, v52
v_add_f32 v5, v5, v53
cvtpk v199, v52, v53
s_nop 4
s_sub_u32 s20, s20, 1
s_branch attn_kernel_L_back0
attn_kernel_L_it0:
s_waitcnt lgkmcnt(4)
mf32 v[176:191], v[224:227], v[128:131], v[208:223]
ds_read_b128 v[224:227], v3 offset:8192
v_add_f32 v4, v4, v5
v_exp_f32 v50, v160
v_exp_f32 v51, v161
mf32 v[176:191], v[228:231], v[132:135], v[176:191]
ds_read_b128 v[228:231], v3 offset:10240
v_exp_f32 v52, v162
v_add_f32 v5, v50, v51
cvtpk v192, v50, v51
mf32 v[176:191], v[232:235], v[136:139], v[176:191]
ds_read_b128 v[232:235], v3 offset:12288
v_exp_f32 v53, v163
v_exp_f32 v54, v164
v_add_f32 v5, v5, v52
v_add_u32 v2, 0x8000, v2
mf32 v[176:191], v[236:239], v[140:143], v[176:191]
ds_read_b128 v[236:239], v3 offset:14336
v_exp_f32 v55, v165
v_add_f32 v5, v5, v53
cvtpk v193, v52, v53
v_add_f32 v5, v5, v54
s_waitcnt lgkmcnt(4)
mf32 v[176:191], v[240:243], v[144:147], v[176:191]
s_barrier
s_sub_u32 s41, s41, 1
ds_read_b128 v[240:243], v3 offset:9216
v_exp_f32 v50, v166
v_add_f32 v5, v5, v55
cvtpk v194, v54, v55
mf32 v[176:191], v[244:247], v[148:151], v[176:191]
ds_read_b128 v[244:247], v3 offset:11264
v_exp_f32 v51, v167
v_add_f32 v5, v5, v50
mf32 v[176:191], v[248:251], v[152:155], v[176:191]
ds_read_b128 v[248:251], v3 offset:13312
v_exp_f32 v52, v168
v_add_f32 v5, v5, v51
cvtpk v195, v50, v51
v_and_b32 v2, 0x1ffff, v2
mf32 v[176:191], v[252:255], v[156:159], v[176:191]
ds_read_b128 v[252:255], v3 offset:15360
v_exp_f32 v53, v169
v_add_f32 v5, v5, v52
s_waitcnt lgkmcnt(4)
mf32 v[64:79], v[224:227], v[200:203], v[64:79]
ds_read_b128 v[224:227], v2 offset:0
v_exp_f32 v54, v170
v_add_f32 v5, v5, v53
cvtpk v196, v52, v53
mf32 v[80:95], v[228:231], v[200:203], v[80:95]
ds_read_b128 v[228:231], v2 offset:1024
v_exp_f32 v55, v171
v_add_f32 v5, v5, v54
mf32 v[96:111], v[232:235], v[200:203], v[96:111]
ds_read_b128 v[232:235], v2 offset:2048
v_exp_f32 v50, v172
v_add_f32 v5, v5, v55
cvtpk v197, v54, v55
mf32 v[112:127], v[236:239], v[200:203], v[112:127]
ds_read_b128 v[236:239], v2 offset:3072
v_exp_f32 v51, v173
v_add_f32 v5, v5, v50
s_waitcnt lgkmcnt(4)
mf32 v[64:79], v[240:243], v[204:207], v[64:79]
ds_read_b128 v[240:243], v2 offset:4096
v_exp_f32 v52, v174
v_add_f32 v5, v5, v51
cvtpk v198, v50, v51
mf32 v[80:95], v[244:247], v[204:207], v[80:95]
ds_read_b128 v[244:247], v2 offset:5120
v_exp_f32 v53, v175
v_add_f32 v5, v5, v52
mf32 v[96:111], v[248:251], v[204:207], v[96:111]
ds_read_b128 v[248:251], v2 offset:6144
v_add_f32 v5, v5, v53
s_sub_u32 s20, s20, 1
v_cmp_nge_f32 vcc, s40, v5
mf32 v[112:127], v[252:255], v[204:207], v[112:127]
ds_read_b128 v[252:255], v2 offset:7168
cvtpk v199, v52, v53
s_cbranch_vccnz attn_kernel_L_slow0
attn_kernel_L_back0:
s_cbranch_scc1 attn_kernel_L_spec0
attn_kernel_L_it1:
s_waitcnt lgkmcnt(4)
mf32 v[160:175], v[224:227], v[128:131], v[208:223]
ds_read_b128 v[224:227], v3 offset:24576
v_add_f32 v4, v4, v5
v_exp_f32 v50, v176
v_exp_f32 v51, v177
mf32 v[160:175], v[228:231], v[132:135], v[160:175]
ds_read_b128 v[228:231], v3 offset:26624
v_exp_f32 v52, v178
v_add_f32 v5, v50, v51
cvtpk v200, v50, v51
mf32 v[160:175], v[232:235], v[136:139], v[160:175]
ds_read_b128 v[232:235], v3 offset:28672
v_exp_f32 v53, v179
v_exp_f32 v54, v180
v_add_f32 v5, v5, v52
mf32 v[160:175], v[236:239], v[140:143], v[160:175]
ds_read_b128 v[236:239], v3 offset:30720
v_exp_f32 v55, v181
v_add_f32 v5, v5, v53
cvtpk v201, v52, v53
v_add_f32 v5, v5, v54
s_waitcnt lgkmcnt(4)
mf32 v[160:175], v[240:243], v[144:147], v[160:175]
ds_read_b128 v[240:243], v3 offset:25600
v_exp_f32 v50, v182
v_add_f32 v5, v5, v55
cvtpk v202, v54, v55
mf32 v[160:175], v[244:247], v[148:151], v[160:175]
ds_read_b128 v[244:247], v3 offset:27648
v_exp_f32 v51, v183
v_add_f32 v5, v5, v50
mf32 v[160:175], v[248:251], v[152:155], v[160:175]
ds_read_b128 v[248:251], v3 offset:29696
v_exp_f32 v52, v184
v_add_f32 v5, v5, v51
cvtpk v203, v50, v51
mf32 v[160:175], v[252:255], v[156:159], v[160:175]
ds_read_b128 v[252:255], v3 offset:31744
v_exp_f32 v53, v185
v_add_f32 v5, v5, v52
s_waitcnt lgkmcnt(4)
mf32 v[64:79], v[224:227], v[192:195], v[64:79]
ds_read_b128 v[224:227], v2 offset:16384
v_exp_f32 v54, v186
v_add_f32 v5, v5, v53
cvtpk v204, v52, v53
mf32 v[80:95], v[228:231], v[192:195], v[80:95]
ds_read_b128 v[228:231], v2 offset:17408
v_exp_f32 v55, v187
v_add_f32 v5, v5, v54
mf32 v[96:111], v[232:235], v[192:195], v[96:111]
ds_read_b128 v[232:235], v2 offset:18432
v_exp_f32 v50, v188
v_add_f32 v5, v5, v55
cvtpk v205, v54, v55
v_mov_b32 v3, v2
mf32 v[112:127], v[236:239], v[192:195], v[112:127]
ds_read_b128 v[236:239], v2 offset:19456
v_exp_f32 v51, v189
v_add_f32 v5, v5, v50
s_waitcnt lgkmcnt(4)
mf32 v[64:79], v[240:243], v[196:199], v[64:79]
ds_read_b128 v[240:243], v2 offset:20480
v_exp_f32 v52, v190
v_add_f32 v5, v5, v51
cvtpk v206, v50, v51
mf32 v[80:95], v[244:247], v[196:199], v[80:95]
ds_read_b128 v[244:247], v2 offset:21504
v_exp_f32 v53, v191
v_add_f32 v5, v5, v52
mf32 v[96:111], v[248:251], v[196:199], v[96:111]
ds_read_b128 v[248:251], v2 offset:22528
v_add_f32 v5, v5, v53
s_sub_u32 s20, s20, 1
v_cmp_nge_f32 vcc, s40, v5
mf32 v[112:127], v[252:255], v[196:199], v[112:127]
ds_read_b128 v[252:255], v2 offset:23552
cvtpk v207, v52, v53
s_cbranch_vccnz attn_kernel_L_slow1
attn_kernel_L_back1:
s_cbranch_scc1 attn_kernel_L_spec1
s_branch attn_kernel_L_it0
attn_kernel_L_slow0:
s_cselect_b32 s22, 1, 0
s_nop 15
v_max3_f32 v13, v160, v161, v162
v_max3_f32 v13, v13, v163, v164
v_max3_f32 v13, v13, v165, v166
v_max3_f32 v13, v13, v167, v168
v_max3_f32 v13, v13, v169, v170
v_max3_f32 v13, v13, v171, v172
v_max3_f32 v13, v13, v173, v174
v_max_f32 v13, v13, v175
v_mov_b32 v15, v13
s_nop 1
v_permlane32_swap_b32 v13, v15
v_max_f32 v13, v13, v15
v_max_f32 v13, 0, v13
v_exp_f32_e64 v14, -v13
v_sub_f32 v208, v208, v13
v_sub_f32 v160, v160, v13
v_sub_f32 v176, v176, v13
v_sub_f32 v209, v209, v13
v_sub_f32 v161, v161, v13
v_sub_f32 v177, v177, v13
v_sub_f32 v210, v210, v13
v_sub_f32 v162, v162, v13
v_sub_f32 v178, v178, v13
v_sub_f32 v211, v211, v13
v_sub_f32 v163, v163, v13
v_sub_f32 v179, v179, v13
v_sub_f32 v212, v212, v13
v_sub_f32 v164, v164, v13
v_sub_f32 v180, v180, v13
v_sub_f32 v213, v213, v13
v_sub_f32 v165, v165, v13
v_sub_f32 v181, v181, v13
v_sub_f32 v214, v214, v13
v_sub_f32 v166, v166, v13
v_sub_f32 v182, v182, v13
v_sub_f32 v215, v215, v13
v_sub_f32 v167, v167, v13
v_sub_f32 v183, v183, v13
v_sub_f32 v216, v216, v13
v_sub_f32 v168, v168, v13
v_sub_f32 v184, v184, v13
v_sub_f32 v217, v217, v13
v_sub_f32 v169, v169, v13
v_sub_f32 v185, v185, v13
v_sub_f32 v218, v218, v13
v_sub_f32 v170, v170, v13
v_sub_f32 v186, v186, v13
v_sub_f32 v219, v219, v13
v_sub_f32 v171, v171, v13
v_sub_f32 v187, v187, v13
v_sub_f32 v220, v220, v13
v_sub_f32 v172, v172, v13
v_sub_f32 v188, v188, v13
v_sub_f32 v221, v221, v13
v_sub_f32 v173, v173, v13
v_sub_f32 v189, v189, v13
v_sub_f32 v222, v222, v13
v_sub_f32 v174, v174, v13
v_sub_f32 v190, v190, v13
v_sub_f32 v223, v223, v13
v_sub_f32 v175, v175, v13
v_sub_f32 v191, v191, v13
v_mul_f32 v64, v64, v14
v_mul_f32 v65, v65, v14
v_mul_f32 v66, v66, v14
v_mul_f32 v67, v67, v14
v_mul_f32 v68, v68, v14
v_mul_f32 v69, v69, v14
v_mul_f32 v70, v70, v14
v_mul_f32 v71, v71, v14
v_mul_f32 v72, v72, v14
v_mul_f32 v73, v73, v14
v_mul_f32 v74, v74, v14
v_mul_f32 v75, v75, v14
v_mul_f32 v76, v76, v14
v_mul_f32 v77, v77, v14
v_mul_f32 v78, v78, v14
v_mul_f32 v79, v79, v14
v_mul_f32 v80, v80, v14
v_mul_f32 v81, v81, v14
v_mul_f32 v82, v82, v14
v_mul_f32 v83, v83, v14
v_mul_f32 v84, v84, v14
v_mul_f32 v85, v85, v14
v_mul_f32 v86, v86, v14
v_mul_f32 v87, v87, v14
v_mul_f32 v88, v88, v14
v_mul_f32 v89, v89, v14
v_mul_f32 v90, v90, v14
v_mul_f32 v91, v91, v14
v_mul_f32 v92, v92, v14
v_mul_f32 v93, v93, v14
v_mul_f32 v94, v94, v14
v_mul_f32 v95, v95, v14
v_mul_f32 v96, v96, v14
v_mul_f32 v97, v97, v14
v_mul_f32 v98, v98, v14
v_mul_f32 v99, v99, v14
v_mul_f32 v100, v100, v14
v_mul_f32 v101, v101, v14
v_mul_f32 v102, v102, v14
v_mul_f32 v103, v103, v14
v_mul_f32 v104, v104, v14
v_mul_f32 v105, v105, v14
v_mul_f32 v106, v106, v14
v_mul_f32 v107, v107, v14
v_mul_f32 v108, v108, v14
v_mul_f32 v109, v109, v14
v_mul_f32 v110, v110, v14
v_mul_f32 v111, v111, v14
v_mul_f32 v112, v112, v14
v_mul_f32 v113, v113, v14
v_mul_f32 v114, v114, v14
v_mul_f32 v115, v115, v14
v_mul_f32 v116, v116, v14
v_mul_f32 v117, v117, v14
v_mul_f32 v118, v118, v14
v_mul_f32 v119, v119, v14
v_mul_f32 v120, v120, v14
v_mul_f32 v121, v121, v14
v_mul_f32 v122, v122, v14
v_mul_f32 v123, v123, v14
v_mul_f32 v124, v124, v14
v_mul_f32 v125, v125, v14
v_mul_f32 v126, v126, v14
v_mul_f32 v127, v127, v14
v_mul_f32 v4, v4, v14
v_mov_b32 v5, 0
v_exp_f32 v6, v160
v_exp_f32 v7, v161
s_nop 0
v_add_f32 v5, v5, v6
v_add_f32 v5, v5, v7
cvtpk v192, v6, v7
v_exp_f32 v6, v162
v_exp_f32 v7, v163
s_nop 0
v_add_f32 v5, v5, v6
v_add_f32 v5, v5, v7
cvtpk v193, v6, v7
v_exp_f32 v6, v164
v_exp_f32 v7, v165
s_nop 0
v_add_f32 v5, v5, v6
v_add_f32 v5, v5, v7
cvtpk v194, v6, v7
v_exp_f32 v6, v166
v_exp_f32 v7, v167
s_nop 0
v_add_f32 v5, v5, v6
v_add_f32 v5, v5, v7
cvtpk v195, v6, v7
v_exp_f32 v6, v168
v_exp_f32 v7, v169
s_nop 0
v_add_f32 v5, v5, v6
v_add_f32 v5, v5, v7
cvtpk v196, v6, v7
v_exp_f32 v6, v170
v_exp_f32 v7, v171
s_nop 0
v_add_f32 v5, v5, v6
v_add_f32 v5, v5, v7
cvtpk v197, v6, v7
v_exp_f32 v6, v172
v_exp_f32 v7, v173
s_nop 0
v_add_f32 v5, v5, v6
v_add_f32 v5, v5, v7
cvtpk v198, v6, v7
v_exp_f32 v6, v174
v_exp_f32 v7, v175
s_nop 0
v_add_f32 v5, v5, v6
v_add_f32 v5, v5, v7
cvtpk v199, v6, v7
s_cmp_eq_u32 s21, 2
s_cbranch_scc1 attn_kernel_L_lback0
s_cmp_lg_u32 s22, 0
s_branch attn_kernel_L_back0
attn_kernel_L_spec0:
s_cmp_eq_u32 s21, 1
s_cbranch_scc1 attn_kernel_L_last1
s_cmp_eq_u32 s21, 3
s_cbranch_scc1 attn_kernel_L_exit0
s_mov_b32 s21, 1
s_mov_b32 s20, 0
v_cmp_le_i32 vcc, 0, v12
s_nop 1
v_cndmask_b32 v208, v48, v208, vcc
v_cmp_le_i32 vcc, 1, v12
s_nop 1
v_cndmask_b32 v209, v48, v209, vcc
v_cmp_le_i32 vcc, 2, v12
s_nop 1
v_cndmask_b32 v210, v48, v210, vcc
v_cmp_le_i32 vcc, 3, v12
s_nop 1
v_cndmask_b32 v211, v48, v211, vcc
v_cmp_le_i32 vcc, 8, v12
s_nop 1
v_cndmask_b32 v212, v48, v212, vcc
v_cmp_le_i32 vcc, 9, v12
s_nop 1
v_cndmask_b32 v213, v48, v213, vcc
v_cmp_le_i32 vcc, 10, v12
s_nop 1
v_cndmask_b32 v214, v48, v214, vcc
v_cmp_le_i32 vcc, 11, v12
s_nop 1
v_cndmask_b32 v215, v48, v215, vcc
v_cmp_le_i32 vcc, 16, v12
s_nop 1
v_cndmask_b32 v216, v48, v216, vcc
v_cmp_le_i32 vcc, 17, v12
s_nop 1
v_cndmask_b32 v217, v48, v217, vcc
v_cmp_le_i32 vcc, 18, v12
s_nop 1
v_cndmask_b32 v218, v48, v218, vcc
v_cmp_le_i32 vcc, 19, v12
s_nop 1
v_cndmask_b32 v219, v48, v219, vcc
v_cmp_le_i32 vcc, 24, v12
s_nop 1
v_cndmask_b32 v220, v48, v220, vcc
v_cmp_le_i32 vcc, 25, v12
s_nop 1
v_cndmask_b32 v221, v48, v221, vcc
v_cmp_le_i32 vcc, 26, v12
s_nop 1
v_cndmask_b32 v222, v48, v222, vcc
v_cmp_le_i32 vcc, 27, v12
s_nop 1
v_cndmask_b32 v223, v48, v223, vcc
s_nop 1
s_branch attn_kernel_L_it1
attn_kernel_L_last0:
s_mov_b32 s21, 2
s_waitcnt lgkmcnt(0)
ds_read_b128 v[224:227], v3 offset:8192
ds_read_b128 v[228:231], v3 offset:10240
ds_read_b128 v[232:235], v3 offset:12288
ds_read_b128 v[236:239], v3 offset:14336
ds_read_b128 v[240:243], v3 offset:9216
ds_read_b128 v[244:247], v3 offset:11264
ds_read_b128 v[248:251], v3 offset:13312
ds_read_b128 v[252:255], v3 offset:15360
v_add_f32 v4, v4, v5
v_mov_b32 v5, 0
s_barrier
s_sub_u32 s41, s41, 1
v_exp_f32 v50, v160
v_exp_f32 v51, v161
s_waitcnt lgkmcnt(7)
mf32 v[64:79], v[224:227], v[200:203], v[64:79]
ds_read_b128 v[224:227], v3 offset:24576
v_add_f32 v5, v5, v50
v_add_f32 v5, v5, v51
cvtpk v192, v50, v51
v_exp_f32 v52, v162
v_exp_f32 v53, v163
s_waitcnt lgkmcnt(7)
mf32 v[80:95], v[228:231], v[200:203], v[80:95]
ds_read_b128 v[228:231], v3 offset:26624
v_add_f32 v5, v5, v52
v_add_f32 v5, v5, v53
cvtpk v193, v52, v53
v_exp_f32 v54, v164
v_exp_f32 v55, v165
s_waitcnt lgkmcnt(7)
mf32 v[96:111], v[232:235], v[200:203], v[96:111]
ds_read_b128 v[232:235], v3 offset:28672
v_add_f32 v5, v5, v54
v_add_f32 v5, v5, v55
cvtpk v194, v54, v55
v_exp_f32 v50, v166
v_exp_f32 v51, v167
s_waitcnt lgkmcnt(7)
mf32 v[112:127], v[236:239], v[200:203], v[112:127]
ds_read_b128 v[236:239], v3 offset:30720
v_add_f32 v5, v5, v50
v_add_f32 v5, v5, v51
cvtpk v195, v50, v51
v_exp_f32 v52, v168
v_exp_f32 v53, v169
s_waitcnt lgkmcnt(7)
mf32 v[64:79], v[240:243], v[204:207], v[64:79]
ds_read_b128 v[240:243], v3 offset:25600
v_add_f32 v5, v5, v52
v_add_f32 v5, v5, v53
cvtpk v196, v52, v53
v_exp_f32 v54, v170
v_exp_f32 v55, v171
s_waitcnt lgkmcnt(7)
mf32 v[80:95], v[244:247], v[204:207], v[80:95]
ds_read_b128 v[244:247], v3 offset:27648
v_add_f32 v5, v5, v54
v_add_f32 v5, v5, v55
cvtpk v197, v54, v55
v_exp_f32 v50, v172
v_exp_f32 v51, v173
s_waitcnt lgkmcnt(7)
mf32 v[96:111], v[248:251], v[204:207], v[96:111]
ds_read_b128 v[248:251], v3 offset:29696
v_add_f32 v5, v5, v50
v_add_f32 v5, v5, v51
cvtpk v198, v50, v51
v_exp_f32 v52, v174
v_exp_f32 v53, v175
s_waitcnt lgkmcnt(7)
mf32 v[112:127], v[252:255], v[204:207], v[112:127]
ds_read_b128 v[252:255], v3 offset:31744
v_add_f32 v5, v5, v52
v_add_f32 v5, v5, v53
cvtpk v199, v52, v53
v_cmp_nge_f32 vcc, s40, v5
s_cbranch_vccnz attn_kernel_L_slow0
attn_kernel_L_lback0:
s_branch attn_kernel_L_fin0
attn_kernel_L_exit0:
s_waitcnt lgkmcnt(0)
ds_read_b128 v[224:227], v3 offset:24576
ds_read_b128 v[228:231], v3 offset:26624
ds_read_b128 v[232:235], v3 offset:28672
ds_read_b128 v[236:239], v3 offset:30720
ds_read_b128 v[240:243], v3 offset:25600
ds_read_b128 v[244:247], v3 offset:27648
ds_read_b128 v[248:251], v3 offset:29696
ds_read_b128 v[252:255], v3 offset:31744
attn_kernel_L_fin0:
v_add_f32 v4, v4, v5
s_waitcnt lgkmcnt(7)
mf32 v[64:79], v[224:227], v[192:195], v[64:79]
v_mov_b32 v15, v4
s_waitcnt lgkmcnt(3)
mf32 v[64:79], v[240:243], v[196:199], v[64:79]
s_waitcnt lgkmcnt(3)
mf32 v[80:95], v[228:231], v[192:195], v[80:95]
v_permlane32_swap_b32 v4, v15
s_waitcnt lgkmcnt(2)
mf32 v[80:95], v[244:247], v[196:199], v[80:95]
v_add_f32 v4, v4, v15
s_waitcnt lgkmcnt(2)
mf32 v[96:111], v[232:235], v[192:195], v[96:111]
v_rcp_f32 v13, v4
s_waitcnt lgkmcnt(1)
mf32 v[96:111], v[248:251], v[196:199], v[96:111]
s_waitcnt lgkmcnt(1)
mf32 v[112:127], v[236:239], v[192:195], v[112:127]
s_waitcnt lgkmcnt(0)
mf32 v[112:127], v[252:255], v[196:199], v[112:127]
s_branch attn_kernel_L_epi
attn_kernel_L_slow1:
s_cselect_b32 s22, 1, 0
s_nop 15
v_max3_f32 v13, v176, v177, v178
v_max3_f32 v13, v13, v179, v180
v_max3_f32 v13, v13, v181, v182
v_max3_f32 v13, v13, v183, v184
v_max3_f32 v13, v13, v185, v186
v_max3_f32 v13, v13, v187, v188
v_max3_f32 v13, v13, v189, v190
v_max_f32 v13, v13, v191
v_mov_b32 v15, v13
s_nop 1
v_permlane32_swap_b32 v13, v15
v_max_f32 v13, v13, v15
v_max_f32 v13, 0, v13
v_exp_f32_e64 v14, -v13
v_sub_f32 v208, v208, v13
v_sub_f32 v176, v176, v13
v_sub_f32 v160, v160, v13
v_sub_f32 v209, v209, v13
v_sub_f32 v177, v177, v13
v_sub_f32 v161, v161, v13
v_sub_f32 v210, v210, v13
v_sub_f32 v178, v178, v13
v_sub_f32 v162, v162, v13
v_sub_f32 v211, v211, v13
v_sub_f32 v179, v179, v13
v_sub_f32 v163, v163, v13
v_sub_f32 v212, v212, v13
v_sub_f32 v180, v180, v13
v_sub_f32 v164, v164, v13
v_sub_f32 v213, v213, v13
v_sub_f32 v181, v181, v13
v_sub_f32 v165, v165, v13
v_sub_f32 v214, v214, v13
v_sub_f32 v182, v182, v13
v_sub_f32 v166, v166, v13
v_sub_f32 v215, v215, v13
v_sub_f32 v183, v183, v13
v_sub_f32 v167, v167, v13
v_sub_f32 v216, v216, v13
v_sub_f32 v184, v184, v13
v_sub_f32 v168, v168, v13
v_sub_f32 v217, v217, v13
v_sub_f32 v185, v185, v13
v_sub_f32 v169, v169, v13
v_sub_f32 v218, v218, v13
v_sub_f32 v186, v186, v13
v_sub_f32 v170, v170, v13
v_sub_f32 v219, v219, v13
v_sub_f32 v187, v187, v13
v_sub_f32 v171, v171, v13
v_sub_f32 v220, v220, v13
v_sub_f32 v188, v188, v13
v_sub_f32 v172, v172, v13
v_sub_f32 v221, v221, v13
v_sub_f32 v189, v189, v13
v_sub_f32 v173, v173, v13
v_sub_f32 v222, v222, v13
v_sub_f32 v190, v190, v13
v_sub_f32 v174, v174, v13
v_sub_f32 v223, v223, v13
v_sub_f32 v191, v191, v13
v_sub_f32 v175, v175, v13
v_mul_f32 v64, v64, v14
v_mul_f32 v65, v65, v14
v_mul_f32 v66, v66, v14
v_mul_f32 v67, v67, v14
v_mul_f32 v68, v68, v14
v_mul_f32 v69, v69, v14
v_mul_f32 v70, v70, v14
v_mul_f32 v71, v71, v14
v_mul_f32 v72, v72, v14
v_mul_f32 v73, v73, v14
v_mul_f32 v74, v74, v14
v_mul_f32 v75, v75, v14
v_mul_f32 v76, v76, v14
v_mul_f32 v77, v77, v14
v_mul_f32 v78, v78, v14
v_mul_f32 v79, v79, v14
v_mul_f32 v80, v80, v14
v_mul_f32 v81, v81, v14
v_mul_f32 v82, v82, v14
v_mul_f32 v83, v83, v14
v_mul_f32 v84, v84, v14
v_mul_f32 v85, v85, v14
v_mul_f32 v86, v86, v14
v_mul_f32 v87, v87, v14
v_mul_f32 v88, v88, v14
v_mul_f32 v89, v89, v14
v_mul_f32 v90, v90, v14
v_mul_f32 v91, v91, v14
v_mul_f32 v92, v92, v14
v_mul_f32 v93, v93, v14
v_mul_f32 v94, v94, v14
v_mul_f32 v95, v95, v14
v_mul_f32 v96, v96, v14
v_mul_f32 v97, v97, v14
v_mul_f32 v98, v98, v14
v_mul_f32 v99, v99, v14
v_mul_f32 v100, v100, v14
v_mul_f32 v101, v101, v14
v_mul_f32 v102, v102, v14
v_mul_f32 v103, v103, v14
v_mul_f32 v104, v104, v14
v_mul_f32 v105, v105, v14
v_mul_f32 v106, v106, v14
v_mul_f32 v107, v107, v14
v_mul_f32 v108, v108, v14
v_mul_f32 v109, v109, v14
v_mul_f32 v110, v110, v14
v_mul_f32 v111, v111, v14
v_mul_f32 v112, v112, v14
v_mul_f32 v113, v113, v14
v_mul_f32 v114, v114, v14
v_mul_f32 v115, v115, v14
v_mul_f32 v116, v116, v14
v_mul_f32 v117, v117, v14
v_mul_f32 v118, v118, v14
v_mul_f32 v119, v119, v14
v_mul_f32 v120, v120, v14
v_mul_f32 v121, v121, v14
v_mul_f32 v122, v122, v14
v_mul_f32 v123, v123, v14
v_mul_f32 v124, v124, v14
v_mul_f32 v125, v125, v14
v_mul_f32 v126, v126, v14
v_mul_f32 v127, v127, v14
v_mul_f32 v4, v4, v14
v_mov_b32 v5, 0
v_exp_f32 v6, v176
v_exp_f32 v7, v177
s_nop 0
v_add_f32 v5, v5, v6
v_add_f32 v5, v5, v7
cvtpk v200, v6, v7
v_exp_f32 v6, v178
v_exp_f32 v7, v179
s_nop 0
v_add_f32 v5, v5, v6
v_add_f32 v5, v5, v7
cvtpk v201, v6, v7
v_exp_f32 v6, v180
v_exp_f32 v7, v181
s_nop 0
v_add_f32 v5, v5, v6
v_add_f32 v5, v5, v7
cvtpk v202, v6, v7
v_exp_f32 v6, v182
v_exp_f32 v7, v183
s_nop 0
v_add_f32 v5, v5, v6
v_add_f32 v5, v5, v7
cvtpk v203, v6, v7
v_exp_f32 v6, v184
v_exp_f32 v7, v185
s_nop 0
v_add_f32 v5, v5, v6
v_add_f32 v5, v5, v7
cvtpk v204, v6, v7
v_exp_f32 v6, v186
v_exp_f32 v7, v187
s_nop 0
v_add_f32 v5, v5, v6
v_add_f32 v5, v5, v7
cvtpk v205, v6, v7
v_exp_f32 v6, v188
v_exp_f32 v7, v189
s_nop 0
v_add_f32 v5, v5, v6
v_add_f32 v5, v5, v7
cvtpk v206, v6, v7
v_exp_f32 v6, v190
v_exp_f32 v7, v191
s_nop 0
v_add_f32 v5, v5, v6
v_add_f32 v5, v5, v7
cvtpk v207, v6, v7
s_cmp_eq_u32 s21, 2
s_cbranch_scc1 attn_kernel_L_lback1
s_cmp_lg_u32 s22, 0
s_branch attn_kernel_L_back1
attn_kernel_L_spec1:
s_cmp_eq_u32 s21, 1
s_cbranch_scc1 attn_kernel_L_last0
s_mov_b32 s21, 1
s_mov_b32 s20, 0
v_cmp_le_i32 vcc, 0, v12
s_nop 1
v_cndmask_b32 v208, v48, v208, vcc
v_cmp_le_i32 vcc, 1, v12
s_nop 1
v_cndmask_b32 v209, v48, v209, vcc
v_cmp_le_i32 vcc, 2, v12
s_nop 1
v_cndmask_b32 v210, v48, v210, vcc
v_cmp_le_i32 vcc, 3, v12
s_nop 1
v_cndmask_b32 v211, v48, v211, vcc
v_cmp_le_i32 vcc, 8, v12
s_nop 1
v_cndmask_b32 v212, v48, v212, vcc
v_cmp_le_i32 vcc, 9, v12
s_nop 1
v_cndmask_b32 v213, v48, v213, vcc
v_cmp_le_i32 vcc, 10, v12
s_nop 1
v_cndmask_b32 v214, v48, v214, vcc
v_cmp_le_i32 vcc, 11, v12
s_nop 1
v_cndmask_b32 v215, v48, v215, vcc
v_cmp_le_i32 vcc, 16, v12
s_nop 1
v_cndmask_b32 v216, v48, v216, vcc
v_cmp_le_i32 vcc, 17, v12
s_nop 1
v_cndmask_b32 v217, v48, v217, vcc
v_cmp_le_i32 vcc, 18, v12
s_nop 1
v_cndmask_b32 v218, v48, v218, vcc
v_cmp_le_i32 vcc, 19, v12
s_nop 1
v_cndmask_b32 v219, v48, v219, vcc
v_cmp_le_i32 vcc, 24, v12
s_nop 1
v_cndmask_b32 v220, v48, v220, vcc
v_cmp_le_i32 vcc, 25, v12
s_nop 1
v_cndmask_b32 v221, v48, v221, vcc
v_cmp_le_i32 vcc, 26, v12
s_nop 1
v_cndmask_b32 v222, v48, v222, vcc
v_cmp_le_i32 vcc, 27, v12
s_nop 1
v_cndmask_b32 v223, v48, v223, vcc
s_nop 1
s_branch attn_kernel_L_it0
attn_kernel_L_last1:
s_mov_b32 s21, 2
s_waitcnt lgkmcnt(0)
ds_read_b128 v[224:227], v3 offset:24576
ds_read_b128 v[228:231], v3 offset:26624
ds_read_b128 v[232:235], v3 offset:28672
ds_read_b128 v[236:239], v3 offset:30720
ds_read_b128 v[240:243], v3 offset:25600
ds_read_b128 v[244:247], v3 offset:27648
ds_read_b128 v[248:251], v3 offset:29696
ds_read_b128 v[252:255], v3 offset:31744
v_add_f32 v4, v4, v5
v_mov_b32 v5, 0
v_exp_f32 v50, v176
v_exp_f32 v51, v177
s_waitcnt lgkmcnt(7)
mf32 v[64:79], v[224:227], v[192:195], v[64:79]
ds_read_b128 v[224:227], v2 offset:8192
v_add_f32 v5, v5, v50
v_add_f32 v5, v5, v51
cvtpk v200, v50, v51
v_exp_f32 v52, v178
v_exp_f32 v53, v179
s_waitcnt lgkmcnt(7)
mf32 v[80:95], v[228:231], v[192:195], v[80:95]
ds_read_b128 v[228:231], v2 offset:10240
v_add_f32 v5, v5, v52
v_add_f32 v5, v5, v53
cvtpk v201, v52, v53
v_exp_f32 v54, v180
v_exp_f32 v55, v181
s_waitcnt lgkmcnt(7)
mf32 v[96:111], v[232:235], v[192:195], v[96:111]
ds_read_b128 v[232:235], v2 offset:12288
v_add_f32 v5, v5, v54
v_add_f32 v5, v5, v55
cvtpk v202, v54, v55
v_exp_f32 v50, v182
v_exp_f32 v51, v183
s_waitcnt lgkmcnt(7)
mf32 v[112:127], v[236:239], v[192:195], v[112:127]
ds_read_b128 v[236:239], v2 offset:14336
v_add_f32 v5, v5, v50
v_add_f32 v5, v5, v51
cvtpk v203, v50, v51
v_exp_f32 v52, v184
v_exp_f32 v53, v185
s_waitcnt lgkmcnt(7)
mf32 v[64:79], v[240:243], v[196:199], v[64:79]
ds_read_b128 v[240:243], v2 offset:9216
v_add_f32 v5, v5, v52
v_add_f32 v5, v5, v53
cvtpk v204, v52, v53
v_exp_f32 v54, v186
v_exp_f32 v55, v187
s_waitcnt lgkmcnt(7)
mf32 v[80:95], v[244:247], v[196:199], v[80:95]
ds_read_b128 v[244:247], v2 offset:11264
v_add_f32 v5, v5, v54
v_add_f32 v5, v5, v55
cvtpk v205, v54, v55
v_exp_f32 v50, v188
v_exp_f32 v51, v189
s_waitcnt lgkmcnt(7)
mf32 v[96:111], v[248:251], v[196:199], v[96:111]
ds_read_b128 v[248:251], v2 offset:13312
v_add_f32 v5, v5, v50
v_add_f32 v5, v5, v51
cvtpk v206, v50, v51
v_exp_f32 v52, v190
v_exp_f32 v53, v191
s_waitcnt lgkmcnt(7)
mf32 v[112:127], v[252:255], v[196:199], v[112:127]
ds_read_b128 v[252:255], v2 offset:15360
v_add_f32 v5, v5, v52
v_add_f32 v5, v5, v53
cvtpk v207, v52, v53
v_cmp_nge_f32 vcc, s40, v5
s_cbranch_vccnz attn_kernel_L_slow1
attn_kernel_L_lback1:
v_add_f32 v4, v4, v5
s_waitcnt lgkmcnt(7)
mf32 v[64:79], v[224:227], v[200:203], v[64:79]
v_mov_b32 v15, v4
s_waitcnt lgkmcnt(3)
mf32 v[64:79], v[240:243], v[204:207], v[64:79]
s_waitcnt lgkmcnt(3)
mf32 v[80:95], v[228:231], v[200:203], v[80:95]
v_permlane32_swap_b32 v4, v15
s_waitcnt lgkmcnt(2)
mf32 v[80:95], v[244:247], v[204:207], v[80:95]
v_add_f32 v4, v4, v15
s_waitcnt lgkmcnt(2)
mf32 v[96:111], v[232:235], v[200:203], v[96:111]
v_rcp_f32 v13, v4
s_waitcnt lgkmcnt(1)
mf32 v[96:111], v[248:251], v[204:207], v[96:111]
s_waitcnt lgkmcnt(1)
mf32 v[112:127], v[236:239], v[200:203], v[112:127]
s_waitcnt lgkmcnt(0)
mf32 v[112:127], v[252:255], v[204:207], v[112:127]
attn_kernel_L_epi:
s_cmp_eq_u32 s41, 0
s_cbranch_scc1 attn_kernel_L_svc_5
s_barrier
s_sub_u32 s41, s41, 1
attn_kernel_L_svc_5:
v_mul_f32 v64, v64, v13
v_mul_f32 v65, v65, v13
cvtpk v16, v64, v65
v_mul_f32 v66, v66, v13
v_mul_f32 v67, v67, v13
cvtpk v17, v66, v67
v_mul_f32 v68, v68, v13
v_mul_f32 v69, v69, v13
cvtpk v18, v68, v69
v_mul_f32 v70, v70, v13
v_mul_f32 v71, v71, v13
cvtpk v19, v70, v71
buffer_store_dwordx4 v[16:19], v1, s[36:39], s46 offen offset:0 sc1
v_mul_f32 v72, v72, v13
v_mul_f32 v73, v73, v13
cvtpk v20, v72, v73
v_mul_f32 v74, v74, v13
v_mul_f32 v75, v75, v13
cvtpk v21, v74, v75
v_mul_f32 v76, v76, v13
v_mul_f32 v77, v77, v13
cvtpk v22, v76, v77
v_mul_f32 v78, v78, v13
v_mul_f32 v79, v79, v13
cvtpk v23, v78, v79
buffer_store_dwordx4 v[20:23], v1, s[36:39], s46 offen offset:1024 sc1
v_mul_f32 v80, v80, v13
v_mul_f32 v81, v81, v13
cvtpk v24, v80, v81
v_mul_f32 v82, v82, v13
v_mul_f32 v83, v83, v13
cvtpk v25, v82, v83
v_mul_f32 v84, v84, v13
v_mul_f32 v85, v85, v13
cvtpk v26, v84, v85
v_mul_f32 v86, v86, v13
v_mul_f32 v87, v87, v13
cvtpk v27, v86, v87
buffer_store_dwordx4 v[24:27], v1, s[36:39], s46 offen offset:2048 sc1
v_mul_f32 v88, v88, v13
v_mul_f32 v89, v89, v13
cvtpk v28, v88, v89
v_mul_f32 v90, v90, v13
v_mul_f32 v91, v91, v13
cvtpk v29, v90, v91
v_mul_f32 v92, v92, v13
v_mul_f32 v93, v93, v13
cvtpk v30, v92, v93
v_mul_f32 v94, v94, v13
v_mul_f32 v95, v95, v13
cvtpk v31, v94, v95
buffer_store_dwordx4 v[28:31], v1, s[36:39], s46 offen offset:3072 sc1
s_cmp_eq_u32 s41, 0
s_cbranch_scc1 attn_kernel_L_svc_6
s_barrier
s_sub_u32 s41, s41, 1
attn_kernel_L_svc_6:
v_mul_f32 v96, v96, v13
v_mul_f32 v97, v97, v13
cvtpk v32, v96, v97
v_mul_f32 v98, v98, v13
v_mul_f32 v99, v99, v13
cvtpk v33, v98, v99
v_mul_f32 v100, v100, v13
v_mul_f32 v101, v101, v13
cvtpk v34, v100, v101
v_mul_f32 v102, v102, v13
v_mul_f32 v103, v103, v13
cvtpk v35, v102, v103
buffer_store_dwordx4 v[32:35], v1, s[36:39], s47 offen offset:0 sc1
v_mul_f32 v104, v104, v13
v_mul_f32 v105, v105, v13
cvtpk v36, v104, v105
v_mul_f32 v106, v106, v13
v_mul_f32 v107, v107, v13
cvtpk v37, v106, v107
v_mul_f32 v108, v108, v13
v_mul_f32 v109, v109, v13
cvtpk v38, v108, v109
v_mul_f32 v110, v110, v13
v_mul_f32 v111, v111, v13
cvtpk v39, v110, v111
buffer_store_dwordx4 v[36:39], v1, s[36:39], s47 offen offset:1024 sc1
v_mul_f32 v112, v112, v13
v_mul_f32 v113, v113, v13
cvtpk v40, v112, v113
v_mul_f32 v114, v114, v13
v_mul_f32 v115, v115, v13
cvtpk v41, v114, v115
v_mul_f32 v116, v116, v13
v_mul_f32 v117, v117, v13
cvtpk v42, v116, v117
v_mul_f32 v118, v118, v13
v_mul_f32 v119, v119, v13
cvtpk v43, v118, v119
buffer_store_dwordx4 v[40:43], v1, s[36:39], s47 offen offset:2048 sc1
v_mul_f32 v120, v120, v13
v_mul_f32 v121, v121, v13
cvtpk v44, v120, v121
v_mul_f32 v122, v122, v13
v_mul_f32 v123, v123, v13
cvtpk v45, v122, v123
v_mul_f32 v124, v124, v13
v_mul_f32 v125, v125, v13
cvtpk v46, v124, v125
v_mul_f32 v126, v126, v13
v_mul_f32 v127, v127, v13
cvtpk v47, v126, v127
buffer_store_dwordx4 v[44:47], v1, s[36:39], s47 offen offset:3072 sc1
s_endpgm
attn_kernel_short:
v_mov_b32 v208, 0
v_mov_b32 v209, 0
v_mov_b32 v210, 0
v_mov_b32 v211, 0
v_mov_b32 v212, 0
v_mov_b32 v213, 0
v_mov_b32 v214, 0
v_mov_b32 v215, 0
v_mov_b32 v216, 0
v_mov_b32 v217, 0
v_mov_b32 v218, 0
v_mov_b32 v219, 0
v_mov_b32 v220, 0
v_mov_b32 v221, 0
v_mov_b32 v222, 0
v_mov_b32 v223, 0
s_cmp_lg_u32 s19, 1
s_cbranch_scc1 attn_kernel_S_nm1a
v_cmp_le_i32 vcc, 0, v12
s_nop 1
v_cndmask_b32 v208, v48, v208, vcc
v_cmp_le_i32 vcc, 1, v12
s_nop 1
v_cndmask_b32 v209, v48, v209, vcc
v_cmp_le_i32 vcc, 2, v12
s_nop 1
v_cndmask_b32 v210, v48, v210, vcc
v_cmp_le_i32 vcc, 3, v12
s_nop 1
v_cndmask_b32 v211, v48, v211, vcc
v_cmp_le_i32 vcc, 8, v12
s_nop 1
v_cndmask_b32 v212, v48, v212, vcc
v_cmp_le_i32 vcc, 9, v12
s_nop 1
v_cndmask_b32 v213, v48, v213, vcc
v_cmp_le_i32 vcc, 10, v12
s_nop 1
v_cndmask_b32 v214, v48, v214, vcc
v_cmp_le_i32 vcc, 11, v12
s_nop 1
v_cndmask_b32 v215, v48, v215, vcc
v_cmp_le_i32 vcc, 16, v12
s_nop 1
v_cndmask_b32 v216, v48, v216, vcc
v_cmp_le_i32 vcc, 17, v12
s_nop 1
v_cndmask_b32 v217, v48, v217, vcc
v_cmp_le_i32 vcc, 18, v12
s_nop 1
v_cndmask_b32 v218, v48, v218, vcc
v_cmp_le_i32 vcc, 19, v12
s_nop 1
v_cndmask_b32 v219, v48, v219, vcc
v_cmp_le_i32 vcc, 24, v12
s_nop 1
v_cndmask_b32 v220, v48, v220, vcc
v_cmp_le_i32 vcc, 25, v12
s_nop 1
v_cndmask_b32 v221, v48, v221, vcc
v_cmp_le_i32 vcc, 26, v12
s_nop 1
v_cndmask_b32 v222, v48, v222, vcc
v_cmp_le_i32 vcc, 27, v12
s_nop 1
v_cndmask_b32 v223, v48, v223, vcc
s_nop 1
attn_kernel_S_nm1a:
buffer_load_dwordx4 v[128:131], v1, s[32:35], s12 offen offset:0
buffer_load_dwordx4 v[132:135], v1, s[32:35], s12 offen offset:1024
buffer_load_dwordx4 v[136:139], v1, s[32:35], s12 offen offset:2048
buffer_load_dwordx4 v[140:143], v1, s[32:35], s12 offen offset:3072
buffer_load_dwordx4 v[144:147], v1, s[32:35], s13 offen offset:0
buffer_load_dwordx4 v[148:151], v1, s[32:35], s13 offen offset:1024
buffer_load_dwordx4 v[152:155], v1, s[32:35], s13 offen offset:2048
buffer_load_dwordx4 v[156:159], v1, s[32:35], s13 offen offset:3072
s_mov_b32 m0, s43
s_add_u32 s44, s43, 0x2000
buffer_load_dwordx4 v10, s[24:27], s42 offen lds
buffer_load_dwordx4 v10, s[24:27], s42 offen offset:1024 lds
s_add_u32 m0, s43, 0x4000
s_add_u32 s43, s43, 0x8000
buffer_load_dwordx4 v11, s[24:27], s42 offen lds
buffer_load_dwordx4 v11, s[24:27], s42 offen offset:1024 lds
s_and_b32 s43, s43, 0x1ffff
s_add_u32 s42, s42, 0x4000
s_mov_b32 m0, s44
s_nop 0
buffer_load_dwordx4 v10, s[28:31], s42 offen lds
buffer_load_dwordx4 v10, s[28:31], s42 offen offset:1024 lds
s_add_u32 m0, s44, 0x4000
s_nop 0
buffer_load_dwordx4 v11, s[28:31], s42 offen lds
buffer_load_dwordx4 v11, s[28:31], s42 offen offset:1024 lds
s_mov_b32 m0, s43
s_add_u32 s44, s43, 0x2000
buffer_load_dwordx4 v10, s[24:27], s42 offen lds
buffer_load_dwordx4 v10, s[24:27], s42 offen offset:1024 lds
s_add_u32 m0, s43, 0x4000
s_add_u32 s43, s43, 0x8000
buffer_load_dwordx4 v11, s[24:27], s42 offen lds
buffer_load_dwordx4 v11, s[24:27], s42 offen offset:1024 lds
s_and_b32 s43, s43, 0x1ffff
s_add_u32 s42, s42, 0x4000
v_mov_b32 v4, 0
v_mov_b32 v5, 0
v_add_u32 v2, 0x8000, v1
v_mov_b32 v3, v1
s_waitcnt vmcnt(6)
s_barrier
ds_read_b128 v[224:227], v1 offset:0
ds_read_b128 v[228:231], v1 offset:1024
ds_read_b128 v[232:235], v1 offset:2048
ds_read_b128 v[236:239], v1 offset:3072
ds_read_b128 v[240:243], v1 offset:4096
ds_read_b128 v[244:247], v1 offset:5120
ds_read_b128 v[248:251], v1 offset:6144
ds_read_b128 v[252:255], v1 offset:7168
s_waitcnt lgkmcnt(4)
mf32 v[160:175], v[224:227], v[128:131], v[208:223]
ds_read_b128 v[224:227], v1 offset:16384
s_mov_b32 m0, s44
s_nop 0
buffer_load_dwordx4 v10, s[28:31], s42 offen lds
v_mov_b32 v64, 0
v_mov_b32 v65, 0
v_mov_b32 v66, 0
v_mov_b32 v67, 0
v_mov_b32 v68, 0
mf32 v[160:175], v[228:231], v[132:135], v[160:175]
ds_read_b128 v[228:231], v1 offset:17408
buffer_load_dwordx4 v10, s[28:31], s42 offen offset:1024 lds
s_add_u32 m0, s44, 0x4000
s_nop 0
v_mov_b32 v69, 0
v_mov_b32 v70, 0
v_mov_b32 v71, 0
v_mov_b32 v72, 0
v_mov_b32 v73, 0
mf32 v[160:175], v[232:235], v[136:139], v[160:175]
ds_read_b128 v[232:235], v1 offset:18432
buffer_load_dwordx4 v11, s[28:31], s42 offen lds
buffer_load_dwordx4 v11, s[28:31], s42 offen offset:1024 lds
s_mov_b32 m0, s43
v_mov_b32 v74, 0
v_mov_b32 v75, 0
v_mov_b32 v76, 0
v_mov_b32 v77, 0
v_mov_b32 v78, 0
mf32 v[160:175], v[236:239], v[140:143], v[160:175]
ds_read_b128 v[236:239], v1 offset:19456
s_add_u32 s44, s43, 0x2000
buffer_load_dwordx4 v10, s[24:27], s42 offen lds
buffer_load_dwordx4 v10, s[24:27], s42 offen offset:1024 lds
v_mov_b32 v79, 0
v_mov_b32 v80, 0
v_mov_b32 v81, 0
v_mov_b32 v82, 0
v_mov_b32 v83, 0
s_waitcnt lgkmcnt(4)
mf32 v[160:175], v[240:243], v[144:147], v[160:175]
ds_read_b128 v[240:243], v1 offset:20480
s_add_u32 m0, s43, 0x4000
s_add_u32 s43, s43, 0x8000
buffer_load_dwordx4 v11, s[24:27], s42 offen lds
v_mov_b32 v84, 0
v_mov_b32 v85, 0
v_mov_b32 v86, 0
v_mov_b32 v87, 0
v_mov_b32 v88, 0
mf32 v[160:175], v[244:247], v[148:151], v[160:175]
ds_read_b128 v[244:247], v1 offset:21504
buffer_load_dwordx4 v11, s[24:27], s42 offen offset:1024 lds
s_and_b32 s43, s43, 0x1ffff
s_add_u32 s42, s42, 0x4000
v_mov_b32 v89, 0
v_mov_b32 v90, 0
v_mov_b32 v91, 0
v_mov_b32 v92, 0
v_mov_b32 v93, 0
mf32 v[160:175], v[248:251], v[152:155], v[160:175]
ds_read_b128 v[248:251], v1 offset:22528
v_mov_b32 v94, 0
v_mov_b32 v95, 0
v_mov_b32 v96, 0
v_mov_b32 v97, 0
v_mov_b32 v98, 0
mf32 v[160:175], v[252:255], v[156:159], v[160:175]
ds_read_b128 v[252:255], v1 offset:23552
v_mov_b32 v99, 0
v_mov_b32 v100, 0
v_mov_b32 v101, 0
v_mov_b32 v102, 0
v_mov_b32 v103, 0
v_mov_b32 v104, 0
v_mov_b32 v105, 0
v_mov_b32 v106, 0
v_mov_b32 v107, 0
v_mov_b32 v108, 0
v_mov_b32 v109, 0
v_mov_b32 v110, 0
v_mov_b32 v111, 0
v_mov_b32 v112, 0
v_mov_b32 v113, 0
v_mov_b32 v114, 0
v_mov_b32 v115, 0
v_mov_b32 v116, 0
v_mov_b32 v117, 0
v_mov_b32 v118, 0
v_mov_b32 v119, 0
v_mov_b32 v120, 0
v_mov_b32 v121, 0
v_mov_b32 v122, 0
v_mov_b32 v123, 0
v_mov_b32 v124, 0
v_mov_b32 v125, 0
v_mov_b32 v126, 0
v_mov_b32 v127, 0
s_mov_b32 m0, s44
s_nop 0
buffer_load_dwordx4 v10, s[28:31], s42 offen lds
buffer_load_dwordx4 v10, s[28:31], s42 offen offset:1024 lds
s_add_u32 m0, s44, 0x4000
s_nop 0
buffer_load_dwordx4 v11, s[28:31], s42 offen lds
buffer_load_dwordx4 v11, s[28:31], s42 offen offset:1024 lds
s_mov_b32 m0, s43
s_add_u32 s44, s43, 0x2000
buffer_load_dwordx4 v10, s[24:27], s42 offen lds
buffer_load_dwordx4 v10, s[24:27], s42 offen offset:1024 lds
s_add_u32 m0, s43, 0x4000
s_add_u32 s43, s43, 0x8000
buffer_load_dwordx4 v11, s[24:27], s42 offen lds
buffer_load_dwordx4 v11, s[24:27], s42 offen offset:1024 lds
s_and_b32 s43, s43, 0x1ffff
s_add_u32 s42, s42, 0x4000
v_max3_f32 v13, v160, v161, v162
v_max3_f32 v13, v13, v163, v164
v_max3_f32 v13, v13, v165, v166
v_max3_f32 v13, v13, v167, v168
v_max3_f32 v13, v13, v169, v170
v_max3_f32 v13, v13, v171, v172
v_max3_f32 v13, v13, v173, v174
v_max_f32 v13, v13, v175
v_mov_b32 v15, v13
s_nop 1
v_permlane32_swap_b32 v13, v15
v_max_f32 v13, v13, v15
v_sub_f32 v160, v160, v13
v_sub_f32 v161, v161, v13
v_sub_f32 v162, v162, v13
v_sub_f32 v163, v163, v13
v_sub_f32 v164, v164, v13
v_sub_f32 v165, v165, v13
v_sub_f32 v166, v166, v13
v_sub_f32 v167, v167, v13
v_sub_f32 v168, v168, v13
v_sub_f32 v169, v169, v13
v_sub_f32 v170, v170, v13
v_sub_f32 v171, v171, v13
v_sub_f32 v172, v172, v13
v_sub_f32 v173, v173, v13
v_sub_f32 v174, v174, v13
v_sub_f32 v175, v175, v13
v_sub_f32 v208, 0, v13
v_sub_f32 v209, 0, v13
v_sub_f32 v210, 0, v13
v_sub_f32 v211, 0, v13
v_sub_f32 v212, 0, v13
v_sub_f32 v213, 0, v13
v_sub_f32 v214, 0, v13
v_sub_f32 v215, 0, v13
v_sub_f32 v216, 0, v13
v_sub_f32 v217, 0, v13
v_sub_f32 v218, 0, v13
v_sub_f32 v219, 0, v13
v_sub_f32 v220, 0, v13
v_sub_f32 v221, 0, v13
v_sub_f32 v222, 0, v13
v_sub_f32 v223, 0, v13
s_mov_b32 s21, 0
s_sub_u32 s20, s19, 3
s_cbranch_scc0 attn_kernel_S_first
s_mov_b32 s21, 3
s_mov_b32 s20, 0
s_cmp_lg_u32 s19, 2
s_cbranch_scc1 attn_kernel_S_first
s_mov_b32 s21, 1
v_cmp_le_i32 vcc, 0, v12
s_nop 1
v_cndmask_b32 v208, v48, v208, vcc
v_cmp_le_i32 vcc, 1, v12
s_nop 1
v_cndmask_b32 v209, v48, v209, vcc
v_cmp_le_i32 vcc, 2, v12
s_nop 1
v_cndmask_b32 v210, v48, v210, vcc
v_cmp_le_i32 vcc, 3, v12
s_nop 1
v_cndmask_b32 v211, v48, v211, vcc
v_cmp_le_i32 vcc, 8, v12
s_nop 1
v_cndmask_b32 v212, v48, v212, vcc
v_cmp_le_i32 vcc, 9, v12
s_nop 1
v_cndmask_b32 v213, v48, v213, vcc
v_cmp_le_i32 vcc, 10, v12
s_nop 1
v_cndmask_b32 v214, v48, v214, vcc
v_cmp_le_i32 vcc, 11, v12
s_nop 1
v_cndmask_b32 v215, v48, v215, vcc
v_cmp_le_i32 vcc, 16, v12
s_nop 1
v_cndmask_b32 v216, v48, v216, vcc
v_cmp_le_i32 vcc, 17, v12
s_nop 1
v_cndmask_b32 v217, v48, v217, vcc
v_cmp_le_i32 vcc, 18, v12
s_nop 1
v_cndmask_b32 v218, v48, v218, vcc
v_cmp_le_i32 vcc, 19, v12
s_nop 1
v_cndmask_b32 v219, v48, v219, vcc
v_cmp_le_i32 vcc, 24, v12
s_nop 1
v_cndmask_b32 v220, v48, v220, vcc
v_cmp_le_i32 vcc, 25, v12
s_nop 1
v_cndmask_b32 v221, v48, v221, vcc
v_cmp_le_i32 vcc, 26, v12
s_nop 1
v_cndmask_b32 v222, v48, v222, vcc
v_cmp_le_i32 vcc, 27, v12
s_nop 1
v_cndmask_b32 v223, v48, v223, vcc
s_nop 1
attn_kernel_S_first:
s_waitcnt vmcnt(14)
s_waitcnt lgkmcnt(0)
s_barrier
s_sub_u32 s41, s41, 1
mf32 v[176:191], v[224:227], v[128:131], v[208:223]
ds_read_b128 v[224:227], v2 offset:0
v_exp_f32 v50, v160
v_exp_f32 v51, v161
s_mov_b32 m0, s44
s_nop 0
buffer_load_dwordx4 v10, s[28:31], s42 offen lds
v_add_f32 v5, v5, v50
v_add_f32 v5, v5, v51
cvtpk v192, v50, v51
mf32 v[176:191], v[228:231], v[132:135], v[176:191]
ds_read_b128 v[228:231], v2 offset:1024
v_exp_f32 v52, v162
v_exp_f32 v53, v163
buffer_load_dwordx4 v10, s[28:31], s42 offen offset:1024 lds
s_add_u32 m0, s44, 0x4000
s_nop 0
v_add_f32 v5, v5, v52
v_add_f32 v5, v5, v53
cvtpk v193, v52, v53
mf32 v[176:191], v[232:235], v[136:139], v[176:191]
ds_read_b128 v[232:235], v2 offset:2048
v_exp_f32 v54, v164
v_exp_f32 v55, v165
buffer_load_dwordx4 v11, s[28:31], s42 offen lds
buffer_load_dwordx4 v11, s[28:31], s42 offen offset:1024 lds
s_mov_b32 m0, s43
v_add_f32 v5, v5, v54
v_add_f32 v5, v5, v55
cvtpk v194, v54, v55
mf32 v[176:191], v[236:239], v[140:143], v[176:191]
ds_read_b128 v[236:239], v2 offset:3072
v_exp_f32 v50, v166
v_exp_f32 v51, v167
s_add_u32 s44, s43, 0x2000
buffer_load_dwordx4 v10, s[24:27], s42 offen lds
buffer_load_dwordx4 v10, s[24:27], s42 offen offset:1024 lds
v_add_f32 v5, v5, v50
v_add_f32 v5, v5, v51
cvtpk v195, v50, v51
mf32 v[176:191], v[240:243], v[144:147], v[176:191]
ds_read_b128 v[240:243], v2 offset:4096
v_exp_f32 v52, v168
v_exp_f32 v53, v169
s_add_u32 m0, s43, 0x4000
s_add_u32 s43, s43, 0x8000
buffer_load_dwordx4 v11, s[24:27], s42 offen lds
v_add_f32 v5, v5, v52
v_add_f32 v5, v5, v53
cvtpk v196, v52, v53
mf32 v[176:191], v[244:247], v[148:151], v[176:191]
ds_read_b128 v[244:247], v2 offset:5120
v_exp_f32 v54, v170
v_exp_f32 v55, v171
buffer_load_dwordx4 v11, s[24:27], s42 offen offset:1024 lds
s_and_b32 s43, s43, 0x1ffff
s_add_u32 s42, s42, 0x4000
v_add_f32 v5, v5, v54
v_add_f32 v5, v5, v55
cvtpk v197, v54, v55
mf32 v[176:191], v[248:251], v[152:155], v[176:191]
ds_read_b128 v[248:251], v2 offset:6144
v_exp_f32 v50, v172
v_exp_f32 v51, v173
s_nop 0
v_add_f32 v5, v5, v50
v_add_f32 v5, v5, v51
cvtpk v198, v50, v51
mf32 v[176:191], v[252:255], v[156:159], v[176:191]
ds_read_b128 v[252:255], v2 offset:7168
v_exp_f32 v52, v174
v_exp_f32 v53, v175
s_nop 0
v_add_f32 v5, v5, v52
v_add_f32 v5, v5, v53
cvtpk v199, v52, v53
s_nop 4
s_sub_u32 s20, s20, 1
s_branch attn_kernel_S_back0
attn_kernel_S_it0:
s_waitcnt lgkmcnt(4)
mf32 v[176:191], v[224:227], v[128:131], v[208:223]
ds_read_b128 v[224:227], v3 offset:8192
v_add_f32 v4, v4, v5
v_exp_f32 v50, v160
v_exp_f32 v51, v161
mf32 v[176:191], v[228:231], v[132:135], v[176:191]
ds_read_b128 v[228:231], v3 offset:10240
v_exp_f32 v52, v162
v_add_f32 v5, v50, v51
cvtpk v192, v50, v51
mf32 v[176:191], v[232:235], v[136:139], v[176:191]
ds_read_b128 v[232:235], v3 offset:12288
v_exp_f32 v53, v163
v_exp_f32 v54, v164
v_add_f32 v5, v5, v52
v_add_u32 v2, 0x8000, v2
mf32 v[176:191], v[236:239], v[140:143], v[176:191]
ds_read_b128 v[236:239], v3 offset:14336
v_exp_f32 v55, v165
v_add_f32 v5, v5, v53
cvtpk v193, v52, v53
v_add_f32 v5, v5, v54
s_waitcnt lgkmcnt(4)
mf32 v[176:191], v[240:243], v[144:147], v[176:191]
s_waitcnt vmcnt(14)
s_barrier
s_sub_u32 s41, s41, 1
ds_read_b128 v[240:243], v3 offset:9216
v_exp_f32 v50, v166
v_add_f32 v5, v5, v55
cvtpk v194, v54, v55
mf32 v[176:191], v[244:247], v[148:151], v[176:191]
s_mov_b32 m0, s44
ds_read_b128 v[244:247], v3 offset:11264
v_exp_f32 v51, v167
v_add_f32 v5, v5, v50
buffer_load_dwordx4 v10, s[28:31], s42 offen lds
mf32 v[176:191], v[248:251], v[152:155], v[176:191]
ds_read_b128 v[248:251], v3 offset:13312
v_exp_f32 v52, v168
v_add_f32 v5, v5, v51
cvtpk v195, v50, v51
v_and_b32 v2, 0x1ffff, v2
buffer_load_dwordx4 v10, s[28:31], s42 offen offset:1024 lds
s_add_u32 m0, s44, 0x4000
mf32 v[176:191], v[252:255], v[156:159], v[176:191]
ds_read_b128 v[252:255], v3 offset:15360
v_exp_f32 v53, v169
v_add_f32 v5, v5, v52
buffer_load_dwordx4 v11, s[28:31], s42 offen lds
s_waitcnt lgkmcnt(4)
mf32 v[64:79], v[224:227], v[200:203], v[64:79]
ds_read_b128 v[224:227], v2 offset:0
v_exp_f32 v54, v170
v_add_f32 v5, v5, v53
cvtpk v196, v52, v53
buffer_load_dwordx4 v11, s[28:31], s42 offen offset:1024 lds
s_mov_b32 m0, s43
mf32 v[80:95], v[228:231], v[200:203], v[80:95]
ds_read_b128 v[228:231], v2 offset:1024
v_exp_f32 v55, v171
v_add_f32 v5, v5, v54
s_add_u32 s44, s43, 0x2000
buffer_load_dwordx4 v10, s[24:27], s42 offen lds
mf32 v[96:111], v[232:235], v[200:203], v[96:111]
ds_read_b128 v[232:235], v2 offset:2048
v_exp_f32 v50, v172
v_add_f32 v5, v5, v55
cvtpk v197, v54, v55
buffer_load_dwordx4 v10, s[24:27], s42 offen offset:1024 lds
s_add_u32 m0, s43, 0x4000
mf32 v[112:127], v[236:239], v[200:203], v[112:127]
ds_read_b128 v[236:239], v2 offset:3072
v_exp_f32 v51, v173
v_add_f32 v5, v5, v50
buffer_load_dwordx4 v11, s[24:27], s42 offen lds
s_waitcnt lgkmcnt(4)
mf32 v[64:79], v[240:243], v[204:207], v[64:79]
ds_read_b128 v[240:243], v2 offset:4096
v_exp_f32 v52, v174
v_add_f32 v5, v5, v51
cvtpk v198, v50, v51
buffer_load_dwordx4 v11, s[24:27], s42 offen offset:1024 lds
s_add_u32 s43, s43, 0x8000
mf32 v[80:95], v[244:247], v[204:207], v[80:95]
ds_read_b128 v[244:247], v2 offset:5120
v_exp_f32 v53, v175
v_add_f32 v5, v5, v52
s_and_b32 s43, s43, 0x1ffff
s_add_u32 s42, s42, 0x4000
mf32 v[96:111], v[248:251], v[204:207], v[96:111]
ds_read_b128 v[248:251], v2 offset:6144
v_add_f32 v5, v5, v53
s_sub_u32 s20, s20, 1
v_cmp_nge_f32 vcc, s40, v5
mf32 v[112:127], v[252:255], v[204:207], v[112:127]
ds_read_b128 v[252:255], v2 offset:7168
cvtpk v199, v52, v53
s_cbranch_vccnz attn_kernel_S_slow0
attn_kernel_S_back0:
s_cbranch_scc1 attn_kernel_S_spec0
attn_kernel_S_it1:
s_waitcnt lgkmcnt(4)
mf32 v[160:175], v[224:227], v[128:131], v[208:223]
ds_read_b128 v[224:227], v3 offset:24576
v_add_f32 v4, v4, v5
v_exp_f32 v50, v176
v_exp_f32 v51, v177
mf32 v[160:175], v[228:231], v[132:135], v[160:175]
ds_read_b128 v[228:231], v3 offset:26624
v_exp_f32 v52, v178
v_add_f32 v5, v50, v51
cvtpk v200, v50, v51
mf32 v[160:175], v[232:235], v[136:139], v[160:175]
ds_read_b128 v[232:235], v3 offset:28672
v_exp_f32 v53, v179
v_exp_f32 v54, v180
v_add_f32 v5, v5, v52
mf32 v[160:175], v[236:239], v[140:143], v[160:175]
ds_read_b128 v[236:239], v3 offset:30720
v_exp_f32 v55, v181
v_add_f32 v5, v5, v53
cvtpk v201, v52, v53
v_add_f32 v5, v5, v54
s_waitcnt lgkmcnt(4)
mf32 v[160:175], v[240:243], v[144:147], v[160:175]
ds_read_b128 v[240:243], v3 offset:25600
v_exp_f32 v50, v182
v_add_f32 v5, v5, v55
cvtpk v202, v54, v55
mf32 v[160:175], v[244:247], v[148:151], v[160:175]
ds_read_b128 v[244:247], v3 offset:27648
v_exp_f32 v51, v183
v_add_f32 v5, v5, v50
mf32 v[160:175], v[248:251], v[152:155], v[160:175]
ds_read_b128 v[248:251], v3 offset:29696
v_exp_f32 v52, v184
v_add_f32 v5, v5, v51
cvtpk v203, v50, v51
mf32 v[160:175], v[252:255], v[156:159], v[160:175]
ds_read_b128 v[252:255], v3 offset:31744
v_exp_f32 v53, v185
v_add_f32 v5, v5, v52
s_waitcnt lgkmcnt(4)
mf32 v[64:79], v[224:227], v[192:195], v[64:79]
ds_read_b128 v[224:227], v2 offset:16384
v_exp_f32 v54, v186
v_add_f32 v5, v5, v53
cvtpk v204, v52, v53
mf32 v[80:95], v[228:231], v[192:195], v[80:95]
ds_read_b128 v[228:231], v2 offset:17408
v_exp_f32 v55, v187
v_add_f32 v5, v5, v54
mf32 v[96:111], v[232:235], v[192:195], v[96:111]
ds_read_b128 v[232:235], v2 offset:18432
v_exp_f32 v50, v188
v_add_f32 v5, v5, v55
cvtpk v205, v54, v55
v_mov_b32 v3, v2
mf32 v[112:127], v[236:239], v[192:195], v[112:127]
ds_read_b128 v[236:239], v2 offset:19456
v_exp_f32 v51, v189
v_add_f32 v5, v5, v50
s_waitcnt lgkmcnt(4)
mf32 v[64:79], v[240:243], v[196:199], v[64:79]
ds_read_b128 v[240:243], v2 offset:20480
v_exp_f32 v52, v190
v_add_f32 v5, v5, v51
cvtpk v206, v50, v51
mf32 v[80:95], v[244:247], v[196:199], v[80:95]
ds_read_b128 v[244:247], v2 offset:21504
v_exp_f32 v53, v191
v_add_f32 v5, v5, v52
mf32 v[96:111], v[248:251], v[196:199], v[96:111]
ds_read_b128 v[248:251], v2 offset:22528
v_add_f32 v5, v5, v53
s_sub_u32 s20, s20, 1
v_cmp_nge_f32 vcc, s40, v5
mf32 v[112:127], v[252:255], v[196:199], v[112:127]
ds_read_b128 v[252:255], v2 offset:23552
cvtpk v207, v52, v53
s_cbranch_vccnz attn_kernel_S_slow1
attn_kernel_S_back1:
s_cbranch_scc1 attn_kernel_S_spec1
s_branch attn_kernel_S_it0
attn_kernel_S_slow0:
s_cselect_b32 s22, 1, 0
s_nop 15
v_max3_f32 v13, v160, v161, v162
v_max3_f32 v13, v13, v163, v164
v_max3_f32 v13, v13, v165, v166
v_max3_f32 v13, v13, v167, v168
v_max3_f32 v13, v13, v169, v170
v_max3_f32 v13, v13, v171, v172
v_max3_f32 v13, v13, v173, v174
v_max_f32 v13, v13, v175
v_mov_b32 v15, v13
s_nop 1
v_permlane32_swap_b32 v13, v15
v_max_f32 v13, v13, v15
v_max_f32 v13, 0, v13
v_exp_f32_e64 v14, -v13
v_sub_f32 v208, v208, v13
v_sub_f32 v160, v160, v13
v_sub_f32 v176, v176, v13
v_sub_f32 v209, v209, v13
v_sub_f32 v161, v161, v13
v_sub_f32 v177, v177, v13
v_sub_f32 v210, v210, v13
v_sub_f32 v162, v162, v13
v_sub_f32 v178, v178, v13
v_sub_f32 v211, v211, v13
v_sub_f32 v163, v163, v13
v_sub_f32 v179, v179, v13
v_sub_f32 v212, v212, v13
v_sub_f32 v164, v164, v13
v_sub_f32 v180, v180, v13
v_sub_f32 v213, v213, v13
v_sub_f32 v165, v165, v13
v_sub_f32 v181, v181, v13
v_sub_f32 v214, v214, v13
v_sub_f32 v166, v166, v13
v_sub_f32 v182, v182, v13
v_sub_f32 v215, v215, v13
v_sub_f32 v167, v167, v13
v_sub_f32 v183, v183, v13
v_sub_f32 v216, v216, v13
v_sub_f32 v168, v168, v13
v_sub_f32 v184, v184, v13
v_sub_f32 v217, v217, v13
v_sub_f32 v169, v169, v13
v_sub_f32 v185, v185, v13
v_sub_f32 v218, v218, v13
v_sub_f32 v170, v170, v13
v_sub_f32 v186, v186, v13
v_sub_f32 v219, v219, v13
v_sub_f32 v171, v171, v13
v_sub_f32 v187, v187, v13
v_sub_f32 v220, v220, v13
v_sub_f32 v172, v172, v13
v_sub_f32 v188, v188, v13
v_sub_f32 v221, v221, v13
v_sub_f32 v173, v173, v13
v_sub_f32 v189, v189, v13
v_sub_f32 v222, v222, v13
v_sub_f32 v174, v174, v13
v_sub_f32 v190, v190, v13
v_sub_f32 v223, v223, v13
v_sub_f32 v175, v175, v13
v_sub_f32 v191, v191, v13
v_mul_f32 v64, v64, v14
v_mul_f32 v65, v65, v14
v_mul_f32 v66, v66, v14
v_mul_f32 v67, v67, v14
v_mul_f32 v68, v68, v14
v_mul_f32 v69, v69, v14
v_mul_f32 v70, v70, v14
v_mul_f32 v71, v71, v14
v_mul_f32 v72, v72, v14
v_mul_f32 v73, v73, v14
v_mul_f32 v74, v74, v14
v_mul_f32 v75, v75, v14
v_mul_f32 v76, v76, v14
v_mul_f32 v77, v77, v14
v_mul_f32 v78, v78, v14
v_mul_f32 v79, v79, v14
v_mul_f32 v80, v80, v14
v_mul_f32 v81, v81, v14
v_mul_f32 v82, v82, v14
v_mul_f32 v83, v83, v14
v_mul_f32 v84, v84, v14
v_mul_f32 v85, v85, v14
v_mul_f32 v86, v86, v14
v_mul_f32 v87, v87, v14
v_mul_f32 v88, v88, v14
v_mul_f32 v89, v89, v14
v_mul_f32 v90, v90, v14
v_mul_f32 v91, v91, v14
v_mul_f32 v92, v92, v14
v_mul_f32 v93, v93, v14
v_mul_f32 v94, v94, v14
v_mul_f32 v95, v95, v14
v_mul_f32 v96, v96, v14
v_mul_f32 v97, v97, v14
v_mul_f32 v98, v98, v14
v_mul_f32 v99, v99, v14
v_mul_f32 v100, v100, v14
v_mul_f32 v101, v101, v14
v_mul_f32 v102, v102, v14
v_mul_f32 v103, v103, v14
v_mul_f32 v104, v104, v14
v_mul_f32 v105, v105, v14
v_mul_f32 v106, v106, v14
v_mul_f32 v107, v107, v14
v_mul_f32 v108, v108, v14
v_mul_f32 v109, v109, v14
v_mul_f32 v110, v110, v14
v_mul_f32 v111, v111, v14
v_mul_f32 v112, v112, v14
v_mul_f32 v113, v113, v14
v_mul_f32 v114, v114, v14
v_mul_f32 v115, v115, v14
v_mul_f32 v116, v116, v14
v_mul_f32 v117, v117, v14
v_mul_f32 v118, v118, v14
v_mul_f32 v119, v119, v14
v_mul_f32 v120, v120, v14
v_mul_f32 v121, v121, v14
v_mul_f32 v122, v122, v14
v_mul_f32 v123, v123, v14
v_mul_f32 v124, v124, v14
v_mul_f32 v125, v125, v14
v_mul_f32 v126, v126, v14
v_mul_f32 v127, v127, v14
v_mul_f32 v4, v4, v14
v_mov_b32 v5, 0
v_exp_f32 v6, v160
v_exp_f32 v7, v161
s_nop 0
v_add_f32 v5, v5, v6
v_add_f32 v5, v5, v7
cvtpk v192, v6, v7
v_exp_f32 v6, v162
v_exp_f32 v7, v163
s_nop 0
v_add_f32 v5, v5, v6
v_add_f32 v5, v5, v7
cvtpk v193, v6, v7
v_exp_f32 v6, v164
v_exp_f32 v7, v165
s_nop 0
v_add_f32 v5, v5, v6
v_add_f32 v5, v5, v7
cvtpk v194, v6, v7
v_exp_f32 v6, v166
v_exp_f32 v7, v167
s_nop 0
v_add_f32 v5, v5, v6
v_add_f32 v5, v5, v7
cvtpk v195, v6, v7
v_exp_f32 v6, v168
v_exp_f32 v7, v169
s_nop 0
v_add_f32 v5, v5, v6
v_add_f32 v5, v5, v7
cvtpk v196, v6, v7
v_exp_f32 v6, v170
v_exp_f32 v7, v171
s_nop 0
v_add_f32 v5, v5, v6
v_add_f32 v5, v5, v7
cvtpk v197, v6, v7
v_exp_f32 v6, v172
v_exp_f32 v7, v173
s_nop 0
v_add_f32 v5, v5, v6
v_add_f32 v5, v5, v7
cvtpk v198, v6, v7
v_exp_f32 v6, v174
v_exp_f32 v7, v175
s_nop 0
v_add_f32 v5, v5, v6
v_add_f32 v5, v5, v7
cvtpk v199, v6, v7
s_cmp_eq_u32 s21, 2
s_cbranch_scc1 attn_kernel_S_lback0
s_cmp_lg_u32 s22, 0
s_branch attn_kernel_S_back0
attn_kernel_S_spec0:
s_cmp_eq_u32 s21, 1
s_cbranch_scc1 attn_kernel_S_last1
s_cmp_eq_u32 s21, 3
s_cbranch_scc1 attn_kernel_S_exit0
s_mov_b32 s21, 1
s_mov_b32 s20, 0
v_cmp_le_i32 vcc, 0, v12
s_nop 1
v_cndmask_b32 v208, v48, v208, vcc
v_cmp_le_i32 vcc, 1, v12
s_nop 1
v_cndmask_b32 v209, v48, v209, vcc
v_cmp_le_i32 vcc, 2, v12
s_nop 1
v_cndmask_b32 v210, v48, v210, vcc
v_cmp_le_i32 vcc, 3, v12
s_nop 1
v_cndmask_b32 v211, v48, v211, vcc
v_cmp_le_i32 vcc, 8, v12
s_nop 1
v_cndmask_b32 v212, v48, v212, vcc
v_cmp_le_i32 vcc, 9, v12
s_nop 1
v_cndmask_b32 v213, v48, v213, vcc
v_cmp_le_i32 vcc, 10, v12
s_nop 1
v_cndmask_b32 v214, v48, v214, vcc
v_cmp_le_i32 vcc, 11, v12
s_nop 1
v_cndmask_b32 v215, v48, v215, vcc
v_cmp_le_i32 vcc, 16, v12
s_nop 1
v_cndmask_b32 v216, v48, v216, vcc
v_cmp_le_i32 vcc, 17, v12
s_nop 1
v_cndmask_b32 v217, v48, v217, vcc
v_cmp_le_i32 vcc, 18, v12
s_nop 1
v_cndmask_b32 v218, v48, v218, vcc
v_cmp_le_i32 vcc, 19, v12
s_nop 1
v_cndmask_b32 v219, v48, v219, vcc
v_cmp_le_i32 vcc, 24, v12
s_nop 1
v_cndmask_b32 v220, v48, v220, vcc
v_cmp_le_i32 vcc, 25, v12
s_nop 1
v_cndmask_b32 v221, v48, v221, vcc
v_cmp_le_i32 vcc, 26, v12
s_nop 1
v_cndmask_b32 v222, v48, v222, vcc
v_cmp_le_i32 vcc, 27, v12
s_nop 1
v_cndmask_b32 v223, v48, v223, vcc
s_nop 1
s_branch attn_kernel_S_it1
attn_kernel_S_last0:
s_mov_b32 s21, 2
s_waitcnt lgkmcnt(0)
ds_read_b128 v[224:227], v3 offset:8192
ds_read_b128 v[228:231], v3 offset:10240
ds_read_b128 v[232:235], v3 offset:12288
ds_read_b128 v[236:239], v3 offset:14336
ds_read_b128 v[240:243], v3 offset:9216
ds_read_b128 v[244:247], v3 offset:11264
ds_read_b128 v[248:251], v3 offset:13312
ds_read_b128 v[252:255], v3 offset:15360
v_add_f32 v4, v4, v5
v_mov_b32 v5, 0
s_waitcnt vmcnt(14)
s_barrier
s_sub_u32 s41, s41, 1
v_exp_f32 v50, v160
v_exp_f32 v51, v161
s_waitcnt lgkmcnt(7)
mf32 v[64:79], v[224:227], v[200:203], v[64:79]
ds_read_b128 v[224:227], v3 offset:24576
v_add_f32 v5, v5, v50
v_add_f32 v5, v5, v51
cvtpk v192, v50, v51
s_mov_b32 m0, s44
s_nop 0
buffer_load_dwordx4 v10, s[28:31], s42 offen lds
v_exp_f32 v52, v162
v_exp_f32 v53, v163
s_waitcnt lgkmcnt(7)
mf32 v[80:95], v[228:231], v[200:203], v[80:95]
ds_read_b128 v[228:231], v3 offset:26624
v_add_f32 v5, v5, v52
v_add_f32 v5, v5, v53
cvtpk v193, v52, v53
buffer_load_dwordx4 v10, s[28:31], s42 offen offset:1024 lds
s_add_u32 m0, s44, 0x4000
s_nop 0
v_exp_f32 v54, v164
v_exp_f32 v55, v165
s_waitcnt lgkmcnt(7)
mf32 v[96:111], v[232:235], v[200:203], v[96:111]
ds_read_b128 v[232:235], v3 offset:28672
v_add_f32 v5, v5, v54
v_add_f32 v5, v5, v55
cvtpk v194, v54, v55
buffer_load_dwordx4 v11, s[28:31], s42 offen lds
buffer_load_dwordx4 v11, s[28:31], s42 offen offset:1024 lds
s_mov_b32 m0, s43
v_exp_f32 v50, v166
v_exp_f32 v51, v167
s_waitcnt lgkmcnt(7)
mf32 v[112:127], v[236:239], v[200:203], v[112:127]
ds_read_b128 v[236:239], v3 offset:30720
v_add_f32 v5, v5, v50
v_add_f32 v5, v5, v51
cvtpk v195, v50, v51
s_add_u32 s44, s43, 0x2000
buffer_load_dwordx4 v10, s[24:27], s42 offen lds
buffer_load_dwordx4 v10, s[24:27], s42 offen offset:1024 lds
v_exp_f32 v52, v168
v_exp_f32 v53, v169
s_waitcnt lgkmcnt(7)
mf32 v[64:79], v[240:243], v[204:207], v[64:79]
ds_read_b128 v[240:243], v3 offset:25600
v_add_f32 v5, v5, v52
v_add_f32 v5, v5, v53
cvtpk v196, v52, v53
s_add_u32 m0, s43, 0x4000
s_add_u32 s43, s43, 0x8000
buffer_load_dwordx4 v11, s[24:27], s42 offen lds
v_exp_f32 v54, v170
v_exp_f32 v55, v171
s_waitcnt lgkmcnt(7)
mf32 v[80:95], v[244:247], v[204:207], v[80:95]
ds_read_b128 v[244:247], v3 offset:27648
v_add_f32 v5, v5, v54
v_add_f32 v5, v5, v55
cvtpk v197, v54, v55
buffer_load_dwordx4 v11, s[24:27], s42 offen offset:1024 lds
s_and_b32 s43, s43, 0x1ffff
s_add_u32 s42, s42, 0x4000
v_exp_f32 v50, v172
v_exp_f32 v51, v173
s_waitcnt lgkmcnt(7)
mf32 v[96:111], v[248:251], v[204:207], v[96:111]
ds_read_b128 v[248:251], v3 offset:29696
v_add_f32 v5, v5, v50
v_add_f32 v5, v5, v51
cvtpk v198, v50, v51
v_exp_f32 v52, v174
v_exp_f32 v53, v175
s_waitcnt lgkmcnt(7)
mf32 v[112:127], v[252:255], v[204:207], v[112:127]
ds_read_b128 v[252:255], v3 offset:31744
v_add_f32 v5, v5, v52
v_add_f32 v5, v5, v53
cvtpk v199, v52, v53
v_cmp_nge_f32 vcc, s40, v5
s_cbranch_vccnz attn_kernel_S_slow0
attn_kernel_S_lback0:
s_branch attn_kernel_S_fin0
attn_kernel_S_exit0:
s_waitcnt lgkmcnt(0)
ds_read_b128 v[224:227], v3 offset:24576
ds_read_b128 v[228:231], v3 offset:26624
ds_read_b128 v[232:235], v3 offset:28672
ds_read_b128 v[236:239], v3 offset:30720
ds_read_b128 v[240:243], v3 offset:25600
ds_read_b128 v[244:247], v3 offset:27648
ds_read_b128 v[248:251], v3 offset:29696
ds_read_b128 v[252:255], v3 offset:31744
attn_kernel_S_fin0:
v_add_f32 v4, v4, v5
s_waitcnt lgkmcnt(7)
mf32 v[64:79], v[224:227], v[192:195], v[64:79]
v_mov_b32 v15, v4
s_waitcnt lgkmcnt(3)
mf32 v[64:79], v[240:243], v[196:199], v[64:79]
s_waitcnt lgkmcnt(3)
mf32 v[80:95], v[228:231], v[192:195], v[80:95]
v_permlane32_swap_b32 v4, v15
s_waitcnt lgkmcnt(2)
mf32 v[80:95], v[244:247], v[196:199], v[80:95]
v_add_f32 v4, v4, v15
s_waitcnt lgkmcnt(2)
mf32 v[96:111], v[232:235], v[192:195], v[96:111]
v_rcp_f32 v13, v4
s_waitcnt lgkmcnt(1)
mf32 v[96:111], v[248:251], v[196:199], v[96:111]
s_waitcnt lgkmcnt(1)
mf32 v[112:127], v[236:239], v[192:195], v[112:127]
s_waitcnt lgkmcnt(0)
mf32 v[112:127], v[252:255], v[196:199], v[112:127]
s_branch attn_kernel_S_epi
attn_kernel_S_slow1:
s_cselect_b32 s22, 1, 0
s_nop 15
v_max3_f32 v13, v176, v177, v178
v_max3_f32 v13, v13, v179, v180
v_max3_f32 v13, v13, v181, v182
v_max3_f32 v13, v13, v183, v184
v_max3_f32 v13, v13, v185, v186
v_max3_f32 v13, v13, v187, v188
v_max3_f32 v13, v13, v189, v190
v_max_f32 v13, v13, v191
v_mov_b32 v15, v13
s_nop 1
v_permlane32_swap_b32 v13, v15
v_max_f32 v13, v13, v15
v_max_f32 v13, 0, v13
v_exp_f32_e64 v14, -v13
v_sub_f32 v208, v208, v13
v_sub_f32 v176, v176, v13
v_sub_f32 v160, v160, v13
v_sub_f32 v209, v209, v13
v_sub_f32 v177, v177, v13
v_sub_f32 v161, v161, v13
v_sub_f32 v210, v210, v13
v_sub_f32 v178, v178, v13
v_sub_f32 v162, v162, v13
v_sub_f32 v211, v211, v13
v_sub_f32 v179, v179, v13
v_sub_f32 v163, v163, v13
v_sub_f32 v212, v212, v13
v_sub_f32 v180, v180, v13
v_sub_f32 v164, v164, v13
v_sub_f32 v213, v213, v13
v_sub_f32 v181, v181, v13
v_sub_f32 v165, v165, v13
v_sub_f32 v214, v214, v13
v_sub_f32 v182, v182, v13
v_sub_f32 v166, v166, v13
v_sub_f32 v215, v215, v13
v_sub_f32 v183, v183, v13
v_sub_f32 v167, v167, v13
v_sub_f32 v216, v216, v13
v_sub_f32 v184, v184, v13
v_sub_f32 v168, v168, v13
v_sub_f32 v217, v217, v13
v_sub_f32 v185, v185, v13
v_sub_f32 v169, v169, v13
v_sub_f32 v218, v218, v13
v_sub_f32 v186, v186, v13
v_sub_f32 v170, v170, v13
v_sub_f32 v219, v219, v13
v_sub_f32 v187, v187, v13
v_sub_f32 v171, v171, v13
v_sub_f32 v220, v220, v13
v_sub_f32 v188, v188, v13
v_sub_f32 v172, v172, v13
v_sub_f32 v221, v221, v13
v_sub_f32 v189, v189, v13
v_sub_f32 v173, v173, v13
v_sub_f32 v222, v222, v13
v_sub_f32 v190, v190, v13
v_sub_f32 v174, v174, v13
v_sub_f32 v223, v223, v13
v_sub_f32 v191, v191, v13
v_sub_f32 v175, v175, v13
v_mul_f32 v64, v64, v14
v_mul_f32 v65, v65, v14
v_mul_f32 v66, v66, v14
v_mul_f32 v67, v67, v14
v_mul_f32 v68, v68, v14
v_mul_f32 v69, v69, v14
v_mul_f32 v70, v70, v14
v_mul_f32 v71, v71, v14
v_mul_f32 v72, v72, v14
v_mul_f32 v73, v73, v14
v_mul_f32 v74, v74, v14
v_mul_f32 v75, v75, v14
v_mul_f32 v76, v76, v14
v_mul_f32 v77, v77, v14
v_mul_f32 v78, v78, v14
v_mul_f32 v79, v79, v14
v_mul_f32 v80, v80, v14
v_mul_f32 v81, v81, v14
v_mul_f32 v82, v82, v14
v_mul_f32 v83, v83, v14
v_mul_f32 v84, v84, v14
v_mul_f32 v85, v85, v14
v_mul_f32 v86, v86, v14
v_mul_f32 v87, v87, v14
v_mul_f32 v88, v88, v14
v_mul_f32 v89, v89, v14
v_mul_f32 v90, v90, v14
v_mul_f32 v91, v91, v14
v_mul_f32 v92, v92, v14
v_mul_f32 v93, v93, v14
v_mul_f32 v94, v94, v14
v_mul_f32 v95, v95, v14
v_mul_f32 v96, v96, v14
v_mul_f32 v97, v97, v14
v_mul_f32 v98, v98, v14
v_mul_f32 v99, v99, v14
v_mul_f32 v100, v100, v14
v_mul_f32 v101, v101, v14
v_mul_f32 v102, v102, v14
v_mul_f32 v103, v103, v14
v_mul_f32 v104, v104, v14
v_mul_f32 v105, v105, v14
v_mul_f32 v106, v106, v14
v_mul_f32 v107, v107, v14
v_mul_f32 v108, v108, v14
v_mul_f32 v109, v109, v14
v_mul_f32 v110, v110, v14
v_mul_f32 v111, v111, v14
v_mul_f32 v112, v112, v14
v_mul_f32 v113, v113, v14
v_mul_f32 v114, v114, v14
v_mul_f32 v115, v115, v14
v_mul_f32 v116, v116, v14
v_mul_f32 v117, v117, v14
v_mul_f32 v118, v118, v14
v_mul_f32 v119, v119, v14
v_mul_f32 v120, v120, v14
v_mul_f32 v121, v121, v14
v_mul_f32 v122, v122, v14
v_mul_f32 v123, v123, v14
v_mul_f32 v124, v124, v14
v_mul_f32 v125, v125, v14
v_mul_f32 v126, v126, v14
v_mul_f32 v127, v127, v14
v_mul_f32 v4, v4, v14
v_mov_b32 v5, 0
v_exp_f32 v6, v176
v_exp_f32 v7, v177
s_nop 0
v_add_f32 v5, v5, v6
v_add_f32 v5, v5, v7
cvtpk v200, v6, v7
v_exp_f32 v6, v178
v_exp_f32 v7, v179
s_nop 0
v_add_f32 v5, v5, v6
v_add_f32 v5, v5, v7
cvtpk v201, v6, v7
v_exp_f32 v6, v180
v_exp_f32 v7, v181
s_nop 0
v_add_f32 v5, v5, v6
v_add_f32 v5, v5, v7
cvtpk v202, v6, v7
v_exp_f32 v6, v182
v_exp_f32 v7, v183
s_nop 0
v_add_f32 v5, v5, v6
v_add_f32 v5, v5, v7
cvtpk v203, v6, v7
v_exp_f32 v6, v184
v_exp_f32 v7, v185
s_nop 0
v_add_f32 v5, v5, v6
v_add_f32 v5, v5, v7
cvtpk v204, v6, v7
v_exp_f32 v6, v186
v_exp_f32 v7, v187
s_nop 0
v_add_f32 v5, v5, v6
v_add_f32 v5, v5, v7
cvtpk v205, v6, v7
v_exp_f32 v6, v188
v_exp_f32 v7, v189
s_nop 0
v_add_f32 v5, v5, v6
v_add_f32 v5, v5, v7
cvtpk v206, v6, v7
v_exp_f32 v6, v190
v_exp_f32 v7, v191
s_nop 0
v_add_f32 v5, v5, v6
v_add_f32 v5, v5, v7
cvtpk v207, v6, v7
s_cmp_eq_u32 s21, 2
s_cbranch_scc1 attn_kernel_S_lback1
s_cmp_lg_u32 s22, 0
s_branch attn_kernel_S_back1
attn_kernel_S_spec1:
s_cmp_eq_u32 s21, 1
s_cbranch_scc1 attn_kernel_S_last0
s_mov_b32 s21, 1
s_mov_b32 s20, 0
v_cmp_le_i32 vcc, 0, v12
s_nop 1
v_cndmask_b32 v208, v48, v208, vcc
v_cmp_le_i32 vcc, 1, v12
s_nop 1
v_cndmask_b32 v209, v48, v209, vcc
v_cmp_le_i32 vcc, 2, v12
s_nop 1
v_cndmask_b32 v210, v48, v210, vcc
v_cmp_le_i32 vcc, 3, v12
s_nop 1
v_cndmask_b32 v211, v48, v211, vcc
v_cmp_le_i32 vcc, 8, v12
s_nop 1
v_cndmask_b32 v212, v48, v212, vcc
v_cmp_le_i32 vcc, 9, v12
s_nop 1
v_cndmask_b32 v213, v48, v213, vcc
v_cmp_le_i32 vcc, 10, v12
s_nop 1
v_cndmask_b32 v214, v48, v214, vcc
v_cmp_le_i32 vcc, 11, v12
s_nop 1
v_cndmask_b32 v215, v48, v215, vcc
v_cmp_le_i32 vcc, 16, v12
s_nop 1
v_cndmask_b32 v216, v48, v216, vcc
v_cmp_le_i32 vcc, 17, v12
s_nop 1
v_cndmask_b32 v217, v48, v217, vcc
v_cmp_le_i32 vcc, 18, v12
s_nop 1
v_cndmask_b32 v218, v48, v218, vcc
v_cmp_le_i32 vcc, 19, v12
s_nop 1
v_cndmask_b32 v219, v48, v219, vcc
v_cmp_le_i32 vcc, 24, v12
s_nop 1
v_cndmask_b32 v220, v48, v220, vcc
v_cmp_le_i32 vcc, 25, v12
s_nop 1
v_cndmask_b32 v221, v48, v221, vcc
v_cmp_le_i32 vcc, 26, v12
s_nop 1
v_cndmask_b32 v222, v48, v222, vcc
v_cmp_le_i32 vcc, 27, v12
s_nop 1
v_cndmask_b32 v223, v48, v223, vcc
s_nop 1
s_branch attn_kernel_S_it0
attn_kernel_S_last1:
s_mov_b32 s21, 2
s_waitcnt lgkmcnt(0)
ds_read_b128 v[224:227], v3 offset:24576
ds_read_b128 v[228:231], v3 offset:26624
ds_read_b128 v[232:235], v3 offset:28672
ds_read_b128 v[236:239], v3 offset:30720
ds_read_b128 v[240:243], v3 offset:25600
ds_read_b128 v[244:247], v3 offset:27648
ds_read_b128 v[248:251], v3 offset:29696
ds_read_b128 v[252:255], v3 offset:31744
v_add_f32 v4, v4, v5
v_mov_b32 v5, 0
v_exp_f32 v50, v176
v_exp_f32 v51, v177
s_waitcnt lgkmcnt(7)
mf32 v[64:79], v[224:227], v[192:195], v[64:79]
ds_read_b128 v[224:227], v2 offset:8192
v_add_f32 v5, v5, v50
v_add_f32 v5, v5, v51
cvtpk v200, v50, v51
v_exp_f32 v52, v178
v_exp_f32 v53, v179
s_waitcnt lgkmcnt(7)
mf32 v[80:95], v[228:231], v[192:195], v[80:95]
ds_read_b128 v[228:231], v2 offset:10240
v_add_f32 v5, v5, v52
v_add_f32 v5, v5, v53
cvtpk v201, v52, v53
v_exp_f32 v54, v180
v_exp_f32 v55, v181
s_waitcnt lgkmcnt(7)
mf32 v[96:111], v[232:235], v[192:195], v[96:111]
ds_read_b128 v[232:235], v2 offset:12288
v_add_f32 v5, v5, v54
v_add_f32 v5, v5, v55
cvtpk v202, v54, v55
v_exp_f32 v50, v182
v_exp_f32 v51, v183
s_waitcnt lgkmcnt(7)
mf32 v[112:127], v[236:239], v[192:195], v[112:127]
ds_read_b128 v[236:239], v2 offset:14336
v_add_f32 v5, v5, v50
v_add_f32 v5, v5, v51
cvtpk v203, v50, v51
v_exp_f32 v52, v184
v_exp_f32 v53, v185
s_waitcnt lgkmcnt(7)
mf32 v[64:79], v[240:243], v[196:199], v[64:79]
ds_read_b128 v[240:243], v2 offset:9216
v_add_f32 v5, v5, v52
v_add_f32 v5, v5, v53
cvtpk v204, v52, v53
v_exp_f32 v54, v186
v_exp_f32 v55, v187
s_waitcnt lgkmcnt(7)
mf32 v[80:95], v[244:247], v[196:199], v[80:95]
ds_read_b128 v[244:247], v2 offset:11264
v_add_f32 v5, v5, v54
v_add_f32 v5, v5, v55
cvtpk v205, v54, v55
v_exp_f32 v50, v188
v_exp_f32 v51, v189
s_waitcnt lgkmcnt(7)
mf32 v[96:111], v[248:251], v[196:199], v[96:111]
ds_read_b128 v[248:251], v2 offset:13312
v_add_f32 v5, v5, v50
v_add_f32 v5, v5, v51
cvtpk v206, v50, v51
v_exp_f32 v52, v190
v_exp_f32 v53, v191
s_waitcnt lgkmcnt(7)
mf32 v[112:127], v[252:255], v[196:199], v[112:127]
ds_read_b128 v[252:255], v2 offset:15360
v_add_f32 v5, v5, v52
v_add_f32 v5, v5, v53
cvtpk v207, v52, v53
v_cmp_nge_f32 vcc, s40, v5
s_cbranch_vccnz attn_kernel_S_slow1
attn_kernel_S_lback1:
v_add_f32 v4, v4, v5
s_waitcnt lgkmcnt(7)
mf32 v[64:79], v[224:227], v[200:203], v[64:79]
v_mov_b32 v15, v4
s_waitcnt lgkmcnt(3)
mf32 v[64:79], v[240:243], v[204:207], v[64:79]
s_waitcnt lgkmcnt(3)
mf32 v[80:95], v[228:231], v[200:203], v[80:95]
v_permlane32_swap_b32 v4, v15
s_waitcnt lgkmcnt(2)
mf32 v[80:95], v[244:247], v[204:207], v[80:95]
v_add_f32 v4, v4, v15
s_waitcnt lgkmcnt(2)
mf32 v[96:111], v[232:235], v[200:203], v[96:111]
v_rcp_f32 v13, v4
s_waitcnt lgkmcnt(1)
mf32 v[96:111], v[248:251], v[204:207], v[96:111]
s_waitcnt lgkmcnt(1)
mf32 v[112:127], v[236:239], v[200:203], v[112:127]
s_waitcnt lgkmcnt(0)
mf32 v[112:127], v[252:255], v[204:207], v[112:127]
attn_kernel_S_epi:
s_cmp_eq_u32 s41, 0
s_cbranch_scc1 attn_kernel_S_svc_7
s_waitcnt vmcnt(14)
s_barrier
s_sub_u32 s41, s41, 1
s_mov_b32 m0, s44
s_nop 0
buffer_load_dwordx4 v10, s[28:31], s42 offen lds
buffer_load_dwordx4 v10, s[28:31], s42 offen offset:1024 lds
s_add_u32 m0, s44, 0x4000
s_nop 0
buffer_load_dwordx4 v11, s[28:31], s42 offen lds
buffer_load_dwordx4 v11, s[28:31], s42 offen offset:1024 lds
s_mov_b32 m0, s43
s_add_u32 s44, s43, 0x2000
buffer_load_dwordx4 v10, s[24:27], s42 offen lds
buffer_load_dwordx4 v10, s[24:27], s42 offen offset:1024 lds
s_add_u32 m0, s43, 0x4000
s_add_u32 s43, s43, 0x8000
buffer_load_dwordx4 v11, s[24:27], s42 offen lds
buffer_load_dwordx4 v11, s[24:27], s42 offen offset:1024 lds
s_and_b32 s43, s43, 0x1ffff
s_add_u32 s42, s42, 0x4000
attn_kernel_S_svc_7:
v_mul_f32 v64, v64, v13
v_mul_f32 v65, v65, v13
cvtpk v16, v64, v65
v_mul_f32 v66, v66, v13
v_mul_f32 v67, v67, v13
cvtpk v17, v66, v67
v_mul_f32 v68, v68, v13
v_mul_f32 v69, v69, v13
cvtpk v18, v68, v69
v_mul_f32 v70, v70, v13
v_mul_f32 v71, v71, v13
cvtpk v19, v70, v71
buffer_store_dwordx4 v[16:19], v1, s[36:39], s46 offen offset:0 sc1
v_mul_f32 v72, v72, v13
v_mul_f32 v73, v73, v13
cvtpk v20, v72, v73
v_mul_f32 v74, v74, v13
v_mul_f32 v75, v75, v13
cvtpk v21, v74, v75
v_mul_f32 v76, v76, v13
v_mul_f32 v77, v77, v13
cvtpk v22, v76, v77
v_mul_f32 v78, v78, v13
v_mul_f32 v79, v79, v13
cvtpk v23, v78, v79
buffer_store_dwordx4 v[20:23], v1, s[36:39], s46 offen offset:1024 sc1
v_mul_f32 v80, v80, v13
v_mul_f32 v81, v81, v13
cvtpk v24, v80, v81
v_mul_f32 v82, v82, v13
v_mul_f32 v83, v83, v13
cvtpk v25, v82, v83
v_mul_f32 v84, v84, v13
v_mul_f32 v85, v85, v13
cvtpk v26, v84, v85
v_mul_f32 v86, v86, v13
v_mul_f32 v87, v87, v13
cvtpk v27, v86, v87
buffer_store_dwordx4 v[24:27], v1, s[36:39], s46 offen offset:2048 sc1
v_mul_f32 v88, v88, v13
v_mul_f32 v89, v89, v13
cvtpk v28, v88, v89
v_mul_f32 v90, v90, v13
v_mul_f32 v91, v91, v13
cvtpk v29, v90, v91
v_mul_f32 v92, v92, v13
v_mul_f32 v93, v93, v13
cvtpk v30, v92, v93
v_mul_f32 v94, v94, v13
v_mul_f32 v95, v95, v13
cvtpk v31, v94, v95
buffer_store_dwordx4 v[28:31], v1, s[36:39], s46 offen offset:3072 sc1
s_cmp_eq_u32 s41, 0
s_cbranch_scc1 attn_kernel_S_svc_8
s_waitcnt vmcnt(14)
s_barrier
s_sub_u32 s41, s41, 1
s_mov_b32 m0, s44
s_nop 0
buffer_load_dwordx4 v10, s[28:31], s42 offen lds
buffer_load_dwordx4 v10, s[28:31], s42 offen offset:1024 lds
s_add_u32 m0, s44, 0x4000
s_nop 0
buffer_load_dwordx4 v11, s[28:31], s42 offen lds
buffer_load_dwordx4 v11, s[28:31], s42 offen offset:1024 lds
s_mov_b32 m0, s43
s_add_u32 s44, s43, 0x2000
buffer_load_dwordx4 v10, s[24:27], s42 offen lds
buffer_load_dwordx4 v10, s[24:27], s42 offen offset:1024 lds
s_add_u32 m0, s43, 0x4000
s_add_u32 s43, s43, 0x8000
buffer_load_dwordx4 v11, s[24:27], s42 offen lds
buffer_load_dwordx4 v11, s[24:27], s42 offen offset:1024 lds
s_and_b32 s43, s43, 0x1ffff
s_add_u32 s42, s42, 0x4000
attn_kernel_S_svc_8:
v_mul_f32 v96, v96, v13
v_mul_f32 v97, v97, v13
cvtpk v32, v96, v97
v_mul_f32 v98, v98, v13
v_mul_f32 v99, v99, v13
cvtpk v33, v98, v99
v_mul_f32 v100, v100, v13
v_mul_f32 v101, v101, v13
cvtpk v34, v100, v101
v_mul_f32 v102, v102, v13
v_mul_f32 v103, v103, v13
cvtpk v35, v102, v103
buffer_store_dwordx4 v[32:35], v1, s[36:39], s47 offen offset:0 sc1
v_mul_f32 v104, v104, v13
v_mul_f32 v105, v105, v13
cvtpk v36, v104, v105
v_mul_f32 v106, v106, v13
v_mul_f32 v107, v107, v13
cvtpk v37, v106, v107
v_mul_f32 v108, v108, v13
v_mul_f32 v109, v109, v13
cvtpk v38, v108, v109
v_mul_f32 v110, v110, v13
v_mul_f32 v111, v111, v13
cvtpk v39, v110, v111
buffer_store_dwordx4 v[36:39], v1, s[36:39], s47 offen offset:1024 sc1
v_mul_f32 v112, v112, v13
v_mul_f32 v113, v113, v13
cvtpk v40, v112, v113
v_mul_f32 v114, v114, v13
v_mul_f32 v115, v115, v13
cvtpk v41, v114, v115
v_mul_f32 v116, v116, v13
v_mul_f32 v117, v117, v13
cvtpk v42, v116, v117
v_mul_f32 v118, v118, v13
v_mul_f32 v119, v119, v13
cvtpk v43, v118, v119
buffer_store_dwordx4 v[40:43], v1, s[36:39], s47 offen offset:2048 sc1
v_mul_f32 v120, v120, v13
v_mul_f32 v121, v121, v13
cvtpk v44, v120, v121
v_mul_f32 v122, v122, v13
v_mul_f32 v123, v123, v13
cvtpk v45, v122, v123
v_mul_f32 v124, v124, v13
v_mul_f32 v125, v125, v13
cvtpk v46, v124, v125
v_mul_f32 v126, v126, v13
v_mul_f32 v127, v127, v13
cvtpk v47, v126, v127
buffer_store_dwordx4 v[44:47], v1, s[36:39], s47 offen offset:3072 sc1
v_mov_b32 v6, -1
v_mov_b32 v7, -1
v_mov_b32 v8, -1
v_mov_b32 v9, -1
buffer_store_dwordx4 v[6:9], v1, s[32:35], s12 offen offset:0 sc1
buffer_store_dwordx4 v[6:9], v1, s[32:35], s12 offen offset:1024 sc1
buffer_store_dwordx4 v[6:9], v1, s[32:35], s13 offen offset:0 sc1
buffer_store_dwordx4 v[6:9], v1, s[32:35], s13 offen offset:1024 sc1
s_lshl_b32 s12, s18, 2
s_sub_u32 s12, 56, s12
s_add_u32 s12, s12, s16
s_lshl_b32 s12, s12, 18
s_lshl_b32 s13, s17, 13
s_add_u32 s12, s12, s13
s_add_u32 s13, s12, 4096
v_mov_b32 v6, -1
v_mov_b32 v7, -1
v_mov_b32 v8, -1
v_mov_b32 v9, -1
buffer_store_dwordx4 v[6:9], v1, s[32:35], s12 offen offset:0 sc1
buffer_store_dwordx4 v[6:9], v1, s[32:35], s12 offen offset:1024 sc1
buffer_store_dwordx4 v[6:9], v1, s[32:35], s13 offen offset:0 sc1
buffer_store_dwordx4 v[6:9], v1, s[32:35], s13 offen offset:1024 sc1
s_mov_b32 s54, 0
attn_kernel_S_tail:
s_cmp_gt_u32 s41, 3
s_cbranch_scc1 attn_kernel_notouch
s_cmp_lg_u32 s54, 0
s_cbranch_scc1 attn_kernel_notouch
s_mov_b32 s54, 1
s_and_b32 s53, s16, 3
s_getpc_b64 s[48:49]
s_add_u32 s48, s48, cs_l3_kernel@rel32@lo+4
s_addc_u32 s49, s49, cs_l3_kernel@rel32@hi+12
s_mov_b32 s50, l3_kernel_end - l3_kernel
s_mov_b32 s51, 0x20000
s_lshr_b32 s52, s2, 3
s_lshl_b32 s52, s52, 2
s_add_u32 s52, s52, s53
s_lshl_b32 s52, s52, 10
v_lshlrev_b32 v52, 7, v0
s_mov_b64 exec, 255
buffer_load_dword v53, v52, s[48:51], s52 offen
s_mov_b64 exec, -1
s_add_u32 s48, s4, 0x3c00000
s_addc_u32 s49, s5, 0
s_mov_b32 s50, 0x400000
s_mov_b32 s51, 0x20000
s_lshr_b32 s52, s2, 3
s_lshl2_add_u32 s52, s52, s53
s_lshr_b32 s55, s52, 4
s_lshl_b32 s55, s55, 19
s_and_b32 s52, s52, 15
s_lshl_b32 s52, s52, 13
s_add_u32 s52, s52, s55
s_bfe_u32 s55, s2, 0x20001
s_lshl_b32 s55, s55, 17
s_add_u32 s52, s52, s55
v_lshlrev_b32 v50, 7, v0
buffer_load_dword v51, v50, s[48:51], s52 offen
attn_kernel_notouch:
s_cmp_eq_u32 s41, 0
s_cbranch_scc1 attn_kernel_S_done
s_waitcnt vmcnt(14)
s_barrier
s_sub_u32 s41, s41, 1
s_mov_b32 m0, s44
s_nop 0
buffer_load_dwordx4 v10, s[28:31], s42 offen lds
buffer_load_dwordx4 v10, s[28:31], s42 offen offset:1024 lds
s_add_u32 m0, s44, 0x4000
s_nop 0
buffer_load_dwordx4 v11, s[28:31], s42 offen lds
buffer_load_dwordx4 v11, s[28:31], s42 offen offset:1024 lds
s_mov_b32 m0, s43
s_add_u32 s44, s43, 0x2000
buffer_load_dwordx4 v10, s[24:27], s42 offen lds
buffer_load_dwordx4 v10, s[24:27], s42 offen offset:1024 lds
s_add_u32 m0, s43, 0x4000
s_add_u32 s43, s43, 0x8000
buffer_load_dwordx4 v11, s[24:27], s42 offen lds
buffer_load_dwordx4 v11, s[24:27], s42 offen offset:1024 lds
s_and_b32 s43, s43, 0x1ffff
s_add_u32 s42, s42, 0x4000
s_branch attn_kernel_S_tail
attn_kernel_S_done:
s_endpgm
attn_kernel_end:
s_endpgm
.text
.globl l3_kernel
.p2align 8
.type l3_kernel,@function
l3_kernel:
cs_l3_kernel:
s_cmp_ge_u32 s2, 256
s_cbranch_scc1 l3_kernel_end
s_load_dwordx2 s[4:5], s[0:1], 88
s_load_dwordx2 s[8:9], s[0:1], 72
v_lshrrev_b32 v1, 6, v0
v_and_b32 v2, 255, v0
v_and_b32 v0, 63, v0
v_readfirstlane_b32 s17, v1
s_bfe_u32 s40, s2, 0x20001
s_and_b32 s43, s2, 1
s_lshl_b32 s43, s43, 5
s_lshr_b32 s44, s2, 3
s_add_u32 s43, s43, s44
s_lshr_b32 s41, s43, 2
s_and_b32 s42, s43, 3
s_and_b32 s16, s17, 3
s_lshr_b32 s18, s17, 2
v_lshlrev_b32 v124, 4, v0
s_lshl_b32 s45, s42, 1
s_lshr_b32 s46, s16, 1
s_add_u32 s45, s45, s46
s_lshl_b32 s45, s45, 19
s_lshl1_add_u32 s46, s40, s18
s_lshl_b32 s46, s46, 16
s_add_u32 s45, s45, s46
s_and_b32 s46, s16, 1
s_lshl_b32 s46, s46, 10
s_add_u32 s45, s45, s46
s_add_u32 s45, s45, 0x3c00000
s_lshl_b32 s47, s18, 15
s_lshl_b32 s48, s16, 10
s_add_u32 s47, s47, s48
s_lshl_b32 s46, s41, 20
s_lshl_b32 s48, s40, 16
s_add_u32 s46, s46, s48
s_add_u32 s46, s46, s47
s_add_u32 s46, s46, 0x2000000
s_lshl_b32 s47, s18, 13
s_lshl_b32 s48, s16, 10
s_add_u32 s47, s47, s48
s_lshl_b32 s48, s18, 13
v_add_u32 v125, s48, v124
v_add_u32 v126, 0x10000, v125
s_lshl_b32 s48, s16, 12
v_add_u32 v127, s48, v124
s_waitcnt lgkmcnt(0)
s_mov_b32 s52, s4
s_mov_b32 s53, s5
s_mov_b32 s54, 0x4000000
s_mov_b32 s55, 0x20000
s_add_u32 s36, s40, 1
s_and_b32 s36, s36, 3
s_lshl_b32 s36, s36, 18
s_add_u32 s36, s36, s46
s_add_u32 s37, s40, 2
s_and_b32 s37, s37, 3
s_lshl_b32 s37, s37, 18
s_add_u32 s37, s37, s46
s_add_u32 s38, s40, 3
s_and_b32 s38, s38, 3
s_lshl_b32 s38, s38, 18
s_add_u32 s38, s38, s46
s_add_u32 s39, s40, 4
s_and_b32 s39, s39, 3
s_lshl_b32 s39, s39, 18
s_add_u32 s39, s39, s46
s_add_u32 m0, s47, 0
s_add_u32 s49, s36, 0
buffer_load_dwordx4 v124, s[52:55], s49 offen lds
s_add_u32 m0, s47, 4096
s_add_u32 s49, s36, 4096
buffer_load_dwordx4 v124, s[52:55], s49 offen lds
s_add_u32 m0, s47, 32768
s_add_u32 s49, s37, 0
buffer_load_dwordx4 v124, s[52:55], s49 offen lds
s_add_u32 m0, s47, 36864
s_add_u32 s49, s37, 4096
buffer_load_dwordx4 v124, s[52:55], s49 offen lds
s_add_u32 m0, s47, 65536
s_add_u32 s49, s38, 0
buffer_load_dwordx4 v124, s[52:55], s49 offen lds
s_add_u32 m0, s47, 69632
s_add_u32 s49, s38, 4096
buffer_load_dwordx4 v124, s[52:55], s49 offen lds
buffer_load_dwordx4 v[128:131], v124, s[52:55], s45 offen offset:0
buffer_load_dwordx4 v[132:135], v124, s[52:55], s45 offen offset:2048
s_add_u32 s45, s45, 4096
buffer_load_dwordx4 v[136:139], v124, s[52:55], s45 offen offset:0
buffer_load_dwordx4 v[140:143], v124, s[52:55], s45 offen offset:2048
s_add_u32 s45, s45, 4096
buffer_load_dwordx4 v[144:147], v124, s[52:55], s45 offen offset:0
buffer_load_dwordx4 v[148:151], v124, s[52:55], s45 offen offset:2048
s_add_u32 s45, s45, 4096
buffer_load_dwordx4 v[152:155], v124, s[52:55], s45 offen offset:0
buffer_load_dwordx4 v[156:159], v124, s[52:55], s45 offen offset:2048
s_add_u32 m0, s47, 16384
s_add_u32 s49, s36, 8192
buffer_load_dwordx4 v124, s[52:55], s49 offen lds
s_add_u32 m0, s47, 20480
s_add_u32 s49, s36, 12288
buffer_load_dwordx4 v124, s[52:55], s49 offen lds
s_add_u32 m0, s47, 49152
s_add_u32 s49, s37, 8192
buffer_load_dwordx4 v124, s[52:55], s49 offen lds
s_add_u32 m0, s47, 53248
s_add_u32 s49, s37, 12288
buffer_load_dwordx4 v124, s[52:55], s49 offen lds
s_add_u32 m0, s47, 81920
s_add_u32 s49, s38, 8192
buffer_load_dwordx4 v124, s[52:55], s49 offen lds
s_add_u32 m0, s47, 86016
s_add_u32 s49, s38, 12288
buffer_load_dwordx4 v124, s[52:55], s49 offen lds
s_add_u32 s56, s4, 0x4000000
s_addc_u32 s57, s5, 0
s_mov_b32 s58, 0x1000000
s_mov_b32 s59, 0x20000
s_lshl2_add_u32 s60, s43, s40
s_lshl_b32 s60, s60, 4
s_add_u32 s60, s60, s16
s_lshl_b32 s60, s60, 12
s_add_u32 s61, s40, 1
s_and_b32 s61, s61, 3
s_lshl_b32 s61, s61, 14
s_add_u32 s61, s61, s60
s_add_u32 s62, s40, 2
s_and_b32 s62, s62, 3
s_lshl_b32 s62, s62, 14
s_add_u32 s62, s62, s60
s_add_u32 s63, s40, 3
s_and_b32 s63, s63, 3
s_lshl_b32 s63, s63, 14
s_add_u32 s63, s63, s60
s_lshl_b32 s48, s18, 15
v_add_u32 v28, s48, v125
v_xor_b32 v29, 0x8000, v28
v_add_u32 v30, 98304, v125
s_waitcnt vmcnt(14)
s_barrier
ds_read_b128 v[100:103], v28 offset:0
ds_read_b128 v[104:107], v29 offset:0
ds_read_b128 v[108:111], v126 offset:0
ds_read_b128 v[112:115], v28 offset:1024
ds_read_b128 v[116:119], v29 offset:1024
s_waitcnt lgkmcnt(4)
s_waitcnt vmcnt(13)
mf32 v[68:83], v[128:131], v[100:103], 0
ds_read_b128 v[120:123], v126 offset:1024
s_add_u32 s45, s45, 4096
buffer_load_dwordx4 v[160:163], v124, s[52:55], s45 offen offset:0
buffer_load_dwordx4 v[164:167], v124, s[52:55], s45 offen offset:2048
s_waitcnt lgkmcnt(4)
mf32 v[84:99], v[128:131], v[104:107], 0
ds_read_b128 v[100:103], v28 offset:2048
s_add_u32 s45, s45, 4096
buffer_load_dwordx4 v[168:171], v124, s[52:55], s45 offen offset:0
buffer_load_dwordx4 v[172:175], v124, s[52:55], s45 offen offset:2048
s_waitcnt lgkmcnt(4)
mf32 v[32:47], v[128:131], v[108:111], 0
ds_read_b128 v[104:107], v29 offset:2048
s_add_u32 s45, s45, 4096
buffer_load_dwordx4 v[176:179], v124, s[52:55], s45 offen offset:0
buffer_load_dwordx4 v[180:183], v124, s[52:55], s45 offen offset:2048
s_waitcnt lgkmcnt(4)
s_waitcnt vmcnt(18)
mf32 v[68:83], v[132:135], v[112:115], v[68:83]
ds_read_b128 v[108:111], v126 offset:2048
s_add_u32 s45, s45, 4096
buffer_load_dwordx4 v[184:187], v124, s[52:55], s45 offen offset:0
buffer_load_dwordx4 v[188:191], v124, s[52:55], s45 offen offset:2048
s_waitcnt lgkmcnt(4)
mf32 v[84:99], v[132:135], v[116:119], v[84:99]
ds_read_b128 v[112:115], v28 offset:3072
s_add_u32 s45, s45, 4096
buffer_load_dwordx4 v[192:195], v124, s[52:55], s45 offen offset:0
buffer_load_dwordx4 v[196:199], v124, s[52:55], s45 offen offset:2048
s_waitcnt lgkmcnt(4)
mf32 v[32:47], v[132:135], v[120:123], v[32:47]
ds_read_b128 v[116:119], v29 offset:3072
s_add_u32 s45, s45, 4096
buffer_load_dwordx4 v[200:203], v124, s[52:55], s45 offen offset:0
buffer_load_dwordx4 v[204:207], v124, s[52:55], s45 offen offset:2048
s_waitcnt lgkmcnt(4)
s_waitcnt vmcnt(23)
mf32 v[68:83], v[136:139], v[100:103], v[68:83]
ds_read_b128 v[120:123], v126 offset:3072
s_add_u32 s45, s45, 4096
buffer_load_dwordx4 v[208:211], v124, s[52:55], s45 offen offset:0
buffer_load_dwordx4 v[212:215], v124, s[52:55], s45 offen offset:2048
s_waitcnt lgkmcnt(4)
mf32 v[84:99], v[136:139], v[104:107], v[84:99]
ds_read_b128 v[100:103], v28 offset:4096
s_add_u32 s45, s45, 4096
buffer_load_dwordx4 v[216:219], v124, s[52:55], s45 offen offset:0
buffer_load_dwordx4 v[220:223], v124, s[52:55], s45 offen offset:2048
s_waitcnt lgkmcnt(4)
mf32 v[32:47], v[136:139], v[108:111], v[32:47]
ds_read_b128 v[104:107], v29 offset:4096
s_waitcnt lgkmcnt(4)
s_waitcnt vmcnt(26)
mf32 v[68:83], v[140:143], v[112:115], v[68:83]
ds_read_b128 v[108:111], v126 offset:4096
s_waitcnt lgkmcnt(4)
mf32 v[84:99], v[140:143], v[116:119], v[84:99]
ds_read_b128 v[112:115], v28 offset:5120
s_waitcnt lgkmcnt(4)
mf32 v[32:47], v[140:143], v[120:123], v[32:47]
ds_read_b128 v[116:119], v29 offset:5120
s_waitcnt lgkmcnt(4)
s_waitcnt vmcnt(25)
mf32 v[68:83], v[144:147], v[100:103], v[68:83]
ds_read_b128 v[120:123], v126 offset:5120
s_waitcnt lgkmcnt(4)
mf32 v[84:99], v[144:147], v[104:107], v[84:99]
ds_read_b128 v[100:103], v28 offset:6144
s_waitcnt lgkmcnt(4)
mf32 v[32:47], v[144:147], v[108:111], v[32:47]
ds_read_b128 v[104:107], v29 offset:6144
s_waitcnt lgkmcnt(4)
s_waitcnt vmcnt(24)
mf32 v[68:83], v[148:151], v[112:115], v[68:83]
ds_read_b128 v[108:111], v126 offset:6144
s_waitcnt lgkmcnt(4)
mf32 v[84:99], v[148:151], v[116:119], v[84:99]
ds_read_b128 v[112:115], v28 offset:7168
s_waitcnt lgkmcnt(4)
mf32 v[32:47], v[148:151], v[120:123], v[32:47]
ds_read_b128 v[116:119], v29 offset:7168
s_waitcnt lgkmcnt(4)
s_waitcnt vmcnt(23)
mf32 v[68:83], v[152:155], v[100:103], v[68:83]
ds_read_b128 v[120:123], v126 offset:7168
s_waitcnt lgkmcnt(4)
mf32 v[84:99], v[152:155], v[104:107], v[84:99]
s_waitcnt vmcnt(16)
s_barrier
ds_read_b128 v[100:103], v28 offset:16384
s_waitcnt lgkmcnt(4)
mf32 v[32:47], v[152:155], v[108:111], v[32:47]
ds_read_b128 v[104:107], v29 offset:16384
s_waitcnt lgkmcnt(4)
mf32 v[68:83], v[156:159], v[112:115], v[68:83]
ds_read_b128 v[108:111], v126 offset:16384
s_waitcnt lgkmcnt(4)
mf32 v[84:99], v[156:159], v[116:119], v[84:99]
ds_read_b128 v[112:115], v28 offset:17408
s_waitcnt lgkmcnt(4)
mf32 v[32:47], v[156:159], v[120:123], v[32:47]
ds_read_b128 v[116:119], v29 offset:17408
s_waitcnt lgkmcnt(4)
s_waitcnt vmcnt(15)
mf32 v[68:83], v[160:163], v[100:103], v[68:83]
ds_read_b128 v[120:123], v126 offset:17408
s_waitcnt lgkmcnt(4)
mf32 v[84:99], v[160:163], v[104:107], v[84:99]
ds_read_b128 v[100:103], v28 offset:18432
s_barrier
s_add_u32 m0, s47, 0
s_add_u32 s49, s36, 16384
buffer_load_dwordx4 v124, s[52:55], s49 offen lds
s_add_u32 m0, s47, 4096
s_add_u32 s49, s36, 20480
buffer_load_dwordx4 v124, s[52:55], s49 offen lds
s_waitcnt lgkmcnt(4)
mf32 v[32:47], v[160:163], v[108:111], v[32:47]
ds_read_b128 v[104:107], v29 offset:18432
s_add_u32 m0, s47, 32768
s_add_u32 s49, s37, 16384
buffer_load_dwordx4 v124, s[52:55], s49 offen lds
s_add_u32 m0, s47, 36864
s_add_u32 s49, s37, 20480
buffer_load_dwordx4 v124, s[52:55], s49 offen lds
s_waitcnt lgkmcnt(4)
s_waitcnt vmcnt(18)
mf32 v[68:83], v[164:167], v[112:115], v[68:83]
ds_read_b128 v[108:111], v126 offset:18432
s_add_u32 m0, s47, 65536
s_add_u32 s49, s38, 16384
buffer_load_dwordx4 v124, s[52:55], s49 offen lds
s_add_u32 m0, s47, 69632
s_add_u32 s49, s38, 20480
buffer_load_dwordx4 v124, s[52:55], s49 offen lds
s_waitcnt lgkmcnt(4)
mf32 v[84:99], v[164:167], v[116:119], v[84:99]
ds_read_b128 v[112:115], v28 offset:19456
s_add_u32 s45, s45, 4096
buffer_load_dwordx4 v[224:227], v124, s[52:55], s45 offen offset:0
buffer_load_dwordx4 v[228:231], v124, s[52:55], s45 offen offset:2048
s_waitcnt lgkmcnt(4)
mf32 v[32:47], v[164:167], v[120:123], v[32:47]
ds_read_b128 v[116:119], v29 offset:19456
s_add_u32 s45, s45, 4096
buffer_load_dwordx4 v[232:235], v124, s[52:55], s45 offen offset:0
buffer_load_dwordx4 v[236:239], v124, s[52:55], s45 offen offset:2048
s_waitcnt lgkmcnt(4)
s_waitcnt vmcnt(23)
mf32 v[68:83], v[168:171], v[100:103], v[68:83]
ds_read_b128 v[120:123], v126 offset:19456
s_add_u32 s45, s45, 4096
buffer_load_dwordx4 v[240:243], v124, s[52:55], s45 offen offset:0
buffer_load_dwordx4 v[244:247], v124, s[52:55], s45 offen offset:2048
s_waitcnt lgkmcnt(4)
mf32 v[84:99], v[168:171], v[104:107], v[84:99]
ds_read_b128 v[100:103], v28 offset:20480
s_add_u32 s45, s45, 4096
buffer_load_dwordx4 v[248:251], v124, s[52:55], s45 offen offset:0
buffer_load_dwordx4 v[252:255], v124, s[52:55], s45 offen offset:2048
s_waitcnt lgkmcnt(4)
mf32 v[32:47], v[168:171], v[108:111], v[32:47]
ds_read_b128 v[104:107], v29 offset:20480
s_waitcnt lgkmcnt(4)
s_waitcnt vmcnt(26)
mf32 v[68:83], v[172:175], v[112:115], v[68:83]
ds_read_b128 v[108:111], v126 offset:20480
s_waitcnt lgkmcnt(4)
mf32 v[84:99], v[172:175], v[116:119], v[84:99]
ds_read_b128 v[112:115], v28 offset:21504
s_waitcnt lgkmcnt(4)
mf32 v[32:47], v[172:175], v[120:123], v[32:47]
ds_read_b128 v[116:119], v29 offset:21504
s_waitcnt lgkmcnt(4)
s_waitcnt vmcnt(25)
mf32 v[68:83], v[176:179], v[100:103], v[68:83]
ds_read_b128 v[120:123], v126 offset:21504
s_waitcnt lgkmcnt(4)
mf32 v[84:99], v[176:179], v[104:107], v[84:99]
ds_read_b128 v[100:103], v28 offset:22528
s_waitcnt lgkmcnt(4)
mf32 v[32:47], v[176:179], v[108:111], v[32:47]
ds_read_b128 v[104:107], v29 offset:22528
s_waitcnt lgkmcnt(4)
s_waitcnt vmcnt(24)
mf32 v[68:83], v[180:183], v[112:115], v[68:83]
ds_read_b128 v[108:111], v126 offset:22528
s_waitcnt lgkmcnt(4)
mf32 v[84:99], v[180:183], v[116:119], v[84:99]
ds_read_b128 v[112:115], v28 offset:23552
s_waitcnt lgkmcnt(4)
mf32 v[32:47], v[180:183], v[120:123], v[32:47]
ds_read_b128 v[116:119], v29 offset:23552
s_waitcnt lgkmcnt(4)
s_waitcnt vmcnt(23)
mf32 v[68:83], v[184:187], v[100:103], v[68:83]
ds_read_b128 v[120:123], v126 offset:23552
s_waitcnt lgkmcnt(4)
mf32 v[84:99], v[184:187], v[104:107], v[84:99]
s_waitcnt vmcnt(8)
s_barrier
ds_read_b128 v[100:103], v28 offset:0
s_waitcnt lgkmcnt(4)
mf32 v[32:47], v[184:187], v[108:111], v[32:47]
ds_read_b128 v[104:107], v29 offset:0
s_waitcnt lgkmcnt(4)
mf32 v[68:83], v[188:191], v[112:115], v[68:83]
ds_read_b128 v[108:111], v126 offset:0
s_waitcnt lgkmcnt(4)
mf32 v[84:99], v[188:191], v[116:119], v[84:99]
ds_read_b128 v[112:115], v28 offset:1024
s_waitcnt lgkmcnt(4)
mf32 v[32:47], v[188:191], v[120:123], v[32:47]
ds_read_b128 v[116:119], v29 offset:1024
s_waitcnt lgkmcnt(4)
mf32 v[68:83], v[192:195], v[100:103], v[68:83]
ds_read_b128 v[120:123], v126 offset:1024
s_waitcnt lgkmcnt(4)
mf32 v[84:99], v[192:195], v[104:107], v[84:99]
ds_read_b128 v[100:103], v28 offset:2048
s_barrier
s_add_u32 m0, s47, 16384
s_add_u32 s49, s36, 24576
buffer_load_dwordx4 v124, s[52:55], s49 offen lds
s_add_u32 m0, s47, 20480
s_add_u32 s49, s36, 28672
buffer_load_dwordx4 v124, s[52:55], s49 offen lds
s_waitcnt lgkmcnt(4)
mf32 v[32:47], v[192:195], v[108:111], v[32:47]
ds_read_b128 v[104:107], v29 offset:2048
s_add_u32 m0, s47, 49152
s_add_u32 s49, s37, 24576
buffer_load_dwordx4 v124, s[52:55], s49 offen lds
s_add_u32 m0, s47, 53248
s_add_u32 s49, s37, 28672
buffer_load_dwordx4 v124, s[52:55], s49 offen lds
s_waitcnt lgkmcnt(4)
mf32 v[68:83], v[196:199], v[112:115], v[68:83]
ds_read_b128 v[108:111], v126 offset:2048
s_add_u32 m0, s47, 81920
s_add_u32 s49, s38, 24576
buffer_load_dwordx4 v124, s[52:55], s49 offen lds
s_add_u32 m0, s47, 86016
s_add_u32 s49, s38, 28672
buffer_load_dwordx4 v124, s[52:55], s49 offen lds
s_waitcnt lgkmcnt(4)
mf32 v[84:99], v[196:199], v[116:119], v[84:99]
ds_read_b128 v[112:115], v28 offset:3072
s_add_u32 m0, s47, 98304
s_add_u32 s49, s39, 0
buffer_load_dwordx4 v124, s[52:55], s49 offen lds
s_add_u32 m0, s47, 102400
s_add_u32 s49, s39, 4096
buffer_load_dwordx4 v124, s[52:55], s49 offen lds
s_waitcnt lgkmcnt(4)
mf32 v[32:47], v[196:199], v[120:123], v[32:47]
ds_read_b128 v[116:119], v29 offset:3072
s_add_u32 m0, s47, 114688
s_add_u32 s49, s39, 8192
buffer_load_dwordx4 v124, s[52:55], s49 offen lds
s_add_u32 m0, s47, 118784
s_add_u32 s49, s39, 12288
buffer_load_dwordx4 v124, s[52:55], s49 offen lds
s_waitcnt lgkmcnt(4)
mf32 v[68:83], v[200:203], v[100:103], v[68:83]
ds_read_b128 v[120:123], v126 offset:3072
s_add_u32 m0, s47, 131072
s_add_u32 s49, s39, 16384
buffer_load_dwordx4 v124, s[52:55], s49 offen lds
s_add_u32 m0, s47, 135168
s_add_u32 s49, s39, 20480
buffer_load_dwordx4 v124, s[52:55], s49 offen lds
s_waitcnt lgkmcnt(4)
mf32 v[84:99], v[200:203], v[104:107], v[84:99]
ds_read_b128 v[100:103], v28 offset:4096
s_add_u32 m0, s47, 147456
s_add_u32 s49, s39, 24576
buffer_load_dwordx4 v124, s[52:55], s49 offen lds
s_add_u32 m0, s47, 151552
s_add_u32 s49, s39, 28672
buffer_load_dwordx4 v124, s[52:55], s49 offen lds
s_waitcnt lgkmcnt(4)
mf32 v[32:47], v[200:203], v[108:111], v[32:47]
ds_read_b128 v[104:107], v29 offset:4096
s_waitcnt lgkmcnt(4)
mf32 v[68:83], v[204:207], v[112:115], v[68:83]
ds_read_b128 v[108:111], v126 offset:4096
s_waitcnt lgkmcnt(4)
mf32 v[84:99], v[204:207], v[116:119], v[84:99]
ds_read_b128 v[112:115], v28 offset:5120
s_waitcnt lgkmcnt(4)
mf32 v[32:47], v[204:207], v[120:123], v[32:47]
ds_read_b128 v[116:119], v29 offset:5120
s_waitcnt lgkmcnt(4)
mf32 v[68:83], v[208:211], v[100:103], v[68:83]
ds_read_b128 v[120:123], v126 offset:5120
s_waitcnt lgkmcnt(4)
mf32 v[84:99], v[208:211], v[104:107], v[84:99]
ds_read_b128 v[100:103], v28 offset:6144
s_waitcnt lgkmcnt(4)
mf32 v[32:47], v[208:211], v[108:111], v[32:47]
ds_read_b128 v[104:107], v29 offset:6144
s_waitcnt lgkmcnt(4)
mf32 v[68:83], v[212:215], v[112:115], v[68:83]
ds_read_b128 v[108:111], v126 offset:6144
s_waitcnt lgkmcnt(4)
mf32 v[84:99], v[212:215], v[116:119], v[84:99]
ds_read_b128 v[112:115], v28 offset:7168
s_waitcnt lgkmcnt(4)
mf32 v[32:47], v[212:215], v[120:123], v[32:47]
ds_read_b128 v[116:119], v29 offset:7168
s_waitcnt lgkmcnt(4)
mf32 v[68:83], v[216:219], v[100:103], v[68:83]
ds_read_b128 v[120:123], v126 offset:7168
s_waitcnt lgkmcnt(4)
mf32 v[84:99], v[216:219], v[104:107], v[84:99]
s_waitcnt vmcnt(8)
s_barrier
ds_read_b128 v[100:103], v28 offset:16384
s_waitcnt lgkmcnt(4)
mf32 v[32:47], v[216:219], v[108:111], v[32:47]
ds_read_b128 v[104:107], v29 offset:16384
s_waitcnt lgkmcnt(4)
mf32 v[68:83], v[220:223], v[112:115], v[68:83]
ds_read_b128 v[108:111], v126 offset:16384
s_waitcnt lgkmcnt(4)
mf32 v[84:99], v[220:223], v[116:119], v[84:99]
ds_read_b128 v[112:115], v28 offset:17408
s_waitcnt lgkmcnt(4)
mf32 v[32:47], v[220:223], v[120:123], v[32:47]
ds_read_b128 v[116:119], v29 offset:17408
s_waitcnt lgkmcnt(4)
mf32 v[68:83], v[224:227], v[100:103], v[68:83]
ds_read_b128 v[120:123], v126 offset:17408
s_waitcnt lgkmcnt(4)
mf32 v[84:99], v[224:227], v[104:107], v[84:99]
ds_read_b128 v[100:103], v28 offset:18432
s_waitcnt lgkmcnt(4)
mf32 v[32:47], v[224:227], v[108:111], v[32:47]
ds_read_b128 v[104:107], v29 offset:18432
s_waitcnt lgkmcnt(4)
mf32 v[68:83], v[228:231], v[112:115], v[68:83]
ds_read_b128 v[108:111], v126 offset:18432
s_and_b32 s20, s2, 7
s_lshl_b32 s20, s20, 3
s_bfe_u32 s22, s2, 0x30003
s_or_b32 s20, s20, s22
s_lshr_b32 s21, s2, 6
s_lshr_b32 s23, s20, 5
s_lshl_b32 s23, s23, 11
s_lshl_b32 s24, s21, 9
s_add_u32 s23, s23, s24
s_and_b32 s24, s20, 31
s_lshl_b32 s24, s24, 4
s_add_u32 s23, s23, s24
s_add_u32 s24, s23, 4096
v_lshlrev_b32 v3, 13, v2
v_mov_b32 v4, 2097152
s_add_u32 s28, s4, 0x3800000
s_addc_u32 s29, s5, 0
s_mov_b32 s30, 0x202000
s_mov_b32 s31, 0x20000
s_mov_b32 s32, s8
s_mov_b32 s33, s9
s_mov_b32 s34, 0x400000
s_mov_b32 s35, 0x20000
s_cmp_lg_u32 s18, 0
s_cbranch_scc1 l3_kernel_nb3l
buffer_load_dwordx4 v[16:19], v3, s[28:31], s23 offen
buffer_load_dwordx4 v[20:23], v3, s[28:31], s24 offen
buffer_load_dwordx4 v[24:27], v4, s[28:31], s23 offen
l3_kernel_nb3l:
s_waitcnt lgkmcnt(4)
mf32 v[84:99], v[228:231], v[116:119], v[84:99]
ds_read_b128 v[112:115], v28 offset:19456
s_waitcnt lgkmcnt(4)
mf32 v[32:47], v[228:231], v[120:123], v[32:47]
ds_read_b128 v[116:119], v29 offset:19456
s_waitcnt lgkmcnt(4)
mf32 v[68:83], v[232:235], v[100:103], v[68:83]
ds_read_b128 v[120:123], v126 offset:19456
s_waitcnt lgkmcnt(4)
mf32 v[84:99], v[232:235], v[104:107], v[84:99]
ds_read_b128 v[100:103], v28 offset:20480
s_waitcnt lgkmcnt(4)
mf32 v[32:47], v[232:235], v[108:111], v[32:47]
ds_read_b128 v[104:107], v29 offset:20480
s_waitcnt lgkmcnt(4)
mf32 v[68:83], v[236:239], v[112:115], v[68:83]
ds_read_b128 v[108:111], v126 offset:20480
s_waitcnt lgkmcnt(4)
mf32 v[84:99], v[236:239], v[116:119], v[84:99]
ds_read_b128 v[112:115], v28 offset:21504
s_waitcnt lgkmcnt(4)
mf32 v[32:47], v[236:239], v[120:123], v[32:47]
ds_read_b128 v[116:119], v29 offset:21504
s_waitcnt lgkmcnt(4)
mf32 v[68:83], v[240:243], v[100:103], v[68:83]
ds_read_b128 v[120:123], v126 offset:21504
s_waitcnt lgkmcnt(4)
mf32 v[84:99], v[240:243], v[104:107], v[84:99]
ds_read_b128 v[100:103], v28 offset:22528
s_waitcnt lgkmcnt(4)
mf32 v[32:47], v[240:243], v[108:111], v[32:47]
ds_read_b128 v[104:107], v29 offset:22528
s_waitcnt lgkmcnt(4)
mf32 v[68:83], v[244:247], v[112:115], v[68:83]
ds_read_b128 v[108:111], v126 offset:22528
s_waitcnt lgkmcnt(4)
mf32 v[84:99], v[244:247], v[116:119], v[84:99]
ds_read_b128 v[112:115], v28 offset:23552
s_waitcnt lgkmcnt(4)
mf32 v[32:47], v[244:247], v[120:123], v[32:47]
ds_read_b128 v[116:119], v29 offset:23552
s_waitcnt lgkmcnt(4)
mf32 v[68:83], v[248:251], v[100:103], v[68:83]
ds_read_b128 v[120:123], v126 offset:23552
s_waitcnt lgkmcnt(4)
mf32 v[84:99], v[248:251], v[104:107], v[84:99]
s_waitcnt vmcnt(4)
s_barrier
ds_read_b128 v[100:103], v30 offset:0
s_waitcnt lgkmcnt(4)
mf32 v[32:47], v[248:251], v[108:111], v[32:47]
ds_read_b128 v[104:107], v30 offset:1024
s_waitcnt lgkmcnt(4)
mf32 v[68:83], v[252:255], v[112:115], v[68:83]
ds_read_b128 v[108:111], v30 offset:2048
s_waitcnt lgkmcnt(4)
mf32 v[84:99], v[252:255], v[116:119], v[84:99]
ds_read_b128 v[112:115], v30 offset:3072
s_waitcnt lgkmcnt(4)
mf32 v[32:47], v[252:255], v[120:123], v[32:47]
ds_read_b128 v[116:119], v30 offset:4096
s_waitcnt lgkmcnt(4)
mf32 v[48:63], v[128:131], v[100:103], 0
ds_read_b128 v[120:123], v30 offset:5120
s_waitcnt lgkmcnt(4)
mf32 v[48:63], v[132:135], v[104:107], v[48:63]
ds_read_b128 v[100:103], v30 offset:6144
s_waitcnt lgkmcnt(4)
mf32 v[48:63], v[136:139], v[108:111], v[48:63]
ds_read_b128 v[104:107], v30 offset:7168
s_waitcnt lgkmcnt(4)
mf32 v[48:63], v[140:143], v[112:115], v[48:63]
ds_read_b128 v[108:111], v30 offset:16384
s_waitcnt lgkmcnt(4)
mf32 v[48:63], v[144:147], v[116:119], v[48:63]
ds_read_b128 v[112:115], v30 offset:17408
s_lshl_b32 s48, s18, 15
v_add_u32 v28, s48, v127
v_xor_b32 v29, 0x8000, v28
v_add_u32 v31, 0x10000, v127
ds_write_b128 v29, v[84:87] offset:0
ds_write_b128 v29, v[88:91] offset:1024
ds_write_b128 v29, v[92:95] offset:2048
ds_write_b128 v29, v[96:99] offset:3072
s_cmp_eq_u32 s18, 0
s_cbranch_scc1 l3_kernel_g2
ds_write_b128 v31, v[32:35] offset:0
ds_write_b128 v31, v[36:39] offset:1024
ds_write_b128 v31, v[40:43] offset:2048
ds_write_b128 v31, v[44:47] offset:3072
l3_kernel_g2:
v_mov_b32 v64, 81920
v_mov_b32 v66, 0
v_mov_b32 v67, 0
ds_write_b64 v64, v[66:67] offset:0
ds_write_b64 v64, v[66:67] offset:8
ds_write_b64 v64, v[66:67] offset:16
s_waitcnt vmcnt(0)
s_add_u32 s51, s18, 1
s_add_u32 s50, s40, s51
s_and_b32 s50, s50, 3
s_lshl2_add_u32 s50, s43, s50
s_lshl2_add_u32 s50, s50, s40
s_lshl2_add_u32 s50, s50, s16
s_lshl_b32 s50, s50, 12
s_add_u32 s51, s40, 3
s_and_b32 s51, s51, 3
s_lshl2_add_u32 s51, s43, s51
s_lshl2_add_u32 s51, s51, s40
s_lshl2_add_u32 s51, s51, s16
s_lshl_b32 s51, s51, 12
s_waitcnt lgkmcnt(0)
s_barrier
ds_read_b128 v[84:87], v28 offset:0
ds_read_b128 v[88:91], v28 offset:1024
ds_read_b128 v[92:95], v28 offset:2048
ds_read_b128 v[96:99], v28 offset:3072
s_waitcnt lgkmcnt(0)
v_add_f32 v68, v68, v84
v_add_f32 v69, v69, v85
v_add_f32 v70, v70, v86
v_add_f32 v71, v71, v87
v_add_f32 v72, v72, v88
v_add_f32 v73, v73, v89
v_add_f32 v74, v74, v90
v_add_f32 v75, v75, v91
v_add_f32 v76, v76, v92
v_add_f32 v77, v77, v93
v_add_f32 v78, v78, v94
v_add_f32 v79, v79, v95
v_add_f32 v80, v80, v96
v_add_f32 v81, v81, v97
v_add_f32 v82, v82, v98
v_add_f32 v83, v83, v99
cvtpk v84, v68, v69
cvtpk v85, v70, v71
cvtpk v86, v72, v73
cvtpk v87, v74, v75
cvtpk v88, v76, v77
cvtpk v89, v78, v79
cvtpk v90, v80, v81
cvtpk v91, v82, v83
buffer_store_dwordx4 v[84:87], v124, s[56:59], s50 offen offset:0 sc1
buffer_store_dwordx4 v[88:91], v124, s[56:59], s50 offen offset:1024 sc1
s_cmp_lg_u32 s18, 0
s_cbranch_scc1 l3_kernel_t2
ds_read_b128 v[68:71], v31 offset:0
ds_read_b128 v[72:75], v31 offset:1024
ds_read_b128 v[76:79], v31 offset:2048
ds_read_b128 v[80:83], v31 offset:3072
s_waitcnt lgkmcnt(0)
v_add_f32 v32, v32, v68
v_add_f32 v33, v33, v69
v_add_f32 v34, v34, v70
v_add_f32 v35, v35, v71
v_add_f32 v36, v36, v72
v_add_f32 v37, v37, v73
v_add_f32 v38, v38, v74
v_add_f32 v39, v39, v75
v_add_f32 v40, v40, v76
v_add_f32 v41, v41, v77
v_add_f32 v42, v42, v78
v_add_f32 v43, v43, v79
v_add_f32 v44, v44, v80
v_add_f32 v45, v45, v81
v_add_f32 v46, v46, v82
v_add_f32 v47, v47, v83
cvtpk v68, v32, v33
cvtpk v69, v34, v35
cvtpk v70, v36, v37
cvtpk v71, v38, v39
cvtpk v72, v40, v41
cvtpk v73, v42, v43
cvtpk v74, v44, v45
cvtpk v75, v46, v47
buffer_store_dwordx4 v[68:71], v124, s[56:59], s51 offen offset:0 sc1
buffer_store_dwordx4 v[72:75], v124, s[56:59], s51 offen offset:1024 sc1
l3_kernel_t2:
mf32 v[48:63], v[148:151], v[120:123], v[48:63]
ds_read_b128 v[116:119], v30 offset:18432
mf32 v[48:63], v[152:155], v[100:103], v[48:63]
ds_read_b128 v[120:123], v30 offset:19456
mf32 v[48:63], v[156:159], v[104:107], v[48:63]
ds_read_b128 v[100:103], v30 offset:20480
mf32 v[48:63], v[160:163], v[108:111], v[48:63]
ds_read_b128 v[104:107], v30 offset:21504
mf32 v[48:63], v[164:167], v[112:115], v[48:63]
ds_read_b128 v[108:111], v30 offset:22528
s_waitcnt lgkmcnt(4)
mf32 v[48:63], v[168:171], v[116:119], v[48:63]
ds_read_b128 v[112:115], v30 offset:23552
s_waitcnt lgkmcnt(4)
mf32 v[48:63], v[172:175], v[120:123], v[48:63]
s_barrier
ds_read_b128 v[116:119], v30 offset:32768
s_waitcnt lgkmcnt(4)
mf32 v[48:63], v[176:179], v[100:103], v[48:63]
ds_read_b128 v[120:123], v30 offset:33792
s_waitcnt lgkmcnt(4)
mf32 v[48:63], v[180:183], v[104:107], v[48:63]
ds_read_b128 v[100:103], v30 offset:34816
s_waitcnt lgkmcnt(4)
mf32 v[48:63], v[184:187], v[108:111], v[48:63]
ds_read_b128 v[104:107], v30 offset:35840
s_waitcnt lgkmcnt(4)
mf32 v[48:63], v[188:191], v[112:115], v[48:63]
ds_read_b128 v[108:111], v30 offset:36864
s_waitcnt lgkmcnt(4)
mf32 v[48:63], v[192:195], v[116:119], v[48:63]
ds_read_b128 v[112:115], v30 offset:37888
s_waitcnt lgkmcnt(4)
mf32 v[48:63], v[196:199], v[120:123], v[48:63]
ds_read_b128 v[116:119], v30 offset:38912
s_waitcnt lgkmcnt(4)
mf32 v[48:63], v[200:203], v[100:103], v[48:63]
ds_read_b128 v[120:123], v30 offset:39936
s_waitcnt lgkmcnt(4)
mf32 v[48:63], v[204:207], v[104:107], v[48:63]
ds_read_b128 v[100:103], v30 offset:49152
s_waitcnt lgkmcnt(4)
mf32 v[48:63], v[208:211], v[108:111], v[48:63]
ds_read_b128 v[104:107], v30 offset:50176
s_waitcnt lgkmcnt(4)
mf32 v[48:63], v[212:215], v[112:115], v[48:63]
ds_read_b128 v[108:111], v30 offset:51200
s_waitcnt lgkmcnt(4)
mf32 v[48:63], v[216:219], v[116:119], v[48:63]
ds_read_b128 v[112:115], v30 offset:52224
s_waitcnt lgkmcnt(4)
mf32 v[48:63], v[220:223], v[120:123], v[48:63]
ds_read_b128 v[116:119], v30 offset:53248
s_waitcnt lgkmcnt(4)
mf32 v[48:63], v[224:227], v[100:103], v[48:63]
ds_read_b128 v[120:123], v30 offset:54272
s_waitcnt lgkmcnt(4)
mf32 v[48:63], v[228:231], v[104:107], v[48:63]
ds_read_b128 v[100:103], v30 offset:55296
s_waitcnt lgkmcnt(4)
mf32 v[48:63], v[232:235], v[108:111], v[48:63]
ds_read_b128 v[104:107], v30 offset:56320
s_waitcnt lgkmcnt(4)
mf32 v[48:63], v[236:239], v[112:115], v[48:63]
s_waitcnt lgkmcnt(3)
mf32 v[48:63], v[240:243], v[116:119], v[48:63]
s_cmp_eq_u32 s18, 0
s_cbranch_scc1 l3_kernel_nopl
buffer_load_dwordx4 v[144:147], v124, s[56:59], s61 offen offset:0 sc1
buffer_load_dwordx4 v[148:151], v124, s[56:59], s61 offen offset:1024 sc1
buffer_load_dwordx4 v[160:163], v124, s[56:59], s62 offen offset:0 sc1
buffer_load_dwordx4 v[164:167], v124, s[56:59], s62 offen offset:1024 sc1
buffer_load_dwordx4 v[176:179], v124, s[56:59], s63 offen offset:0 sc1
buffer_load_dwordx4 v[180:183], v124, s[56:59], s63 offen offset:1024 sc1
l3_kernel_nopl:
s_waitcnt lgkmcnt(2)
mf32 v[48:63], v[244:247], v[120:123], v[48:63]
s_waitcnt lgkmcnt(1)
mf32 v[48:63], v[248:251], v[100:103], v[48:63]
s_waitcnt lgkmcnt(0)
mf32 v[48:63], v[252:255], v[104:107], v[48:63]
s_lshl_b32 s44, s16, 2
s_add_u32 s44, s44, 81924
v_mov_b32 v30, s44
v_mov_b32 v1, 1
s_cmp_eq_u32 s18, 1
s_cbranch_scc1 l3_kernel_fin
s_nop 6
ds_write_b128 v127, v[48:51] offset:49152
ds_write_b128 v127, v[52:55] offset:50176
ds_write_b128 v127, v[56:59] offset:51200
ds_write_b128 v127, v[60:63] offset:52224
s_waitcnt lgkmcnt(0)
ds_write_b32 v30, v1
v_lshrrev_b32 v5, 5, v0
v_cvt_f32_u32 v5, v5
v_and_b32 v13, 31, v0
v_cvt_f32_u32 v13, v13
v_mul_f32 v6, 0x3d000000, v13
v_mul_f32 v7, v6, v5
v_mul_f32 v7, 4.0, v7
v_fmamk_f32 v8, v6, 0x00000000, v7
v_fmamk_f32 v9, v6, 0x3f800000, v7
v_fmamk_f32 v10, v6, 0x40000000, v7
v_fmamk_f32 v11, v6, 0x40400000, v7
v_cos_f32 v8, v8
v_cos_f32 v9, v9
v_cos_f32 v10, v10
v_cos_f32 v11, v11
s_nop 0
cvtpk v68, v8, v9
cvtpk v69, v10, v11
v_fmamk_f32 v8, v6, 0x41000000, v7
v_fmamk_f32 v9, v6, 0x41100000, v7
v_fmamk_f32 v10, v6, 0x41200000, v7
v_fmamk_f32 v11, v6, 0x41300000, v7
v_cos_f32 v8, v8
v_cos_f32 v9, v9
v_cos_f32 v10, v10
v_cos_f32 v11, v11
s_nop 0
cvtpk v70, v8, v9
cvtpk v71, v10, v11
v_fmamk_f32 v8, v6, 0x41800000, v7
v_fmamk_f32 v9, v6, 0x41880000, v7
v_fmamk_f32 v10, v6, 0x41900000, v7
v_fmamk_f32 v11, v6, 0x41980000, v7
v_cos_f32 v8, v8
v_cos_f32 v9, v9
v_cos_f32 v10, v10
v_cos_f32 v11, v11
s_nop 0
cvtpk v72, v8, v9
cvtpk v73, v10, v11
v_fmamk_f32 v8, v6, 0x41c00000, v7
v_fmamk_f32 v9, v6, 0x41c80000, v7
v_fmamk_f32 v10, v6, 0x41d00000, v7
v_fmamk_f32 v11, v6, 0x41d80000, v7
v_cos_f32 v8, v8
v_cos_f32 v9, v9
v_cos_f32 v10, v10
v_cos_f32 v11, v11
s_nop 0
cvtpk v74, v8, v9
cvtpk v75, v10, v11
v_add_f32 v7, 0x3e800000, v7
v_fmamk_f32 v8, v6, 0x00000000, v7
v_fmamk_f32 v9, v6, 0x3f800000, v7
v_fmamk_f32 v10, v6, 0x40000000, v7
v_fmamk_f32 v11, v6, 0x40400000, v7
v_cos_f32 v8, v8
v_cos_f32 v9, v9
v_cos_f32 v10, v10
v_cos_f32 v11, v11
s_nop 0
cvtpk v76, v8, v9
cvtpk v77, v10, v11
v_fmamk_f32 v8, v6, 0x41000000, v7
v_fmamk_f32 v9, v6, 0x41100000, v7
v_fmamk_f32 v10, v6, 0x41200000, v7
v_fmamk_f32 v11, v6, 0x41300000, v7
v_cos_f32 v8, v8
v_cos_f32 v9, v9
v_cos_f32 v10, v10
v_cos_f32 v11, v11
s_nop 0
cvtpk v78, v8, v9
cvtpk v79, v10, v11
v_fmamk_f32 v8, v6, 0x41800000, v7
v_fmamk_f32 v9, v6, 0x41880000, v7
v_fmamk_f32 v10, v6, 0x41900000, v7
v_fmamk_f32 v11, v6, 0x41980000, v7
v_cos_f32 v8, v8
v_cos_f32 v9, v9
v_cos_f32 v10, v10
v_cos_f32 v11, v11
s_nop 0
cvtpk v80, v8, v9
cvtpk v81, v10, v11
v_fmamk_f32 v8, v6, 0x41c00000, v7
v_fmamk_f32 v9, v6, 0x41c80000, v7
v_fmamk_f32 v10, v6, 0x41d00000, v7
v_fmamk_f32 v11, v6, 0x41d80000, v7
v_cos_f32 v8, v8
v_cos_f32 v9, v9
v_cos_f32 v10, v10
v_cos_f32 v11, v11
s_nop 0
cvtpk v82, v8, v9
cvtpk v83, v10, v11
v_and_b32 v12, 15, v0
v_cvt_f32_u32 v12, v12
v_mul_f32 v6, 0x3d800000, v12
v_mul_f32 v7, 0x3e800000, v5
v_and_b32 v13, 16, v0
v_cmp_eq_u32 vcc, 0, v13
v_mov_b32 v14, 0
v_fmamk_f32 v8, v6, 0x00000000, v7
v_fmamk_f32 v9, v6, 0x3f800000, v7
v_fmamk_f32 v10, v6, 0x40000000, v7
v_fmamk_f32 v11, v6, 0x40400000, v7
v_cos_f32 v8, v8
v_cos_f32 v9, v9
v_cos_f32 v10, v10
v_cos_f32 v11, v11
s_nop 0
cvtpk v32, v8, v9
cvtpk v33, v10, v11
v_fmamk_f32 v8, v6, 0x40800000, v7
v_fmamk_f32 v9, v6, 0x40a00000, v7
v_fmamk_f32 v10, v6, 0x40c00000, v7
v_fmamk_f32 v11, v6, 0x40e00000, v7
v_cos_f32 v8, v8
v_cos_f32 v9, v9
v_cos_f32 v10, v10
v_cos_f32 v11, v11
s_nop 0
cvtpk v34, v8, v9
cvtpk v35, v10, v11
v_cndmask_b32 v84, v14, v32, vcc
v_cndmask_b32 v88, v32, v14, vcc
v_cndmask_b32 v85, v14, v33, vcc
v_cndmask_b32 v89, v33, v14, vcc
v_cndmask_b32 v86, v14, v34, vcc
v_cndmask_b32 v90, v34, v14, vcc
v_cndmask_b32 v87, v14, v35, vcc
v_cndmask_b32 v91, v35, v14, vcc
v_add_f32 v7, 0xbe800000, v7
v_fmamk_f32 v8, v6, 0x00000000, v7
v_fmamk_f32 v9, v6, 0x3f800000, v7
v_fmamk_f32 v10, v6, 0x40000000, v7
v_fmamk_f32 v11, v6, 0x40400000, v7
v_cos_f32 v8, v8
v_cos_f32 v9, v9
v_cos_f32 v10, v10
v_cos_f32 v11, v11
s_nop 0
cvtpk v32, v8, v9
cvtpk v33, v10, v11
v_fmamk_f32 v8, v6, 0x40800000, v7
v_fmamk_f32 v9, v6, 0x40a00000, v7
v_fmamk_f32 v10, v6, 0x40c00000, v7
v_fmamk_f32 v11, v6, 0x40e00000, v7
v_cos_f32 v8, v8
v_cos_f32 v9, v9
v_cos_f32 v10, v10
v_cos_f32 v11, v11
s_nop 0
cvtpk v34, v8, v9
cvtpk v35, v10, v11
v_cndmask_b32 v92, v14, v32, vcc
v_cndmask_b32 v96, v32, v14, vcc
v_cndmask_b32 v93, v14, v33, vcc
v_cndmask_b32 v97, v33, v14, vcc
v_cndmask_b32 v94, v14, v34, vcc
v_cndmask_b32 v98, v34, v14, vcc
v_cndmask_b32 v95, v14, v35, vcc
v_cndmask_b32 v99, v35, v14, vcc
v_mul_f32 v6, 0x3b000000, v12
v_mul_f32 v7, v6, v5
v_mul_f32 v7, 4.0, v7
v_fmamk_f32 v8, v6, 0x00000000, v7
v_cos_f32 v192, v8
v_sin_f32 v208, v8
v_fmamk_f32 v9, v6, 0x3f800000, v7
v_cos_f32 v193, v9
v_sin_f32 v209, v9
v_fmamk_f32 v8, v6, 0x40000000, v7
v_cos_f32 v194, v8
v_sin_f32 v210, v8
v_fmamk_f32 v9, v6, 0x40400000, v7
v_cos_f32 v195, v9
v_sin_f32 v211, v9
v_fmamk_f32 v8, v6, 0x41000000, v7
v_cos_f32 v196, v8
v_sin_f32 v212, v8
v_fmamk_f32 v9, v6, 0x41100000, v7
v_cos_f32 v197, v9
v_sin_f32 v213, v9
v_fmamk_f32 v8, v6, 0x41200000, v7
v_cos_f32 v198, v8
v_sin_f32 v214, v8
v_fmamk_f32 v9, v6, 0x41300000, v7
v_cos_f32 v199, v9
v_sin_f32 v215, v9
v_fmamk_f32 v8, v6, 0x41800000, v7
v_cos_f32 v200, v8
v_sin_f32 v216, v8
v_fmamk_f32 v9, v6, 0x41880000, v7
v_cos_f32 v201, v9
v_sin_f32 v217, v9
v_fmamk_f32 v8, v6, 0x41900000, v7
v_cos_f32 v202, v8
v_sin_f32 v218, v8
v_fmamk_f32 v9, v6, 0x41980000, v7
v_cos_f32 v203, v9
v_sin_f32 v219, v9
v_fmamk_f32 v8, v6, 0x41c00000, v7
v_cos_f32 v204, v8
v_sin_f32 v220, v8
v_fmamk_f32 v9, v6, 0x41c80000, v7
v_cos_f32 v205, v9
v_sin_f32 v221, v9
v_fmamk_f32 v8, v6, 0x41d00000, v7
v_cos_f32 v206, v8
v_sin_f32 v222, v8
v_fmamk_f32 v9, v6, 0x41d80000, v7
v_cos_f32 v207, v9
v_sin_f32 v223, v9
v_and_b32 v13, 31, v2
v_lshlrev_b32 v13, 4, v13
v_lshrrev_b32 v15, 5, v2
v_lshl_add_u32 v13, v15, 1, v13
v_add_u32 v13, 65536, v13
v_cmp_eq_u32 vcc, 0, v2
v_mov_b32 v15, 73728
s_waitcnt vmcnt(0)
v_cndmask_b32 v20, v20, v14, vcc
v_cndmask_b32 v21, v21, v14, vcc
v_cndmask_b32 v22, v22, v14, vcc
v_cndmask_b32 v23, v23, v14, vcc
ds_write_b16 v13, v16 offset:0
ds_write_b16_d16_hi v13, v16 offset:1024
ds_write_b16 v13, v17 offset:2048
ds_write_b16_d16_hi v13, v17 offset:3072
ds_write_b16 v13, v18 offset:4096
ds_write_b16_d16_hi v13, v18 offset:5120
ds_write_b16 v13, v19 offset:6144
ds_write_b16_d16_hi v13, v19 offset:7168
ds_write_b16 v13, v20 offset:512
ds_write_b16_d16_hi v13, v20 offset:1536
ds_write_b16 v13, v21 offset:2560
ds_write_b16_d16_hi v13, v21 offset:3584
ds_write_b16 v13, v22 offset:4608
ds_write_b16_d16_hi v13, v22 offset:5632
ds_write_b16 v13, v23 offset:6656
ds_write_b16_d16_hi v13, v23 offset:7680
s_and_saveexec_b64 s[36:37], vcc
ds_write_b128 v15, v[24:27]
s_mov_b64 exec, s[36:37]
s_lshl_b32 s25, s16, 11
s_add_u32 s25, s25, 65536
v_lshlrev_b32 v13, 4, v0
v_add_u32 v13, s25, v13
v_bfe_u32 v15, v0, 4, 1
s_lshl_b32 s25, s16, 2
s_add_u32 s25, s25, 73728
v_lshl_add_u32 v15, v15, 1, s25
v_mov_b32 v137, 0
v_mov_b32 v138, 0
v_mov_b32 v139, 0
v_mov_b32 v140, 0
v_mov_b32 v141, 0
v_mov_b32 v142, 0
v_mov_b32 v143, 0
v_mov_b32 v144, 0
v_mov_b32 v145, 0
v_mov_b32 v146, 0
v_mov_b32 v147, 0
v_mov_b32 v148, 0
v_mov_b32 v149, 0
v_mov_b32 v150, 0
v_mov_b32 v151, 0
s_waitcnt lgkmcnt(0)
v_mov_b32 v30, 81920
v_mov_b32 v31, 1
s_mov_b64 exec, 1
ds_add_u32 v30, v31
s_mov_b64 exec, -1
l3_kernel_meet:
ds_read_b32 v31, v30
s_waitcnt lgkmcnt(0)
v_readfirstlane_b32 s44, v31
s_nop 0
s_cmp_lt_u32 s44, 4
s_cbranch_scc1 l3_kernel_meet
ds_read_u16 v136, v15
ds_read_b128 v[128:131], v13
ds_read_b128 v[132:135], v13 offset:1024
v_and_b32 v15, 1, v0
v_lshlrev_b32 v15, 31, v15
v_cmp_gt_u32 vcc, 32, v0
v_mul_f32 v6, 0x3b000000, v12
v_mul_f32 v7, v6, v5
v_mul_f32 v7, 4.0, v7
s_waitcnt lgkmcnt(2)
v_lshlrev_b32 v136, 16, v136
v_xor_b32 v136, v136, v15
v_cndmask_b32 v136, v14, v136, vcc
s_waitcnt lgkmcnt(0)
s_nop 0
mf32 v[136:151], v[128:131], v[84:87], v[136:151]
mf32 v[136:151], v[132:135], v[88:91], v[136:151]
mf32 v[152:167], v[128:131], v[92:95], 0
mf32 v[152:167], v[132:135], v[96:99], v[152:167]
s_lshr_b32 s25, s21, 1
s_lshl_b32 s25, s25, 4
s_and_b32 s26, s21, 1
s_lshl_b32 s26, s26, 2
s_add_u32 s25, s25, s26
s_lshr_b32 s26, s16, 1
s_lshl_b32 s26, s26, 3
s_add_u32 s25, s25, s26
s_and_b32 s26, s16, 1
s_lshl_b32 s26, s26, 1
s_add_u32 s25, s25, s26
s_lshl_b32 s25, s25, 6
s_add_u32 s25, s25, s20
s_lshl_b32 s25, s25, 11
s_add_u32 s26, s25, 131072
v_mul_f32 v8, v136, v208
v_mul_f32 v136, v136, v192
v_fma_f32 v136, -v152, v208, v136
v_fma_f32 v152, v152, v192, v8
v_mul_f32 v8, v137, v209
v_mul_f32 v137, v137, v193
v_fma_f32 v137, -v153, v209, v137
v_fma_f32 v153, v153, v193, v8
v_mul_f32 v8, v138, v210
v_mul_f32 v138, v138, v194
v_fma_f32 v138, -v154, v210, v138
v_fma_f32 v154, v154, v194, v8
v_mul_f32 v8, v139, v211
v_mul_f32 v139, v139, v195
v_fma_f32 v139, -v155, v211, v139
v_fma_f32 v155, v155, v195, v8
v_mul_f32 v8, v140, v212
v_mul_f32 v140, v140, v196
v_fma_f32 v140, -v156, v212, v140
v_fma_f32 v156, v156, v196, v8
v_mul_f32 v8, v141, v213
v_mul_f32 v141, v141, v197
v_fma_f32 v141, -v157, v213, v141
v_fma_f32 v157, v157, v197, v8
v_mul_f32 v8, v142, v214
v_mul_f32 v142, v142, v198
v_fma_f32 v142, -v158, v214, v142
v_fma_f32 v158, v158, v198, v8
v_mul_f32 v8, v143, v215
v_mul_f32 v143, v143, v199
v_fma_f32 v143, -v159, v215, v143
v_fma_f32 v159, v159, v199, v8
v_mul_f32 v8, v144, v216
v_mul_f32 v144, v144, v200
v_fma_f32 v144, -v160, v216, v144
v_fma_f32 v160, v160, v200, v8
v_mul_f32 v8, v145, v217
v_mul_f32 v145, v145, v201
v_fma_f32 v145, -v161, v217, v145
v_fma_f32 v161, v161, v201, v8
v_mul_f32 v8, v146, v218
v_mul_f32 v146, v146, v202
v_fma_f32 v146, -v162, v218, v146
v_fma_f32 v162, v162, v202, v8
v_mul_f32 v8, v147, v219
v_mul_f32 v147, v147, v203
v_fma_f32 v147, -v163, v219, v147
v_fma_f32 v163, v163, v203, v8
v_mul_f32 v8, v148, v220
v_mul_f32 v148, v148, v204
v_fma_f32 v148, -v164, v220, v148
v_fma_f32 v164, v164, v204, v8
v_mul_f32 v8, v149, v221
v_mul_f32 v149, v149, v205
v_fma_f32 v149, -v165, v221, v149
v_fma_f32 v165, v165, v205, v8
v_mul_f32 v8, v150, v222
v_mul_f32 v150, v150, v206
v_fma_f32 v150, -v166, v222, v150
v_fma_f32 v166, v166, v206, v8
v_mul_f32 v8, v151, v223
v_mul_f32 v151, v151, v207
v_fma_f32 v151, -v167, v223, v151
v_fma_f32 v167, v167, v207, v8
cvtpk v168, v136, v137
cvtpk v169, v138, v139
cvtpk v170, v140, v141
cvtpk v171, v142, v143
cvtpk v172, v144, v145
cvtpk v173, v146, v147
cvtpk v174, v148, v149
cvtpk v175, v150, v151
cvtpk v176, v152, v153
cvtpk v177, v154, v155
cvtpk v178, v156, v157
cvtpk v179, v158, v159
cvtpk v180, v160, v161
cvtpk v181, v162, v163
cvtpk v182, v164, v165
cvtpk v183, v166, v167
v_and_b32 v13, 31, v0
v_lshlrev_b32 v13, 5, v13
mf32 v[136:151], v[168:171], v[68:71], 0
mf32 v[136:151], v[172:175], v[72:75], v[136:151]
mf32 v[136:151], v[176:179], v[76:79], v[136:151]
mf32 v[136:151], v[180:183], v[80:83], v[136:151]
v_lshrrev_b32 v15, 5, v0
v_lshl_add_u32 v13, v15, 4, v13
s_nop 9
cvtpk v16, v136, v137
cvtpk v17, v138, v139
cvtpk v18, v140, v141
cvtpk v19, v142, v143
cvtpk v20, v144, v145
cvtpk v21, v146, v147
cvtpk v22, v148, v149
cvtpk v23, v150, v151
s_nop 1
v_permlane32_swap_b32 v16, v18
v_permlane32_swap_b32 v17, v19
buffer_store_dwordx4 v[16:19], v13, s[32:35], s25 offen offset:1024 nt
v_permlane32_swap_b32 v20, v22
v_permlane32_swap_b32 v21, v23
buffer_store_dwordx4 v[20:23], v13, s[32:35], s26 offen offset:1024 nt
s_endpgm
l3_kernel_fin:
v_and_b32 v3, 31, v0
v_lshlrev_b32 v3, 11, v3
v_lshrrev_b32 v4, 5, v0
v_lshl_add_u32 v3, v4, 4, v3
s_lshl2_add_u32 s65, s41, s40
s_lshl_b32 s65, s65, 16
s_lshl_b32 s66, s42, 8
s_add_u32 s65, s65, s66
s_lshl_b32 s66, s16, 6
s_add_u32 s65, s65, s66
s_mov_b32 s52, s8
s_mov_b32 s53, s9
s_mov_b32 s54, 0x400000
s_mov_b32 s55, 0x20000
l3_kernel_pw:
ds_read_b32 v31, v30
s_waitcnt lgkmcnt(0)
v_readfirstlane_b32 s44, v31
s_nop 0
s_cmp_lg_u32 s44, 1
s_cbranch_scc1 l3_kernel_pw
ds_read_b128 v[128:131], v127 offset:49152
ds_read_b128 v[132:135], v127 offset:50176
ds_read_b128 v[136:139], v127 offset:51200
ds_read_b128 v[140:143], v127 offset:52224
s_mov_b32 s44, 0
s_waitcnt lgkmcnt(0)
s_branch l3_kernel_chk
l3_kernel_again:
buffer_load_dwordx4 v[144:147], v124, s[56:59], s61 offen offset:0 sc1
buffer_load_dwordx4 v[148:151], v124, s[56:59], s61 offen offset:1024 sc1
buffer_load_dwordx4 v[160:163], v124, s[56:59], s62 offen offset:0 sc1
buffer_load_dwordx4 v[164:167], v124, s[56:59], s62 offen offset:1024 sc1
buffer_load_dwordx4 v[176:179], v124, s[56:59], s63 offen offset:0 sc1
buffer_load_dwordx4 v[180:183], v124, s[56:59], s63 offen offset:1024 sc1
l3_kernel_chk:
s_waitcnt vmcnt(0)
v_max3_u32 v4, v144, v145, v146
v_max3_u32 v4, v4, v147, v148
v_max3_u32 v4, v4, v149, v150
v_max3_u32 v4, v4, v151, v160
v_max3_u32 v4, v4, v161, v162
v_max3_u32 v4, v4, v163, v164
v_max3_u32 v4, v4, v165, v166
v_max3_u32 v4, v4, v167, v176
v_max3_u32 v4, v4, v177, v178
v_max3_u32 v4, v4, v179, v180
v_max3_u32 v4, v4, v181, v182
v_max_u32 v4, v4, v183
v_cmp_eq_u32 vcc, -1, v4
s_add_u32 s44, s44, 1
s_cbranch_vccz l3_kernel_got
s_cmp_lt_u32 s44, 0x10000
s_cbranch_scc1 l3_kernel_again
l3_kernel_got:
v_add_f32 v48, v48, v128
v_add_f32 v49, v49, v129
v_add_f32 v50, v50, v130
v_add_f32 v51, v51, v131
v_add_f32 v52, v52, v132
v_add_f32 v53, v53, v133
v_add_f32 v54, v54, v134
v_add_f32 v55, v55, v135
v_add_f32 v56, v56, v136
v_add_f32 v57, v57, v137
v_add_f32 v58, v58, v138
v_add_f32 v59, v59, v139
v_add_f32 v60, v60, v140
v_add_f32 v61, v61, v141
v_add_f32 v62, v62, v142
v_add_f32 v63, v63, v143
v_lshlrev_b32 v64, 16, v144
v_add_f32 v48, v48, v64
v_and_b32 v64, 0xffff0000, v144
v_add_f32 v49, v49, v64
v_lshlrev_b32 v64, 16, v145
v_add_f32 v50, v50, v64
v_and_b32 v64, 0xffff0000, v145
v_add_f32 v51, v51, v64
v_lshlrev_b32 v64, 16, v146
v_add_f32 v52, v52, v64
v_and_b32 v64, 0xffff0000, v146
v_add_f32 v53, v53, v64
v_lshlrev_b32 v64, 16, v147
v_add_f32 v54, v54, v64
v_and_b32 v64, 0xffff0000, v147
v_add_f32 v55, v55, v64
v_lshlrev_b32 v64, 16, v148
v_add_f32 v56, v56, v64
v_and_b32 v64, 0xffff0000, v148
v_add_f32 v57, v57, v64
v_lshlrev_b32 v64, 16, v149
v_add_f32 v58, v58, v64
v_and_b32 v64, 0xffff0000, v149
v_add_f32 v59, v59, v64
v_lshlrev_b32 v64, 16, v150
v_add_f32 v60, v60, v64
v_and_b32 v64, 0xffff0000, v150
v_add_f32 v61, v61, v64
v_lshlrev_b32 v64, 16, v151
v_add_f32 v62, v62, v64
v_and_b32 v64, 0xffff0000, v151
v_add_f32 v63, v63, v64
v_lshlrev_b32 v64, 16, v160
v_add_f32 v48, v48, v64
v_and_b32 v64, 0xffff0000, v160
v_add_f32 v49, v49, v64
v_lshlrev_b32 v64, 16, v161
v_add_f32 v50, v50, v64
v_and_b32 v64, 0xffff0000, v161
v_add_f32 v51, v51, v64
v_lshlrev_b32 v64, 16, v162
v_add_f32 v52, v52, v64
v_and_b32 v64, 0xffff0000, v162
v_add_f32 v53, v53, v64
v_lshlrev_b32 v64, 16, v163
v_add_f32 v54, v54, v64
v_and_b32 v64, 0xffff0000, v163
v_add_f32 v55, v55, v64
v_lshlrev_b32 v64, 16, v164
v_add_f32 v56, v56, v64
v_and_b32 v64, 0xffff0000, v164
v_add_f32 v57, v57, v64
v_lshlrev_b32 v64, 16, v165
v_add_f32 v58, v58, v64
v_and_b32 v64, 0xffff0000, v165
v_add_f32 v59, v59, v64
v_lshlrev_b32 v64, 16, v166
v_add_f32 v60, v60, v64
v_and_b32 v64, 0xffff0000, v166
v_add_f32 v61, v61, v64
v_lshlrev_b32 v64, 16, v167
v_add_f32 v62, v62, v64
v_and_b32 v64, 0xffff0000, v167
v_add_f32 v63, v63, v64
v_lshlrev_b32 v64, 16, v176
v_add_f32 v48, v48, v64
v_and_b32 v64, 0xffff0000, v176
v_add_f32 v49, v49, v64
v_lshlrev_b32 v64, 16, v177
v_add_f32 v50, v50, v64
v_and_b32 v64, 0xffff0000, v177
v_add_f32 v51, v51, v64
v_lshlrev_b32 v64, 16, v178
v_add_f32 v52, v52, v64
v_and_b32 v64, 0xffff0000, v178
v_add_f32 v53, v53, v64
v_lshlrev_b32 v64, 16, v179
v_add_f32 v54, v54, v64
v_and_b32 v64, 0xffff0000, v179
v_add_f32 v55, v55, v64
v_lshlrev_b32 v64, 16, v180
v_add_f32 v56, v56, v64
v_and_b32 v64, 0xffff0000, v180
v_add_f32 v57, v57, v64
v_lshlrev_b32 v64, 16, v181
v_add_f32 v58, v58, v64
v_and_b32 v64, 0xffff0000, v181
v_add_f32 v59, v59, v64
v_lshlrev_b32 v64, 16, v182
v_add_f32 v60, v60, v64
v_and_b32 v64, 0xffff0000, v182
v_add_f32 v61, v61, v64
v_lshlrev_b32 v64, 16, v183
v_add_f32 v62, v62, v64
v_and_b32 v64, 0xffff0000, v183
v_add_f32 v63, v63, v64
cvtpk v8, v48, v49
cvtpk v9, v50, v51
cvtpk v10, v52, v53
cvtpk v11, v54, v55
cvtpk v12, v56, v57
cvtpk v13, v58, v59
cvtpk v14, v60, v61
cvtpk v15, v62, v63
s_nop 1
v_permlane32_swap_b32 v8, v10
v_permlane32_swap_b32 v9, v11
buffer_store_dwordx4 v[8:11], v3, s[52:55], s65 offen offset:0 nt
v_permlane32_swap_b32 v12, v14
v_permlane32_swap_b32 v13, v15
buffer_store_dwordx4 v[12:15], v3, s[52:55], s65 offen offset:32 nt
l3_kernel_end:
s_endpgm
.section .rodata,"a"
.p2align 6
kdl_l1_kernel:
.amdhsa_kernel l1_kernel
  .amdhsa_next_free_vgpr 256
  .amdhsa_next_free_sgpr 96
  .amdhsa_accum_offset 256
  .amdhsa_group_segment_fixed_size 0
  .amdhsa_kernarg_size 96
  .amdhsa_user_sgpr_count 2
  .amdhsa_user_sgpr_kernarg_segment_ptr 1
  .amdhsa_system_sgpr_workgroup_id_x 1
  .amdhsa_float_denorm_mode_32 3
.end_amdhsa_kernel
.section .rodata,"a"
.p2align 6
kdl_attn_kernel:
.amdhsa_kernel attn_kernel
  .amdhsa_next_free_vgpr 256
  .amdhsa_next_free_sgpr 68
  .amdhsa_accum_offset 256
  .amdhsa_group_segment_fixed_size 0
  .amdhsa_kernarg_size 96
  .amdhsa_user_sgpr_count 2
  .amdhsa_user_sgpr_kernarg_segment_ptr 1
  .amdhsa_system_sgpr_workgroup_id_x 1
  .amdhsa_float_denorm_mode_32 3
.end_amdhsa_kernel
.section .rodata,"a"
.p2align 6
kdl_l3_kernel:
.amdhsa_kernel l3_kernel
  .amdhsa_next_free_vgpr 256
  .amdhsa_next_free_sgpr 67
  .amdhsa_accum_offset 256
  .amdhsa_group_segment_fixed_size 0
  .amdhsa_kernarg_size 96
  .amdhsa_user_sgpr_count 2
  .amdhsa_user_sgpr_kernarg_segment_ptr 1
  .amdhsa_system_sgpr_workgroup_id_x 1
  .amdhsa_float_denorm_mode_32 3
.end_amdhsa_kernel
```
